```python
import torch

def _softmax(x, axis=-1):
    return torch.softmax(x, dim=axis)
def _gelu(x):
    return torch.nn.functional.gelu(x, approximate="tanh")
def _silu(x):
    return torch.nn.functional.silu(x)
def _sigmoid(x):
    return torch.sigmoid(x)
def _layernorm(x, axis=-1, eps=1e-5):
    m = x.mean(dim=axis, keepdim=True)
    v = x.var(dim=axis, keepdim=True, unbiased=False)
    return (x - m) / torch.sqrt(v + eps)
def _scatter_add(tgt, idx, src, axis=0):
    return tgt.clone().index_add_(axis, idx, src)
def _segment_sum(src, seg, n):
    out = torch.zeros((n,) + src.shape[1:], dtype=src.dtype)
    return out.index_add_(0, seg, src)
def _pad(x, pw):
    flat = tuple(v for pair in reversed(pw) for v in pair)
    return torch.nn.functional.pad(x, flat)

kernel_name = 'interleave_layers__spectral_gfnet__grouped_kv_mqa__prompt'

def setup_inputs():

    _w = (lambda a: (lambda t: t.to(torch.bfloat16) if t.is_floating_point() else t)(torch.as_tensor(a)))
    def _A_setup():
        B, S, D = 1, 2048, 576
        Df = D // 2 + 1
        return {
            "x": _w((lambda *s: torch.randn(*s, dtype=torch.bfloat16) * 0.05)(B, S, D)),
            "w_r": _w((lambda *s: torch.randn(*s, dtype=torch.bfloat16) * 1.6)(S, Df) * 0.02),
            "w_i": _w((lambda *s: torch.randn(*s, dtype=torch.bfloat16) * 1.6)(S, Df) * 0.02),
        }
    _A_in = _A_setup()

    def _B_setup():
        B, S, D, H = 1, 2048, 576, 32
        Dh = D // H
        return {
            "x": _w((lambda *s: torch.randn(*s, dtype=torch.bfloat16) * 0.05)(B, S, D)),
            "wq": _w((lambda *s: torch.randn(*s, dtype=torch.bfloat16) * 0.05)(D, H * Dh)),
            "wk": _w((lambda *s: torch.randn(*s, dtype=torch.bfloat16) * 0.05)(D, Dh)),
            "wv": _w((lambda *s: torch.randn(*s, dtype=torch.bfloat16) * 0.05)(D, Dh)),
            "wo": _w((lambda *s: torch.randn(*s, dtype=torch.bfloat16) * 0.05)(H * Dh, D)),
        }
    _B_in = _B_setup()

    return {
        "A_x": _A_in["x"],
        "A_w_r": _A_in["w_r"],
        "A_w_i": _A_in["w_i"],
        "B_x": _B_in["x"],
        "B_wq": _B_in["wq"],
        "B_wk": _B_in["wk"],
        "B_wv": _B_in["wv"],
        "B_wo": _B_in["wo"],
    }

def reference(A_x, A_w_r, A_w_i, B_x, B_wq, B_wk, B_wv, B_wo):
    def _A_ref(x, w_r, w_i):
        B, S, D = x.shape
        X = (lambda x, axes=(-2,-1): torch.fft.rfft2(x.float(), dim=axes))(x, axes=(-2, -1))
        W = w_r + 1j * w_i
        X = X * W
        y = (lambda x, s, axes=(-2,-1): torch.fft.irfft2(x, s=s, dim=axes).to(torch.bfloat16))(X, (S, D), axes=(-2, -1))
        return y

    def _B_ref(x, wq, wk, wv, wo):
        B, S, D = x.shape
        H = 32
        Dh = D // H
        q = (lambda x, *d: x.permute(*d))((x @ wq).reshape(B, S, H, Dh), 0, 2, 1, 3)
        k = x @ wk
        v = x @ wv
        scores = torch.einsum("bhqd,bkd->bhqk", q, k) * (Dh ** -0.5)
        p = _softmax(scores, axis=-1)
        o = torch.einsum("bhqk,bkd->bhqd", p, v)
        return (lambda x, *d: x.permute(*d))(o, 0, 2, 1, 3).reshape(B, S, H * Dh) @ wo

    x = A_x
    x = x + _A_ref(_layernorm(x, axis=-1), A_w_r, A_w_i)
    x = x + _B_ref(_layernorm(x, axis=-1), B_wq, B_wk, B_wv, B_wo)
    x = x + _A_ref(_layernorm(x, axis=-1), A_w_r, A_w_i)
    x = x + _B_ref(_layernorm(x, axis=-1), B_wq, B_wk, B_wv, B_wo)
    return x
```

```asm
; @launch kernel=k1_kernel grid=(256,1,1) block=(512,1,1) lds=110592
; @launch kernel=k2a_kernel grid=(249,1,1) block=(512,1,1) lds=73728
; @launch kernel=kfa_kernel grid=(256,1,1) block=(512,1,1) lds=163840
; @launch kernel=k2b_kernel grid=(252,1,1) block=(512,1,1) lds=40960
; @launch kernel=kfb_kernel grid=(256,1,1) block=(512,1,1) lds=163840
.amdgcn_target "amdgcn-amd-amdhsa--gfx950"
.text
.p2align 8
.type k1_kernel,@function
k1_kernel:
  s_cmp_ge_u32 s2, 256
  s_cbranch_scc1 k1_kernel_end
    s_load_dwordx2 s[4:5], s[0:1], 80
    s_load_dwordx4 s[44:47], s[0:1], 0
    s_load_dwordx2 s[48:49], s[0:1], 16
    s_load_dwordx2 s[50:51], s[0:1], 32
    s_load_dwordx4 s[52:55], s[0:1], 40
    s_load_dwordx2 s[40:41], s[0:1], 56
    v_lshrrev_b32 v239, 6, v0
    v_and_b32 v238, 63, v0
    v_readfirstlane_b32 s20, v239
    s_and_b32 s21, s2, 7
    s_lshl_b32 s21, s21, 2
    s_lshr_b32 s23, s2, 3
    s_and_b32 s22, s23, 3
    s_add_u32 s21, s21, s22
    s_lshr_b32 s22, s2, 5
    s_lshr_b32 s32, s21, 3
    s_lshl_b32 s32, s32, 9
    s_and_b32 s33, s21, 1
    s_lshl_b32 s33, s33, 8
    s_add_u32 s32, s32, s33
    s_bfe_u32 s33, s21, 0x10001
    s_lshl_b32 s33, s33, 6
    s_add_u32 s32, s32, s33
    s_bfe_u32 s33, s21, 0x10002
    s_lshl_b32 s33, s33, 4
    s_add_u32 s32, s32, s33
    v_lshrrev_b32 v239, 3, v238
    s_lshl_b32 s24, s20, 3
    v_add_u32 v239, s24, v239
    v_lshrrev_b32 v240, 1, v239
    v_and_b32 v240, 7, v240
    v_and_b32 v241, 7, v238
    v_xor_b32 v240, v240, v241
    v_and_b32 v241, 31, v239
    v_lshrrev_b32 v239, 5, v239
    v_lshlrev_b32 v239, 7, v239
    v_and_b32 v242, 1, v241
    v_lshl_add_u32 v239, v242, 5, v239
    v_lshrrev_b32 v241, 1, v241
    v_add3_u32 v239, v239, v241, s32
    v_mul_u32_u24 v236, 1152, v239
    v_lshl_add_u32 v236, v240, 4, v236
    s_mov_b32 s24, 0
    s_lshl_b32 s25, s20, 10
    s_waitcnt lgkmcnt(0)
    s_mov_b32 s12, s44
    s_mov_b32 s13, s45
    s_mov_b32 s14, 2359296
    s_mov_b32 s15, 0x20000
  s_cmp_ge_u32 s20, 3
  s_cbranch_scc1 k1_kernel_side
        s_mov_b32 m0, s25
        s_add_u32 s25, s25, 8192
        buffer_load_dwordx4 v236, s[12:15], s24 offen lds
        s_add_u32 s24, s24, 128
  s_barrier
        s_mov_b32 m0, s25
        s_add_u32 s25, s25, 8192
        buffer_load_dwordx4 v236, s[12:15], s24 offen lds
        s_add_u32 s24, s24, 128
        s_mov_b32 m0, s25
        s_add_u32 s25, s25, 8192
        buffer_load_dwordx4 v236, s[12:15], s24 offen lds
        s_add_u32 s24, s24, 128
        s_mov_b32 m0, s25
        s_add_u32 s25, s25, 8192
        buffer_load_dwordx4 v236, s[12:15], s24 offen lds
        s_add_u32 s24, s24, 128
        s_mov_b32 m0, s25
        s_add_u32 s25, s25, 8192
        buffer_load_dwordx4 v236, s[12:15], s24 offen lds
        s_add_u32 s24, s24, 128
        s_mov_b32 m0, s25
        s_add_u32 s25, s25, 8192
        buffer_load_dwordx4 v236, s[12:15], s24 offen lds
        s_add_u32 s24, s24, 128
        s_mov_b32 m0, s25
        s_add_u32 s25, s25, 8192
        buffer_load_dwordx4 v236, s[12:15], s24 offen lds
        s_add_u32 s24, s24, 128
        s_mov_b32 m0, s25
        s_add_u32 s25, s25, 8192
        buffer_load_dwordx4 v236, s[12:15], s24 offen lds
        s_add_u32 s24, s24, 128
        s_mov_b32 m0, s25
        s_add_u32 s25, s25, 8192
        buffer_load_dwordx4 v236, s[12:15], s24 offen lds
        s_add_u32 s24, s24, 128
        s_mov_b32 s8, s4
        s_mov_b32 s9, s5
        s_mov_b32 s10, 0x10000000
        s_mov_b32 s11, 0x20000
        v_and_b32 v240, 31, v238
        v_lshrrev_b32 v241, 5, v238
        v_lshrrev_b32 v239, 1, v240
        v_and_b32 v239, 7, v239
        v_lshlrev_b32 v242, 7, v240
            v_add_u32 v208, 0, v241
            v_xor_b32 v208, v208, v239
            v_lshl_add_u32 v208, v208, 4, v242
            v_add_u32 v209, 2, v241
            v_xor_b32 v209, v209, v239
            v_lshl_add_u32 v209, v209, 4, v242
            v_add_u32 v210, 4, v241
            v_xor_b32 v210, v210, v239
            v_lshl_add_u32 v210, v210, 4, v242
            v_add_u32 v211, 6, v241
            v_xor_b32 v211, v211, v239
            v_lshl_add_u32 v211, v211, 4, v242
        v_and_b32 v240, 31, v238
        v_lshrrev_b32 v241, 5, v238
        v_mul_u32_u24 v243, 16512, v241
        v_lshl_add_u32 v243, v240, 3, v243
        s_mul_i32 s30, s22, 297216
        s_mul_i32 s31, s20, 132096
        s_add_u32 s30, s30, s31
        s_lshl_b32 s31, s21, 9
        s_add_u32 s30, s30, s31
        s_add_u32 s30, s30, 0
        s_lshl_b32 s34, s20, 12
        v_lshlrev_b32 v212, 4, v238
        v_add_u32 v212, s34, v212
        v_add_u32 v212, 73728, v212
            s_mul_i32 s34, s22, 72
            s_lshl_b32 s35, s20, 5
            s_add_u32 s34, s34, s35
            v_and_b32 v28, 31, v238
            v_add_u32 v28, s34, v28
            v_min_u32 v28, 575, v28
    v_lshrrev_b32 v36, 1, v28
    v_mov_b32 v37, 288
    v_cmp_eq_u32 vcc, 1, v28
  s_nop 1
    v_cndmask_b32 v36, v36, v37, vcc
    v_cvt_f32_u32 v32, v36
    v_mul_f32 v32, 0x3ae38e39, v32
    v_and_b32 v36, 1, v28
    v_cvt_f32_u32 v33, v36
    v_mul_f32 v33, 0x3e800000, v33
    v_mov_b32 v37, 0
    v_cndmask_b32 v33, v33, v37, vcc
    v_mov_b32 v34, 0x3d715bef
    v_mov_b32 v37, 0x3d2aaaab
    v_cmp_gt_u32 vcc, 2, v28
  s_nop 1
    v_cndmask_b32 v34, v34, v37, vcc
        v_lshrrev_b32 v35, 5, v238
        v_lshlrev_b32 v35, 3, v35
        v_cvt_f32_u32 v35, v35
        v_mul_f32 v36, 0x41800000, v32
        v_fract_f32 v36, v36
        v_cos_f32 v24, v36
        v_add_f32 v37, 0x41800000, v35
  v_fma_f32 v8, v35, v32, v33
  v_fma_f32 v16, v37, v32, v33
  v_add_f32 v35, 1.0, v35
  v_add_f32 v37, 1.0, v37
  v_fma_f32 v9, v35, v32, v33
  v_fma_f32 v17, v37, v32, v33
  v_add_f32 v35, 1.0, v35
  v_add_f32 v37, 1.0, v37
  v_fma_f32 v10, v35, v32, v33
  v_fma_f32 v18, v37, v32, v33
  v_add_f32 v35, 1.0, v35
  v_add_f32 v37, 1.0, v37
  v_fma_f32 v11, v35, v32, v33
  v_fma_f32 v19, v37, v32, v33
  v_add_f32 v35, 1.0, v35
  v_add_f32 v37, 1.0, v37
  v_fma_f32 v12, v35, v32, v33
  v_fma_f32 v20, v37, v32, v33
  v_add_f32 v35, 1.0, v35
  v_add_f32 v37, 1.0, v37
  v_fma_f32 v13, v35, v32, v33
  v_fma_f32 v21, v37, v32, v33
  v_add_f32 v35, 1.0, v35
  v_add_f32 v37, 1.0, v37
  v_fma_f32 v14, v35, v32, v33
  v_fma_f32 v22, v37, v32, v33
  v_add_f32 v35, 1.0, v35
  v_add_f32 v37, 1.0, v37
  v_fma_f32 v15, v35, v32, v33
  v_fma_f32 v23, v37, v32, v33
  v_add_f32 v24, v24, v24
  v_fract_f32 v8, v8
  v_fract_f32 v9, v9
  v_fract_f32 v10, v10
  v_fract_f32 v11, v11
  v_fract_f32 v12, v12
  v_fract_f32 v13, v13
  v_fract_f32 v14, v14
  v_fract_f32 v15, v15
  v_fract_f32 v16, v16
  v_fract_f32 v17, v17
  v_fract_f32 v18, v18
  v_fract_f32 v19, v19
  v_fract_f32 v20, v20
  v_fract_f32 v21, v21
  v_fract_f32 v22, v22
  v_fract_f32 v23, v23
  v_cos_f32 v8, v8
  v_cos_f32 v9, v9
  v_cos_f32 v10, v10
  v_cos_f32 v11, v11
  v_cos_f32 v12, v12
  v_cos_f32 v13, v13
  v_cos_f32 v14, v14
  v_cos_f32 v15, v15
  v_cos_f32 v16, v16
  v_cos_f32 v17, v17
  v_cos_f32 v18, v18
  v_cos_f32 v19, v19
  v_cos_f32 v20, v20
  v_cos_f32 v21, v21
  v_cos_f32 v22, v22
  v_cos_f32 v23, v23
  v_sub_f32 v25, 0, v24
  v_pk_mul_f32 v[8:9], v[8:9], v[34:35] op_sel_hi:[1,0]
  v_pk_mul_f32 v[10:11], v[10:11], v[34:35] op_sel_hi:[1,0]
  v_pk_mul_f32 v[12:13], v[12:13], v[34:35] op_sel_hi:[1,0]
  v_pk_mul_f32 v[14:15], v[14:15], v[34:35] op_sel_hi:[1,0]
  v_pk_mul_f32 v[16:17], v[16:17], v[34:35] op_sel_hi:[1,0]
  v_pk_mul_f32 v[18:19], v[18:19], v[34:35] op_sel_hi:[1,0]
  v_pk_mul_f32 v[20:21], v[20:21], v[34:35] op_sel_hi:[1,0]
  v_pk_mul_f32 v[22:23], v[22:23], v[34:35] op_sel_hi:[1,0]
  v_cvt_pk_bf16_f32 v200, v8, v9
  v_cvt_pk_bf16_f32 v201, v10, v11
  v_cvt_pk_bf16_f32 v202, v12, v13
  v_cvt_pk_bf16_f32 v203, v14, v15
  s_waitcnt vmcnt(8)
  s_barrier
  ds_read_b128 v[184:187], v208 offset:0
  ds_read_b128 v[188:191], v208 offset:4096
  ds_read_b128 v[192:195], v209 offset:0
  ds_read_b128 v[196:199], v209 offset:4096
  s_waitcnt lgkmcnt(2)
  v_mfma_f32_32x32x16_bf16 v[152:167], v[200:203], v[184:187], 0
  v_cvt_pk_bf16_f32 v204, v16, v17
  v_cvt_pk_bf16_f32 v205, v18, v19
  v_mfma_f32_32x32x16_bf16 v[168:183], v[200:203], v[188:191], 0
  v_cvt_pk_bf16_f32 v206, v20, v21
  v_cvt_pk_bf16_f32 v207, v22, v23
  ds_read_b128 v[184:187], v210 offset:0
  ds_read_b128 v[188:191], v210 offset:4096
  s_waitcnt lgkmcnt(2)
  v_mfma_f32_32x32x16_bf16 v[152:167], v[204:207], v[192:195], v[152:167]
  v_fmac_f32 v8, v25, v16
  v_fmac_f32 v9, v25, v17
  v_fmac_f32 v10, v25, v18
  v_fmac_f32 v11, v25, v19
  v_cvt_pk_bf16_f32 v200, -v8, -v9
  v_cvt_pk_bf16_f32 v201, -v10, -v11
  v_mfma_f32_32x32x16_bf16 v[168:183], v[204:207], v[196:199], v[168:183]
  v_fmac_f32 v12, v25, v20
  v_fmac_f32 v13, v25, v21
  v_fmac_f32 v14, v25, v22
  v_fmac_f32 v15, v25, v23
  v_cvt_pk_bf16_f32 v202, -v12, -v13
  v_cvt_pk_bf16_f32 v203, -v14, -v15
  ds_read_b128 v[192:195], v211 offset:0
  ds_read_b128 v[196:199], v211 offset:4096
  s_waitcnt lgkmcnt(2)
  v_mfma_f32_32x32x16_bf16 v[152:167], v[200:203], v[184:187], v[152:167]
  v_fmac_f32 v16, v24, v8
  v_fmac_f32 v17, v24, v9
  v_fmac_f32 v18, v24, v10
  v_fmac_f32 v19, v24, v11
  v_cvt_pk_bf16_f32 v204, -v16, -v17
  v_cvt_pk_bf16_f32 v205, -v18, -v19
  v_mfma_f32_32x32x16_bf16 v[168:183], v[200:203], v[188:191], v[168:183]
  v_fmac_f32 v20, v24, v12
  v_fmac_f32 v21, v24, v13
  v_fmac_f32 v22, v24, v14
  v_fmac_f32 v23, v24, v15
  v_cvt_pk_bf16_f32 v206, -v20, -v21
  v_cvt_pk_bf16_f32 v207, -v22, -v23
  s_waitcnt vmcnt(7)
  s_barrier
  ds_read_b128 v[184:187], v208 offset:8192
  ds_read_b128 v[188:191], v208 offset:12288
  s_waitcnt lgkmcnt(2)
  v_mfma_f32_32x32x16_bf16 v[152:167], v[204:207], v[192:195], v[152:167]
  v_fmac_f32 v8, v25, v16
  v_fmac_f32 v9, v25, v17
  v_fmac_f32 v10, v25, v18
  v_fmac_f32 v11, v25, v19
  v_cvt_pk_bf16_f32 v200, v8, v9
  v_cvt_pk_bf16_f32 v201, v10, v11
  v_mfma_f32_32x32x16_bf16 v[168:183], v[204:207], v[196:199], v[168:183]
  v_fmac_f32 v12, v25, v20
  v_fmac_f32 v13, v25, v21
  v_fmac_f32 v14, v25, v22
  v_fmac_f32 v15, v25, v23
  v_cvt_pk_bf16_f32 v202, v12, v13
  v_cvt_pk_bf16_f32 v203, v14, v15
  ds_read_b128 v[192:195], v209 offset:8192
  ds_read_b128 v[196:199], v209 offset:12288
  s_waitcnt lgkmcnt(2)
  v_mfma_f32_32x32x16_bf16 v[152:167], v[200:203], v[184:187], v[152:167]
  v_fmac_f32 v16, v24, v8
  v_fmac_f32 v17, v24, v9
  v_fmac_f32 v18, v24, v10
  v_fmac_f32 v19, v24, v11
  v_cvt_pk_bf16_f32 v204, v16, v17
  v_cvt_pk_bf16_f32 v205, v18, v19
  v_mfma_f32_32x32x16_bf16 v[168:183], v[200:203], v[188:191], v[168:183]
  v_fmac_f32 v20, v24, v12
  v_fmac_f32 v21, v24, v13
  v_fmac_f32 v22, v24, v14
  v_fmac_f32 v23, v24, v15
  v_cvt_pk_bf16_f32 v206, v20, v21
  v_cvt_pk_bf16_f32 v207, v22, v23
  ds_read_b128 v[184:187], v210 offset:8192
  ds_read_b128 v[188:191], v210 offset:12288
  s_waitcnt lgkmcnt(2)
  v_mfma_f32_32x32x16_bf16 v[152:167], v[204:207], v[192:195], v[152:167]
  v_fmac_f32 v8, v25, v16
  v_fmac_f32 v9, v25, v17
  v_fmac_f32 v10, v25, v18
  v_fmac_f32 v11, v25, v19
  v_cvt_pk_bf16_f32 v200, -v8, -v9
  v_cvt_pk_bf16_f32 v201, -v10, -v11
  v_mfma_f32_32x32x16_bf16 v[168:183], v[204:207], v[196:199], v[168:183]
  v_fmac_f32 v12, v25, v20
  v_fmac_f32 v13, v25, v21
  v_fmac_f32 v14, v25, v22
  v_fmac_f32 v15, v25, v23
  v_cvt_pk_bf16_f32 v202, -v12, -v13
  v_cvt_pk_bf16_f32 v203, -v14, -v15
  ds_read_b128 v[192:195], v211 offset:8192
  ds_read_b128 v[196:199], v211 offset:12288
  s_waitcnt lgkmcnt(2)
  v_mfma_f32_32x32x16_bf16 v[152:167], v[200:203], v[184:187], v[152:167]
  v_fmac_f32 v16, v24, v8
  v_fmac_f32 v17, v24, v9
  v_fmac_f32 v18, v24, v10
  v_fmac_f32 v19, v24, v11
  v_cvt_pk_bf16_f32 v204, -v16, -v17
  v_cvt_pk_bf16_f32 v205, -v18, -v19
  v_mfma_f32_32x32x16_bf16 v[168:183], v[200:203], v[188:191], v[168:183]
  v_fmac_f32 v20, v24, v12
  v_fmac_f32 v21, v24, v13
  v_fmac_f32 v22, v24, v14
  v_fmac_f32 v23, v24, v15
  v_cvt_pk_bf16_f32 v206, -v20, -v21
  v_cvt_pk_bf16_f32 v207, -v22, -v23
  s_waitcnt vmcnt(6)
  s_barrier
  ds_read_b128 v[184:187], v208 offset:16384
  ds_read_b128 v[188:191], v208 offset:20480
  s_waitcnt lgkmcnt(2)
  v_mfma_f32_32x32x16_bf16 v[152:167], v[204:207], v[192:195], v[152:167]
  v_fmac_f32 v8, v25, v16
  v_fmac_f32 v9, v25, v17
  v_fmac_f32 v10, v25, v18
  v_fmac_f32 v11, v25, v19
  v_cvt_pk_bf16_f32 v200, v8, v9
  v_cvt_pk_bf16_f32 v201, v10, v11
  v_mfma_f32_32x32x16_bf16 v[168:183], v[204:207], v[196:199], v[168:183]
  v_fmac_f32 v12, v25, v20
  v_fmac_f32 v13, v25, v21
  v_fmac_f32 v14, v25, v22
  v_fmac_f32 v15, v25, v23
  v_cvt_pk_bf16_f32 v202, v12, v13
  v_cvt_pk_bf16_f32 v203, v14, v15
  ds_read_b128 v[192:195], v209 offset:16384
  ds_read_b128 v[196:199], v209 offset:20480
  s_waitcnt lgkmcnt(2)
  v_mfma_f32_32x32x16_bf16 v[152:167], v[200:203], v[184:187], v[152:167]
  v_fmac_f32 v16, v24, v8
  v_fmac_f32 v17, v24, v9
  v_fmac_f32 v18, v24, v10
  v_fmac_f32 v19, v24, v11
  v_cvt_pk_bf16_f32 v204, v16, v17
  v_cvt_pk_bf16_f32 v205, v18, v19
  v_mfma_f32_32x32x16_bf16 v[168:183], v[200:203], v[188:191], v[168:183]
  v_fmac_f32 v20, v24, v12
  v_fmac_f32 v21, v24, v13
  v_fmac_f32 v22, v24, v14
  v_fmac_f32 v23, v24, v15
  v_cvt_pk_bf16_f32 v206, v20, v21
  v_cvt_pk_bf16_f32 v207, v22, v23
  ds_read_b128 v[184:187], v210 offset:16384
  ds_read_b128 v[188:191], v210 offset:20480
  s_waitcnt lgkmcnt(2)
  v_mfma_f32_32x32x16_bf16 v[152:167], v[204:207], v[192:195], v[152:167]
  v_fmac_f32 v8, v25, v16
  v_fmac_f32 v9, v25, v17
  v_fmac_f32 v10, v25, v18
  v_fmac_f32 v11, v25, v19
  v_cvt_pk_bf16_f32 v200, -v8, -v9
  v_cvt_pk_bf16_f32 v201, -v10, -v11
  v_mfma_f32_32x32x16_bf16 v[168:183], v[204:207], v[196:199], v[168:183]
  v_fmac_f32 v12, v25, v20
  v_fmac_f32 v13, v25, v21
  v_fmac_f32 v14, v25, v22
  v_fmac_f32 v15, v25, v23
  v_cvt_pk_bf16_f32 v202, -v12, -v13
  v_cvt_pk_bf16_f32 v203, -v14, -v15
  ds_read_b128 v[192:195], v211 offset:16384
  ds_read_b128 v[196:199], v211 offset:20480
  s_waitcnt lgkmcnt(2)
  v_mfma_f32_32x32x16_bf16 v[152:167], v[200:203], v[184:187], v[152:167]
  v_fmac_f32 v16, v24, v8
  v_fmac_f32 v17, v24, v9
  v_fmac_f32 v18, v24, v10
  v_fmac_f32 v19, v24, v11
  v_cvt_pk_bf16_f32 v204, -v16, -v17
  v_cvt_pk_bf16_f32 v205, -v18, -v19
  v_mfma_f32_32x32x16_bf16 v[168:183], v[200:203], v[188:191], v[168:183]
  v_fmac_f32 v20, v24, v12
  v_fmac_f32 v21, v24, v13
  v_fmac_f32 v22, v24, v14
  v_fmac_f32 v23, v24, v15
  v_cvt_pk_bf16_f32 v206, -v20, -v21
  v_cvt_pk_bf16_f32 v207, -v22, -v23
  s_waitcnt vmcnt(5)
  s_barrier
  ds_read_b128 v[184:187], v208 offset:24576
  ds_read_b128 v[188:191], v208 offset:28672
  s_waitcnt lgkmcnt(2)
  v_mfma_f32_32x32x16_bf16 v[152:167], v[204:207], v[192:195], v[152:167]
  v_fmac_f32 v8, v25, v16
  v_fmac_f32 v9, v25, v17
  v_fmac_f32 v10, v25, v18
  v_fmac_f32 v11, v25, v19
  v_cvt_pk_bf16_f32 v200, v8, v9
  v_cvt_pk_bf16_f32 v201, v10, v11
  v_mfma_f32_32x32x16_bf16 v[168:183], v[204:207], v[196:199], v[168:183]
  v_fmac_f32 v12, v25, v20
  v_fmac_f32 v13, v25, v21
  v_fmac_f32 v14, v25, v22
  v_fmac_f32 v15, v25, v23
  v_cvt_pk_bf16_f32 v202, v12, v13
  v_cvt_pk_bf16_f32 v203, v14, v15
  ds_read_b128 v[192:195], v209 offset:24576
  ds_read_b128 v[196:199], v209 offset:28672
  s_waitcnt lgkmcnt(2)
  v_mfma_f32_32x32x16_bf16 v[152:167], v[200:203], v[184:187], v[152:167]
  v_fmac_f32 v16, v24, v8
  v_fmac_f32 v17, v24, v9
  v_fmac_f32 v18, v24, v10
  v_fmac_f32 v19, v24, v11
  v_cvt_pk_bf16_f32 v204, v16, v17
  v_cvt_pk_bf16_f32 v205, v18, v19
  v_mfma_f32_32x32x16_bf16 v[168:183], v[200:203], v[188:191], v[168:183]
  v_fmac_f32 v20, v24, v12
  v_fmac_f32 v21, v24, v13
  v_fmac_f32 v22, v24, v14
  v_fmac_f32 v23, v24, v15
  v_cvt_pk_bf16_f32 v206, v20, v21
  v_cvt_pk_bf16_f32 v207, v22, v23
  ds_read_b128 v[184:187], v210 offset:24576
  ds_read_b128 v[188:191], v210 offset:28672
  s_waitcnt lgkmcnt(2)
  v_mfma_f32_32x32x16_bf16 v[152:167], v[204:207], v[192:195], v[152:167]
  v_fmac_f32 v8, v25, v16
  v_fmac_f32 v9, v25, v17
  v_fmac_f32 v10, v25, v18
  v_fmac_f32 v11, v25, v19
  v_cvt_pk_bf16_f32 v200, -v8, -v9
  v_cvt_pk_bf16_f32 v201, -v10, -v11
  v_mfma_f32_32x32x16_bf16 v[168:183], v[204:207], v[196:199], v[168:183]
  v_fmac_f32 v12, v25, v20
  v_fmac_f32 v13, v25, v21
  v_fmac_f32 v14, v25, v22
  v_fmac_f32 v15, v25, v23
  v_cvt_pk_bf16_f32 v202, -v12, -v13
  v_cvt_pk_bf16_f32 v203, -v14, -v15
  ds_read_b128 v[192:195], v211 offset:24576
  ds_read_b128 v[196:199], v211 offset:28672
  s_waitcnt lgkmcnt(2)
  v_mfma_f32_32x32x16_bf16 v[152:167], v[200:203], v[184:187], v[152:167]
  v_fmac_f32 v16, v24, v8
  v_fmac_f32 v17, v24, v9
  v_fmac_f32 v18, v24, v10
  v_fmac_f32 v19, v24, v11
  v_cvt_pk_bf16_f32 v204, -v16, -v17
  v_cvt_pk_bf16_f32 v205, -v18, -v19
  v_mfma_f32_32x32x16_bf16 v[168:183], v[200:203], v[188:191], v[168:183]
  v_fmac_f32 v20, v24, v12
  v_fmac_f32 v21, v24, v13
  v_fmac_f32 v22, v24, v14
  v_fmac_f32 v23, v24, v15
  v_cvt_pk_bf16_f32 v206, -v20, -v21
  v_cvt_pk_bf16_f32 v207, -v22, -v23
  s_waitcnt vmcnt(4)
  s_barrier
  v_add_u32 v208, 32768, v208
  v_add_u32 v209, 32768, v209
  v_add_u32 v210, 32768, v210
  v_add_u32 v211, 32768, v211
  ds_read_b128 v[184:187], v208 offset:0
  ds_read_b128 v[188:191], v208 offset:4096
  s_waitcnt lgkmcnt(2)
  v_mfma_f32_32x32x16_bf16 v[152:167], v[204:207], v[192:195], v[152:167]
  v_fmac_f32 v8, v25, v16
  v_fmac_f32 v9, v25, v17
  v_fmac_f32 v10, v25, v18
  v_fmac_f32 v11, v25, v19
  v_cvt_pk_bf16_f32 v200, v8, v9
  v_cvt_pk_bf16_f32 v201, v10, v11
  v_mfma_f32_32x32x16_bf16 v[168:183], v[204:207], v[196:199], v[168:183]
  v_fmac_f32 v12, v25, v20
  v_fmac_f32 v13, v25, v21
  v_fmac_f32 v14, v25, v22
  v_fmac_f32 v15, v25, v23
  v_cvt_pk_bf16_f32 v202, v12, v13
  v_cvt_pk_bf16_f32 v203, v14, v15
  ds_read_b128 v[192:195], v209 offset:0
  ds_read_b128 v[196:199], v209 offset:4096
  s_waitcnt lgkmcnt(2)
  v_mfma_f32_32x32x16_bf16 v[152:167], v[200:203], v[184:187], v[152:167]
  v_fmac_f32 v16, v24, v8
  v_fmac_f32 v17, v24, v9
  v_fmac_f32 v18, v24, v10
  v_fmac_f32 v19, v24, v11
  v_cvt_pk_bf16_f32 v204, v16, v17
  v_cvt_pk_bf16_f32 v205, v18, v19
  v_mfma_f32_32x32x16_bf16 v[168:183], v[200:203], v[188:191], v[168:183]
  v_fmac_f32 v20, v24, v12
  v_fmac_f32 v21, v24, v13
  v_fmac_f32 v22, v24, v14
  v_fmac_f32 v23, v24, v15
  v_cvt_pk_bf16_f32 v206, v20, v21
  v_cvt_pk_bf16_f32 v207, v22, v23
  ds_read_b128 v[184:187], v210 offset:0
  ds_read_b128 v[188:191], v210 offset:4096
  s_waitcnt lgkmcnt(2)
  v_mfma_f32_32x32x16_bf16 v[152:167], v[204:207], v[192:195], v[152:167]
  v_fmac_f32 v8, v25, v16
  v_fmac_f32 v9, v25, v17
  v_fmac_f32 v10, v25, v18
  v_fmac_f32 v11, v25, v19
  v_cvt_pk_bf16_f32 v200, -v8, -v9
  v_cvt_pk_bf16_f32 v201, -v10, -v11
  v_mfma_f32_32x32x16_bf16 v[168:183], v[204:207], v[196:199], v[168:183]
  v_fmac_f32 v12, v25, v20
  v_fmac_f32 v13, v25, v21
  v_fmac_f32 v14, v25, v22
  v_fmac_f32 v15, v25, v23
  v_cvt_pk_bf16_f32 v202, -v12, -v13
  v_cvt_pk_bf16_f32 v203, -v14, -v15
  ds_read_b128 v[192:195], v211 offset:0
  ds_read_b128 v[196:199], v211 offset:4096
  s_waitcnt lgkmcnt(2)
  v_mfma_f32_32x32x16_bf16 v[152:167], v[200:203], v[184:187], v[152:167]
  v_fmac_f32 v16, v24, v8
  v_fmac_f32 v17, v24, v9
  v_fmac_f32 v18, v24, v10
  v_fmac_f32 v19, v24, v11
  v_cvt_pk_bf16_f32 v204, -v16, -v17
  v_cvt_pk_bf16_f32 v205, -v18, -v19
  v_mfma_f32_32x32x16_bf16 v[168:183], v[200:203], v[188:191], v[168:183]
  v_fmac_f32 v20, v24, v12
  v_fmac_f32 v21, v24, v13
  v_fmac_f32 v22, v24, v14
  v_fmac_f32 v23, v24, v15
  v_cvt_pk_bf16_f32 v206, -v20, -v21
  v_cvt_pk_bf16_f32 v207, -v22, -v23
  s_waitcnt vmcnt(3)
  s_barrier
  ds_read_b128 v[184:187], v208 offset:8192
  ds_read_b128 v[188:191], v208 offset:12288
  s_waitcnt lgkmcnt(2)
  v_mfma_f32_32x32x16_bf16 v[152:167], v[204:207], v[192:195], v[152:167]
  v_fmac_f32 v8, v25, v16
  v_fmac_f32 v9, v25, v17
  v_fmac_f32 v10, v25, v18
  v_fmac_f32 v11, v25, v19
  v_cvt_pk_bf16_f32 v200, v8, v9
  v_cvt_pk_bf16_f32 v201, v10, v11
  v_mfma_f32_32x32x16_bf16 v[168:183], v[204:207], v[196:199], v[168:183]
  v_fmac_f32 v12, v25, v20
  v_fmac_f32 v13, v25, v21
  v_fmac_f32 v14, v25, v22
  v_fmac_f32 v15, v25, v23
  v_cvt_pk_bf16_f32 v202, v12, v13
  v_cvt_pk_bf16_f32 v203, v14, v15
  ds_read_b128 v[192:195], v209 offset:8192
  ds_read_b128 v[196:199], v209 offset:12288
  s_waitcnt lgkmcnt(2)
  v_mfma_f32_32x32x16_bf16 v[152:167], v[200:203], v[184:187], v[152:167]
  v_fmac_f32 v16, v24, v8
  v_fmac_f32 v17, v24, v9
  v_fmac_f32 v18, v24, v10
  v_fmac_f32 v19, v24, v11
  v_cvt_pk_bf16_f32 v204, v16, v17
  v_cvt_pk_bf16_f32 v205, v18, v19
  v_mfma_f32_32x32x16_bf16 v[168:183], v[200:203], v[188:191], v[168:183]
  v_fmac_f32 v20, v24, v12
  v_fmac_f32 v21, v24, v13
  v_fmac_f32 v22, v24, v14
  v_fmac_f32 v23, v24, v15
  v_cvt_pk_bf16_f32 v206, v20, v21
  v_cvt_pk_bf16_f32 v207, v22, v23
  ds_read_b128 v[184:187], v210 offset:8192
  ds_read_b128 v[188:191], v210 offset:12288
  s_waitcnt lgkmcnt(2)
  v_mfma_f32_32x32x16_bf16 v[152:167], v[204:207], v[192:195], v[152:167]
  v_fmac_f32 v8, v25, v16
  v_fmac_f32 v9, v25, v17
  v_fmac_f32 v10, v25, v18
  v_fmac_f32 v11, v25, v19
  v_cvt_pk_bf16_f32 v200, -v8, -v9
  v_cvt_pk_bf16_f32 v201, -v10, -v11
  v_mfma_f32_32x32x16_bf16 v[168:183], v[204:207], v[196:199], v[168:183]
  v_fmac_f32 v12, v25, v20
  v_fmac_f32 v13, v25, v21
  v_fmac_f32 v14, v25, v22
  v_fmac_f32 v15, v25, v23
  v_cvt_pk_bf16_f32 v202, -v12, -v13
  v_cvt_pk_bf16_f32 v203, -v14, -v15
  ds_read_b128 v[192:195], v211 offset:8192
  ds_read_b128 v[196:199], v211 offset:12288
  s_waitcnt lgkmcnt(2)
  v_mfma_f32_32x32x16_bf16 v[152:167], v[200:203], v[184:187], v[152:167]
  v_fmac_f32 v16, v24, v8
  v_fmac_f32 v17, v24, v9
  v_fmac_f32 v18, v24, v10
  v_fmac_f32 v19, v24, v11
  v_cvt_pk_bf16_f32 v204, -v16, -v17
  v_cvt_pk_bf16_f32 v205, -v18, -v19
  v_mfma_f32_32x32x16_bf16 v[168:183], v[200:203], v[188:191], v[168:183]
  v_fmac_f32 v20, v24, v12
  v_fmac_f32 v21, v24, v13
  v_fmac_f32 v22, v24, v14
  v_fmac_f32 v23, v24, v15
  v_cvt_pk_bf16_f32 v206, -v20, -v21
  v_cvt_pk_bf16_f32 v207, -v22, -v23
  s_waitcnt vmcnt(2)
  s_barrier
  ds_read_b128 v[184:187], v208 offset:16384
  ds_read_b128 v[188:191], v208 offset:20480
  s_waitcnt lgkmcnt(2)
  v_mfma_f32_32x32x16_bf16 v[152:167], v[204:207], v[192:195], v[152:167]
  v_fmac_f32 v8, v25, v16
  v_fmac_f32 v9, v25, v17
  v_fmac_f32 v10, v25, v18
  v_fmac_f32 v11, v25, v19
  v_cvt_pk_bf16_f32 v200, v8, v9
  v_cvt_pk_bf16_f32 v201, v10, v11
  v_mfma_f32_32x32x16_bf16 v[168:183], v[204:207], v[196:199], v[168:183]
  v_fmac_f32 v12, v25, v20
  v_fmac_f32 v13, v25, v21
  v_fmac_f32 v14, v25, v22
  v_fmac_f32 v15, v25, v23
  v_cvt_pk_bf16_f32 v202, v12, v13
  v_cvt_pk_bf16_f32 v203, v14, v15
  ds_read_b128 v[192:195], v209 offset:16384
  ds_read_b128 v[196:199], v209 offset:20480
  s_waitcnt lgkmcnt(2)
  v_mfma_f32_32x32x16_bf16 v[152:167], v[200:203], v[184:187], v[152:167]
  v_fmac_f32 v16, v24, v8
  v_fmac_f32 v17, v24, v9
  v_fmac_f32 v18, v24, v10
  v_fmac_f32 v19, v24, v11
  v_cvt_pk_bf16_f32 v204, v16, v17
  v_cvt_pk_bf16_f32 v205, v18, v19
  v_mfma_f32_32x32x16_bf16 v[168:183], v[200:203], v[188:191], v[168:183]
  v_fmac_f32 v20, v24, v12
  v_fmac_f32 v21, v24, v13
  v_fmac_f32 v22, v24, v14
  v_fmac_f32 v23, v24, v15
  v_cvt_pk_bf16_f32 v206, v20, v21
  v_cvt_pk_bf16_f32 v207, v22, v23
  ds_read_b128 v[184:187], v210 offset:16384
  ds_read_b128 v[188:191], v210 offset:20480
  s_waitcnt lgkmcnt(2)
  v_mfma_f32_32x32x16_bf16 v[152:167], v[204:207], v[192:195], v[152:167]
  v_fmac_f32 v8, v25, v16
  v_fmac_f32 v9, v25, v17
  v_fmac_f32 v10, v25, v18
  v_fmac_f32 v11, v25, v19
  v_cvt_pk_bf16_f32 v200, -v8, -v9
  v_cvt_pk_bf16_f32 v201, -v10, -v11
  v_mfma_f32_32x32x16_bf16 v[168:183], v[204:207], v[196:199], v[168:183]
  v_fmac_f32 v12, v25, v20
  v_fmac_f32 v13, v25, v21
  v_fmac_f32 v14, v25, v22
  v_fmac_f32 v15, v25, v23
  v_cvt_pk_bf16_f32 v202, -v12, -v13
  v_cvt_pk_bf16_f32 v203, -v14, -v15
  ds_read_b128 v[192:195], v211 offset:16384
  ds_read_b128 v[196:199], v211 offset:20480
  s_waitcnt lgkmcnt(2)
  v_mfma_f32_32x32x16_bf16 v[152:167], v[200:203], v[184:187], v[152:167]
  v_fmac_f32 v16, v24, v8
  v_fmac_f32 v17, v24, v9
  v_fmac_f32 v18, v24, v10
  v_fmac_f32 v19, v24, v11
  v_cvt_pk_bf16_f32 v204, -v16, -v17
  v_cvt_pk_bf16_f32 v205, -v18, -v19
  v_mfma_f32_32x32x16_bf16 v[168:183], v[200:203], v[188:191], v[168:183]
  v_fmac_f32 v20, v24, v12
  v_fmac_f32 v21, v24, v13
  v_fmac_f32 v22, v24, v14
  v_fmac_f32 v23, v24, v15
  v_cvt_pk_bf16_f32 v206, -v20, -v21
  v_cvt_pk_bf16_f32 v207, -v22, -v23
  s_waitcnt vmcnt(1)
  s_barrier
  ds_read_b128 v[184:187], v208 offset:24576
  ds_read_b128 v[188:191], v208 offset:28672
  s_waitcnt lgkmcnt(2)
  v_mfma_f32_32x32x16_bf16 v[152:167], v[204:207], v[192:195], v[152:167]
  v_fmac_f32 v8, v25, v16
  v_fmac_f32 v9, v25, v17
  v_fmac_f32 v10, v25, v18
  v_fmac_f32 v11, v25, v19
  v_cvt_pk_bf16_f32 v200, v8, v9
  v_cvt_pk_bf16_f32 v201, v10, v11
  v_mfma_f32_32x32x16_bf16 v[168:183], v[204:207], v[196:199], v[168:183]
  v_fmac_f32 v12, v25, v20
  v_fmac_f32 v13, v25, v21
  v_fmac_f32 v14, v25, v22
  v_fmac_f32 v15, v25, v23
  v_cvt_pk_bf16_f32 v202, v12, v13
  v_cvt_pk_bf16_f32 v203, v14, v15
  ds_read_b128 v[192:195], v209 offset:24576
  ds_read_b128 v[196:199], v209 offset:28672
  s_waitcnt lgkmcnt(2)
  v_mfma_f32_32x32x16_bf16 v[152:167], v[200:203], v[184:187], v[152:167]
  v_fmac_f32 v16, v24, v8
  v_fmac_f32 v17, v24, v9
  v_fmac_f32 v18, v24, v10
  v_fmac_f32 v19, v24, v11
  v_cvt_pk_bf16_f32 v204, v16, v17
  v_cvt_pk_bf16_f32 v205, v18, v19
  v_mfma_f32_32x32x16_bf16 v[168:183], v[200:203], v[188:191], v[168:183]
  v_fmac_f32 v20, v24, v12
  v_fmac_f32 v21, v24, v13
  v_fmac_f32 v22, v24, v14
  v_fmac_f32 v23, v24, v15
  v_cvt_pk_bf16_f32 v206, v20, v21
  v_cvt_pk_bf16_f32 v207, v22, v23
  ds_read_b128 v[184:187], v210 offset:24576
  ds_read_b128 v[188:191], v210 offset:28672
  s_waitcnt lgkmcnt(2)
  v_mfma_f32_32x32x16_bf16 v[152:167], v[204:207], v[192:195], v[152:167]
  v_fmac_f32 v8, v25, v16
  v_fmac_f32 v9, v25, v17
  v_fmac_f32 v10, v25, v18
  v_fmac_f32 v11, v25, v19
  v_cvt_pk_bf16_f32 v200, -v8, -v9
  v_cvt_pk_bf16_f32 v201, -v10, -v11
  v_mfma_f32_32x32x16_bf16 v[168:183], v[204:207], v[196:199], v[168:183]
  v_fmac_f32 v12, v25, v20
  v_fmac_f32 v13, v25, v21
  v_fmac_f32 v14, v25, v22
  v_fmac_f32 v15, v25, v23
  v_cvt_pk_bf16_f32 v202, -v12, -v13
  v_cvt_pk_bf16_f32 v203, -v14, -v15
  ds_read_b128 v[192:195], v211 offset:24576
  ds_read_b128 v[196:199], v211 offset:28672
  s_waitcnt lgkmcnt(2)
  v_mfma_f32_32x32x16_bf16 v[152:167], v[200:203], v[184:187], v[152:167]
  v_fmac_f32 v16, v24, v8
  v_fmac_f32 v17, v24, v9
  v_fmac_f32 v18, v24, v10
  v_fmac_f32 v19, v24, v11
  v_cvt_pk_bf16_f32 v204, -v16, -v17
  v_cvt_pk_bf16_f32 v205, -v18, -v19
  v_mfma_f32_32x32x16_bf16 v[168:183], v[200:203], v[188:191], v[168:183]
  v_fmac_f32 v20, v24, v12
  v_fmac_f32 v21, v24, v13
  v_fmac_f32 v22, v24, v14
  v_fmac_f32 v23, v24, v15
  v_cvt_pk_bf16_f32 v206, -v20, -v21
  v_cvt_pk_bf16_f32 v207, -v22, -v23
  s_waitcnt vmcnt(0)
  s_barrier
  ds_read_b128 v[184:187], v208 offset:32768
  ds_read_b128 v[188:191], v208 offset:36864
  s_waitcnt lgkmcnt(2)
  v_mfma_f32_32x32x16_bf16 v[152:167], v[204:207], v[192:195], v[152:167]
  v_fmac_f32 v8, v25, v16
  v_fmac_f32 v9, v25, v17
  v_fmac_f32 v10, v25, v18
  v_fmac_f32 v11, v25, v19
  v_cvt_pk_bf16_f32 v200, v8, v9
  v_cvt_pk_bf16_f32 v201, v10, v11
  v_mfma_f32_32x32x16_bf16 v[168:183], v[204:207], v[196:199], v[168:183]
  v_fmac_f32 v12, v25, v20
  v_fmac_f32 v13, v25, v21
  v_fmac_f32 v14, v25, v22
  v_fmac_f32 v15, v25, v23
  v_cvt_pk_bf16_f32 v202, v12, v13
  v_cvt_pk_bf16_f32 v203, v14, v15
  ds_read_b128 v[192:195], v209 offset:32768
  ds_read_b128 v[196:199], v209 offset:36864
  s_waitcnt lgkmcnt(2)
  v_mfma_f32_32x32x16_bf16 v[152:167], v[200:203], v[184:187], v[152:167]
  v_fmac_f32 v16, v24, v8
  v_fmac_f32 v17, v24, v9
  v_fmac_f32 v18, v24, v10
  v_fmac_f32 v19, v24, v11
  v_cvt_pk_bf16_f32 v204, v16, v17
  v_cvt_pk_bf16_f32 v205, v18, v19
  v_mfma_f32_32x32x16_bf16 v[168:183], v[200:203], v[188:191], v[168:183]
  v_fmac_f32 v20, v24, v12
  v_fmac_f32 v21, v24, v13
  v_fmac_f32 v22, v24, v14
  v_fmac_f32 v23, v24, v15
  v_cvt_pk_bf16_f32 v206, v20, v21
  v_cvt_pk_bf16_f32 v207, v22, v23
  ds_read_b128 v[184:187], v210 offset:32768
  ds_read_b128 v[188:191], v210 offset:36864
  s_waitcnt lgkmcnt(2)
  v_mfma_f32_32x32x16_bf16 v[152:167], v[204:207], v[192:195], v[152:167]
  v_fmac_f32 v8, v25, v16
  v_fmac_f32 v9, v25, v17
  v_fmac_f32 v10, v25, v18
  v_fmac_f32 v11, v25, v19
  v_cvt_pk_bf16_f32 v200, -v8, -v9
  v_cvt_pk_bf16_f32 v201, -v10, -v11
  v_mfma_f32_32x32x16_bf16 v[168:183], v[204:207], v[196:199], v[168:183]
  v_fmac_f32 v12, v25, v20
  v_fmac_f32 v13, v25, v21
  v_fmac_f32 v14, v25, v22
  v_fmac_f32 v15, v25, v23
  v_cvt_pk_bf16_f32 v202, -v12, -v13
  v_cvt_pk_bf16_f32 v203, -v14, -v15
  ds_read_b128 v[192:195], v211 offset:32768
  ds_read_b128 v[196:199], v211 offset:36864
  s_waitcnt lgkmcnt(2)
  v_mfma_f32_32x32x16_bf16 v[152:167], v[200:203], v[184:187], v[152:167]
  v_fmac_f32 v16, v24, v8
  v_fmac_f32 v17, v24, v9
  v_fmac_f32 v18, v24, v10
  v_fmac_f32 v19, v24, v11
  v_cvt_pk_bf16_f32 v204, -v16, -v17
  v_cvt_pk_bf16_f32 v205, -v18, -v19
  v_mfma_f32_32x32x16_bf16 v[168:183], v[200:203], v[188:191], v[168:183]
  v_fmac_f32 v20, v24, v12
  v_fmac_f32 v21, v24, v13
  v_fmac_f32 v22, v24, v14
  v_fmac_f32 v23, v24, v15
  v_cvt_pk_bf16_f32 v206, -v20, -v21
  v_cvt_pk_bf16_f32 v207, -v22, -v23
  s_waitcnt lgkmcnt(0)
  s_nop 0
  v_mfma_f32_32x32x16_bf16 v[152:167], v[204:207], v[192:195], v[152:167]
  v_mfma_f32_32x32x16_bf16 v[168:183], v[204:207], v[196:199], v[168:183]
  v_mov_b32 v241, 0
  s_cmp_eq_u32 s20, 2
  s_cbranch_scc1 k1_kernel_ep8
  s_nop 7
  v_cvt_pk_bf16_f32 v216, v152, v153
  v_cvt_pk_bf16_f32 v217, v154, v155
  s_add_u32 s34, s30, 0
  buffer_store_dwordx2 v[216:217], v243, s[8:11], s34 offen sc1
  v_cvt_pk_bf16_f32 v218, v156, v157
  v_cvt_pk_bf16_f32 v219, v158, v159
  s_add_u32 s34, s30, 33024
  buffer_store_dwordx2 v[218:219], v243, s[8:11], s34 offen sc1
  v_cvt_pk_bf16_f32 v220, v160, v161
  v_cvt_pk_bf16_f32 v221, v162, v163
  s_add_u32 s34, s30, 66048
  buffer_store_dwordx2 v[220:221], v243, s[8:11], s34 offen sc1
  v_cvt_pk_bf16_f32 v222, v164, v165
  v_cvt_pk_bf16_f32 v223, v166, v167
  s_add_u32 s34, s30, 99072
  buffer_store_dwordx2 v[222:223], v243, s[8:11], s34 offen sc1
  v_cvt_pk_bf16_f32 v224, v168, v169
  v_cvt_pk_bf16_f32 v225, v170, v171
  s_add_u32 s34, s30, 256
  buffer_store_dwordx2 v[224:225], v243, s[8:11], s34 offen sc1
  v_cvt_pk_bf16_f32 v226, v172, v173
  v_cvt_pk_bf16_f32 v227, v174, v175
  s_add_u32 s34, s30, 33280
  buffer_store_dwordx2 v[226:227], v243, s[8:11], s34 offen sc1
  v_cvt_pk_bf16_f32 v228, v176, v177
  v_cvt_pk_bf16_f32 v229, v178, v179
  s_add_u32 s34, s30, 66304
  buffer_store_dwordx2 v[228:229], v243, s[8:11], s34 offen sc1
  v_cvt_pk_bf16_f32 v230, v180, v181
  v_cvt_pk_bf16_f32 v231, v182, v183
  s_add_u32 s34, s30, 99328
  buffer_store_dwordx2 v[230:231], v243, s[8:11], s34 offen sc1
  s_branch k1_kernel_fin
k1_kernel_ep8:
  s_nop 7
  v_cvt_pk_bf16_f32 v216, v152, v153
  v_cvt_pk_bf16_f32 v217, v154, v155
  s_add_u32 s34, s30, 0
  buffer_store_dwordx2 v[216:217], v243, s[8:11], s34 offen sc1
  v_cvt_pk_bf16_f32 v224, v168, v169
  v_cvt_pk_bf16_f32 v225, v170, v171
  s_add_u32 s34, s30, 256
  buffer_store_dwordx2 v[224:225], v243, s[8:11], s34 offen sc1
  s_branch k1_kernel_fin
k1_kernel_side:
    s_cmp_eq_u32 s20, 6
    s_cbranch_scc1 k1_kernel_w6
    s_cmp_eq_u32 s20, 7
    s_cbranch_scc1 k1_kernel_w7a
        s_mov_b32 m0, s25
        s_add_u32 s25, s25, 8192
        buffer_load_dwordx4 v236, s[12:15], s24 offen lds
        s_add_u32 s24, s24, 128
  s_barrier
        s_mov_b32 m0, s25
        s_add_u32 s25, s25, 8192
        buffer_load_dwordx4 v236, s[12:15], s24 offen lds
        s_add_u32 s24, s24, 128
        s_mov_b32 m0, s25
        s_add_u32 s25, s25, 8192
        buffer_load_dwordx4 v236, s[12:15], s24 offen lds
        s_add_u32 s24, s24, 128
        s_mov_b32 m0, s25
        s_add_u32 s25, s25, 8192
        buffer_load_dwordx4 v236, s[12:15], s24 offen lds
        s_add_u32 s24, s24, 128
        s_mov_b32 m0, s25
        s_add_u32 s25, s25, 8192
        buffer_load_dwordx4 v236, s[12:15], s24 offen lds
        s_add_u32 s24, s24, 128
        s_mov_b32 m0, s25
        s_add_u32 s25, s25, 8192
        buffer_load_dwordx4 v236, s[12:15], s24 offen lds
        s_add_u32 s24, s24, 128
        s_mov_b32 m0, s25
        s_add_u32 s25, s25, 8192
        buffer_load_dwordx4 v236, s[12:15], s24 offen lds
        s_add_u32 s24, s24, 128
        s_mov_b32 m0, s25
        s_add_u32 s25, s25, 8192
        buffer_load_dwordx4 v236, s[12:15], s24 offen lds
        s_add_u32 s24, s24, 128
        s_mov_b32 m0, s25
        s_add_u32 s25, s25, 8192
        buffer_load_dwordx4 v236, s[12:15], s24 offen lds
        s_add_u32 s24, s24, 128
        s_mov_b32 s8, s4
        s_mov_b32 s9, s5
        s_mov_b32 s10, 0x10000000
        s_mov_b32 s11, 0x20000
        v_and_b32 v240, 31, v238
        v_lshrrev_b32 v241, 5, v238
        v_lshrrev_b32 v239, 1, v240
        v_and_b32 v239, 7, v239
        v_lshlrev_b32 v242, 7, v240
            v_add_u32 v208, 0, v241
            v_xor_b32 v208, v208, v239
            v_lshl_add_u32 v208, v208, 4, v242
            v_add_u32 v209, 2, v241
            v_xor_b32 v209, v209, v239
            v_lshl_add_u32 v209, v209, 4, v242
            v_add_u32 v210, 4, v241
            v_xor_b32 v210, v210, v239
            v_lshl_add_u32 v210, v210, 4, v242
            v_add_u32 v211, 6, v241
            v_xor_b32 v211, v211, v239
            v_lshl_add_u32 v211, v211, 4, v242
        s_sub_u32 s34, s20, 3
        s_lshl_b32 s34, s34, 6
        v_add_u32 v239, s34, v238
  s_mov_b32 s3, 57
  v_mul_u32_u24 v240, s3, v239
  v_lshrrev_b32 v240, 10, v240
        v_mul_u32_u24 v241, 18, v240
        v_sub_u32 v241, v239, v241
        s_lshr_b32 s34, s2, 5
        s_mul_i32 s34, s34, 18
        v_add_u32 v241, s34, v241
        s_and_b32 s34, s2, 7
        s_lshl_b32 s34, s34, 3
        v_add_u32 v240, s34, v240
        s_bfe_u32 s35, s2, 0x20003
        v_lshlrev_b32 v149, 14, v241
        v_lshrrev_b32 v242, 4, v240
        v_lshlrev_b32 v242, 6, v242
        v_and_b32 v148, 15, v240
        v_add_u32 v242, v242, v148
        s_lshl_b32 s34, s35, 4
        v_add_u32 v242, s34, v242
        v_lshl_add_u32 v149, v242, 4, v149
        s_lshl_b32 s34, s35, 8
        v_add_u32 v240, s34, v240
        v_mul_u32_u24 v148, 578, v240
        v_lshl_add_u32 v148, v241, 2, v148
        v_cmp_gt_u32 vcc, 144, v239
  s_nop 3
        s_mov_b64 s[42:43], vcc
        v_cmp_ne_u32 vcc, 0, v241
  s_nop 3
        s_and_b64 s[40:41], s[42:43], vcc
        s_mov_b32 s16, s46
        s_mov_b32 s17, s47
        s_mov_b32 s18, 1183744
        s_mov_b32 s19, 0x20000
        s_mov_b32 s56, s48
        s_mov_b32 s57, s49
        s_mov_b32 s58, 1183744
        s_mov_b32 s59, 0x20000
  s_waitcnt vmcnt(8)
  s_barrier
  s_mov_b64 exec, s[42:43]
            s_mov_b32 s34, 0
            buffer_load_dword v152, v148, s[16:19], s34 offen
            buffer_load_dword v160, v148, s[56:59], s34 offen
            s_mov_b32 s34, 36992
            buffer_load_dword v153, v148, s[16:19], s34 offen
            buffer_load_dword v161, v148, s[56:59], s34 offen
  s_mov_b64 exec, -1
  s_waitcnt vmcnt(11)
  s_barrier
  s_mov_b64 exec, s[42:43]
            s_mov_b32 s34, 73984
            buffer_load_dword v154, v148, s[16:19], s34 offen
            buffer_load_dword v162, v148, s[56:59], s34 offen
            s_mov_b32 s34, 110976
            buffer_load_dword v155, v148, s[16:19], s34 offen
            buffer_load_dword v163, v148, s[56:59], s34 offen
  s_mov_b64 exec, -1
  s_waitcnt vmcnt(14)
  s_barrier
  s_mov_b64 exec, s[42:43]
            s_mov_b32 s34, 591872
            buffer_load_dword v156, v148, s[16:19], s34 offen
            buffer_load_dword v164, v148, s[56:59], s34 offen
            s_mov_b32 s34, 628864
            buffer_load_dword v157, v148, s[16:19], s34 offen
            buffer_load_dword v165, v148, s[56:59], s34 offen
  s_mov_b64 exec, -1
  s_waitcnt vmcnt(17)
  s_barrier
  s_mov_b64 exec, s[42:43]
            s_mov_b32 s34, 665856
            buffer_load_dword v158, v148, s[16:19], s34 offen
            buffer_load_dword v166, v148, s[56:59], s34 offen
            s_mov_b32 s34, 702848
            buffer_load_dword v159, v148, s[16:19], s34 offen
            buffer_load_dword v167, v148, s[56:59], s34 offen
  s_mov_b64 exec, -1
  s_waitcnt vmcnt(20)
  s_barrier
  s_waitcnt vmcnt(19)
  s_barrier
  s_waitcnt vmcnt(18)
  s_barrier
  s_waitcnt vmcnt(17)
  s_barrier
  s_waitcnt vmcnt(16)
  s_barrier
    s_mul_i32 s34, s2, 162
    v_and_b32 v239, 0x3ff, v0
    v_subrev_u32 v239, 192, v239
    v_cmp_gt_u32 vcc, 162, v239
  s_nop 3
    s_mov_b64 s[38:39], vcc
    v_add_u32 v239, s34, v239
    v_lshlrev_b32 v92, 4, v239
  s_mov_b32 s3, 58255
  v_mul_u32_u24 v240, s3, v239
  v_lshrrev_b32 v240, 25, v240
    v_mul_u32_u24 v241, 576, v240
    v_sub_u32 v241, v239, v241
    v_lshlrev_b32 v240, 3, v240
    v_cvt_f32_u32 v240, v240
    v_lshrrev_b32 v239, 1, v241
    v_mov_b32 v242, 288
    v_cmp_eq_u32 vcc, 1, v241
  s_nop 1
    v_cndmask_b32 v239, v239, v242, vcc
    v_cvt_f32_u32 v8, v239
    v_mul_f32 v8, 0x3ae38e39, v8
    v_and_b32 v239, 1, v241
    v_cvt_f32_u32 v9, v239
    v_mul_f32 v9, 0x3e800000, v9
    v_mov_b32 v242, 0
    v_cndmask_b32 v9, v9, v242, vcc
    v_mov_b32 v10, 0x3d715bef
    v_mov_b32 v242, 0x3d2aaaab
    v_cmp_gt_u32 vcc, 2, v241
  s_nop 1
    v_cndmask_b32 v10, v10, v242, vcc
        v_fma_f32 v12, v240, v8, v9
        v_add_f32 v240, 1.0, v240
        v_fract_f32 v12, v12
        v_fma_f32 v13, v240, v8, v9
        v_add_f32 v240, 1.0, v240
        v_fract_f32 v13, v13
        v_fma_f32 v14, v240, v8, v9
        v_add_f32 v240, 1.0, v240
        v_fract_f32 v14, v14
        v_fma_f32 v15, v240, v8, v9
        v_add_f32 v240, 1.0, v240
        v_fract_f32 v15, v15
        v_fma_f32 v16, v240, v8, v9
        v_add_f32 v240, 1.0, v240
        v_fract_f32 v16, v16
        v_fma_f32 v17, v240, v8, v9
        v_add_f32 v240, 1.0, v240
        v_fract_f32 v17, v17
        v_fma_f32 v18, v240, v8, v9
        v_add_f32 v240, 1.0, v240
        v_fract_f32 v18, v18
        v_fma_f32 v19, v240, v8, v9
        v_add_f32 v240, 1.0, v240
        v_fract_f32 v19, v19
  v_cos_f32 v12, v12
  v_cos_f32 v13, v13
  v_cos_f32 v14, v14
  v_cos_f32 v15, v15
  v_cos_f32 v16, v16
  v_cos_f32 v17, v17
  v_cos_f32 v18, v18
  v_cos_f32 v19, v19
  v_mul_f32 v12, v12, v10
  v_mul_f32 v13, v13, v10
  v_mul_f32 v14, v14, v10
  v_mul_f32 v15, v15, v10
  v_mul_f32 v16, v16, v10
  v_mul_f32 v17, v17, v10
  v_mul_f32 v18, v18, v10
  v_mul_f32 v19, v19, v10
  v_cvt_pk_bf16_f32 v88, v12, v13
  v_cvt_pk_bf16_f32 v89, v14, v15
  v_cvt_pk_bf16_f32 v90, v16, v17
  v_cvt_pk_bf16_f32 v91, v18, v19
    s_mov_b64 exec, s[38:39]
    s_mov_b32 s34, 11911168
    buffer_store_dwordx4 v[88:91], v92, s[8:11], s34 offen
    s_mov_b64 exec, -1
    s_waitcnt vmcnt(1)
    s_mov_b32 s36, 0x05040100
    s_mov_b32 s37, 0x07060302
  v_perm_b32 v168, v160, v152, s36
  v_perm_b32 v176, v160, v152, s37
  v_perm_b32 v169, v161, v153, s36
  v_perm_b32 v177, v161, v153, s37
  v_perm_b32 v170, v162, v154, s36
  v_perm_b32 v178, v162, v154, s37
  v_perm_b32 v171, v163, v155, s36
  v_perm_b32 v179, v163, v155, s37
  v_perm_b32 v172, v164, v156, s36
  v_perm_b32 v180, v164, v156, s37
  v_perm_b32 v173, v165, v157, s36
  v_perm_b32 v181, v165, v157, s37
  v_perm_b32 v174, v166, v158, s36
  v_perm_b32 v182, v166, v158, s37
  v_perm_b32 v175, v167, v159, s36
  v_perm_b32 v183, v167, v159, s37
    s_mov_b64 exec, s[42:43]
    s_mov_b32 s34, 9560064
    buffer_store_dwordx4 v[176:179], v149, s[8:11], s34 offen
    s_mov_b32 s34, 9564160
    buffer_store_dwordx4 v[180:183], v149, s[8:11], s34 offen
    s_mov_b64 exec, s[40:41]
    s_cbranch_execz k1_kernel_noa
    s_mov_b32 s34, 9551872
    buffer_store_dwordx4 v[168:171], v149, s[8:11], s34 offen
    s_mov_b32 s34, 9555968
    buffer_store_dwordx4 v[172:175], v149, s[8:11], s34 offen
k1_kernel_noa:
  s_mov_b64 exec, -1
  s_branch k1_kernel_fin
k1_kernel_w6:
        s_mov_b32 m0, s25
        s_add_u32 s25, s25, 8192
        buffer_load_dwordx4 v236, s[12:15], s24 offen lds
        s_add_u32 s24, s24, 128
  s_barrier
        s_mov_b32 m0, s25
        s_add_u32 s25, s25, 8192
        buffer_load_dwordx4 v236, s[12:15], s24 offen lds
        s_add_u32 s24, s24, 128
        s_mov_b32 m0, s25
        s_add_u32 s25, s25, 8192
        buffer_load_dwordx4 v236, s[12:15], s24 offen lds
        s_add_u32 s24, s24, 128
        s_mov_b32 m0, s25
        s_add_u32 s25, s25, 8192
        buffer_load_dwordx4 v236, s[12:15], s24 offen lds
        s_add_u32 s24, s24, 128
        s_mov_b32 m0, s25
        s_add_u32 s25, s25, 8192
        buffer_load_dwordx4 v236, s[12:15], s24 offen lds
        s_add_u32 s24, s24, 128
        s_mov_b32 m0, s25
        s_add_u32 s25, s25, 8192
        buffer_load_dwordx4 v236, s[12:15], s24 offen lds
        s_add_u32 s24, s24, 128
        s_mov_b32 m0, s25
        s_add_u32 s25, s25, 8192
        buffer_load_dwordx4 v236, s[12:15], s24 offen lds
        s_add_u32 s24, s24, 128
        s_mov_b32 m0, s25
        s_add_u32 s25, s25, 8192
        buffer_load_dwordx4 v236, s[12:15], s24 offen lds
        s_add_u32 s24, s24, 128
        s_mov_b32 m0, s25
        s_add_u32 s25, s25, 8192
        buffer_load_dwordx4 v236, s[12:15], s24 offen lds
        s_add_u32 s24, s24, 128
        s_mov_b32 s8, s4
        s_mov_b32 s9, s5
        s_mov_b32 s10, 0x10000000
        s_mov_b32 s11, 0x20000
        v_and_b32 v240, 31, v238
        v_lshrrev_b32 v241, 5, v238
        v_lshrrev_b32 v239, 1, v240
        v_and_b32 v239, 7, v239
        v_lshlrev_b32 v242, 7, v240
            v_add_u32 v208, 0, v241
            v_xor_b32 v208, v208, v239
            v_lshl_add_u32 v208, v208, 4, v242
            v_add_u32 v209, 2, v241
            v_xor_b32 v209, v209, v239
            v_lshl_add_u32 v209, v209, 4, v242
            v_add_u32 v210, 4, v241
            v_xor_b32 v210, v210, v239
            v_lshl_add_u32 v210, v210, 4, v242
            v_add_u32 v211, 6, v241
            v_xor_b32 v211, v211, v239
            v_lshl_add_u32 v211, v211, 4, v242
        s_mul_i32 s34, s2, 18
        v_add_u32 v239, s34, v238
        v_lshrrev_b32 v240, 3, v239
        v_and_b32 v241, 7, v239
        v_lshlrev_b32 v100, 4, v239
        v_and_b32 v242, 3, v241
        v_lshlrev_b32 v242, 3, v242
        v_mul_u32_u24 v240, 36, v240
        v_cmp_gt_u32 s[38:39], 18, v238
        v_cmp_gt_u32 vcc, 4, v241
  s_nop 3
        s_and_b64 s[42:43], s[38:39], vcc
        s_andn2_b64 s[40:41], s[38:39], vcc
            v_add_u32 v8, 0, v242
            v_min_u32 v8, 17, v8
            v_lshl_add_u32 v8, v8, 1, v240
            v_add_u32 v9, 1, v242
            v_min_u32 v9, 17, v9
            v_lshl_add_u32 v9, v9, 1, v240
            v_add_u32 v10, 2, v242
            v_min_u32 v10, 17, v10
            v_lshl_add_u32 v10, v10, 1, v240
            v_add_u32 v11, 3, v242
            v_min_u32 v11, 17, v11
            v_lshl_add_u32 v11, v11, 1, v240
            v_add_u32 v12, 4, v242
            v_min_u32 v12, 17, v12
            v_lshl_add_u32 v12, v12, 1, v240
            v_add_u32 v13, 5, v242
            v_min_u32 v13, 17, v13
            v_lshl_add_u32 v13, v13, 1, v240
            v_add_u32 v14, 6, v242
            v_min_u32 v14, 17, v14
            v_lshl_add_u32 v14, v14, 1, v240
            v_add_u32 v15, 7, v242
            v_min_u32 v15, 17, v15
            v_lshl_add_u32 v15, v15, 1, v240
        s_and_b32 s34, s2, 7
        s_lshl_b32 s34, s34, 6
        v_add_u32 v239, s34, v238
        v_lshlrev_b32 v149, 4, v239
        v_and_b32 v240, 255, v239
        v_lshrrev_b32 v239, 8, v239
        v_lshrrev_b32 v241, 6, v240
        v_lshlrev_b32 v241, 4, v241
        v_and_b32 v242, 15, v240
        v_add_u32 v241, v241, v242
        v_bfe_u32 v242, v240, 4, 2
        v_lshl_add_u32 v242, v239, 2, v242
        v_lshl_add_u32 v241, v242, 8, v241
        v_mul_u32_u24 v148, 578, v241
        v_add_u32 v148, 576, v148
  s_waitcnt vmcnt(8)
  s_barrier
            s_mov_b32 s16, s52
            s_mov_b32 s17, s53
            s_mov_b32 s18, 20736
            s_mov_b32 s19, 0x20000
            s_mov_b64 exec, s[42:43]
  buffer_load_ushort v184, v8, s[16:19], 0 offen
  buffer_load_ushort v185, v9, s[16:19], 0 offen
  buffer_load_ushort v186, v10, s[16:19], 0 offen
  buffer_load_ushort v187, v11, s[16:19], 0 offen
  buffer_load_ushort v188, v12, s[16:19], 0 offen
  buffer_load_ushort v189, v13, s[16:19], 0 offen
  buffer_load_ushort v190, v14, s[16:19], 0 offen
  buffer_load_ushort v191, v15, s[16:19], 0 offen
  s_mov_b64 exec, -1
  s_waitcnt vmcnt(15)
  s_barrier
            s_mov_b32 s16, s54
            s_mov_b32 s17, s55
            s_mov_b32 s18, 20736
            s_mov_b32 s19, 0x20000
            s_mov_b64 exec, s[40:41]
  buffer_load_ushort v184, v8, s[16:19], 0 offen
  buffer_load_ushort v185, v9, s[16:19], 0 offen
  buffer_load_ushort v186, v10, s[16:19], 0 offen
  buffer_load_ushort v187, v11, s[16:19], 0 offen
  buffer_load_ushort v188, v12, s[16:19], 0 offen
  buffer_load_ushort v189, v13, s[16:19], 0 offen
  buffer_load_ushort v190, v14, s[16:19], 0 offen
  buffer_load_ushort v191, v15, s[16:19], 0 offen
  s_mov_b64 exec, -1
  s_waitcnt vmcnt(22)
  s_barrier
        s_mov_b32 s16, s46
        s_mov_b32 s17, s47
        s_mov_b32 s18, 1183744
        s_mov_b32 s19, 0x20000
        s_mov_b32 s56, s48
        s_mov_b32 s57, s49
        s_mov_b32 s58, 1183744
        s_mov_b32 s59, 0x20000
                s_mov_b32 s34, 0
                buffer_load_ushort v152, v148, s[16:19], s34 offen
                buffer_load_ushort v160, v148, s[56:59], s34 offen
                s_mov_b32 s34, 36992
                buffer_load_ushort v153, v148, s[16:19], s34 offen
                buffer_load_ushort v161, v148, s[56:59], s34 offen
                s_mov_b32 s34, 73984
                buffer_load_ushort v154, v148, s[16:19], s34 offen
                buffer_load_ushort v162, v148, s[56:59], s34 offen
                s_mov_b32 s34, 110976
                buffer_load_ushort v155, v148, s[16:19], s34 offen
                buffer_load_ushort v163, v148, s[56:59], s34 offen
  s_waitcnt vmcnt(29)
  s_barrier
  s_waitcnt vmcnt(28)
  s_barrier
  s_waitcnt vmcnt(27)
  s_barrier
  s_waitcnt vmcnt(26)
  s_barrier
  s_waitcnt vmcnt(25)
  s_barrier
  s_waitcnt vmcnt(24)
  s_barrier
    s_waitcnt vmcnt(0)
    s_mov_b64 exec, s[38:39]
    v_lshl_or_b32 v96, v185, 16, v184
    v_lshl_or_b32 v97, v187, 16, v186
    v_lshl_or_b32 v98, v189, 16, v188
    v_lshl_or_b32 v99, v191, 16, v190
    s_mov_b32 s34, 14827520
    buffer_store_dwordx4 v[96:99], v100, s[8:11], s34 offen
    s_mov_b64 exec, -1
    s_cmp_lt_u32 s2, 8
    s_cbranch_scc0 k1_kernel_fin
  v_lshl_or_b32 v168, v160, 16, v152
  v_lshl_or_b32 v169, v161, 16, v153
  v_lshl_or_b32 v170, v162, 16, v154
  v_lshl_or_b32 v171, v163, 16, v155
    s_mov_b32 s34, 9551872
    buffer_store_dwordx4 v[168:171], v149, s[8:11], s34 offen
    s_branch k1_kernel_fin
k1_kernel_w7a:
  s_cmp_eq_u32 s22, 0
  s_cbranch_scc0 k1_kernel_help
        s_mov_b32 m0, s25
        s_add_u32 s25, s25, 8192
        buffer_load_dwordx4 v236, s[12:15], s24 offen lds
        s_add_u32 s24, s24, 128
  s_barrier
        s_mov_b32 m0, s25
        s_add_u32 s25, s25, 8192
        buffer_load_dwordx4 v236, s[12:15], s24 offen lds
        s_add_u32 s24, s24, 128
        s_mov_b32 m0, s25
        s_add_u32 s25, s25, 8192
        buffer_load_dwordx4 v236, s[12:15], s24 offen lds
        s_add_u32 s24, s24, 128
        s_mov_b32 m0, s25
        s_add_u32 s25, s25, 8192
        buffer_load_dwordx4 v236, s[12:15], s24 offen lds
        s_add_u32 s24, s24, 128
        s_mov_b32 m0, s25
        s_add_u32 s25, s25, 8192
        buffer_load_dwordx4 v236, s[12:15], s24 offen lds
        s_add_u32 s24, s24, 128
        s_mov_b32 m0, s25
        s_add_u32 s25, s25, 8192
        buffer_load_dwordx4 v236, s[12:15], s24 offen lds
        s_add_u32 s24, s24, 128
        s_mov_b32 m0, s25
        s_add_u32 s25, s25, 8192
        buffer_load_dwordx4 v236, s[12:15], s24 offen lds
        s_add_u32 s24, s24, 128
        s_mov_b32 m0, s25
        s_add_u32 s25, s25, 8192
        buffer_load_dwordx4 v236, s[12:15], s24 offen lds
        s_add_u32 s24, s24, 128
        s_mov_b32 m0, s25
        s_add_u32 s25, s25, 8192
        buffer_load_dwordx4 v236, s[12:15], s24 offen lds
        s_add_u32 s24, s24, 128
        s_mov_b32 s8, s4
        s_mov_b32 s9, s5
        s_mov_b32 s10, 0x10000000
        s_mov_b32 s11, 0x20000
        v_and_b32 v240, 31, v238
        v_lshrrev_b32 v241, 5, v238
        v_lshrrev_b32 v239, 1, v240
        v_and_b32 v239, 7, v239
        v_lshlrev_b32 v242, 7, v240
            v_add_u32 v208, 0, v241
            v_xor_b32 v208, v208, v239
            v_lshl_add_u32 v208, v208, 4, v242
            v_add_u32 v209, 2, v241
            v_xor_b32 v209, v209, v239
            v_lshl_add_u32 v209, v209, 4, v242
            v_add_u32 v210, 4, v241
            v_xor_b32 v210, v210, v239
            v_lshl_add_u32 v210, v210, 4, v242
            v_add_u32 v211, 6, v241
            v_xor_b32 v211, v211, v239
            v_lshl_add_u32 v211, v211, 4, v242
        v_lshlrev_b32 v148, 4, v238
        s_mov_b32 s16, s50
        s_mov_b32 s17, s51
        s_mov_b32 s18, 663552
        s_mov_b32 s19, 0x20000
        s_mul_i32 s34, s2, 6144
        s_cmp_lt_u32 s2, 108
        s_cbranch_scc1 k1_kernel_pfs
        s_mov_b32 s16, s40
        s_mov_b32 s17, s41
        s_sub_u32 s34, s34, 663552
k1_kernel_pfs:
  buffer_load_dwordx4 v[144:147], v148, s[16:19], s34 offen
  s_add_u32 s34, s34, 1024
  buffer_load_dwordx4 v[144:147], v148, s[16:19], s34 offen
  s_add_u32 s34, s34, 1024
  buffer_load_dwordx4 v[144:147], v148, s[16:19], s34 offen
  s_add_u32 s34, s34, 1024
  buffer_load_dwordx4 v[144:147], v148, s[16:19], s34 offen
  s_add_u32 s34, s34, 1024
  buffer_load_dwordx4 v[144:147], v148, s[16:19], s34 offen
  s_add_u32 s34, s34, 1024
  buffer_load_dwordx4 v[144:147], v148, s[16:19], s34 offen
  s_add_u32 s34, s34, 1024
  v_mov_b32 v112, 0
  v_mov_b32 v113, 0
  v_mov_b32 v114, 0
  v_mov_b32 v115, 0
  v_mov_b32 v116, 0
  v_mov_b32 v117, 0
  v_mov_b32 v118, 0
  v_mov_b32 v119, 0
  v_mov_b32 v120, 0
  v_mov_b32 v121, 0
  v_mov_b32 v122, 0
  v_mov_b32 v123, 0
  v_mov_b32 v124, 0
  v_mov_b32 v125, 0
  v_mov_b32 v126, 0
  v_mov_b32 v127, 0
  v_mov_b32 v150, 0x3f803f80
  s_waitcnt vmcnt(14)
  s_barrier
  ds_read_b128 v[184:187], v208 offset:0
  ds_read_b128 v[188:191], v208 offset:4096
  ds_read_b128 v[192:195], v209 offset:0
  ds_read_b128 v[196:199], v209 offset:4096
  s_waitcnt lgkmcnt(2)
  v_dot2c_f32_bf16 v112, v184, v184
  v_dot2c_f32_bf16 v120, v184, v150
  v_dot2c_f32_bf16 v116, v188, v188
  v_dot2c_f32_bf16 v124, v188, v150
  v_dot2c_f32_bf16 v113, v185, v185
  v_dot2c_f32_bf16 v121, v185, v150
  v_dot2c_f32_bf16 v117, v189, v189
  v_dot2c_f32_bf16 v125, v189, v150
  v_dot2c_f32_bf16 v114, v186, v186
  v_dot2c_f32_bf16 v122, v186, v150
  v_dot2c_f32_bf16 v118, v190, v190
  v_dot2c_f32_bf16 v126, v190, v150
  v_dot2c_f32_bf16 v115, v187, v187
  v_dot2c_f32_bf16 v123, v187, v150
  v_dot2c_f32_bf16 v119, v191, v191
  v_dot2c_f32_bf16 v127, v191, v150
  ds_read_b128 v[184:187], v210 offset:0
  ds_read_b128 v[188:191], v210 offset:4096
  s_waitcnt lgkmcnt(2)
  v_dot2c_f32_bf16 v112, v192, v192
  v_dot2c_f32_bf16 v120, v192, v150
  v_dot2c_f32_bf16 v116, v196, v196
  v_dot2c_f32_bf16 v124, v196, v150
  v_dot2c_f32_bf16 v113, v193, v193
  v_dot2c_f32_bf16 v121, v193, v150
  v_dot2c_f32_bf16 v117, v197, v197
  v_dot2c_f32_bf16 v125, v197, v150
  v_dot2c_f32_bf16 v114, v194, v194
  v_dot2c_f32_bf16 v122, v194, v150
  v_dot2c_f32_bf16 v118, v198, v198
  v_dot2c_f32_bf16 v126, v198, v150
  v_dot2c_f32_bf16 v115, v195, v195
  v_dot2c_f32_bf16 v123, v195, v150
  v_dot2c_f32_bf16 v119, v199, v199
  v_dot2c_f32_bf16 v127, v199, v150
  ds_read_b128 v[192:195], v211 offset:0
  ds_read_b128 v[196:199], v211 offset:4096
  s_waitcnt lgkmcnt(2)
  v_dot2c_f32_bf16 v112, v184, v184
  v_dot2c_f32_bf16 v120, v184, v150
  v_dot2c_f32_bf16 v116, v188, v188
  v_dot2c_f32_bf16 v124, v188, v150
  v_dot2c_f32_bf16 v113, v185, v185
  v_dot2c_f32_bf16 v121, v185, v150
  v_dot2c_f32_bf16 v117, v189, v189
  v_dot2c_f32_bf16 v125, v189, v150
  v_dot2c_f32_bf16 v114, v186, v186
  v_dot2c_f32_bf16 v122, v186, v150
  v_dot2c_f32_bf16 v118, v190, v190
  v_dot2c_f32_bf16 v126, v190, v150
  v_dot2c_f32_bf16 v115, v187, v187
  v_dot2c_f32_bf16 v123, v187, v150
  v_dot2c_f32_bf16 v119, v191, v191
  v_dot2c_f32_bf16 v127, v191, v150
  s_waitcnt vmcnt(13)
  s_barrier
  ds_read_b128 v[184:187], v208 offset:8192
  ds_read_b128 v[188:191], v208 offset:12288
  s_waitcnt lgkmcnt(2)
  v_dot2c_f32_bf16 v112, v192, v192
  v_dot2c_f32_bf16 v120, v192, v150
  v_dot2c_f32_bf16 v116, v196, v196
  v_dot2c_f32_bf16 v124, v196, v150
  v_dot2c_f32_bf16 v113, v193, v193
  v_dot2c_f32_bf16 v121, v193, v150
  v_dot2c_f32_bf16 v117, v197, v197
  v_dot2c_f32_bf16 v125, v197, v150
  v_dot2c_f32_bf16 v114, v194, v194
  v_dot2c_f32_bf16 v122, v194, v150
  v_dot2c_f32_bf16 v118, v198, v198
  v_dot2c_f32_bf16 v126, v198, v150
  v_dot2c_f32_bf16 v115, v195, v195
  v_dot2c_f32_bf16 v123, v195, v150
  v_dot2c_f32_bf16 v119, v199, v199
  v_dot2c_f32_bf16 v127, v199, v150
  ds_read_b128 v[192:195], v209 offset:8192
  ds_read_b128 v[196:199], v209 offset:12288
  s_waitcnt lgkmcnt(2)
  v_dot2c_f32_bf16 v112, v184, v184
  v_dot2c_f32_bf16 v120, v184, v150
  v_dot2c_f32_bf16 v116, v188, v188
  v_dot2c_f32_bf16 v124, v188, v150
  v_dot2c_f32_bf16 v113, v185, v185
  v_dot2c_f32_bf16 v121, v185, v150
  v_dot2c_f32_bf16 v117, v189, v189
  v_dot2c_f32_bf16 v125, v189, v150
  v_dot2c_f32_bf16 v114, v186, v186
  v_dot2c_f32_bf16 v122, v186, v150
  v_dot2c_f32_bf16 v118, v190, v190
  v_dot2c_f32_bf16 v126, v190, v150
  v_dot2c_f32_bf16 v115, v187, v187
  v_dot2c_f32_bf16 v123, v187, v150
  v_dot2c_f32_bf16 v119, v191, v191
  v_dot2c_f32_bf16 v127, v191, v150
  ds_read_b128 v[184:187], v210 offset:8192
  ds_read_b128 v[188:191], v210 offset:12288
  s_waitcnt lgkmcnt(2)
  v_dot2c_f32_bf16 v112, v192, v192
  v_dot2c_f32_bf16 v120, v192, v150
  v_dot2c_f32_bf16 v116, v196, v196
  v_dot2c_f32_bf16 v124, v196, v150
  v_dot2c_f32_bf16 v113, v193, v193
  v_dot2c_f32_bf16 v121, v193, v150
  v_dot2c_f32_bf16 v117, v197, v197
  v_dot2c_f32_bf16 v125, v197, v150
  v_dot2c_f32_bf16 v114, v194, v194
  v_dot2c_f32_bf16 v122, v194, v150
  v_dot2c_f32_bf16 v118, v198, v198
  v_dot2c_f32_bf16 v126, v198, v150
  v_dot2c_f32_bf16 v115, v195, v195
  v_dot2c_f32_bf16 v123, v195, v150
  v_dot2c_f32_bf16 v119, v199, v199
  v_dot2c_f32_bf16 v127, v199, v150
  ds_read_b128 v[192:195], v211 offset:8192
  ds_read_b128 v[196:199], v211 offset:12288
  s_waitcnt lgkmcnt(2)
  v_dot2c_f32_bf16 v112, v184, v184
  v_dot2c_f32_bf16 v120, v184, v150
  v_dot2c_f32_bf16 v116, v188, v188
  v_dot2c_f32_bf16 v124, v188, v150
  v_dot2c_f32_bf16 v113, v185, v185
  v_dot2c_f32_bf16 v121, v185, v150
  v_dot2c_f32_bf16 v117, v189, v189
  v_dot2c_f32_bf16 v125, v189, v150
  v_dot2c_f32_bf16 v114, v186, v186
  v_dot2c_f32_bf16 v122, v186, v150
  v_dot2c_f32_bf16 v118, v190, v190
  v_dot2c_f32_bf16 v126, v190, v150
  v_dot2c_f32_bf16 v115, v187, v187
  v_dot2c_f32_bf16 v123, v187, v150
  v_dot2c_f32_bf16 v119, v191, v191
  v_dot2c_f32_bf16 v127, v191, v150
  s_waitcnt vmcnt(12)
  s_barrier
  ds_read_b128 v[184:187], v208 offset:16384
  ds_read_b128 v[188:191], v208 offset:20480
  s_waitcnt lgkmcnt(2)
  v_dot2c_f32_bf16 v112, v192, v192
  v_dot2c_f32_bf16 v120, v192, v150
  v_dot2c_f32_bf16 v116, v196, v196
  v_dot2c_f32_bf16 v124, v196, v150
  v_dot2c_f32_bf16 v113, v193, v193
  v_dot2c_f32_bf16 v121, v193, v150
  v_dot2c_f32_bf16 v117, v197, v197
  v_dot2c_f32_bf16 v125, v197, v150
  v_dot2c_f32_bf16 v114, v194, v194
  v_dot2c_f32_bf16 v122, v194, v150
  v_dot2c_f32_bf16 v118, v198, v198
  v_dot2c_f32_bf16 v126, v198, v150
  v_dot2c_f32_bf16 v115, v195, v195
  v_dot2c_f32_bf16 v123, v195, v150
  v_dot2c_f32_bf16 v119, v199, v199
  v_dot2c_f32_bf16 v127, v199, v150
  ds_read_b128 v[192:195], v209 offset:16384
  ds_read_b128 v[196:199], v209 offset:20480
  s_waitcnt lgkmcnt(2)
  v_dot2c_f32_bf16 v112, v184, v184
  v_dot2c_f32_bf16 v120, v184, v150
  v_dot2c_f32_bf16 v116, v188, v188
  v_dot2c_f32_bf16 v124, v188, v150
  v_dot2c_f32_bf16 v113, v185, v185
  v_dot2c_f32_bf16 v121, v185, v150
  v_dot2c_f32_bf16 v117, v189, v189
  v_dot2c_f32_bf16 v125, v189, v150
  v_dot2c_f32_bf16 v114, v186, v186
  v_dot2c_f32_bf16 v122, v186, v150
  v_dot2c_f32_bf16 v118, v190, v190
  v_dot2c_f32_bf16 v126, v190, v150
  v_dot2c_f32_bf16 v115, v187, v187
  v_dot2c_f32_bf16 v123, v187, v150
  v_dot2c_f32_bf16 v119, v191, v191
  v_dot2c_f32_bf16 v127, v191, v150
  ds_read_b128 v[184:187], v210 offset:16384
  ds_read_b128 v[188:191], v210 offset:20480
  s_waitcnt lgkmcnt(2)
  v_dot2c_f32_bf16 v112, v192, v192
  v_dot2c_f32_bf16 v120, v192, v150
  v_dot2c_f32_bf16 v116, v196, v196
  v_dot2c_f32_bf16 v124, v196, v150
  v_dot2c_f32_bf16 v113, v193, v193
  v_dot2c_f32_bf16 v121, v193, v150
  v_dot2c_f32_bf16 v117, v197, v197
  v_dot2c_f32_bf16 v125, v197, v150
  v_dot2c_f32_bf16 v114, v194, v194
  v_dot2c_f32_bf16 v122, v194, v150
  v_dot2c_f32_bf16 v118, v198, v198
  v_dot2c_f32_bf16 v126, v198, v150
  v_dot2c_f32_bf16 v115, v195, v195
  v_dot2c_f32_bf16 v123, v195, v150
  v_dot2c_f32_bf16 v119, v199, v199
  v_dot2c_f32_bf16 v127, v199, v150
  ds_read_b128 v[192:195], v211 offset:16384
  ds_read_b128 v[196:199], v211 offset:20480
  s_waitcnt lgkmcnt(2)
  v_dot2c_f32_bf16 v112, v184, v184
  v_dot2c_f32_bf16 v120, v184, v150
  v_dot2c_f32_bf16 v116, v188, v188
  v_dot2c_f32_bf16 v124, v188, v150
  v_dot2c_f32_bf16 v113, v185, v185
  v_dot2c_f32_bf16 v121, v185, v150
  v_dot2c_f32_bf16 v117, v189, v189
  v_dot2c_f32_bf16 v125, v189, v150
  v_dot2c_f32_bf16 v114, v186, v186
  v_dot2c_f32_bf16 v122, v186, v150
  v_dot2c_f32_bf16 v118, v190, v190
  v_dot2c_f32_bf16 v126, v190, v150
  v_dot2c_f32_bf16 v115, v187, v187
  v_dot2c_f32_bf16 v123, v187, v150
  v_dot2c_f32_bf16 v119, v191, v191
  v_dot2c_f32_bf16 v127, v191, v150
  s_waitcnt vmcnt(11)
  s_barrier
  ds_read_b128 v[184:187], v208 offset:24576
  ds_read_b128 v[188:191], v208 offset:28672
  s_waitcnt lgkmcnt(2)
  v_dot2c_f32_bf16 v112, v192, v192
  v_dot2c_f32_bf16 v120, v192, v150
  v_dot2c_f32_bf16 v116, v196, v196
  v_dot2c_f32_bf16 v124, v196, v150
  v_dot2c_f32_bf16 v113, v193, v193
  v_dot2c_f32_bf16 v121, v193, v150
  v_dot2c_f32_bf16 v117, v197, v197
  v_dot2c_f32_bf16 v125, v197, v150
  v_dot2c_f32_bf16 v114, v194, v194
  v_dot2c_f32_bf16 v122, v194, v150
  v_dot2c_f32_bf16 v118, v198, v198
  v_dot2c_f32_bf16 v126, v198, v150
  v_dot2c_f32_bf16 v115, v195, v195
  v_dot2c_f32_bf16 v123, v195, v150
  v_dot2c_f32_bf16 v119, v199, v199
  v_dot2c_f32_bf16 v127, v199, v150
  ds_read_b128 v[192:195], v209 offset:24576
  ds_read_b128 v[196:199], v209 offset:28672
  s_waitcnt lgkmcnt(2)
  v_dot2c_f32_bf16 v112, v184, v184
  v_dot2c_f32_bf16 v120, v184, v150
  v_dot2c_f32_bf16 v116, v188, v188
  v_dot2c_f32_bf16 v124, v188, v150
  v_dot2c_f32_bf16 v113, v185, v185
  v_dot2c_f32_bf16 v121, v185, v150
  v_dot2c_f32_bf16 v117, v189, v189
  v_dot2c_f32_bf16 v125, v189, v150
  v_dot2c_f32_bf16 v114, v186, v186
  v_dot2c_f32_bf16 v122, v186, v150
  v_dot2c_f32_bf16 v118, v190, v190
  v_dot2c_f32_bf16 v126, v190, v150
  v_dot2c_f32_bf16 v115, v187, v187
  v_dot2c_f32_bf16 v123, v187, v150
  v_dot2c_f32_bf16 v119, v191, v191
  v_dot2c_f32_bf16 v127, v191, v150
  ds_read_b128 v[184:187], v210 offset:24576
  ds_read_b128 v[188:191], v210 offset:28672
  s_waitcnt lgkmcnt(2)
  v_dot2c_f32_bf16 v112, v192, v192
  v_dot2c_f32_bf16 v120, v192, v150
  v_dot2c_f32_bf16 v116, v196, v196
  v_dot2c_f32_bf16 v124, v196, v150
  v_dot2c_f32_bf16 v113, v193, v193
  v_dot2c_f32_bf16 v121, v193, v150
  v_dot2c_f32_bf16 v117, v197, v197
  v_dot2c_f32_bf16 v125, v197, v150
  v_dot2c_f32_bf16 v114, v194, v194
  v_dot2c_f32_bf16 v122, v194, v150
  v_dot2c_f32_bf16 v118, v198, v198
  v_dot2c_f32_bf16 v126, v198, v150
  v_dot2c_f32_bf16 v115, v195, v195
  v_dot2c_f32_bf16 v123, v195, v150
  v_dot2c_f32_bf16 v119, v199, v199
  v_dot2c_f32_bf16 v127, v199, v150
  ds_read_b128 v[192:195], v211 offset:24576
  ds_read_b128 v[196:199], v211 offset:28672
  s_waitcnt lgkmcnt(2)
  v_dot2c_f32_bf16 v112, v184, v184
  v_dot2c_f32_bf16 v120, v184, v150
  v_dot2c_f32_bf16 v116, v188, v188
  v_dot2c_f32_bf16 v124, v188, v150
  v_dot2c_f32_bf16 v113, v185, v185
  v_dot2c_f32_bf16 v121, v185, v150
  v_dot2c_f32_bf16 v117, v189, v189
  v_dot2c_f32_bf16 v125, v189, v150
  v_dot2c_f32_bf16 v114, v186, v186
  v_dot2c_f32_bf16 v122, v186, v150
  v_dot2c_f32_bf16 v118, v190, v190
  v_dot2c_f32_bf16 v126, v190, v150
  v_dot2c_f32_bf16 v115, v187, v187
  v_dot2c_f32_bf16 v123, v187, v150
  v_dot2c_f32_bf16 v119, v191, v191
  v_dot2c_f32_bf16 v127, v191, v150
  s_waitcnt vmcnt(10)
  s_barrier
  v_add_u32 v208, 32768, v208
  v_add_u32 v209, 32768, v209
  v_add_u32 v210, 32768, v210
  v_add_u32 v211, 32768, v211
  ds_read_b128 v[184:187], v208 offset:0
  ds_read_b128 v[188:191], v208 offset:4096
  s_waitcnt lgkmcnt(2)
  v_dot2c_f32_bf16 v112, v192, v192
  v_dot2c_f32_bf16 v120, v192, v150
  v_dot2c_f32_bf16 v116, v196, v196
  v_dot2c_f32_bf16 v124, v196, v150
  v_dot2c_f32_bf16 v113, v193, v193
  v_dot2c_f32_bf16 v121, v193, v150
  v_dot2c_f32_bf16 v117, v197, v197
  v_dot2c_f32_bf16 v125, v197, v150
  v_dot2c_f32_bf16 v114, v194, v194
  v_dot2c_f32_bf16 v122, v194, v150
  v_dot2c_f32_bf16 v118, v198, v198
  v_dot2c_f32_bf16 v126, v198, v150
  v_dot2c_f32_bf16 v115, v195, v195
  v_dot2c_f32_bf16 v123, v195, v150
  v_dot2c_f32_bf16 v119, v199, v199
  v_dot2c_f32_bf16 v127, v199, v150
  ds_read_b128 v[192:195], v209 offset:0
  ds_read_b128 v[196:199], v209 offset:4096
  s_waitcnt lgkmcnt(2)
  v_dot2c_f32_bf16 v112, v184, v184
  v_dot2c_f32_bf16 v120, v184, v150
  v_dot2c_f32_bf16 v116, v188, v188
  v_dot2c_f32_bf16 v124, v188, v150
  v_dot2c_f32_bf16 v113, v185, v185
  v_dot2c_f32_bf16 v121, v185, v150
  v_dot2c_f32_bf16 v117, v189, v189
  v_dot2c_f32_bf16 v125, v189, v150
  v_dot2c_f32_bf16 v114, v186, v186
  v_dot2c_f32_bf16 v122, v186, v150
  v_dot2c_f32_bf16 v118, v190, v190
  v_dot2c_f32_bf16 v126, v190, v150
  v_dot2c_f32_bf16 v115, v187, v187
  v_dot2c_f32_bf16 v123, v187, v150
  v_dot2c_f32_bf16 v119, v191, v191
  v_dot2c_f32_bf16 v127, v191, v150
  ds_read_b128 v[184:187], v210 offset:0
  ds_read_b128 v[188:191], v210 offset:4096
  s_waitcnt lgkmcnt(2)
  v_dot2c_f32_bf16 v112, v192, v192
  v_dot2c_f32_bf16 v120, v192, v150
  v_dot2c_f32_bf16 v116, v196, v196
  v_dot2c_f32_bf16 v124, v196, v150
  v_dot2c_f32_bf16 v113, v193, v193
  v_dot2c_f32_bf16 v121, v193, v150
  v_dot2c_f32_bf16 v117, v197, v197
  v_dot2c_f32_bf16 v125, v197, v150
  v_dot2c_f32_bf16 v114, v194, v194
  v_dot2c_f32_bf16 v122, v194, v150
  v_dot2c_f32_bf16 v118, v198, v198
  v_dot2c_f32_bf16 v126, v198, v150
  v_dot2c_f32_bf16 v115, v195, v195
  v_dot2c_f32_bf16 v123, v195, v150
  v_dot2c_f32_bf16 v119, v199, v199
  v_dot2c_f32_bf16 v127, v199, v150
  ds_read_b128 v[192:195], v211 offset:0
  ds_read_b128 v[196:199], v211 offset:4096
  s_waitcnt lgkmcnt(2)
  v_dot2c_f32_bf16 v112, v184, v184
  v_dot2c_f32_bf16 v120, v184, v150
  v_dot2c_f32_bf16 v116, v188, v188
  v_dot2c_f32_bf16 v124, v188, v150
  v_dot2c_f32_bf16 v113, v185, v185
  v_dot2c_f32_bf16 v121, v185, v150
  v_dot2c_f32_bf16 v117, v189, v189
  v_dot2c_f32_bf16 v125, v189, v150
  v_dot2c_f32_bf16 v114, v186, v186
  v_dot2c_f32_bf16 v122, v186, v150
  v_dot2c_f32_bf16 v118, v190, v190
  v_dot2c_f32_bf16 v126, v190, v150
  v_dot2c_f32_bf16 v115, v187, v187
  v_dot2c_f32_bf16 v123, v187, v150
  v_dot2c_f32_bf16 v119, v191, v191
  v_dot2c_f32_bf16 v127, v191, v150
  s_waitcnt vmcnt(9)
  s_barrier
  ds_read_b128 v[184:187], v208 offset:8192
  ds_read_b128 v[188:191], v208 offset:12288
  s_waitcnt lgkmcnt(2)
  v_dot2c_f32_bf16 v112, v192, v192
  v_dot2c_f32_bf16 v120, v192, v150
  v_dot2c_f32_bf16 v116, v196, v196
  v_dot2c_f32_bf16 v124, v196, v150
  v_dot2c_f32_bf16 v113, v193, v193
  v_dot2c_f32_bf16 v121, v193, v150
  v_dot2c_f32_bf16 v117, v197, v197
  v_dot2c_f32_bf16 v125, v197, v150
  v_dot2c_f32_bf16 v114, v194, v194
  v_dot2c_f32_bf16 v122, v194, v150
  v_dot2c_f32_bf16 v118, v198, v198
  v_dot2c_f32_bf16 v126, v198, v150
  v_dot2c_f32_bf16 v115, v195, v195
  v_dot2c_f32_bf16 v123, v195, v150
  v_dot2c_f32_bf16 v119, v199, v199
  v_dot2c_f32_bf16 v127, v199, v150
  ds_read_b128 v[192:195], v209 offset:8192
  ds_read_b128 v[196:199], v209 offset:12288
  s_waitcnt lgkmcnt(2)
  v_dot2c_f32_bf16 v112, v184, v184
  v_dot2c_f32_bf16 v120, v184, v150
  v_dot2c_f32_bf16 v116, v188, v188
  v_dot2c_f32_bf16 v124, v188, v150
  v_dot2c_f32_bf16 v113, v185, v185
  v_dot2c_f32_bf16 v121, v185, v150
  v_dot2c_f32_bf16 v117, v189, v189
  v_dot2c_f32_bf16 v125, v189, v150
  v_dot2c_f32_bf16 v114, v186, v186
  v_dot2c_f32_bf16 v122, v186, v150
  v_dot2c_f32_bf16 v118, v190, v190
  v_dot2c_f32_bf16 v126, v190, v150
  v_dot2c_f32_bf16 v115, v187, v187
  v_dot2c_f32_bf16 v123, v187, v150
  v_dot2c_f32_bf16 v119, v191, v191
  v_dot2c_f32_bf16 v127, v191, v150
  ds_read_b128 v[184:187], v210 offset:8192
  ds_read_b128 v[188:191], v210 offset:12288
  s_waitcnt lgkmcnt(2)
  v_dot2c_f32_bf16 v112, v192, v192
  v_dot2c_f32_bf16 v120, v192, v150
  v_dot2c_f32_bf16 v116, v196, v196
  v_dot2c_f32_bf16 v124, v196, v150
  v_dot2c_f32_bf16 v113, v193, v193
  v_dot2c_f32_bf16 v121, v193, v150
  v_dot2c_f32_bf16 v117, v197, v197
  v_dot2c_f32_bf16 v125, v197, v150
  v_dot2c_f32_bf16 v114, v194, v194
  v_dot2c_f32_bf16 v122, v194, v150
  v_dot2c_f32_bf16 v118, v198, v198
  v_dot2c_f32_bf16 v126, v198, v150
  v_dot2c_f32_bf16 v115, v195, v195
  v_dot2c_f32_bf16 v123, v195, v150
  v_dot2c_f32_bf16 v119, v199, v199
  v_dot2c_f32_bf16 v127, v199, v150
  ds_read_b128 v[192:195], v211 offset:8192
  ds_read_b128 v[196:199], v211 offset:12288
  s_waitcnt lgkmcnt(2)
  v_dot2c_f32_bf16 v112, v184, v184
  v_dot2c_f32_bf16 v120, v184, v150
  v_dot2c_f32_bf16 v116, v188, v188
  v_dot2c_f32_bf16 v124, v188, v150
  v_dot2c_f32_bf16 v113, v185, v185
  v_dot2c_f32_bf16 v121, v185, v150
  v_dot2c_f32_bf16 v117, v189, v189
  v_dot2c_f32_bf16 v125, v189, v150
  v_dot2c_f32_bf16 v114, v186, v186
  v_dot2c_f32_bf16 v122, v186, v150
  v_dot2c_f32_bf16 v118, v190, v190
  v_dot2c_f32_bf16 v126, v190, v150
  v_dot2c_f32_bf16 v115, v187, v187
  v_dot2c_f32_bf16 v123, v187, v150
  v_dot2c_f32_bf16 v119, v191, v191
  v_dot2c_f32_bf16 v127, v191, v150
  s_waitcnt vmcnt(8)
  s_barrier
  ds_read_b128 v[184:187], v208 offset:16384
  ds_read_b128 v[188:191], v208 offset:20480
  s_waitcnt lgkmcnt(2)
  v_dot2c_f32_bf16 v112, v192, v192
  v_dot2c_f32_bf16 v120, v192, v150
  v_dot2c_f32_bf16 v116, v196, v196
  v_dot2c_f32_bf16 v124, v196, v150
  v_dot2c_f32_bf16 v113, v193, v193
  v_dot2c_f32_bf16 v121, v193, v150
  v_dot2c_f32_bf16 v117, v197, v197
  v_dot2c_f32_bf16 v125, v197, v150
  v_dot2c_f32_bf16 v114, v194, v194
  v_dot2c_f32_bf16 v122, v194, v150
  v_dot2c_f32_bf16 v118, v198, v198
  v_dot2c_f32_bf16 v126, v198, v150
  v_dot2c_f32_bf16 v115, v195, v195
  v_dot2c_f32_bf16 v123, v195, v150
  v_dot2c_f32_bf16 v119, v199, v199
  v_dot2c_f32_bf16 v127, v199, v150
  ds_read_b128 v[192:195], v209 offset:16384
  ds_read_b128 v[196:199], v209 offset:20480
  s_waitcnt lgkmcnt(2)
  v_dot2c_f32_bf16 v112, v184, v184
  v_dot2c_f32_bf16 v120, v184, v150
  v_dot2c_f32_bf16 v116, v188, v188
  v_dot2c_f32_bf16 v124, v188, v150
  v_dot2c_f32_bf16 v113, v185, v185
  v_dot2c_f32_bf16 v121, v185, v150
  v_dot2c_f32_bf16 v117, v189, v189
  v_dot2c_f32_bf16 v125, v189, v150
  v_dot2c_f32_bf16 v114, v186, v186
  v_dot2c_f32_bf16 v122, v186, v150
  v_dot2c_f32_bf16 v118, v190, v190
  v_dot2c_f32_bf16 v126, v190, v150
  v_dot2c_f32_bf16 v115, v187, v187
  v_dot2c_f32_bf16 v123, v187, v150
  v_dot2c_f32_bf16 v119, v191, v191
  v_dot2c_f32_bf16 v127, v191, v150
  ds_read_b128 v[184:187], v210 offset:16384
  ds_read_b128 v[188:191], v210 offset:20480
  s_waitcnt lgkmcnt(2)
  v_dot2c_f32_bf16 v112, v192, v192
  v_dot2c_f32_bf16 v120, v192, v150
  v_dot2c_f32_bf16 v116, v196, v196
  v_dot2c_f32_bf16 v124, v196, v150
  v_dot2c_f32_bf16 v113, v193, v193
  v_dot2c_f32_bf16 v121, v193, v150
  v_dot2c_f32_bf16 v117, v197, v197
  v_dot2c_f32_bf16 v125, v197, v150
  v_dot2c_f32_bf16 v114, v194, v194
  v_dot2c_f32_bf16 v122, v194, v150
  v_dot2c_f32_bf16 v118, v198, v198
  v_dot2c_f32_bf16 v126, v198, v150
  v_dot2c_f32_bf16 v115, v195, v195
  v_dot2c_f32_bf16 v123, v195, v150
  v_dot2c_f32_bf16 v119, v199, v199
  v_dot2c_f32_bf16 v127, v199, v150
  ds_read_b128 v[192:195], v211 offset:16384
  ds_read_b128 v[196:199], v211 offset:20480
  s_waitcnt lgkmcnt(2)
  v_dot2c_f32_bf16 v112, v184, v184
  v_dot2c_f32_bf16 v120, v184, v150
  v_dot2c_f32_bf16 v116, v188, v188
  v_dot2c_f32_bf16 v124, v188, v150
  v_dot2c_f32_bf16 v113, v185, v185
  v_dot2c_f32_bf16 v121, v185, v150
  v_dot2c_f32_bf16 v117, v189, v189
  v_dot2c_f32_bf16 v125, v189, v150
  v_dot2c_f32_bf16 v114, v186, v186
  v_dot2c_f32_bf16 v122, v186, v150
  v_dot2c_f32_bf16 v118, v190, v190
  v_dot2c_f32_bf16 v126, v190, v150
  v_dot2c_f32_bf16 v115, v187, v187
  v_dot2c_f32_bf16 v123, v187, v150
  v_dot2c_f32_bf16 v119, v191, v191
  v_dot2c_f32_bf16 v127, v191, v150
  s_waitcnt vmcnt(7)
  s_barrier
  ds_read_b128 v[184:187], v208 offset:24576
  ds_read_b128 v[188:191], v208 offset:28672
  s_waitcnt lgkmcnt(2)
  v_dot2c_f32_bf16 v112, v192, v192
  v_dot2c_f32_bf16 v120, v192, v150
  v_dot2c_f32_bf16 v116, v196, v196
  v_dot2c_f32_bf16 v124, v196, v150
  v_dot2c_f32_bf16 v113, v193, v193
  v_dot2c_f32_bf16 v121, v193, v150
  v_dot2c_f32_bf16 v117, v197, v197
  v_dot2c_f32_bf16 v125, v197, v150
  v_dot2c_f32_bf16 v114, v194, v194
  v_dot2c_f32_bf16 v122, v194, v150
  v_dot2c_f32_bf16 v118, v198, v198
  v_dot2c_f32_bf16 v126, v198, v150
  v_dot2c_f32_bf16 v115, v195, v195
  v_dot2c_f32_bf16 v123, v195, v150
  v_dot2c_f32_bf16 v119, v199, v199
  v_dot2c_f32_bf16 v127, v199, v150
  ds_read_b128 v[192:195], v209 offset:24576
  ds_read_b128 v[196:199], v209 offset:28672
  s_waitcnt lgkmcnt(2)
  v_dot2c_f32_bf16 v112, v184, v184
  v_dot2c_f32_bf16 v120, v184, v150
  v_dot2c_f32_bf16 v116, v188, v188
  v_dot2c_f32_bf16 v124, v188, v150
  v_dot2c_f32_bf16 v113, v185, v185
  v_dot2c_f32_bf16 v121, v185, v150
  v_dot2c_f32_bf16 v117, v189, v189
  v_dot2c_f32_bf16 v125, v189, v150
  v_dot2c_f32_bf16 v114, v186, v186
  v_dot2c_f32_bf16 v122, v186, v150
  v_dot2c_f32_bf16 v118, v190, v190
  v_dot2c_f32_bf16 v126, v190, v150
  v_dot2c_f32_bf16 v115, v187, v187
  v_dot2c_f32_bf16 v123, v187, v150
  v_dot2c_f32_bf16 v119, v191, v191
  v_dot2c_f32_bf16 v127, v191, v150
  ds_read_b128 v[184:187], v210 offset:24576
  ds_read_b128 v[188:191], v210 offset:28672
  s_waitcnt lgkmcnt(2)
  v_dot2c_f32_bf16 v112, v192, v192
  v_dot2c_f32_bf16 v120, v192, v150
  v_dot2c_f32_bf16 v116, v196, v196
  v_dot2c_f32_bf16 v124, v196, v150
  v_dot2c_f32_bf16 v113, v193, v193
  v_dot2c_f32_bf16 v121, v193, v150
  v_dot2c_f32_bf16 v117, v197, v197
  v_dot2c_f32_bf16 v125, v197, v150
  v_dot2c_f32_bf16 v114, v194, v194
  v_dot2c_f32_bf16 v122, v194, v150
  v_dot2c_f32_bf16 v118, v198, v198
  v_dot2c_f32_bf16 v126, v198, v150
  v_dot2c_f32_bf16 v115, v195, v195
  v_dot2c_f32_bf16 v123, v195, v150
  v_dot2c_f32_bf16 v119, v199, v199
  v_dot2c_f32_bf16 v127, v199, v150
  ds_read_b128 v[192:195], v211 offset:24576
  ds_read_b128 v[196:199], v211 offset:28672
  s_waitcnt lgkmcnt(2)
  v_dot2c_f32_bf16 v112, v184, v184
  v_dot2c_f32_bf16 v120, v184, v150
  v_dot2c_f32_bf16 v116, v188, v188
  v_dot2c_f32_bf16 v124, v188, v150
  v_dot2c_f32_bf16 v113, v185, v185
  v_dot2c_f32_bf16 v121, v185, v150
  v_dot2c_f32_bf16 v117, v189, v189
  v_dot2c_f32_bf16 v125, v189, v150
  v_dot2c_f32_bf16 v114, v186, v186
  v_dot2c_f32_bf16 v122, v186, v150
  v_dot2c_f32_bf16 v118, v190, v190
  v_dot2c_f32_bf16 v126, v190, v150
  v_dot2c_f32_bf16 v115, v187, v187
  v_dot2c_f32_bf16 v123, v187, v150
  v_dot2c_f32_bf16 v119, v191, v191
  v_dot2c_f32_bf16 v127, v191, v150
  s_waitcnt vmcnt(6)
  s_barrier
  ds_read_b128 v[184:187], v208 offset:32768
  ds_read_b128 v[188:191], v208 offset:36864
  s_waitcnt lgkmcnt(2)
  v_dot2c_f32_bf16 v112, v192, v192
  v_dot2c_f32_bf16 v120, v192, v150
  v_dot2c_f32_bf16 v116, v196, v196
  v_dot2c_f32_bf16 v124, v196, v150
  v_dot2c_f32_bf16 v113, v193, v193
  v_dot2c_f32_bf16 v121, v193, v150
  v_dot2c_f32_bf16 v117, v197, v197
  v_dot2c_f32_bf16 v125, v197, v150
  v_dot2c_f32_bf16 v114, v194, v194
  v_dot2c_f32_bf16 v122, v194, v150
  v_dot2c_f32_bf16 v118, v198, v198
  v_dot2c_f32_bf16 v126, v198, v150
  v_dot2c_f32_bf16 v115, v195, v195
  v_dot2c_f32_bf16 v123, v195, v150
  v_dot2c_f32_bf16 v119, v199, v199
  v_dot2c_f32_bf16 v127, v199, v150
  ds_read_b128 v[192:195], v209 offset:32768
  ds_read_b128 v[196:199], v209 offset:36864
  s_waitcnt lgkmcnt(2)
  v_dot2c_f32_bf16 v112, v184, v184
  v_dot2c_f32_bf16 v120, v184, v150
  v_dot2c_f32_bf16 v116, v188, v188
  v_dot2c_f32_bf16 v124, v188, v150
  v_dot2c_f32_bf16 v113, v185, v185
  v_dot2c_f32_bf16 v121, v185, v150
  v_dot2c_f32_bf16 v117, v189, v189
  v_dot2c_f32_bf16 v125, v189, v150
  v_dot2c_f32_bf16 v114, v186, v186
  v_dot2c_f32_bf16 v122, v186, v150
  v_dot2c_f32_bf16 v118, v190, v190
  v_dot2c_f32_bf16 v126, v190, v150
  v_dot2c_f32_bf16 v115, v187, v187
  v_dot2c_f32_bf16 v123, v187, v150
  v_dot2c_f32_bf16 v119, v191, v191
  v_dot2c_f32_bf16 v127, v191, v150
  ds_read_b128 v[184:187], v210 offset:32768
  ds_read_b128 v[188:191], v210 offset:36864
  s_waitcnt lgkmcnt(2)
  v_dot2c_f32_bf16 v112, v192, v192
  v_dot2c_f32_bf16 v120, v192, v150
  v_dot2c_f32_bf16 v116, v196, v196
  v_dot2c_f32_bf16 v124, v196, v150
  v_dot2c_f32_bf16 v113, v193, v193
  v_dot2c_f32_bf16 v121, v193, v150
  v_dot2c_f32_bf16 v117, v197, v197
  v_dot2c_f32_bf16 v125, v197, v150
  v_dot2c_f32_bf16 v114, v194, v194
  v_dot2c_f32_bf16 v122, v194, v150
  v_dot2c_f32_bf16 v118, v198, v198
  v_dot2c_f32_bf16 v126, v198, v150
  v_dot2c_f32_bf16 v115, v195, v195
  v_dot2c_f32_bf16 v123, v195, v150
  v_dot2c_f32_bf16 v119, v199, v199
  v_dot2c_f32_bf16 v127, v199, v150
  ds_read_b128 v[192:195], v211 offset:32768
  ds_read_b128 v[196:199], v211 offset:36864
  s_waitcnt lgkmcnt(2)
  v_dot2c_f32_bf16 v112, v184, v184
  v_dot2c_f32_bf16 v120, v184, v150
  v_dot2c_f32_bf16 v116, v188, v188
  v_dot2c_f32_bf16 v124, v188, v150
  v_dot2c_f32_bf16 v113, v185, v185
  v_dot2c_f32_bf16 v121, v185, v150
  v_dot2c_f32_bf16 v117, v189, v189
  v_dot2c_f32_bf16 v125, v189, v150
  v_dot2c_f32_bf16 v114, v186, v186
  v_dot2c_f32_bf16 v122, v186, v150
  v_dot2c_f32_bf16 v118, v190, v190
  v_dot2c_f32_bf16 v126, v190, v150
  v_dot2c_f32_bf16 v115, v187, v187
  v_dot2c_f32_bf16 v123, v187, v150
  v_dot2c_f32_bf16 v119, v191, v191
  v_dot2c_f32_bf16 v127, v191, v150
  s_waitcnt lgkmcnt(0)
  v_dot2c_f32_bf16 v112, v192, v192
  v_dot2c_f32_bf16 v120, v192, v150
  v_dot2c_f32_bf16 v116, v196, v196
  v_dot2c_f32_bf16 v124, v196, v150
  v_dot2c_f32_bf16 v113, v193, v193
  v_dot2c_f32_bf16 v121, v193, v150
  v_dot2c_f32_bf16 v117, v197, v197
  v_dot2c_f32_bf16 v125, v197, v150
  v_dot2c_f32_bf16 v114, v194, v194
  v_dot2c_f32_bf16 v122, v194, v150
  v_dot2c_f32_bf16 v118, v198, v198
  v_dot2c_f32_bf16 v126, v198, v150
  v_dot2c_f32_bf16 v115, v195, v195
  v_dot2c_f32_bf16 v123, v195, v150
  v_dot2c_f32_bf16 v119, v199, v199
  v_dot2c_f32_bf16 v127, v199, v150
  v_add_f32 v112, v112, v113
  v_add_f32 v114, v114, v115
  v_add_f32 v116, v116, v117
  v_add_f32 v118, v118, v119
  v_add_f32 v120, v120, v121
  v_add_f32 v122, v122, v123
  v_add_f32 v124, v124, v125
  v_add_f32 v126, v126, v127
  v_add_f32 v112, v112, v114
    v_mov_b32 v239, v112
    v_mov_b32 v240, v112
  s_nop 1
    v_permlane32_swap_b32 v239, v240
    v_add_f32 v112, v239, v240
  v_add_f32 v116, v116, v118
    v_mov_b32 v239, v116
    v_mov_b32 v240, v116
  s_nop 1
    v_permlane32_swap_b32 v239, v240
    v_add_f32 v116, v239, v240
  v_add_f32 v120, v120, v122
    v_mov_b32 v239, v120
    v_mov_b32 v240, v120
  s_nop 1
    v_permlane32_swap_b32 v239, v240
    v_add_f32 v120, v239, v240
  v_add_f32 v124, v124, v126
    v_mov_b32 v239, v124
    v_mov_b32 v240, v124
  s_nop 1
    v_permlane32_swap_b32 v239, v240
    v_add_f32 v124, v239, v240
  s_mov_b32 s34, 0xbae38e39
  v_mul_f32 v239, v120, v120
  v_fma_f32 v112, v239, s34, v112
  v_mul_f32 v239, v124, v124
  v_fma_f32 v116, v239, s34, v116
    v_cmp_gt_u32 vcc, 32, v238
  s_nop 1
    v_cndmask_b32 v112, v116, v112, vcc
    v_max_f32 v112, 0, v112
    v_lshlrev_b32 v239, 2, v238
    s_lshl_b32 s34, s21, 8
    s_add_u32 s34, s34, 9519104
    buffer_store_dword v112, v239, s[8:11], s34 offen
    s_branch k1_kernel_w7
k1_kernel_help:
        s_mov_b32 m0, s25
        s_add_u32 s25, s25, 8192
        buffer_load_dwordx4 v236, s[12:15], s24 offen lds
        s_add_u32 s24, s24, 128
  s_barrier
        s_mov_b32 m0, s25
        s_add_u32 s25, s25, 8192
        buffer_load_dwordx4 v236, s[12:15], s24 offen lds
        s_add_u32 s24, s24, 128
        s_mov_b32 m0, s25
        s_add_u32 s25, s25, 8192
        buffer_load_dwordx4 v236, s[12:15], s24 offen lds
        s_add_u32 s24, s24, 128
        s_mov_b32 m0, s25
        s_add_u32 s25, s25, 8192
        buffer_load_dwordx4 v236, s[12:15], s24 offen lds
        s_add_u32 s24, s24, 128
        s_mov_b32 m0, s25
        s_add_u32 s25, s25, 8192
        buffer_load_dwordx4 v236, s[12:15], s24 offen lds
        s_add_u32 s24, s24, 128
        s_mov_b32 m0, s25
        s_add_u32 s25, s25, 8192
        buffer_load_dwordx4 v236, s[12:15], s24 offen lds
        s_add_u32 s24, s24, 128
        s_mov_b32 m0, s25
        s_add_u32 s25, s25, 8192
        buffer_load_dwordx4 v236, s[12:15], s24 offen lds
        s_add_u32 s24, s24, 128
        s_mov_b32 m0, s25
        s_add_u32 s25, s25, 8192
        buffer_load_dwordx4 v236, s[12:15], s24 offen lds
        s_add_u32 s24, s24, 128
        s_mov_b32 m0, s25
        s_add_u32 s25, s25, 8192
        buffer_load_dwordx4 v236, s[12:15], s24 offen lds
        s_add_u32 s24, s24, 128
        s_mov_b32 s8, s4
        s_mov_b32 s9, s5
        s_mov_b32 s10, 0x10000000
        s_mov_b32 s11, 0x20000
        v_and_b32 v240, 31, v238
        v_lshrrev_b32 v241, 5, v238
        v_lshrrev_b32 v239, 1, v240
        v_and_b32 v239, 7, v239
        v_lshlrev_b32 v242, 7, v240
            v_add_u32 v208, 0, v241
            v_xor_b32 v208, v208, v239
            v_lshl_add_u32 v208, v208, 4, v242
            v_add_u32 v209, 2, v241
            v_xor_b32 v209, v209, v239
            v_lshl_add_u32 v209, v209, 4, v242
            v_add_u32 v210, 4, v241
            v_xor_b32 v210, v210, v239
            v_lshl_add_u32 v210, v210, 4, v242
            v_add_u32 v211, 6, v241
            v_xor_b32 v211, v211, v239
            v_lshl_add_u32 v211, v211, 4, v242
        v_lshlrev_b32 v148, 4, v238
        s_mov_b32 s16, s50
        s_mov_b32 s17, s51
        s_mov_b32 s18, 663552
        s_mov_b32 s19, 0x20000
        s_mul_i32 s34, s2, 6144
        s_cmp_lt_u32 s2, 108
        s_cbranch_scc1 k1_kernel_pfh
        s_mov_b32 s16, s40
        s_mov_b32 s17, s41
        s_sub_u32 s34, s34, 663552
k1_kernel_pfh:
  buffer_load_dwordx4 v[144:147], v148, s[16:19], s34 offen
  s_add_u32 s34, s34, 1024
  buffer_load_dwordx4 v[144:147], v148, s[16:19], s34 offen
  s_add_u32 s34, s34, 1024
  buffer_load_dwordx4 v[144:147], v148, s[16:19], s34 offen
  s_add_u32 s34, s34, 1024
  buffer_load_dwordx4 v[144:147], v148, s[16:19], s34 offen
  s_add_u32 s34, s34, 1024
  buffer_load_dwordx4 v[144:147], v148, s[16:19], s34 offen
  s_add_u32 s34, s34, 1024
  buffer_load_dwordx4 v[144:147], v148, s[16:19], s34 offen
  s_add_u32 s34, s34, 1024
  s_waitcnt vmcnt(14)
  s_barrier
  s_waitcnt vmcnt(13)
  s_barrier
  s_waitcnt vmcnt(12)
  s_barrier
  s_waitcnt vmcnt(11)
  s_barrier
  s_waitcnt vmcnt(10)
  s_barrier
  s_waitcnt vmcnt(9)
  s_barrier
  s_waitcnt vmcnt(8)
  s_barrier
  s_waitcnt vmcnt(7)
  s_barrier
  s_waitcnt vmcnt(6)
  s_barrier
k1_kernel_w7:
    v_lshlrev_b32 v239, 4, v238
    s_cmp_lt_u32 s2, 8
    s_cbranch_scc0 k1_kernel_noz
    v_mov_b32 v8, 0
    v_mov_b32 v9, 0
    v_mov_b32 v10, 0
    v_mov_b32 v11, 0
    s_lshl_b32 s34, s2, 10
    s_add_u32 s34, s34, 9527296
    buffer_store_dwordx4 v[8:11], v239, s[8:11], s34 offen
k1_kernel_noz:
  s_nop 1
    v_mov_b32 v8, 0
    v_mov_b32 v9, 0
    v_lshlrev_b32 v12, 3, v238
    s_lshl_b32 s34, s2, 9
    s_add_u32 s34, s34, 26214400
    buffer_store_dwordx2 v[8:9], v12, s[8:11], s34 offen sc1
k1_kernel_fin:
  s_waitcnt vmcnt(0)
k1_kernel_end:
  s_endpgm
.p2align 8
.type k2a_kernel,@function
k2a_kernel:
  s_cmp_ge_u32 s2, 249
  s_cbranch_scc1 k2a_kernel_end
  s_load_dwordx2 s[4:5], s[0:1], 80
  s_load_dwordx2 s[44:45], s[0:1], 32
  s_load_dwordx2 s[46:47], s[0:1], 56
  s_cmp_ge_u32 s2, 144
  s_cbranch_scc1 k2a_kernel_extra
    v_lshrrev_b32 v233, 6, v0
    v_and_b32 v237, 63, v0
    v_readfirstlane_b32 s22, v233
    s_mul_i32 s23, s2, 16512
    v_lshlrev_b32 v231, 4, v237
    v_lshlrev_b32 v232, 3, v237
  s_nop 0
    s_and_b32 s20, s22, 3
    s_lshr_b32 s21, s22, 2
    s_lshl_b32 s22, s20, 12
    s_add_u32 s23, s23, s22
    s_add_u32 s24, s23, 2379776
    s_add_u32 s23, s23, 0
    s_lshl_b32 s25, s20, 11
    s_add_u32 s25, s25, 9519104
    s_lshl_b32 s26, s2, 14
    s_lshl_b32 s27, s20, 10
    s_add_u32 s26, s26, s27
    s_lshl_b32 s27, s21, 13
    s_add_u32 s26, s26, s27
    s_add_u32 s26, s26, 9551872
    s_waitcnt lgkmcnt(0)
    s_mov_b32 s8, s4
    s_mov_b32 s9, s5
    s_mov_b32 s10, 0x10000000
    s_mov_b32 s11, 0x20000
    s_lshl_b32 s27, s21, 10
    s_add_u32 s25, s25, s27
    s_lshl_b32 s27, s21, 11
    s_add_u32 s23, s23, s27
  buffer_load_dwordx2 v[20:21], v232, s[8:11], s25 offen offset:0
  buffer_load_dwordx2 v[22:23], v232, s[8:11], s25 offen offset:512
  buffer_load_dwordx4 v[4:7], v231, s[8:11], s23 offen offset:0
  buffer_load_dwordx4 v[8:11], v231, s[8:11], s23 offen offset:1024
    v_and_b32 v233, 15, v237
    v_lshrrev_b32 v234, 4, v237
    v_cvt_f32_u32 v240, v233
    v_cvt_f32_u32 v239, v234
    s_lshl_b32 s28, s20, 4
    v_add_u32 v235, s28, v233
    v_cvt_f32_u32 v238, v235
    v_lshrrev_b32 v235, 1, v233
    v_and_b32 v235, 7, v235
    v_lshlrev_b32 v236, 7, v233
    s_lshl_b32 s29, s21, 13
    v_add_u32 v236, s29, v236
    v_xor_b32 v229, v234, v235
    v_lshl_add_u32 v229, v229, 4, v236
    v_xor_b32 v230, 64, v229
    v_lshrrev_b32 v228, 1, v234
    s_lshl_b32 s29, s20, 1
    v_add_u32 v228, s29, v228
    v_xor_b32 v228, v228, v235
    v_lshl_add_u32 v228, v228, 4, v236
    v_and_b32 v235, 1, v234
    v_lshl_add_u32 v228, v235, 3, v228
    s_lshl_b32 s29, s21, 13
    v_subrev_u32 v246, s29, v228
    s_lshl_b32 s29, s21, 11
    v_add_u32 v246, s29, v246
    s_lshl_b32 s29, s20, 11
    v_lshlrev_b32 v241, 2, v237
    v_add_u32 v241, s29, v241
    v_add_u32 v241, 32768, v241
    v_mul_f32 v233, 0x3c800000, v238
    v_mul_f32 v234, 0x41000000, v239
    v_mul_f32 v234, v234, v233
    v_mul_f32 v235, 0x42000000, v233
    v_add_f32 v235, v235, v234
    v_cos_f32 v242, v233
    v_sin_f32 v243, v233
    v_cos_f32 v148, v234
    v_sin_f32 v149, v234
    v_cos_f32 v164, v235
    v_sin_f32 v165, v235
  v_pk_mul_f32 v[150:151], v[148:149], v[242:243] op_sel:[0,0] op_sel_hi:[1,0]
  v_pk_mul_f32 v[166:167], v[164:165], v[242:243] op_sel:[0,0] op_sel_hi:[1,0]
  v_pk_fma_f32 v[150:151], v[148:149], v[242:243], v[150:151] op_sel:[1,1,0] op_sel_hi:[0,1,1] neg_lo:[1,0,0]
  v_pk_fma_f32 v[166:167], v[164:165], v[242:243], v[166:167] op_sel:[1,1,0] op_sel_hi:[0,1,1] neg_lo:[1,0,0]
  v_pk_mul_f32 v[152:153], v[150:151], v[242:243] op_sel:[0,0] op_sel_hi:[1,0]
  v_pk_mul_f32 v[168:169], v[166:167], v[242:243] op_sel:[0,0] op_sel_hi:[1,0]
  v_pk_fma_f32 v[152:153], v[150:151], v[242:243], v[152:153] op_sel:[1,1,0] op_sel_hi:[0,1,1] neg_lo:[1,0,0]
  v_pk_fma_f32 v[168:169], v[166:167], v[242:243], v[168:169] op_sel:[1,1,0] op_sel_hi:[0,1,1] neg_lo:[1,0,0]
  v_pk_mul_f32 v[154:155], v[152:153], v[242:243] op_sel:[0,0] op_sel_hi:[1,0]
  v_pk_mul_f32 v[170:171], v[168:169], v[242:243] op_sel:[0,0] op_sel_hi:[1,0]
  v_pk_fma_f32 v[154:155], v[152:153], v[242:243], v[154:155] op_sel:[1,1,0] op_sel_hi:[0,1,1] neg_lo:[1,0,0]
  v_pk_fma_f32 v[170:171], v[168:169], v[242:243], v[170:171] op_sel:[1,1,0] op_sel_hi:[0,1,1] neg_lo:[1,0,0]
  v_pk_mul_f32 v[156:157], v[154:155], v[242:243] op_sel:[0,0] op_sel_hi:[1,0]
  v_pk_mul_f32 v[172:173], v[170:171], v[242:243] op_sel:[0,0] op_sel_hi:[1,0]
  v_pk_fma_f32 v[156:157], v[154:155], v[242:243], v[156:157] op_sel:[1,1,0] op_sel_hi:[0,1,1] neg_lo:[1,0,0]
  v_pk_fma_f32 v[172:173], v[170:171], v[242:243], v[172:173] op_sel:[1,1,0] op_sel_hi:[0,1,1] neg_lo:[1,0,0]
  v_pk_mul_f32 v[158:159], v[156:157], v[242:243] op_sel:[0,0] op_sel_hi:[1,0]
  v_pk_mul_f32 v[174:175], v[172:173], v[242:243] op_sel:[0,0] op_sel_hi:[1,0]
  v_pk_fma_f32 v[158:159], v[156:157], v[242:243], v[158:159] op_sel:[1,1,0] op_sel_hi:[0,1,1] neg_lo:[1,0,0]
  v_pk_fma_f32 v[174:175], v[172:173], v[242:243], v[174:175] op_sel:[1,1,0] op_sel_hi:[0,1,1] neg_lo:[1,0,0]
  v_pk_mul_f32 v[160:161], v[158:159], v[242:243] op_sel:[0,0] op_sel_hi:[1,0]
  v_pk_mul_f32 v[176:177], v[174:175], v[242:243] op_sel:[0,0] op_sel_hi:[1,0]
  v_pk_fma_f32 v[160:161], v[158:159], v[242:243], v[160:161] op_sel:[1,1,0] op_sel_hi:[0,1,1] neg_lo:[1,0,0]
  v_pk_fma_f32 v[176:177], v[174:175], v[242:243], v[176:177] op_sel:[1,1,0] op_sel_hi:[0,1,1] neg_lo:[1,0,0]
  v_pk_mul_f32 v[162:163], v[160:161], v[242:243] op_sel:[0,0] op_sel_hi:[1,0]
  v_pk_mul_f32 v[178:179], v[176:177], v[242:243] op_sel:[0,0] op_sel_hi:[1,0]
  v_pk_fma_f32 v[162:163], v[160:161], v[242:243], v[162:163] op_sel:[1,1,0] op_sel_hi:[0,1,1] neg_lo:[1,0,0]
  v_pk_fma_f32 v[178:179], v[176:177], v[242:243], v[178:179] op_sel:[1,1,0] op_sel_hi:[0,1,1] neg_lo:[1,0,0]
  v_cvt_pk_bf16_f32 v36, v148, v150
  v_cvt_pk_bf16_f32 v44, v149, v151
  v_cvt_pk_bf16_f32 v37, v152, v154
  v_cvt_pk_bf16_f32 v45, v153, v155
  v_cvt_pk_bf16_f32 v38, v156, v158
  v_cvt_pk_bf16_f32 v46, v157, v159
  v_cvt_pk_bf16_f32 v39, v160, v162
  v_cvt_pk_bf16_f32 v47, v161, v163
  v_cvt_pk_bf16_f32 v40, v164, v166
  v_cvt_pk_bf16_f32 v48, v165, v167
  v_cvt_pk_bf16_f32 v41, v168, v170
  v_cvt_pk_bf16_f32 v49, v169, v171
  v_cvt_pk_bf16_f32 v42, v172, v174
  v_cvt_pk_bf16_f32 v50, v173, v175
  v_cvt_pk_bf16_f32 v43, v176, v178
  v_cvt_pk_bf16_f32 v51, v177, v179
  v_xor_b32 v52, 0x80008000, v44
  v_xor_b32 v53, 0x80008000, v45
  v_xor_b32 v54, 0x80008000, v46
  v_xor_b32 v55, 0x80008000, v47
  v_xor_b32 v56, 0x80008000, v48
  v_xor_b32 v57, 0x80008000, v49
  v_xor_b32 v58, 0x80008000, v50
  v_xor_b32 v59, 0x80008000, v51
    v_mul_f32 v233, 0x3a000000, v238
    v_mul_f32 v234, 4.0, v239
    v_mul_f32 v234, v234, v233
    v_mul_f32 v235, 0x41800000, v233
    v_add_f32 v235, v235, v234
  v_cos_f32 v84, v234
  v_sin_f32 v92, v234
  v_add_f32 v234, v234, v233
  v_cos_f32 v88, v235
  v_sin_f32 v96, v235
  v_add_f32 v235, v235, v233
  v_cos_f32 v85, v234
  v_sin_f32 v93, v234
  v_add_f32 v234, v234, v233
  v_cos_f32 v89, v235
  v_sin_f32 v97, v235
  v_add_f32 v235, v235, v233
  v_cos_f32 v86, v234
  v_sin_f32 v94, v234
  v_add_f32 v234, v234, v233
  v_cos_f32 v90, v235
  v_sin_f32 v98, v235
  v_add_f32 v235, v235, v233
  v_cos_f32 v87, v234
  v_sin_f32 v95, v234
  v_cos_f32 v91, v235
  v_sin_f32 v99, v235
  buffer_load_dwordx4 v[28:31], v231, s[8:11], s26 offen
  s_add_u32 s27, s26, 4096
  buffer_load_dwordx4 v[32:35], v231, s[8:11], s27 offen
  s_mov_b32 s29, 0x3ae38e39
  v_mov_b32 v233, 0x3727c5ac
  s_waitcnt vmcnt(4)
  v_fma_f32 v20, v20, s29, v233
  v_fma_f32 v21, v21, s29, v233
  v_fma_f32 v22, v22, s29, v233
  v_fma_f32 v23, v23, s29, v233
  v_rsq_f32 v20, v20
  v_rsq_f32 v21, v21
  v_rsq_f32 v22, v22
  v_rsq_f32 v23, v23
  s_waitcnt vmcnt(2)
  v_lshlrev_b32 v116, 16, v4
  v_and_b32 v120, 0xffff0000, v4
  v_lshlrev_b32 v117, 16, v6
  v_and_b32 v121, 0xffff0000, v6
  v_lshlrev_b32 v118, 16, v8
  v_and_b32 v122, 0xffff0000, v8
  v_lshlrev_b32 v119, 16, v10
  v_and_b32 v123, 0xffff0000, v10
  v_lshlrev_b32 v124, 16, v5
  v_and_b32 v128, 0xffff0000, v5
  v_lshlrev_b32 v125, 16, v7
  v_and_b32 v129, 0xffff0000, v7
  v_lshlrev_b32 v126, 16, v9
  v_and_b32 v130, 0xffff0000, v9
  v_lshlrev_b32 v127, 16, v11
  v_and_b32 v131, 0xffff0000, v11
  s_cmp_eq_u32 s21, 0
  s_cbranch_scc0 k2a_kernel_rb
  v_mov_b32 v132, v116
  v_mov_b32 v133, v117
  v_mov_b32 v134, v118
  v_mov_b32 v135, v119
  v_mov_b32 v136, v120
  v_mov_b32 v137, v121
  v_mov_b32 v138, v122
  v_mov_b32 v139, v123
  ds_write_b32 v241, v5 offset:0
  ds_write_b32 v241, v7 offset:256
  ds_write_b32 v241, v9 offset:512
  ds_write_b32 v241, v11 offset:768
  s_branch k2a_kernel_rd
k2a_kernel_rb:
  v_mov_b32 v140, v124
  v_mov_b32 v141, v125
  v_mov_b32 v142, v126
  v_mov_b32 v143, v127
  v_mov_b32 v144, v128
  v_mov_b32 v145, v129
  v_mov_b32 v146, v130
  v_mov_b32 v147, v131
  ds_write_b32 v241, v4 offset:1024
  ds_write_b32 v241, v6 offset:1280
  ds_write_b32 v241, v8 offset:1536
  ds_write_b32 v241, v10 offset:1792
k2a_kernel_rd:
  v_pk_mul_f32 v[116:117], v[116:117], v[20:21]
  v_pk_mul_f32 v[118:119], v[118:119], v[22:23]
  v_pk_mul_f32 v[120:121], v[120:121], v[20:21]
  v_pk_mul_f32 v[122:123], v[122:123], v[22:23]
  v_pk_mul_f32 v[124:125], v[124:125], v[20:21]
  v_pk_mul_f32 v[126:127], v[126:127], v[22:23]
  v_pk_mul_f32 v[128:129], v[128:129], v[20:21]
  v_pk_mul_f32 v[130:131], v[130:131], v[22:23]
  s_cmp_lg_u32 s2, 0
  s_cbranch_scc1 k2a_kernel_n0
  v_mov_b32 v116, v120
  v_mov_b32 v120, 0
  v_mov_b32 v117, v121
  v_mov_b32 v121, 0
  v_mov_b32 v118, v122
  v_mov_b32 v122, 0
  v_mov_b32 v119, v123
  v_mov_b32 v123, 0
k2a_kernel_n0:
  s_or_b32 s33, s2, s21
  v_cvt_pk_bf16_f32 v180, v116, v117
  v_cvt_pk_bf16_f32 v181, v118, v119
  ds_write_b64 v246, v[180:181] offset:0
  v_cvt_pk_bf16_f32 v182, v120, v121
  v_cvt_pk_bf16_f32 v183, v122, v123
  ds_write_b64 v246, v[182:183] offset:4096
  v_cvt_pk_bf16_f32 v184, v124, v125
  v_cvt_pk_bf16_f32 v185, v126, v127
  ds_write_b64 v246, v[184:185] offset:8192
  v_cvt_pk_bf16_f32 v186, v128, v129
  v_cvt_pk_bf16_f32 v187, v130, v131
  ds_write_b64 v246, v[186:187] offset:12288
            v_add_f32 v233, 0x0, v240
            v_mul_f32 v233, 0x3d000000, v233
            v_mul_f32 v234, 4.0, v239
            v_mul_f32 v234, v234, v233
            v_mul_f32 v235, 0x41800000, v233
            v_add_f32 v235, v235, v234
            v_cos_f32 v242, v233
            v_sin_f32 v243, v233
            v_cos_f32 v148, v234
            v_sin_f32 v149, v234
            v_cos_f32 v156, v235
            v_sin_f32 v157, v235
  v_pk_mul_f32 v[150:151], v[148:149], v[242:243] op_sel:[0,0] op_sel_hi:[1,0]
  v_pk_mul_f32 v[158:159], v[156:157], v[242:243] op_sel:[0,0] op_sel_hi:[1,0]
  v_pk_fma_f32 v[150:151], v[148:149], v[242:243], v[150:151] op_sel:[1,1,0] op_sel_hi:[0,1,1] neg_lo:[1,0,0]
  v_pk_fma_f32 v[158:159], v[156:157], v[242:243], v[158:159] op_sel:[1,1,0] op_sel_hi:[0,1,1] neg_lo:[1,0,0]
  v_pk_mul_f32 v[152:153], v[150:151], v[242:243] op_sel:[0,0] op_sel_hi:[1,0]
  v_pk_mul_f32 v[160:161], v[158:159], v[242:243] op_sel:[0,0] op_sel_hi:[1,0]
  v_pk_fma_f32 v[152:153], v[150:151], v[242:243], v[152:153] op_sel:[1,1,0] op_sel_hi:[0,1,1] neg_lo:[1,0,0]
  v_pk_fma_f32 v[160:161], v[158:159], v[242:243], v[160:161] op_sel:[1,1,0] op_sel_hi:[0,1,1] neg_lo:[1,0,0]
  v_pk_mul_f32 v[154:155], v[152:153], v[242:243] op_sel:[0,0] op_sel_hi:[1,0]
  v_pk_mul_f32 v[162:163], v[160:161], v[242:243] op_sel:[0,0] op_sel_hi:[1,0]
  v_pk_fma_f32 v[154:155], v[152:153], v[242:243], v[154:155] op_sel:[1,1,0] op_sel_hi:[0,1,1] neg_lo:[1,0,0]
  v_pk_fma_f32 v[162:163], v[160:161], v[242:243], v[162:163] op_sel:[1,1,0] op_sel_hi:[0,1,1] neg_lo:[1,0,0]
            v_add_f32 v233, 0x41800000, v240
            v_mul_f32 v233, 0x3d000000, v233
            v_mul_f32 v234, 4.0, v239
            v_mul_f32 v234, v234, v233
            v_mul_f32 v235, 0x41800000, v233
            v_add_f32 v235, v235, v234
            v_cos_f32 v244, v233
            v_sin_f32 v245, v233
            v_cos_f32 v164, v234
            v_sin_f32 v165, v234
            v_cos_f32 v172, v235
            v_sin_f32 v173, v235
  v_pk_mul_f32 v[166:167], v[164:165], v[244:245] op_sel:[0,0] op_sel_hi:[1,0]
  v_pk_mul_f32 v[174:175], v[172:173], v[244:245] op_sel:[0,0] op_sel_hi:[1,0]
  v_pk_fma_f32 v[166:167], v[164:165], v[244:245], v[166:167] op_sel:[1,1,0] op_sel_hi:[0,1,1] neg_lo:[1,0,0]
  v_pk_fma_f32 v[174:175], v[172:173], v[244:245], v[174:175] op_sel:[1,1,0] op_sel_hi:[0,1,1] neg_lo:[1,0,0]
  v_pk_mul_f32 v[168:169], v[166:167], v[244:245] op_sel:[0,0] op_sel_hi:[1,0]
  v_pk_mul_f32 v[176:177], v[174:175], v[244:245] op_sel:[0,0] op_sel_hi:[1,0]
  v_pk_fma_f32 v[168:169], v[166:167], v[244:245], v[168:169] op_sel:[1,1,0] op_sel_hi:[0,1,1] neg_lo:[1,0,0]
  v_pk_fma_f32 v[176:177], v[174:175], v[244:245], v[176:177] op_sel:[1,1,0] op_sel_hi:[0,1,1] neg_lo:[1,0,0]
  v_pk_mul_f32 v[170:171], v[168:169], v[244:245] op_sel:[0,0] op_sel_hi:[1,0]
  v_pk_mul_f32 v[178:179], v[176:177], v[244:245] op_sel:[0,0] op_sel_hi:[1,0]
  v_pk_fma_f32 v[170:171], v[168:169], v[244:245], v[170:171] op_sel:[1,1,0] op_sel_hi:[0,1,1] neg_lo:[1,0,0]
  v_pk_fma_f32 v[178:179], v[176:177], v[244:245], v[178:179] op_sel:[1,1,0] op_sel_hi:[0,1,1] neg_lo:[1,0,0]
  v_cvt_pk_bf16_f32 v60, v148, v150
  v_cvt_pk_bf16_f32 v68, v149, v151
  v_cvt_pk_bf16_f32 v61, v152, v154
  v_cvt_pk_bf16_f32 v69, v153, v155
  v_cvt_pk_bf16_f32 v62, v156, v158
  v_cvt_pk_bf16_f32 v70, v157, v159
  v_cvt_pk_bf16_f32 v63, v160, v162
  v_cvt_pk_bf16_f32 v71, v161, v163
  v_cvt_pk_bf16_f32 v64, v164, v166
  v_cvt_pk_bf16_f32 v72, v165, v167
  v_cvt_pk_bf16_f32 v65, v168, v170
  v_cvt_pk_bf16_f32 v73, v169, v171
  v_cvt_pk_bf16_f32 v66, v172, v174
  v_cvt_pk_bf16_f32 v74, v173, v175
  v_cvt_pk_bf16_f32 v67, v176, v178
  v_cvt_pk_bf16_f32 v75, v177, v179
  v_xor_b32 v76, 0x80008000, v68
  v_xor_b32 v77, 0x80008000, v69
  v_xor_b32 v78, 0x80008000, v70
  v_xor_b32 v79, 0x80008000, v71
  v_xor_b32 v80, 0x80008000, v72
  v_xor_b32 v81, 0x80008000, v73
  v_xor_b32 v82, 0x80008000, v74
  v_xor_b32 v83, 0x80008000, v75
  s_waitcnt lgkmcnt(0)
  s_barrier
  ds_read_b128 v[148:151], v229 offset:0
  ds_read_b128 v[152:155], v229 offset:4096
  ds_read_b128 v[156:159], v230 offset:0
  ds_read_b128 v[160:163], v230 offset:4096
  ds_read_b128 v[164:167], v229 offset:2048
  ds_read_b128 v[168:171], v229 offset:6144
  ds_read_b128 v[172:175], v230 offset:2048
  ds_read_b128 v[176:179], v230 offset:6144
  s_cmp_eq_u32 s21, 0
  s_cbranch_scc0 k2a_kernel_xr1
  ds_read_b32 v220, v241 offset:1024
  ds_read_b32 v221, v241 offset:1280
  ds_read_b32 v222, v241 offset:1536
  ds_read_b32 v223, v241 offset:1792
  s_branch k2a_kernel_xr2
k2a_kernel_xr1:
  ds_read_b32 v220, v241 offset:0
  ds_read_b32 v221, v241 offset:256
  ds_read_b32 v222, v241 offset:512
  ds_read_b32 v223, v241 offset:768
k2a_kernel_xr2:
  s_mov_b32 s30, 0x3a000000
  s_mov_b32 s31, 0x3a000000
  v_cvt_f32_u32 v236, s28
  v_fma_f32 v236, v239, 4.0, v236
  v_add_f32 v233, 0x0, v240
  v_mul_f32 v233, 0x3a000000, v233
  v_mul_f32 v234, v233, v236
  v_add_f32 v232, 0x41800000, v240
  v_mul_f32 v232, 0x3a000000, v232
  v_mul_f32 v235, v232, v236
  v_cos_f32 v100, v234
  v_sin_f32 v108, v234
  v_add_f32 v234, v234, v233
  v_cos_f32 v104, v235
  s_waitcnt lgkmcnt(0)
  v_mfma_f32_16x16x32_bf16 v[116:119], v[148:151], v[36:39], 0
  v_sin_f32 v112, v235
  v_add_f32 v235, v235, v232
  v_mfma_f32_16x16x32_bf16 v[120:123], v[152:155], v[36:39], 0
  v_cos_f32 v101, v234
  v_sin_f32 v109, v234
  v_mfma_f32_16x16x32_bf16 v[116:119], v[152:155], v[44:47], v[116:119]
  v_add_f32 v234, v234, v233
  v_cos_f32 v105, v235
  v_mfma_f32_16x16x32_bf16 v[120:123], v[148:151], v[52:55], v[120:123]
  v_sin_f32 v113, v235
  v_add_f32 v235, v235, v232
  v_mfma_f32_16x16x32_bf16 v[116:119], v[156:159], v[40:43], v[116:119]
  v_cos_f32 v102, v234
  v_sin_f32 v110, v234
  v_mfma_f32_16x16x32_bf16 v[120:123], v[160:163], v[40:43], v[120:123]
  v_add_f32 v234, v234, v233
  v_cos_f32 v106, v235
  v_mfma_f32_16x16x32_bf16 v[116:119], v[160:163], v[48:51], v[116:119]
  v_sin_f32 v114, v235
  v_add_f32 v235, v235, v232
  v_mfma_f32_16x16x32_bf16 v[120:123], v[156:159], v[56:59], v[120:123]
  v_cos_f32 v103, v234
  v_sin_f32 v111, v234
  v_cos_f32 v107, v235
  v_mfma_f32_16x16x32_bf16 v[124:127], v[164:167], v[36:39], 0
  v_sin_f32 v115, v235
  v_mul_f32 v100, s30, v100
  v_mfma_f32_16x16x32_bf16 v[128:131], v[168:171], v[36:39], 0
  v_mul_f32 v108, s30, v108
  v_mul_f32 v101, s30, v101
  v_mfma_f32_16x16x32_bf16 v[124:127], v[168:171], v[44:47], v[124:127]
  v_mul_f32 v109, s30, v109
  v_mul_f32 v102, s30, v102
  v_mfma_f32_16x16x32_bf16 v[128:131], v[164:167], v[52:55], v[128:131]
  v_mul_f32 v110, s30, v110
  v_mul_f32 v103, s30, v103
  v_mfma_f32_16x16x32_bf16 v[124:127], v[172:175], v[40:43], v[124:127]
  v_mul_f32 v111, s30, v111
  v_mul_f32 v104, s30, v104
  v_mfma_f32_16x16x32_bf16 v[128:131], v[176:179], v[40:43], v[128:131]
  v_mul_f32 v112, s30, v112
  v_mul_f32 v105, s30, v105
  v_mfma_f32_16x16x32_bf16 v[124:127], v[176:179], v[48:51], v[124:127]
  v_mul_f32 v113, s30, v113
  v_mul_f32 v106, s30, v106
  v_mfma_f32_16x16x32_bf16 v[128:131], v[172:175], v[56:59], v[128:131]
  v_mul_f32 v114, s30, v114
  v_mul_f32 v107, s30, v107
  v_mul_f32 v115, s30, v115
  s_cmp_eq_u32 s21, 0
  s_cbranch_scc0 k2a_kernel_xu1
  v_lshlrev_b32 v140, 16, v220
  v_and_b32 v144, 0xffff0000, v220
  v_lshlrev_b32 v141, 16, v221
  v_and_b32 v145, 0xffff0000, v221
  v_lshlrev_b32 v142, 16, v222
  v_and_b32 v146, 0xffff0000, v222
  v_lshlrev_b32 v143, 16, v223
  v_and_b32 v147, 0xffff0000, v223
  s_branch k2a_kernel_xu2
k2a_kernel_xu1:
  v_lshlrev_b32 v132, 16, v220
  v_and_b32 v136, 0xffff0000, v220
  v_lshlrev_b32 v133, 16, v221
  v_and_b32 v137, 0xffff0000, v221
  v_lshlrev_b32 v134, 16, v222
  v_and_b32 v138, 0xffff0000, v222
  v_lshlrev_b32 v135, 16, v223
  v_and_b32 v139, 0xffff0000, v223
k2a_kernel_xu2:
  v_pk_mul_f32 v[180:181], v[116:117], v[84:85]
  v_pk_mul_f32 v[182:183], v[120:121], v[84:85]
  v_pk_mul_f32 v[184:185], v[118:119], v[86:87]
  v_pk_mul_f32 v[186:187], v[122:123], v[86:87]
  v_pk_mul_f32 v[188:189], v[124:125], v[88:89]
  v_pk_mul_f32 v[190:191], v[128:129], v[88:89]
  v_pk_mul_f32 v[192:193], v[126:127], v[90:91]
  v_pk_mul_f32 v[194:195], v[130:131], v[90:91]
  v_pk_fma_f32 v[180:181], v[120:121], v[92:93], v[180:181]
  v_pk_fma_f32 v[182:183], v[116:117], v[92:93], v[182:183] neg_lo:[0,1,0] neg_hi:[0,1,0]
  v_pk_fma_f32 v[184:185], v[122:123], v[94:95], v[184:185]
  v_pk_fma_f32 v[186:187], v[118:119], v[94:95], v[186:187] neg_lo:[0,1,0] neg_hi:[0,1,0]
  v_pk_fma_f32 v[188:189], v[128:129], v[96:97], v[188:189]
  v_pk_fma_f32 v[190:191], v[124:125], v[96:97], v[190:191] neg_lo:[0,1,0] neg_hi:[0,1,0]
  v_pk_fma_f32 v[192:193], v[130:131], v[98:99], v[192:193]
  v_pk_fma_f32 v[194:195], v[126:127], v[98:99], v[194:195] neg_lo:[0,1,0] neg_hi:[0,1,0]
  v_cvt_pk_bf16_f32 v196, v180, v181
  v_cvt_pk_bf16_f32 v200, v182, v183
  v_cvt_pk_bf16_f32 v197, v184, v185
  v_cvt_pk_bf16_f32 v201, v186, v187
  v_cvt_pk_bf16_f32 v198, v188, v189
  v_cvt_pk_bf16_f32 v202, v190, v191
  v_cvt_pk_bf16_f32 v199, v192, v193
  v_cvt_pk_bf16_f32 v203, v194, v195
  s_waitcnt vmcnt(0)
  v_mfma_f32_16x16x32_bf16 v[116:119], v[60:63], v[196:199], 0
  v_lshlrev_b32 v204, 16, v28
  v_and_b32 v212, 0xffff0000, v28
  v_mfma_f32_16x16x32_bf16 v[120:123], v[60:63], v[200:203], 0
  v_lshlrev_b32 v205, 16, v29
  v_and_b32 v213, 0xffff0000, v29
  v_mfma_f32_16x16x32_bf16 v[116:119], v[68:71], v[200:203], v[116:119]
  v_lshlrev_b32 v206, 16, v30
  v_and_b32 v214, 0xffff0000, v30
  v_mfma_f32_16x16x32_bf16 v[120:123], v[76:79], v[196:199], v[120:123]
  v_lshlrev_b32 v207, 16, v31
  v_and_b32 v215, 0xffff0000, v31
  v_mfma_f32_16x16x32_bf16 v[124:127], v[64:67], v[196:199], 0
  v_lshlrev_b32 v208, 16, v32
  v_and_b32 v216, 0xffff0000, v32
  v_mfma_f32_16x16x32_bf16 v[128:131], v[64:67], v[200:203], 0
  v_lshlrev_b32 v209, 16, v33
  v_and_b32 v217, 0xffff0000, v33
  v_mfma_f32_16x16x32_bf16 v[124:127], v[72:75], v[200:203], v[124:127]
  v_lshlrev_b32 v210, 16, v34
  v_and_b32 v218, 0xffff0000, v34
  v_mfma_f32_16x16x32_bf16 v[128:131], v[80:83], v[196:199], v[128:131]
  v_lshlrev_b32 v211, 16, v35
  v_and_b32 v219, 0xffff0000, v35
  v_pk_mul_f32 v[180:181], v[116:117], v[204:205]
  v_pk_mul_f32 v[182:183], v[120:121], v[204:205]
  v_pk_mul_f32 v[184:185], v[118:119], v[206:207]
  v_pk_mul_f32 v[186:187], v[122:123], v[206:207]
  v_pk_mul_f32 v[188:189], v[124:125], v[208:209]
  s_nop 0
  v_pk_mul_f32 v[190:191], v[128:129], v[208:209]
  v_pk_mul_f32 v[192:193], v[126:127], v[210:211]
  v_pk_mul_f32 v[194:195], v[130:131], v[210:211]
  v_pk_fma_f32 v[180:181], v[120:121], v[212:213], v[180:181] neg_lo:[0,1,0] neg_hi:[0,1,0]
  v_pk_fma_f32 v[182:183], v[116:117], v[212:213], v[182:183]
  v_pk_fma_f32 v[184:185], v[122:123], v[214:215], v[184:185] neg_lo:[0,1,0] neg_hi:[0,1,0]
  v_pk_fma_f32 v[186:187], v[118:119], v[214:215], v[186:187]
  v_pk_fma_f32 v[188:189], v[128:129], v[216:217], v[188:189] neg_lo:[0,1,0] neg_hi:[0,1,0]
  v_pk_fma_f32 v[190:191], v[124:125], v[216:217], v[190:191]
  v_pk_fma_f32 v[192:193], v[130:131], v[218:219], v[192:193] neg_lo:[0,1,0] neg_hi:[0,1,0]
  v_pk_fma_f32 v[194:195], v[126:127], v[218:219], v[194:195]
  v_cvt_pk_bf16_f32 v196, v180, v181
  v_cvt_pk_bf16_f32 v200, v182, v183
  v_cvt_pk_bf16_f32 v197, v184, v185
  v_cvt_pk_bf16_f32 v201, v186, v187
  v_cvt_pk_bf16_f32 v198, v188, v189
  v_cvt_pk_bf16_f32 v202, v190, v191
  v_cvt_pk_bf16_f32 v199, v192, v193
  v_cvt_pk_bf16_f32 v203, v194, v195
  s_nop 0
  v_mfma_f32_16x16x32_bf16 v[116:119], v[196:199], v[60:63], 0
  v_mfma_f32_16x16x32_bf16 v[120:123], v[200:203], v[60:63], 0
  v_mfma_f32_16x16x32_bf16 v[116:119], v[200:203], v[76:79], v[116:119]
  v_mfma_f32_16x16x32_bf16 v[120:123], v[196:199], v[68:71], v[120:123]
  v_mfma_f32_16x16x32_bf16 v[124:127], v[196:199], v[64:67], 0
  v_mfma_f32_16x16x32_bf16 v[128:131], v[200:203], v[64:67], 0
  v_mfma_f32_16x16x32_bf16 v[124:127], v[200:203], v[80:83], v[124:127]
  v_mfma_f32_16x16x32_bf16 v[128:131], v[196:199], v[72:75], v[128:131]
  s_nop 2
  v_pk_mul_f32 v[180:181], v[116:117], v[100:101]
  v_pk_mul_f32 v[182:183], v[120:121], v[100:101]
  v_pk_mul_f32 v[184:185], v[118:119], v[102:103]
  v_pk_mul_f32 v[186:187], v[122:123], v[102:103]
  v_pk_mul_f32 v[188:189], v[124:125], v[104:105]
  v_pk_mul_f32 v[190:191], v[128:129], v[104:105]
  v_pk_mul_f32 v[192:193], v[126:127], v[106:107]
  v_pk_mul_f32 v[194:195], v[130:131], v[106:107]
  v_pk_fma_f32 v[180:181], v[120:121], v[108:109], v[180:181] neg_lo:[0,1,0] neg_hi:[0,1,0]
  v_pk_fma_f32 v[182:183], v[116:117], v[108:109], v[182:183]
  v_pk_fma_f32 v[184:185], v[122:123], v[110:111], v[184:185] neg_lo:[0,1,0] neg_hi:[0,1,0]
  v_pk_fma_f32 v[186:187], v[118:119], v[110:111], v[186:187]
  v_pk_fma_f32 v[188:189], v[128:129], v[112:113], v[188:189] neg_lo:[0,1,0] neg_hi:[0,1,0]
  v_pk_fma_f32 v[190:191], v[124:125], v[112:113], v[190:191]
  v_pk_fma_f32 v[192:193], v[130:131], v[114:115], v[192:193] neg_lo:[0,1,0] neg_hi:[0,1,0]
  v_pk_fma_f32 v[194:195], v[126:127], v[114:115], v[194:195]
  v_cvt_pk_bf16_f32 v196, v180, v181
  v_cvt_pk_bf16_f32 v200, v182, v183
  v_cvt_pk_bf16_f32 v197, v184, v185
  v_cvt_pk_bf16_f32 v201, v186, v187
  v_cvt_pk_bf16_f32 v198, v188, v189
  v_cvt_pk_bf16_f32 v202, v190, v191
  v_cvt_pk_bf16_f32 v199, v192, v193
  v_cvt_pk_bf16_f32 v203, v194, v195
  ds_write_b64 v228, v[196:197] offset:16384
  ds_write_b64 v228, v[198:199] offset:18432
  ds_write_b64 v228, v[200:201] offset:20480
  ds_write_b64 v228, v[202:203] offset:22528
  s_waitcnt lgkmcnt(0)
  s_barrier
  ds_read_b128 v[148:151], v229 offset:16384
  ds_read_b128 v[152:155], v229 offset:20480
  ds_read_b128 v[156:159], v230 offset:16384
  ds_read_b128 v[160:163], v230 offset:20480
  ds_read_b128 v[164:167], v229 offset:18432
  ds_read_b128 v[168:171], v229 offset:22528
  ds_read_b128 v[172:175], v230 offset:18432
  ds_read_b128 v[176:179], v230 offset:22528
  s_waitcnt lgkmcnt(0)
  s_cmp_lg_u32 s33, 0
  s_cbranch_scc1 k2a_kernel_f0
  v_mfma_f32_16x16x32_bf16 v[136:139], v[36:39], v[148:151], v[136:139]
  v_mfma_f32_16x16x32_bf16 v[136:139], v[52:55], v[152:155], v[136:139]
  v_mfma_f32_16x16x32_bf16 v[136:139], v[40:43], v[156:159], v[136:139]
  v_mfma_f32_16x16x32_bf16 v[136:139], v[56:59], v[160:163], v[136:139]
  v_mfma_f32_16x16x32_bf16 v[144:147], v[36:39], v[164:167], v[144:147]
  v_mfma_f32_16x16x32_bf16 v[144:147], v[52:55], v[168:171], v[144:147]
  v_mfma_f32_16x16x32_bf16 v[144:147], v[40:43], v[172:175], v[144:147]
  v_mfma_f32_16x16x32_bf16 v[144:147], v[56:59], v[176:179], v[144:147]
  s_branch k2a_kernel_f1
k2a_kernel_f0:
  v_mfma_f32_16x16x32_bf16 v[132:135], v[36:39], v[148:151], v[132:135]
  v_mfma_f32_16x16x32_bf16 v[136:139], v[36:39], v[152:155], v[136:139]
  v_mfma_f32_16x16x32_bf16 v[132:135], v[52:55], v[152:155], v[132:135]
  v_mfma_f32_16x16x32_bf16 v[136:139], v[44:47], v[148:151], v[136:139]
  v_mfma_f32_16x16x32_bf16 v[132:135], v[40:43], v[156:159], v[132:135]
  v_mfma_f32_16x16x32_bf16 v[136:139], v[40:43], v[160:163], v[136:139]
  v_mfma_f32_16x16x32_bf16 v[132:135], v[56:59], v[160:163], v[132:135]
  v_mfma_f32_16x16x32_bf16 v[136:139], v[48:51], v[156:159], v[136:139]
  v_mfma_f32_16x16x32_bf16 v[140:143], v[36:39], v[164:167], v[140:143]
  v_mfma_f32_16x16x32_bf16 v[144:147], v[36:39], v[168:171], v[144:147]
  v_mfma_f32_16x16x32_bf16 v[140:143], v[52:55], v[168:171], v[140:143]
  v_mfma_f32_16x16x32_bf16 v[144:147], v[44:47], v[164:167], v[144:147]
  v_mfma_f32_16x16x32_bf16 v[140:143], v[40:43], v[172:175], v[140:143]
  v_mfma_f32_16x16x32_bf16 v[144:147], v[40:43], v[176:179], v[144:147]
  v_mfma_f32_16x16x32_bf16 v[140:143], v[56:59], v[176:179], v[140:143]
  v_mfma_f32_16x16x32_bf16 v[144:147], v[48:51], v[172:175], v[144:147]
k2a_kernel_f1:
  s_nop 7
  v_cvt_pk_bf16_f32 v220, v132, v136
  v_cvt_pk_bf16_f32 v221, v133, v137
  v_cvt_pk_bf16_f32 v222, v134, v138
  v_cvt_pk_bf16_f32 v223, v135, v139
  v_cvt_pk_bf16_f32 v224, v140, v144
  v_cvt_pk_bf16_f32 v225, v141, v145
  v_cvt_pk_bf16_f32 v226, v142, v146
  v_cvt_pk_bf16_f32 v227, v143, v147
  s_cmp_eq_u32 s21, 0
  s_cbranch_scc0 k2a_kernel_xb
  ds_write_b32 v241, v224 offset:0
  ds_write_b32 v241, v225 offset:256
  ds_write_b32 v241, v226 offset:512
  ds_write_b32 v241, v227 offset:768
  v_mov_b32 v148, v220
  v_mov_b32 v150, v221
  v_mov_b32 v152, v222
  v_mov_b32 v154, v223
  s_waitcnt lgkmcnt(0)
  s_barrier
  ds_read_b32 v149, v241 offset:1024
  ds_read_b32 v151, v241 offset:1280
  ds_read_b32 v153, v241 offset:1536
  ds_read_b32 v155, v241 offset:1792
  s_branch k2a_kernel_xs
k2a_kernel_xb:
  ds_write_b32 v241, v220 offset:1024
  ds_write_b32 v241, v221 offset:1280
  ds_write_b32 v241, v222 offset:1536
  ds_write_b32 v241, v223 offset:1792
  v_mov_b32 v149, v224
  v_mov_b32 v151, v225
  v_mov_b32 v153, v226
  v_mov_b32 v155, v227
  s_waitcnt lgkmcnt(0)
  s_barrier
  ds_read_b32 v148, v241 offset:0
  ds_read_b32 v150, v241 offset:256
  ds_read_b32 v152, v241 offset:512
  ds_read_b32 v154, v241 offset:768
  s_add_u32 s24, s24, 2048
k2a_kernel_xs:
  s_waitcnt lgkmcnt(0)
  buffer_store_dwordx4 v[148:151], v231, s[8:11], s24 offen offset:0 sc1
  buffer_store_dwordx4 v[152:155], v231, s[8:11], s24 offen offset:1024 sc1
  s_waitcnt vmcnt(0)
  s_branch k2a_kernel_fin
k2a_kernel_extra:
    s_waitcnt lgkmcnt(0)
    s_mov_b32 s8, s4
    s_mov_b32 s9, s5
    s_mov_b32 s10, 0x10000000
    s_mov_b32 s11, 0x20000
    v_lshrrev_b32 v239, 6, v0
    v_and_b32 v238, 63, v0
    v_readfirstlane_b32 s20, v239
    s_sub_u32 s21, s2, 144
    s_cmp_lt_u32 s21, 60
    s_cbranch_scc0 k2a_kernel_pty2
    s_mov_b32 s40, 0
    s_mul_i32 s22, s21, 43
    s_lshr_b32 s22, s22, 8
    s_mul_i32 s24, s22, 6
    s_sub_u32 s23, s21, s24
    s_mul_i32 s33, s23, 3
    s_mov_b32 s41, 3
    s_branch k2a_kernel_pty
k2a_kernel_pty2:
    s_sub_u32 s21, s21, 60
    s_mov_b32 s40, 1
    s_mul_i32 s22, s21, 52
    s_lshr_b32 s22, s22, 8
    s_mul_i32 s24, s22, 5
    s_sub_u32 s23, s21, s24
    s_lshl_b32 s33, s23, 2
    s_mov_b32 s41, 4
k2a_kernel_pty:
    s_add_u32 s33, s33, s20
    v_and_b32 v240, 31, v238
    v_lshrrev_b32 v241, 5, v238
    v_mul_u32_u24 v237, 9216, v241
    v_lshl_add_u32 v237, v240, 4, v237
    s_lshl_b32 s26, s33, 9
    s_add_u32 s26, s26, 11911168
    s_lshl_b32 s25, s20, 10
    s_waitcnt lgkmcnt(0)
    s_cmp_eq_u32 s40, 1
    s_cbranch_scc1 k2a_kernel_ptwo
    s_mov_b32 s12, s44
    s_mov_b32 s13, s45
    s_mov_b32 s14, 663552
    s_mov_b32 s15, 0x20000
    s_mov_b32 s28, 1152
    s_lshl_b32 s24, s22, 7
    s_cmp_eq_u32 s22, 9
    s_cbranch_scc0 k2a_kernel_psrc
    s_mov_b32 s12, s4
    s_mov_b32 s13, s5
    s_mov_b32 s14, 0x10000000
    s_mov_b32 s28, 128
    s_mov_b32 s24, 14827520
k2a_kernel_psrc:
    s_lshl_b32 s27, s28, 6
    v_lshrrev_b32 v239, 3, v238
    v_bfe_u32 v240, v238, 4, 1
    v_lshlrev_b32 v240, 2, v240
    v_and_b32 v241, 7, v238
    v_xor_b32 v240, v240, v241
    s_lshl_b32 s34, s20, 3
    v_add_u32 v239, s34, v239
    v_mul_u32_u24 v236, s28, v239
    v_lshl_add_u32 v236, v240, 4, v236
        s_cmp_ge_u32 s20, s41
        s_cbranch_scc1 k2a_kernel_phelp1
        s_cmp_ge_u32 s33, 18
        s_cbranch_scc1 k2a_kernel_phelp1
        s_mov_b32 m0, s25
        s_add_u32 s25, s25, 8192
        buffer_load_dwordx4 v236, s[12:15], s24 offen lds
        s_add_u32 s24, s24, s27
  buffer_load_dwordx4 v[8:11], v237, s[8:11], s26 offen
  s_add_u32 s26, s26, 18432
  buffer_load_dwordx4 v[12:15], v237, s[8:11], s26 offen
  s_add_u32 s26, s26, 18432
  buffer_load_dwordx4 v[16:19], v237, s[8:11], s26 offen
  s_add_u32 s26, s26, 18432
  buffer_load_dwordx4 v[20:23], v237, s[8:11], s26 offen
  s_add_u32 s26, s26, 18432
  s_barrier
        s_mov_b32 m0, s25
        s_add_u32 s25, s25, 8192
        buffer_load_dwordx4 v236, s[12:15], s24 offen lds
        s_add_u32 s24, s24, s27
  buffer_load_dwordx4 v[24:27], v237, s[8:11], s26 offen
  s_add_u32 s26, s26, 18432
  buffer_load_dwordx4 v[28:31], v237, s[8:11], s26 offen
  s_add_u32 s26, s26, 18432
  buffer_load_dwordx4 v[32:35], v237, s[8:11], s26 offen
  s_add_u32 s26, s26, 18432
  buffer_load_dwordx4 v[36:39], v237, s[8:11], s26 offen
  s_add_u32 s26, s26, 18432
        s_mov_b32 m0, s25
        s_add_u32 s25, s25, 8192
        buffer_load_dwordx4 v236, s[12:15], s24 offen lds
        s_add_u32 s24, s24, s27
  buffer_load_dwordx4 v[40:43], v237, s[8:11], s26 offen
  s_add_u32 s26, s26, 18432
  buffer_load_dwordx4 v[44:47], v237, s[8:11], s26 offen
  s_add_u32 s26, s26, 18432
  buffer_load_dwordx4 v[48:51], v237, s[8:11], s26 offen
  s_add_u32 s26, s26, 18432
  buffer_load_dwordx4 v[52:55], v237, s[8:11], s26 offen
  s_add_u32 s26, s26, 18432
        s_mov_b32 m0, s25
        s_add_u32 s25, s25, 8192
        buffer_load_dwordx4 v236, s[12:15], s24 offen lds
        s_add_u32 s24, s24, s27
  buffer_load_dwordx4 v[56:59], v237, s[8:11], s26 offen
  s_add_u32 s26, s26, 18432
  buffer_load_dwordx4 v[60:63], v237, s[8:11], s26 offen
  s_add_u32 s26, s26, 18432
  buffer_load_dwordx4 v[64:67], v237, s[8:11], s26 offen
  s_add_u32 s26, s26, 18432
  buffer_load_dwordx4 v[68:71], v237, s[8:11], s26 offen
  s_add_u32 s26, s26, 18432
        v_and_b32 v239, 15, v238
        v_lshrrev_b32 v240, 2, v239
        v_lshrrev_b32 v241, 5, v238
        v_lshl_add_u32 v241, v241, 3, v240
        v_lshlrev_b32 v241, 7, v241
        v_bfe_u32 v242, v238, 4, 1
        v_lshlrev_b32 v242, 1, v242
        v_bfe_u32 v244, v239, 1, 1
        v_add_u32 v242, v242, v244
        v_lshrrev_b32 v240, 1, v240
        v_lshlrev_b32 v240, 2, v240
        v_and_b32 v239, 1, v239
        v_lshl_add_u32 v241, v239, 3, v241
        v_xor_b32 v244, v242, v240
        v_lshl_add_u32 v204, v244, 4, v241
        v_add_u32 v242, 4, v242
        v_xor_b32 v244, v242, v240
        v_lshl_add_u32 v205, v244, 4, v241
        v_add_u32 v206, 36864, v204
        v_add_u32 v207, 36864, v205
        v_and_b32 v239, 31, v238
        v_lshrrev_b32 v240, 5, v238
        v_mul_u32_u24 v240, 10240, v240
        v_lshl_add_u32 v247, v239, 4, v240
        s_lshl_b32 s48, s22, 10
        s_mul_i32 s34, s33, 40960
        s_add_u32 s48, s48, s34
        s_add_u32 s48, s48, 14901248
  s_waitcnt vmcnt(15)
  s_barrier
  ds_read_b64_tr_b16 v[184:185], v204 offset:0
  ds_read_b64_tr_b16 v[186:187], v204 offset:512
  ds_read_b64_tr_b16 v[188:189], v205 offset:0
  ds_read_b64_tr_b16 v[190:191], v205 offset:512
  ds_read_b64_tr_b16 v[192:193], v204 offset:2048
  ds_read_b64_tr_b16 v[194:195], v204 offset:2560
  ds_read_b64_tr_b16 v[196:197], v205 offset:2048
  ds_read_b64_tr_b16 v[198:199], v205 offset:2560
  s_waitcnt lgkmcnt(4)
  v_mfma_f32_32x32x16_bf16 v[152:167], v[8:11], v[184:187], 0
  v_mfma_f32_32x32x16_bf16 v[168:183], v[8:11], v[188:191], 0
        s_mov_b32 m0, s25
        s_add_u32 s25, s25, 8192
        buffer_load_dwordx4 v236, s[12:15], s24 offen lds
        s_add_u32 s24, s24, s27
  buffer_load_dwordx4 v[72:75], v237, s[8:11], s26 offen
  s_add_u32 s26, s26, 18432
  ds_read_b64_tr_b16 v[184:185], v204 offset:4096
  ds_read_b64_tr_b16 v[186:187], v204 offset:4608
  ds_read_b64_tr_b16 v[188:189], v205 offset:4096
  ds_read_b64_tr_b16 v[190:191], v205 offset:4608
  s_waitcnt lgkmcnt(4)
  v_mfma_f32_32x32x16_bf16 v[152:167], v[12:15], v[192:195], v[152:167]
  v_mfma_f32_32x32x16_bf16 v[168:183], v[12:15], v[196:199], v[168:183]
  buffer_load_dwordx4 v[76:79], v237, s[8:11], s26 offen
  s_add_u32 s26, s26, 18432
  ds_read_b64_tr_b16 v[192:193], v204 offset:6144
  ds_read_b64_tr_b16 v[194:195], v204 offset:6656
  ds_read_b64_tr_b16 v[196:197], v205 offset:6144
  ds_read_b64_tr_b16 v[198:199], v205 offset:6656
  s_waitcnt lgkmcnt(4)
  v_mfma_f32_32x32x16_bf16 v[152:167], v[16:19], v[184:187], v[152:167]
  v_mfma_f32_32x32x16_bf16 v[168:183], v[16:19], v[188:191], v[168:183]
  buffer_load_dwordx4 v[80:83], v237, s[8:11], s26 offen
  s_add_u32 s26, s26, 18432
  s_waitcnt vmcnt(14)
  s_barrier
  ds_read_b64_tr_b16 v[184:185], v204 offset:8192
  ds_read_b64_tr_b16 v[186:187], v204 offset:8704
  ds_read_b64_tr_b16 v[188:189], v205 offset:8192
  ds_read_b64_tr_b16 v[190:191], v205 offset:8704
  s_waitcnt lgkmcnt(4)
  v_mfma_f32_32x32x16_bf16 v[152:167], v[20:23], v[192:195], v[152:167]
  v_mfma_f32_32x32x16_bf16 v[168:183], v[20:23], v[196:199], v[168:183]
  buffer_load_dwordx4 v[84:87], v237, s[8:11], s26 offen
  s_add_u32 s26, s26, 18432
  ds_read_b64_tr_b16 v[192:193], v204 offset:10240
  ds_read_b64_tr_b16 v[194:195], v204 offset:10752
  ds_read_b64_tr_b16 v[196:197], v205 offset:10240
  ds_read_b64_tr_b16 v[198:199], v205 offset:10752
  s_waitcnt lgkmcnt(4)
  v_mfma_f32_32x32x16_bf16 v[152:167], v[24:27], v[184:187], v[152:167]
  v_mfma_f32_32x32x16_bf16 v[168:183], v[24:27], v[188:191], v[168:183]
        s_mov_b32 m0, s25
        s_add_u32 s25, s25, 8192
        buffer_load_dwordx4 v236, s[12:15], s24 offen lds
        s_add_u32 s24, s24, s27
  buffer_load_dwordx4 v[88:91], v237, s[8:11], s26 offen
  s_add_u32 s26, s26, 18432
  ds_read_b64_tr_b16 v[184:185], v204 offset:12288
  ds_read_b64_tr_b16 v[186:187], v204 offset:12800
  ds_read_b64_tr_b16 v[188:189], v205 offset:12288
  ds_read_b64_tr_b16 v[190:191], v205 offset:12800
  s_waitcnt lgkmcnt(4)
  v_mfma_f32_32x32x16_bf16 v[152:167], v[28:31], v[192:195], v[152:167]
  v_mfma_f32_32x32x16_bf16 v[168:183], v[28:31], v[196:199], v[168:183]
  buffer_load_dwordx4 v[92:95], v237, s[8:11], s26 offen
  s_add_u32 s26, s26, 18432
  ds_read_b64_tr_b16 v[192:193], v204 offset:14336
  ds_read_b64_tr_b16 v[194:195], v204 offset:14848
  ds_read_b64_tr_b16 v[196:197], v205 offset:14336
  ds_read_b64_tr_b16 v[198:199], v205 offset:14848
  s_waitcnt lgkmcnt(4)
  v_mfma_f32_32x32x16_bf16 v[152:167], v[32:35], v[184:187], v[152:167]
  v_mfma_f32_32x32x16_bf16 v[168:183], v[32:35], v[188:191], v[168:183]
  buffer_load_dwordx4 v[96:99], v237, s[8:11], s26 offen
  s_add_u32 s26, s26, 18432
  s_waitcnt vmcnt(14)
  s_barrier
  ds_read_b64_tr_b16 v[184:185], v204 offset:16384
  ds_read_b64_tr_b16 v[186:187], v204 offset:16896
  ds_read_b64_tr_b16 v[188:189], v205 offset:16384
  ds_read_b64_tr_b16 v[190:191], v205 offset:16896
  s_waitcnt lgkmcnt(4)
  v_mfma_f32_32x32x16_bf16 v[152:167], v[36:39], v[192:195], v[152:167]
  v_mfma_f32_32x32x16_bf16 v[168:183], v[36:39], v[196:199], v[168:183]
  buffer_load_dwordx4 v[100:103], v237, s[8:11], s26 offen
  s_add_u32 s26, s26, 18432
  ds_read_b64_tr_b16 v[192:193], v204 offset:18432
  ds_read_b64_tr_b16 v[194:195], v204 offset:18944
  ds_read_b64_tr_b16 v[196:197], v205 offset:18432
  ds_read_b64_tr_b16 v[198:199], v205 offset:18944
  s_waitcnt lgkmcnt(4)
  v_mfma_f32_32x32x16_bf16 v[152:167], v[40:43], v[184:187], v[152:167]
  v_mfma_f32_32x32x16_bf16 v[168:183], v[40:43], v[188:191], v[168:183]
        s_mov_b32 m0, s25
        s_add_u32 s25, s25, 8192
        buffer_load_dwordx4 v236, s[12:15], s24 offen lds
        s_add_u32 s24, s24, s27
  buffer_load_dwordx4 v[104:107], v237, s[8:11], s26 offen
  s_add_u32 s26, s26, 18432
  ds_read_b64_tr_b16 v[184:185], v204 offset:20480
  ds_read_b64_tr_b16 v[186:187], v204 offset:20992
  ds_read_b64_tr_b16 v[188:189], v205 offset:20480
  ds_read_b64_tr_b16 v[190:191], v205 offset:20992
  s_waitcnt lgkmcnt(4)
  v_mfma_f32_32x32x16_bf16 v[152:167], v[44:47], v[192:195], v[152:167]
  v_mfma_f32_32x32x16_bf16 v[168:183], v[44:47], v[196:199], v[168:183]
  buffer_load_dwordx4 v[108:111], v237, s[8:11], s26 offen
  s_add_u32 s26, s26, 18432
  ds_read_b64_tr_b16 v[192:193], v204 offset:22528
  ds_read_b64_tr_b16 v[194:195], v204 offset:23040
  ds_read_b64_tr_b16 v[196:197], v205 offset:22528
  ds_read_b64_tr_b16 v[198:199], v205 offset:23040
  s_waitcnt lgkmcnt(4)
  v_mfma_f32_32x32x16_bf16 v[152:167], v[48:51], v[184:187], v[152:167]
  v_mfma_f32_32x32x16_bf16 v[168:183], v[48:51], v[188:191], v[168:183]
  buffer_load_dwordx4 v[112:115], v237, s[8:11], s26 offen
  s_add_u32 s26, s26, 18432
  s_waitcnt vmcnt(14)
  s_barrier
  ds_read_b64_tr_b16 v[184:185], v204 offset:24576
  ds_read_b64_tr_b16 v[186:187], v204 offset:25088
  ds_read_b64_tr_b16 v[188:189], v205 offset:24576
  ds_read_b64_tr_b16 v[190:191], v205 offset:25088
  s_waitcnt lgkmcnt(4)
  v_mfma_f32_32x32x16_bf16 v[152:167], v[52:55], v[192:195], v[152:167]
  v_mfma_f32_32x32x16_bf16 v[168:183], v[52:55], v[196:199], v[168:183]
  buffer_load_dwordx4 v[116:119], v237, s[8:11], s26 offen
  s_add_u32 s26, s26, 18432
  ds_read_b64_tr_b16 v[192:193], v204 offset:26624
  ds_read_b64_tr_b16 v[194:195], v204 offset:27136
  ds_read_b64_tr_b16 v[196:197], v205 offset:26624
  ds_read_b64_tr_b16 v[198:199], v205 offset:27136
  s_waitcnt lgkmcnt(4)
  v_mfma_f32_32x32x16_bf16 v[152:167], v[56:59], v[184:187], v[152:167]
  v_mfma_f32_32x32x16_bf16 v[168:183], v[56:59], v[188:191], v[168:183]
        s_mov_b32 m0, s25
        s_add_u32 s25, s25, 8192
        buffer_load_dwordx4 v236, s[12:15], s24 offen lds
        s_add_u32 s24, s24, s27
  buffer_load_dwordx4 v[120:123], v237, s[8:11], s26 offen
  s_add_u32 s26, s26, 18432
  ds_read_b64_tr_b16 v[184:185], v204 offset:28672
  ds_read_b64_tr_b16 v[186:187], v204 offset:29184
  ds_read_b64_tr_b16 v[188:189], v205 offset:28672
  ds_read_b64_tr_b16 v[190:191], v205 offset:29184
  s_waitcnt lgkmcnt(4)
  v_mfma_f32_32x32x16_bf16 v[152:167], v[60:63], v[192:195], v[152:167]
  v_mfma_f32_32x32x16_bf16 v[168:183], v[60:63], v[196:199], v[168:183]
  buffer_load_dwordx4 v[124:127], v237, s[8:11], s26 offen
  s_add_u32 s26, s26, 18432
  ds_read_b64_tr_b16 v[192:193], v204 offset:30720
  ds_read_b64_tr_b16 v[194:195], v204 offset:31232
  ds_read_b64_tr_b16 v[196:197], v205 offset:30720
  ds_read_b64_tr_b16 v[198:199], v205 offset:31232
  s_waitcnt lgkmcnt(4)
  v_mfma_f32_32x32x16_bf16 v[152:167], v[64:67], v[184:187], v[152:167]
  v_mfma_f32_32x32x16_bf16 v[168:183], v[64:67], v[188:191], v[168:183]
  buffer_load_dwordx4 v[128:131], v237, s[8:11], s26 offen
  s_add_u32 s26, s26, 18432
  s_waitcnt vmcnt(14)
  s_barrier
  ds_read_b64_tr_b16 v[184:185], v204 offset:32768
  ds_read_b64_tr_b16 v[186:187], v204 offset:33280
  ds_read_b64_tr_b16 v[188:189], v205 offset:32768
  ds_read_b64_tr_b16 v[190:191], v205 offset:33280
  s_waitcnt lgkmcnt(4)
  v_mfma_f32_32x32x16_bf16 v[152:167], v[68:71], v[192:195], v[152:167]
  v_mfma_f32_32x32x16_bf16 v[168:183], v[68:71], v[196:199], v[168:183]
  buffer_load_dwordx4 v[132:135], v237, s[8:11], s26 offen
  s_add_u32 s26, s26, 18432
  ds_read_b64_tr_b16 v[192:193], v204 offset:34816
  ds_read_b64_tr_b16 v[194:195], v204 offset:35328
  ds_read_b64_tr_b16 v[196:197], v205 offset:34816
  ds_read_b64_tr_b16 v[198:199], v205 offset:35328
  s_waitcnt lgkmcnt(4)
  v_mfma_f32_32x32x16_bf16 v[152:167], v[72:75], v[184:187], v[152:167]
  v_mfma_f32_32x32x16_bf16 v[168:183], v[72:75], v[188:191], v[168:183]
        s_mov_b32 m0, s25
        s_add_u32 s25, s25, 8192
        buffer_load_dwordx4 v236, s[12:15], s24 offen lds
        s_add_u32 s24, s24, s27
  buffer_load_dwordx4 v[136:139], v237, s[8:11], s26 offen
  s_add_u32 s26, s26, 18432
  ds_read_b64_tr_b16 v[184:185], v206 offset:0
  ds_read_b64_tr_b16 v[186:187], v206 offset:512
  ds_read_b64_tr_b16 v[188:189], v207 offset:0
  ds_read_b64_tr_b16 v[190:191], v207 offset:512
  s_waitcnt lgkmcnt(4)
  v_mfma_f32_32x32x16_bf16 v[152:167], v[76:79], v[192:195], v[152:167]
  v_mfma_f32_32x32x16_bf16 v[168:183], v[76:79], v[196:199], v[168:183]
  buffer_load_dwordx4 v[140:143], v237, s[8:11], s26 offen
  s_add_u32 s26, s26, 18432
  ds_read_b64_tr_b16 v[192:193], v206 offset:2048
  ds_read_b64_tr_b16 v[194:195], v206 offset:2560
  ds_read_b64_tr_b16 v[196:197], v207 offset:2048
  ds_read_b64_tr_b16 v[198:199], v207 offset:2560
  s_waitcnt lgkmcnt(4)
  v_mfma_f32_32x32x16_bf16 v[152:167], v[80:83], v[184:187], v[152:167]
  v_mfma_f32_32x32x16_bf16 v[168:183], v[80:83], v[188:191], v[168:183]
  buffer_load_dwordx4 v[144:147], v237, s[8:11], s26 offen
  s_add_u32 s26, s26, 18432
  s_waitcnt vmcnt(14)
  s_barrier
  ds_read_b64_tr_b16 v[184:185], v206 offset:4096
  ds_read_b64_tr_b16 v[186:187], v206 offset:4608
  ds_read_b64_tr_b16 v[188:189], v207 offset:4096
  ds_read_b64_tr_b16 v[190:191], v207 offset:4608
  s_waitcnt lgkmcnt(4)
  v_mfma_f32_32x32x16_bf16 v[152:167], v[84:87], v[192:195], v[152:167]
  v_mfma_f32_32x32x16_bf16 v[168:183], v[84:87], v[196:199], v[168:183]
  buffer_load_dwordx4 v[148:151], v237, s[8:11], s26 offen
  s_add_u32 s26, s26, 18432
  ds_read_b64_tr_b16 v[192:193], v206 offset:6144
  ds_read_b64_tr_b16 v[194:195], v206 offset:6656
  ds_read_b64_tr_b16 v[196:197], v207 offset:6144
  ds_read_b64_tr_b16 v[198:199], v207 offset:6656
  s_waitcnt lgkmcnt(4)
  v_mfma_f32_32x32x16_bf16 v[152:167], v[88:91], v[184:187], v[152:167]
  v_mfma_f32_32x32x16_bf16 v[168:183], v[88:91], v[188:191], v[168:183]
  ds_read_b64_tr_b16 v[184:185], v206 offset:8192
  ds_read_b64_tr_b16 v[186:187], v206 offset:8704
  ds_read_b64_tr_b16 v[188:189], v207 offset:8192
  ds_read_b64_tr_b16 v[190:191], v207 offset:8704
  s_waitcnt lgkmcnt(4)
  v_mfma_f32_32x32x16_bf16 v[152:167], v[92:95], v[192:195], v[152:167]
  v_mfma_f32_32x32x16_bf16 v[168:183], v[92:95], v[196:199], v[168:183]
  ds_read_b64_tr_b16 v[192:193], v206 offset:10240
  ds_read_b64_tr_b16 v[194:195], v206 offset:10752
  ds_read_b64_tr_b16 v[196:197], v207 offset:10240
  ds_read_b64_tr_b16 v[198:199], v207 offset:10752
  s_waitcnt lgkmcnt(4)
  v_mfma_f32_32x32x16_bf16 v[152:167], v[96:99], v[184:187], v[152:167]
  v_mfma_f32_32x32x16_bf16 v[168:183], v[96:99], v[188:191], v[168:183]
  s_waitcnt vmcnt(10)
  s_barrier
  ds_read_b64_tr_b16 v[184:185], v206 offset:12288
  ds_read_b64_tr_b16 v[186:187], v206 offset:12800
  ds_read_b64_tr_b16 v[188:189], v207 offset:12288
  ds_read_b64_tr_b16 v[190:191], v207 offset:12800
  s_waitcnt lgkmcnt(4)
  v_mfma_f32_32x32x16_bf16 v[152:167], v[100:103], v[192:195], v[152:167]
  v_mfma_f32_32x32x16_bf16 v[168:183], v[100:103], v[196:199], v[168:183]
  ds_read_b64_tr_b16 v[192:193], v206 offset:14336
  ds_read_b64_tr_b16 v[194:195], v206 offset:14848
  ds_read_b64_tr_b16 v[196:197], v207 offset:14336
  ds_read_b64_tr_b16 v[198:199], v207 offset:14848
  s_waitcnt lgkmcnt(4)
  v_mfma_f32_32x32x16_bf16 v[152:167], v[104:107], v[184:187], v[152:167]
  v_mfma_f32_32x32x16_bf16 v[168:183], v[104:107], v[188:191], v[168:183]
  ds_read_b64_tr_b16 v[184:185], v206 offset:16384
  ds_read_b64_tr_b16 v[186:187], v206 offset:16896
  ds_read_b64_tr_b16 v[188:189], v207 offset:16384
  ds_read_b64_tr_b16 v[190:191], v207 offset:16896
  s_waitcnt lgkmcnt(4)
  v_mfma_f32_32x32x16_bf16 v[152:167], v[108:111], v[192:195], v[152:167]
  v_mfma_f32_32x32x16_bf16 v[168:183], v[108:111], v[196:199], v[168:183]
  ds_read_b64_tr_b16 v[192:193], v206 offset:18432
  ds_read_b64_tr_b16 v[194:195], v206 offset:18944
  ds_read_b64_tr_b16 v[196:197], v207 offset:18432
  ds_read_b64_tr_b16 v[198:199], v207 offset:18944
  s_waitcnt lgkmcnt(4)
  v_mfma_f32_32x32x16_bf16 v[152:167], v[112:115], v[184:187], v[152:167]
  v_mfma_f32_32x32x16_bf16 v[168:183], v[112:115], v[188:191], v[168:183]
  s_waitcnt vmcnt(5)
  s_barrier
  ds_read_b64_tr_b16 v[184:185], v206 offset:20480
  ds_read_b64_tr_b16 v[186:187], v206 offset:20992
  ds_read_b64_tr_b16 v[188:189], v207 offset:20480
  ds_read_b64_tr_b16 v[190:191], v207 offset:20992
  s_waitcnt lgkmcnt(4)
  v_mfma_f32_32x32x16_bf16 v[152:167], v[116:119], v[192:195], v[152:167]
  v_mfma_f32_32x32x16_bf16 v[168:183], v[116:119], v[196:199], v[168:183]
  ds_read_b64_tr_b16 v[192:193], v206 offset:22528
  ds_read_b64_tr_b16 v[194:195], v206 offset:23040
  ds_read_b64_tr_b16 v[196:197], v207 offset:22528
  ds_read_b64_tr_b16 v[198:199], v207 offset:23040
  s_waitcnt lgkmcnt(4)
  v_mfma_f32_32x32x16_bf16 v[152:167], v[120:123], v[184:187], v[152:167]
  v_mfma_f32_32x32x16_bf16 v[168:183], v[120:123], v[188:191], v[168:183]
  ds_read_b64_tr_b16 v[184:185], v206 offset:24576
  ds_read_b64_tr_b16 v[186:187], v206 offset:25088
  ds_read_b64_tr_b16 v[188:189], v207 offset:24576
  ds_read_b64_tr_b16 v[190:191], v207 offset:25088
  s_waitcnt lgkmcnt(4)
  v_mfma_f32_32x32x16_bf16 v[152:167], v[124:127], v[192:195], v[152:167]
  v_mfma_f32_32x32x16_bf16 v[168:183], v[124:127], v[196:199], v[168:183]
  ds_read_b64_tr_b16 v[192:193], v206 offset:26624
  ds_read_b64_tr_b16 v[194:195], v206 offset:27136
  ds_read_b64_tr_b16 v[196:197], v207 offset:26624
  ds_read_b64_tr_b16 v[198:199], v207 offset:27136
  s_waitcnt lgkmcnt(4)
  v_mfma_f32_32x32x16_bf16 v[152:167], v[128:131], v[184:187], v[152:167]
  v_mfma_f32_32x32x16_bf16 v[168:183], v[128:131], v[188:191], v[168:183]
  s_waitcnt vmcnt(0)
  s_barrier
  ds_read_b64_tr_b16 v[184:185], v206 offset:28672
  ds_read_b64_tr_b16 v[186:187], v206 offset:29184
  ds_read_b64_tr_b16 v[188:189], v207 offset:28672
  ds_read_b64_tr_b16 v[190:191], v207 offset:29184
  s_waitcnt lgkmcnt(4)
  v_mfma_f32_32x32x16_bf16 v[152:167], v[132:135], v[192:195], v[152:167]
  v_mfma_f32_32x32x16_bf16 v[168:183], v[132:135], v[196:199], v[168:183]
  ds_read_b64_tr_b16 v[192:193], v206 offset:30720
  ds_read_b64_tr_b16 v[194:195], v206 offset:31232
  ds_read_b64_tr_b16 v[196:197], v207 offset:30720
  ds_read_b64_tr_b16 v[198:199], v207 offset:31232
  s_waitcnt lgkmcnt(4)
  v_mfma_f32_32x32x16_bf16 v[152:167], v[136:139], v[184:187], v[152:167]
  v_mfma_f32_32x32x16_bf16 v[168:183], v[136:139], v[188:191], v[168:183]
  ds_read_b64_tr_b16 v[184:185], v206 offset:32768
  ds_read_b64_tr_b16 v[186:187], v206 offset:33280
  ds_read_b64_tr_b16 v[188:189], v207 offset:32768
  ds_read_b64_tr_b16 v[190:191], v207 offset:33280
  s_waitcnt lgkmcnt(4)
  v_mfma_f32_32x32x16_bf16 v[152:167], v[140:143], v[192:195], v[152:167]
  v_mfma_f32_32x32x16_bf16 v[168:183], v[140:143], v[196:199], v[168:183]
  ds_read_b64_tr_b16 v[192:193], v206 offset:34816
  ds_read_b64_tr_b16 v[194:195], v206 offset:35328
  ds_read_b64_tr_b16 v[196:197], v207 offset:34816
  ds_read_b64_tr_b16 v[198:199], v207 offset:35328
  s_waitcnt lgkmcnt(4)
  v_mfma_f32_32x32x16_bf16 v[152:167], v[144:147], v[184:187], v[152:167]
  v_mfma_f32_32x32x16_bf16 v[168:183], v[144:147], v[188:191], v[168:183]
  s_waitcnt lgkmcnt(0)
  v_mfma_f32_32x32x16_bf16 v[152:167], v[148:151], v[192:195], v[152:167]
  v_mfma_f32_32x32x16_bf16 v[168:183], v[148:151], v[196:199], v[168:183]
    s_cmp_eq_u32 s33, 0
    s_cbranch_scc0 k2a_kernel_pnz
    s_nop 7
    s_nop 3
    v_cmp_gt_u32 vcc, 32, v238
    v_mov_b32 v239, 0
  s_nop 0
    v_cndmask_b32 v152, v152, v239, vcc
    v_cndmask_b32 v168, v168, v239, vcc
k2a_kernel_pnz:
  s_nop 8
  v_cvt_pk_bf16_f32 v216, v152, v153
  v_cvt_pk_bf16_f32 v217, v154, v155
  v_cvt_pk_bf16_f32 v218, v156, v157
  v_cvt_pk_bf16_f32 v219, v158, v159
  s_add_u32 s34, s48, 0
  buffer_store_dwordx4 v[216:219], v247, s[8:11], s34 offen sc1
  v_cvt_pk_bf16_f32 v220, v160, v161
  v_cvt_pk_bf16_f32 v221, v162, v163
  v_cvt_pk_bf16_f32 v222, v164, v165
  v_cvt_pk_bf16_f32 v223, v166, v167
  s_add_u32 s34, s48, 20480
  buffer_store_dwordx4 v[220:223], v247, s[8:11], s34 offen sc1
  v_cvt_pk_bf16_f32 v224, v168, v169
  v_cvt_pk_bf16_f32 v225, v170, v171
  v_cvt_pk_bf16_f32 v226, v172, v173
  v_cvt_pk_bf16_f32 v227, v174, v175
  s_add_u32 s34, s48, 512
  buffer_store_dwordx4 v[224:227], v247, s[8:11], s34 offen sc1
  v_cvt_pk_bf16_f32 v228, v176, v177
  v_cvt_pk_bf16_f32 v229, v178, v179
  v_cvt_pk_bf16_f32 v230, v180, v181
  v_cvt_pk_bf16_f32 v231, v182, v183
  s_add_u32 s34, s48, 20992
  buffer_store_dwordx4 v[228:231], v247, s[8:11], s34 offen sc1
  s_branch k2a_kernel_pfin
k2a_kernel_phelp1:
        s_mov_b32 m0, s25
        s_add_u32 s25, s25, 8192
        buffer_load_dwordx4 v236, s[12:15], s24 offen lds
        s_add_u32 s24, s24, s27
  s_barrier
        s_mov_b32 m0, s25
        s_add_u32 s25, s25, 8192
        buffer_load_dwordx4 v236, s[12:15], s24 offen lds
        s_add_u32 s24, s24, s27
        s_mov_b32 m0, s25
        s_add_u32 s25, s25, 8192
        buffer_load_dwordx4 v236, s[12:15], s24 offen lds
        s_add_u32 s24, s24, s27
        s_mov_b32 m0, s25
        s_add_u32 s25, s25, 8192
        buffer_load_dwordx4 v236, s[12:15], s24 offen lds
        s_add_u32 s24, s24, s27
  s_waitcnt vmcnt(3)
  s_barrier
        s_mov_b32 m0, s25
        s_add_u32 s25, s25, 8192
        buffer_load_dwordx4 v236, s[12:15], s24 offen lds
        s_add_u32 s24, s24, s27
  s_waitcnt vmcnt(3)
  s_barrier
        s_mov_b32 m0, s25
        s_add_u32 s25, s25, 8192
        buffer_load_dwordx4 v236, s[12:15], s24 offen lds
        s_add_u32 s24, s24, s27
  s_waitcnt vmcnt(3)
  s_barrier
        s_mov_b32 m0, s25
        s_add_u32 s25, s25, 8192
        buffer_load_dwordx4 v236, s[12:15], s24 offen lds
        s_add_u32 s24, s24, s27
  s_waitcnt vmcnt(3)
  s_barrier
        s_mov_b32 m0, s25
        s_add_u32 s25, s25, 8192
        buffer_load_dwordx4 v236, s[12:15], s24 offen lds
        s_add_u32 s24, s24, s27
  s_waitcnt vmcnt(3)
  s_barrier
        s_mov_b32 m0, s25
        s_add_u32 s25, s25, 8192
        buffer_load_dwordx4 v236, s[12:15], s24 offen lds
        s_add_u32 s24, s24, s27
  s_waitcnt vmcnt(3)
  s_barrier
  s_waitcnt vmcnt(2)
  s_barrier
  s_waitcnt vmcnt(1)
  s_barrier
  s_waitcnt vmcnt(0)
  s_barrier
  s_branch k2a_kernel_pfin
k2a_kernel_ptwo:
    s_mov_b32 s12, s46
    s_mov_b32 s13, s47
    s_mov_b32 s14, 663552
    s_mov_b32 s15, 0x20000
    s_mov_b32 s24, 0
    s_mov_b32 s27, 128
    v_lshrrev_b32 v239, 3, v238
    s_lshl_b32 s34, s20, 3
    v_add_u32 v239, s34, v239
    v_lshrrev_b32 v240, 1, v239
    v_and_b32 v240, 7, v240
    v_and_b32 v241, 7, v238
    v_xor_b32 v245, v240, v241
    v_lshrrev_b32 v240, 4, v239
    s_lshl_b32 s34, s22, 2
    v_add_u32 v240, s34, v240
    v_bfe_u32 v241, v239, 2, 1
    v_bfe_u32 v242, v239, 3, 1
    v_and_b32 v239, 3, v239
    v_lshl_add_u32 v239, v242, 2, v239
  s_mov_b32 s3, 29
  v_mul_u32_u24 v242, s3, v240
  v_lshrrev_b32 v242, 8, v242
    v_mul_u32_u24 v244, 9, v242
    v_sub_u32 v240, v240, v244
    v_mul_u32_u24 v242, 144, v242
    v_lshrrev_b32 v244, 2, v240
    v_mul_u32_u24 v244, 72, v244
    v_and_b32 v243, 3, v240
    v_mul_u32_u24 v243, 18, v243
    v_add_u32 v244, v244, v243
    v_lshl_add_u32 v244, v241, 3, v244
    v_add_u32 v244, v244, v239
    v_mul_u32_u24 v241, 72, v241
    v_lshrrev_b32 v243, 1, v239
    v_mul_u32_u24 v243, 18, v243
    v_and_b32 v239, 1, v239
    v_add3_u32 v241, v241, v243, v239
    v_add_u32 v241, 16, v241
    v_cmp_eq_u32 vcc, 8, v240
  s_nop 1
    v_cndmask_b32 v244, v244, v241, vcc
    v_add_u32 v244, v244, v242
    v_mul_u32_u24 v236, 1152, v244
    v_lshl_add_u32 v236, v245, 4, v236
        s_cmp_ge_u32 s20, s41
        s_cbranch_scc1 k2a_kernel_phelp2
        s_cmp_ge_u32 s33, 18
        s_cbranch_scc1 k2a_kernel_phelp2
        s_mov_b32 m0, s25
        s_add_u32 s25, s25, 8192
        buffer_load_dwordx4 v236, s[12:15], s24 offen lds
        s_add_u32 s24, s24, s27
  buffer_load_dwordx4 v[8:11], v237, s[8:11], s26 offen
  s_add_u32 s26, s26, 18432
  buffer_load_dwordx4 v[12:15], v237, s[8:11], s26 offen
  s_add_u32 s26, s26, 18432
  buffer_load_dwordx4 v[16:19], v237, s[8:11], s26 offen
  s_add_u32 s26, s26, 18432
  buffer_load_dwordx4 v[20:23], v237, s[8:11], s26 offen
  s_add_u32 s26, s26, 18432
  s_barrier
        s_mov_b32 m0, s25
        s_add_u32 s25, s25, 8192
        buffer_load_dwordx4 v236, s[12:15], s24 offen lds
        s_add_u32 s24, s24, s27
  buffer_load_dwordx4 v[24:27], v237, s[8:11], s26 offen
  s_add_u32 s26, s26, 18432
  buffer_load_dwordx4 v[28:31], v237, s[8:11], s26 offen
  s_add_u32 s26, s26, 18432
  buffer_load_dwordx4 v[32:35], v237, s[8:11], s26 offen
  s_add_u32 s26, s26, 18432
  buffer_load_dwordx4 v[36:39], v237, s[8:11], s26 offen
  s_add_u32 s26, s26, 18432
        s_mov_b32 m0, s25
        s_add_u32 s25, s25, 8192
        buffer_load_dwordx4 v236, s[12:15], s24 offen lds
        s_add_u32 s24, s24, s27
  buffer_load_dwordx4 v[40:43], v237, s[8:11], s26 offen
  s_add_u32 s26, s26, 18432
  buffer_load_dwordx4 v[44:47], v237, s[8:11], s26 offen
  s_add_u32 s26, s26, 18432
  buffer_load_dwordx4 v[48:51], v237, s[8:11], s26 offen
  s_add_u32 s26, s26, 18432
  buffer_load_dwordx4 v[52:55], v237, s[8:11], s26 offen
  s_add_u32 s26, s26, 18432
        s_mov_b32 m0, s25
        s_add_u32 s25, s25, 8192
        buffer_load_dwordx4 v236, s[12:15], s24 offen lds
        s_add_u32 s24, s24, s27
  buffer_load_dwordx4 v[56:59], v237, s[8:11], s26 offen
  s_add_u32 s26, s26, 18432
  buffer_load_dwordx4 v[60:63], v237, s[8:11], s26 offen
  s_add_u32 s26, s26, 18432
  buffer_load_dwordx4 v[64:67], v237, s[8:11], s26 offen
  s_add_u32 s26, s26, 18432
  buffer_load_dwordx4 v[68:71], v237, s[8:11], s26 offen
  s_add_u32 s26, s26, 18432
        v_and_b32 v240, 31, v238
        v_lshrrev_b32 v241, 5, v238
        v_lshrrev_b32 v239, 1, v240
        v_and_b32 v239, 7, v239
        v_lshlrev_b32 v242, 7, v240
            v_add_u32 v200, 0, v241
            v_xor_b32 v200, v200, v239
            v_lshl_add_u32 v200, v200, 4, v242
            v_add_u32 v201, 2, v241
            v_xor_b32 v201, v201, v239
            v_lshl_add_u32 v201, v201, 4, v242
            v_add_u32 v202, 4, v241
            v_xor_b32 v202, v202, v239
            v_lshl_add_u32 v202, v202, 4, v242
            v_add_u32 v203, 6, v241
            v_xor_b32 v203, v203, v239
            v_lshl_add_u32 v203, v203, 4, v242
  s_waitcnt vmcnt(15)
  s_barrier
  ds_read_b128 v[184:187], v200 offset:0
  ds_read_b128 v[188:191], v200 offset:4096
  ds_read_b128 v[192:195], v201 offset:0
  ds_read_b128 v[196:199], v201 offset:4096
  s_waitcnt lgkmcnt(2)
  v_mfma_f32_32x32x16_bf16 v[152:167], v[184:187], v[8:11], 0
  v_mfma_f32_32x32x16_bf16 v[168:183], v[188:191], v[8:11], 0
        s_mov_b32 m0, s25
        s_add_u32 s25, s25, 8192
        buffer_load_dwordx4 v236, s[12:15], s24 offen lds
        s_add_u32 s24, s24, s27
  buffer_load_dwordx4 v[72:75], v237, s[8:11], s26 offen
  s_add_u32 s26, s26, 18432
  ds_read_b128 v[184:187], v202 offset:0
  ds_read_b128 v[188:191], v202 offset:4096
  s_waitcnt lgkmcnt(2)
  v_mfma_f32_32x32x16_bf16 v[152:167], v[192:195], v[12:15], v[152:167]
  v_mfma_f32_32x32x16_bf16 v[168:183], v[196:199], v[12:15], v[168:183]
  buffer_load_dwordx4 v[76:79], v237, s[8:11], s26 offen
  s_add_u32 s26, s26, 18432
  ds_read_b128 v[192:195], v203 offset:0
  ds_read_b128 v[196:199], v203 offset:4096
  s_waitcnt lgkmcnt(2)
  v_mfma_f32_32x32x16_bf16 v[152:167], v[184:187], v[16:19], v[152:167]
  v_mfma_f32_32x32x16_bf16 v[168:183], v[188:191], v[16:19], v[168:183]
  buffer_load_dwordx4 v[80:83], v237, s[8:11], s26 offen
  s_add_u32 s26, s26, 18432
  s_waitcnt vmcnt(14)
  s_barrier
  ds_read_b128 v[184:187], v200 offset:8192
  ds_read_b128 v[188:191], v200 offset:12288
  s_waitcnt lgkmcnt(2)
  v_mfma_f32_32x32x16_bf16 v[152:167], v[192:195], v[20:23], v[152:167]
  v_mfma_f32_32x32x16_bf16 v[168:183], v[196:199], v[20:23], v[168:183]
  buffer_load_dwordx4 v[84:87], v237, s[8:11], s26 offen
  s_add_u32 s26, s26, 18432
  ds_read_b128 v[192:195], v201 offset:8192
  ds_read_b128 v[196:199], v201 offset:12288
  s_waitcnt lgkmcnt(2)
  v_mfma_f32_32x32x16_bf16 v[152:167], v[184:187], v[24:27], v[152:167]
  v_mfma_f32_32x32x16_bf16 v[168:183], v[188:191], v[24:27], v[168:183]
        s_mov_b32 m0, s25
        s_add_u32 s25, s25, 8192
        buffer_load_dwordx4 v236, s[12:15], s24 offen lds
        s_add_u32 s24, s24, s27
  buffer_load_dwordx4 v[88:91], v237, s[8:11], s26 offen
  s_add_u32 s26, s26, 18432
  ds_read_b128 v[184:187], v202 offset:8192
  ds_read_b128 v[188:191], v202 offset:12288
  s_waitcnt lgkmcnt(2)
  v_mfma_f32_32x32x16_bf16 v[152:167], v[192:195], v[28:31], v[152:167]
  v_mfma_f32_32x32x16_bf16 v[168:183], v[196:199], v[28:31], v[168:183]
  buffer_load_dwordx4 v[92:95], v237, s[8:11], s26 offen
  s_add_u32 s26, s26, 18432
  ds_read_b128 v[192:195], v203 offset:8192
  ds_read_b128 v[196:199], v203 offset:12288
  s_waitcnt lgkmcnt(2)
  v_mfma_f32_32x32x16_bf16 v[152:167], v[184:187], v[32:35], v[152:167]
  v_mfma_f32_32x32x16_bf16 v[168:183], v[188:191], v[32:35], v[168:183]
  buffer_load_dwordx4 v[96:99], v237, s[8:11], s26 offen
  s_add_u32 s26, s26, 18432
  s_waitcnt vmcnt(14)
  s_barrier
  ds_read_b128 v[184:187], v200 offset:16384
  ds_read_b128 v[188:191], v200 offset:20480
  s_waitcnt lgkmcnt(2)
  v_mfma_f32_32x32x16_bf16 v[152:167], v[192:195], v[36:39], v[152:167]
  v_mfma_f32_32x32x16_bf16 v[168:183], v[196:199], v[36:39], v[168:183]
  buffer_load_dwordx4 v[100:103], v237, s[8:11], s26 offen
  s_add_u32 s26, s26, 18432
  ds_read_b128 v[192:195], v201 offset:16384
  ds_read_b128 v[196:199], v201 offset:20480
  s_waitcnt lgkmcnt(2)
  v_mfma_f32_32x32x16_bf16 v[152:167], v[184:187], v[40:43], v[152:167]
  v_mfma_f32_32x32x16_bf16 v[168:183], v[188:191], v[40:43], v[168:183]
        s_mov_b32 m0, s25
        s_add_u32 s25, s25, 8192
        buffer_load_dwordx4 v236, s[12:15], s24 offen lds
        s_add_u32 s24, s24, s27
  buffer_load_dwordx4 v[104:107], v237, s[8:11], s26 offen
  s_add_u32 s26, s26, 18432
  ds_read_b128 v[184:187], v202 offset:16384
  ds_read_b128 v[188:191], v202 offset:20480
  s_waitcnt lgkmcnt(2)
  v_mfma_f32_32x32x16_bf16 v[152:167], v[192:195], v[44:47], v[152:167]
  v_mfma_f32_32x32x16_bf16 v[168:183], v[196:199], v[44:47], v[168:183]
  buffer_load_dwordx4 v[108:111], v237, s[8:11], s26 offen
  s_add_u32 s26, s26, 18432
  ds_read_b128 v[192:195], v203 offset:16384
  ds_read_b128 v[196:199], v203 offset:20480
  s_waitcnt lgkmcnt(2)
  v_mfma_f32_32x32x16_bf16 v[152:167], v[184:187], v[48:51], v[152:167]
  v_mfma_f32_32x32x16_bf16 v[168:183], v[188:191], v[48:51], v[168:183]
  buffer_load_dwordx4 v[112:115], v237, s[8:11], s26 offen
  s_add_u32 s26, s26, 18432
  s_waitcnt vmcnt(14)
  s_barrier
  ds_read_b128 v[184:187], v200 offset:24576
  ds_read_b128 v[188:191], v200 offset:28672
  s_waitcnt lgkmcnt(2)
  v_mfma_f32_32x32x16_bf16 v[152:167], v[192:195], v[52:55], v[152:167]
  v_mfma_f32_32x32x16_bf16 v[168:183], v[196:199], v[52:55], v[168:183]
  buffer_load_dwordx4 v[116:119], v237, s[8:11], s26 offen
  s_add_u32 s26, s26, 18432
  ds_read_b128 v[192:195], v201 offset:24576
  ds_read_b128 v[196:199], v201 offset:28672
  s_waitcnt lgkmcnt(2)
  v_mfma_f32_32x32x16_bf16 v[152:167], v[184:187], v[56:59], v[152:167]
  v_mfma_f32_32x32x16_bf16 v[168:183], v[188:191], v[56:59], v[168:183]
        s_mov_b32 m0, s25
        s_add_u32 s25, s25, 8192
        buffer_load_dwordx4 v236, s[12:15], s24 offen lds
        s_add_u32 s24, s24, s27
  buffer_load_dwordx4 v[120:123], v237, s[8:11], s26 offen
  s_add_u32 s26, s26, 18432
  ds_read_b128 v[184:187], v202 offset:24576
  ds_read_b128 v[188:191], v202 offset:28672
  s_waitcnt lgkmcnt(2)
  v_mfma_f32_32x32x16_bf16 v[152:167], v[192:195], v[60:63], v[152:167]
  v_mfma_f32_32x32x16_bf16 v[168:183], v[196:199], v[60:63], v[168:183]
  buffer_load_dwordx4 v[124:127], v237, s[8:11], s26 offen
  s_add_u32 s26, s26, 18432
  ds_read_b128 v[192:195], v203 offset:24576
  ds_read_b128 v[196:199], v203 offset:28672
  s_waitcnt lgkmcnt(2)
  v_mfma_f32_32x32x16_bf16 v[152:167], v[184:187], v[64:67], v[152:167]
  v_mfma_f32_32x32x16_bf16 v[168:183], v[188:191], v[64:67], v[168:183]
  buffer_load_dwordx4 v[128:131], v237, s[8:11], s26 offen
  s_add_u32 s26, s26, 18432
  s_waitcnt vmcnt(14)
  s_barrier
  v_add_u32 v200, 32768, v200
  v_add_u32 v201, 32768, v201
  v_add_u32 v202, 32768, v202
  v_add_u32 v203, 32768, v203
  ds_read_b128 v[184:187], v200 offset:0
  ds_read_b128 v[188:191], v200 offset:4096
  s_waitcnt lgkmcnt(2)
  v_mfma_f32_32x32x16_bf16 v[152:167], v[192:195], v[68:71], v[152:167]
  v_mfma_f32_32x32x16_bf16 v[168:183], v[196:199], v[68:71], v[168:183]
  buffer_load_dwordx4 v[132:135], v237, s[8:11], s26 offen
  s_add_u32 s26, s26, 18432
  ds_read_b128 v[192:195], v201 offset:0
  ds_read_b128 v[196:199], v201 offset:4096
  s_waitcnt lgkmcnt(2)
  v_mfma_f32_32x32x16_bf16 v[152:167], v[184:187], v[72:75], v[152:167]
  v_mfma_f32_32x32x16_bf16 v[168:183], v[188:191], v[72:75], v[168:183]
        s_mov_b32 m0, s25
        s_add_u32 s25, s25, 8192
        buffer_load_dwordx4 v236, s[12:15], s24 offen lds
        s_add_u32 s24, s24, s27
  buffer_load_dwordx4 v[136:139], v237, s[8:11], s26 offen
  s_add_u32 s26, s26, 18432
  ds_read_b128 v[184:187], v202 offset:0
  ds_read_b128 v[188:191], v202 offset:4096
  s_waitcnt lgkmcnt(2)
  v_mfma_f32_32x32x16_bf16 v[152:167], v[192:195], v[76:79], v[152:167]
  v_mfma_f32_32x32x16_bf16 v[168:183], v[196:199], v[76:79], v[168:183]
  buffer_load_dwordx4 v[140:143], v237, s[8:11], s26 offen
  s_add_u32 s26, s26, 18432
  ds_read_b128 v[192:195], v203 offset:0
  ds_read_b128 v[196:199], v203 offset:4096
  s_waitcnt lgkmcnt(2)
  v_mfma_f32_32x32x16_bf16 v[152:167], v[184:187], v[80:83], v[152:167]
  v_mfma_f32_32x32x16_bf16 v[168:183], v[188:191], v[80:83], v[168:183]
  buffer_load_dwordx4 v[144:147], v237, s[8:11], s26 offen
  s_add_u32 s26, s26, 18432
  s_waitcnt vmcnt(14)
  s_barrier
  ds_read_b128 v[184:187], v200 offset:8192
  ds_read_b128 v[188:191], v200 offset:12288
  s_waitcnt lgkmcnt(2)
  v_mfma_f32_32x32x16_bf16 v[152:167], v[192:195], v[84:87], v[152:167]
  v_mfma_f32_32x32x16_bf16 v[168:183], v[196:199], v[84:87], v[168:183]
  buffer_load_dwordx4 v[148:151], v237, s[8:11], s26 offen
  s_add_u32 s26, s26, 18432
  ds_read_b128 v[192:195], v201 offset:8192
  ds_read_b128 v[196:199], v201 offset:12288
  s_waitcnt lgkmcnt(2)
  v_mfma_f32_32x32x16_bf16 v[152:167], v[184:187], v[88:91], v[152:167]
  v_mfma_f32_32x32x16_bf16 v[168:183], v[188:191], v[88:91], v[168:183]
  ds_read_b128 v[184:187], v202 offset:8192
  ds_read_b128 v[188:191], v202 offset:12288
  s_waitcnt lgkmcnt(2)
  v_mfma_f32_32x32x16_bf16 v[152:167], v[192:195], v[92:95], v[152:167]
  v_mfma_f32_32x32x16_bf16 v[168:183], v[196:199], v[92:95], v[168:183]
  ds_read_b128 v[192:195], v203 offset:8192
  ds_read_b128 v[196:199], v203 offset:12288
  s_waitcnt lgkmcnt(2)
  v_mfma_f32_32x32x16_bf16 v[152:167], v[184:187], v[96:99], v[152:167]
  v_mfma_f32_32x32x16_bf16 v[168:183], v[188:191], v[96:99], v[168:183]
  s_waitcnt vmcnt(10)
  s_barrier
  ds_read_b128 v[184:187], v200 offset:16384
  ds_read_b128 v[188:191], v200 offset:20480
  s_waitcnt lgkmcnt(2)
  v_mfma_f32_32x32x16_bf16 v[152:167], v[192:195], v[100:103], v[152:167]
  v_mfma_f32_32x32x16_bf16 v[168:183], v[196:199], v[100:103], v[168:183]
  ds_read_b128 v[192:195], v201 offset:16384
  ds_read_b128 v[196:199], v201 offset:20480
  s_waitcnt lgkmcnt(2)
  v_mfma_f32_32x32x16_bf16 v[152:167], v[184:187], v[104:107], v[152:167]
  v_mfma_f32_32x32x16_bf16 v[168:183], v[188:191], v[104:107], v[168:183]
  ds_read_b128 v[184:187], v202 offset:16384
  ds_read_b128 v[188:191], v202 offset:20480
  s_waitcnt lgkmcnt(2)
  v_mfma_f32_32x32x16_bf16 v[152:167], v[192:195], v[108:111], v[152:167]
  v_mfma_f32_32x32x16_bf16 v[168:183], v[196:199], v[108:111], v[168:183]
  ds_read_b128 v[192:195], v203 offset:16384
  ds_read_b128 v[196:199], v203 offset:20480
  s_waitcnt lgkmcnt(2)
  v_mfma_f32_32x32x16_bf16 v[152:167], v[184:187], v[112:115], v[152:167]
  v_mfma_f32_32x32x16_bf16 v[168:183], v[188:191], v[112:115], v[168:183]
  s_waitcnt vmcnt(5)
  s_barrier
  ds_read_b128 v[184:187], v200 offset:24576
  ds_read_b128 v[188:191], v200 offset:28672
  s_waitcnt lgkmcnt(2)
  v_mfma_f32_32x32x16_bf16 v[152:167], v[192:195], v[116:119], v[152:167]
  v_mfma_f32_32x32x16_bf16 v[168:183], v[196:199], v[116:119], v[168:183]
  ds_read_b128 v[192:195], v201 offset:24576
  ds_read_b128 v[196:199], v201 offset:28672
  s_waitcnt lgkmcnt(2)
  v_mfma_f32_32x32x16_bf16 v[152:167], v[184:187], v[120:123], v[152:167]
  v_mfma_f32_32x32x16_bf16 v[168:183], v[188:191], v[120:123], v[168:183]
  ds_read_b128 v[184:187], v202 offset:24576
  ds_read_b128 v[188:191], v202 offset:28672
  s_waitcnt lgkmcnt(2)
  v_mfma_f32_32x32x16_bf16 v[152:167], v[192:195], v[124:127], v[152:167]
  v_mfma_f32_32x32x16_bf16 v[168:183], v[196:199], v[124:127], v[168:183]
  ds_read_b128 v[192:195], v203 offset:24576
  ds_read_b128 v[196:199], v203 offset:28672
  s_waitcnt lgkmcnt(2)
  v_mfma_f32_32x32x16_bf16 v[152:167], v[184:187], v[128:131], v[152:167]
  v_mfma_f32_32x32x16_bf16 v[168:183], v[188:191], v[128:131], v[168:183]
  s_waitcnt vmcnt(0)
  s_barrier
  ds_read_b128 v[184:187], v200 offset:32768
  ds_read_b128 v[188:191], v200 offset:36864
  s_waitcnt lgkmcnt(2)
  v_mfma_f32_32x32x16_bf16 v[152:167], v[192:195], v[132:135], v[152:167]
  v_mfma_f32_32x32x16_bf16 v[168:183], v[196:199], v[132:135], v[168:183]
  ds_read_b128 v[192:195], v201 offset:32768
  ds_read_b128 v[196:199], v201 offset:36864
  s_waitcnt lgkmcnt(2)
  v_mfma_f32_32x32x16_bf16 v[152:167], v[184:187], v[136:139], v[152:167]
  v_mfma_f32_32x32x16_bf16 v[168:183], v[188:191], v[136:139], v[168:183]
  ds_read_b128 v[184:187], v202 offset:32768
  ds_read_b128 v[188:191], v202 offset:36864
  s_waitcnt lgkmcnt(2)
  v_mfma_f32_32x32x16_bf16 v[152:167], v[192:195], v[140:143], v[152:167]
  v_mfma_f32_32x32x16_bf16 v[168:183], v[196:199], v[140:143], v[168:183]
  ds_read_b128 v[192:195], v203 offset:32768
  ds_read_b128 v[196:199], v203 offset:36864
  s_waitcnt lgkmcnt(2)
  v_mfma_f32_32x32x16_bf16 v[152:167], v[184:187], v[144:147], v[152:167]
  v_mfma_f32_32x32x16_bf16 v[168:183], v[188:191], v[144:147], v[168:183]
  s_waitcnt lgkmcnt(0)
  v_mfma_f32_32x32x16_bf16 v[152:167], v[192:195], v[148:151], v[152:167]
  v_mfma_f32_32x32x16_bf16 v[168:183], v[196:199], v[148:151], v[168:183]
    s_lshl_b32 s34, s22, 2
    s_mul_i32 s34, s34, 18432
    s_lshl_b32 s35, s33, 9
    s_add_u32 s34, s34, s35
    s_add_u32 s34, s34, 14163968
  s_nop 5
  v_cvt_pk_bf16_f32 v216, v152, v153
  v_cvt_pk_bf16_f32 v217, v154, v155
  v_cvt_pk_bf16_f32 v218, v156, v157
  v_cvt_pk_bf16_f32 v219, v158, v159
  buffer_store_dwordx4 v[216:219], v237, s[8:11], s34 offen sc1
  s_add_u32 s34, s34, 18432
  v_cvt_pk_bf16_f32 v220, v160, v161
  v_cvt_pk_bf16_f32 v221, v162, v163
  v_cvt_pk_bf16_f32 v222, v164, v165
  v_cvt_pk_bf16_f32 v223, v166, v167
  buffer_store_dwordx4 v[220:223], v237, s[8:11], s34 offen sc1
  s_add_u32 s34, s34, 18432
  v_cvt_pk_bf16_f32 v216, v168, v169
  v_cvt_pk_bf16_f32 v217, v170, v171
  v_cvt_pk_bf16_f32 v218, v172, v173
  v_cvt_pk_bf16_f32 v219, v174, v175
  buffer_store_dwordx4 v[216:219], v237, s[8:11], s34 offen sc1
  s_add_u32 s34, s34, 18432
  v_cvt_pk_bf16_f32 v220, v176, v177
  v_cvt_pk_bf16_f32 v221, v178, v179
  v_cvt_pk_bf16_f32 v222, v180, v181
  v_cvt_pk_bf16_f32 v223, v182, v183
  buffer_store_dwordx4 v[220:223], v237, s[8:11], s34 offen sc1
  s_add_u32 s34, s34, 18432
  s_branch k2a_kernel_pfin
k2a_kernel_phelp2:
        s_mov_b32 m0, s25
        s_add_u32 s25, s25, 8192
        buffer_load_dwordx4 v236, s[12:15], s24 offen lds
        s_add_u32 s24, s24, s27
  s_barrier
        s_mov_b32 m0, s25
        s_add_u32 s25, s25, 8192
        buffer_load_dwordx4 v236, s[12:15], s24 offen lds
        s_add_u32 s24, s24, s27
        s_mov_b32 m0, s25
        s_add_u32 s25, s25, 8192
        buffer_load_dwordx4 v236, s[12:15], s24 offen lds
        s_add_u32 s24, s24, s27
        s_mov_b32 m0, s25
        s_add_u32 s25, s25, 8192
        buffer_load_dwordx4 v236, s[12:15], s24 offen lds
        s_add_u32 s24, s24, s27
  s_waitcnt vmcnt(3)
  s_barrier
        s_mov_b32 m0, s25
        s_add_u32 s25, s25, 8192
        buffer_load_dwordx4 v236, s[12:15], s24 offen lds
        s_add_u32 s24, s24, s27
  s_waitcnt vmcnt(3)
  s_barrier
        s_mov_b32 m0, s25
        s_add_u32 s25, s25, 8192
        buffer_load_dwordx4 v236, s[12:15], s24 offen lds
        s_add_u32 s24, s24, s27
  s_waitcnt vmcnt(3)
  s_barrier
        s_mov_b32 m0, s25
        s_add_u32 s25, s25, 8192
        buffer_load_dwordx4 v236, s[12:15], s24 offen lds
        s_add_u32 s24, s24, s27
  s_waitcnt vmcnt(3)
  s_barrier
        s_mov_b32 m0, s25
        s_add_u32 s25, s25, 8192
        buffer_load_dwordx4 v236, s[12:15], s24 offen lds
        s_add_u32 s24, s24, s27
  s_waitcnt vmcnt(3)
  s_barrier
        s_mov_b32 m0, s25
        s_add_u32 s25, s25, 8192
        buffer_load_dwordx4 v236, s[12:15], s24 offen lds
        s_add_u32 s24, s24, s27
  s_waitcnt vmcnt(3)
  s_barrier
  s_waitcnt vmcnt(2)
  s_barrier
  s_waitcnt vmcnt(1)
  s_barrier
  s_waitcnt vmcnt(0)
  s_barrier
k2a_kernel_pfin:
  s_waitcnt vmcnt(0)
k2a_kernel_fin:
k2a_kernel_end:
  s_endpgm
.p2align 8
.type kfa_kernel,@function
kfa_kernel:
  s_cmp_ge_u32 s2, 256
  s_cbranch_scc1 kfa_kernel_end
  s_load_dwordx2 s[4:5], s[0:1], 80
    v_lshrrev_b32 v209, 6, v0
    v_and_b32 v208, 63, v0
    v_readfirstlane_b32 s20, v209
    s_and_b32 s21, s2, 7
    s_lshl_b32 s21, s21, 2
    s_lshr_b32 s23, s2, 3
    s_and_b32 s22, s23, 3
    s_add_u32 s21, s21, s22
    s_lshr_b32 s22, s2, 5
    v_and_b32 v210, 31, v208
    v_lshrrev_b32 v211, 5, v208
    v_mul_u32_u24 v206, 16512, v211
    v_lshl_add_u32 v206, v210, 4, v206
    v_mul_u32_u24 v207, 10240, v211
    v_lshlrev_b32 v204, 3, v210
    v_lshl_add_u32 v204, v211, 9, v204
    v_add_u32 v202, 36864, v204
    v_add_u32 v205, 256, v204
    s_lshl_b32 s24, s21, 9
    s_mul_i32 s25, s20, 33024
    s_add_u32 s24, s24, s25
    s_add_u32 s24, s24, 2379776
    s_lshl_b32 s25, s20, 10
    s_mul_i32 s26, s22, 1152
    s_add_u32 s26, s26, 14901248
    s_mov_b32 s27, 20480
    s_mov_b64 s[42:43], -1
    s_waitcnt lgkmcnt(0)
    s_mov_b32 s8, s4
    s_mov_b32 s9, s5
    s_mov_b32 s10, 0x10000000
    s_mov_b32 s11, 0x20000
    s_cmp_lt_u32 s20, 2
    s_cbranch_scc1 kfa_kernel_wq
    s_cmp_eq_u32 s20, 2
    s_cbranch_scc1 kfa_kernel_w2
    s_cmp_eq_u32 s20, 7
    s_cbranch_scc1 kfa_kernel_stats
    s_cmp_eq_u32 s20, 3
    s_cbranch_scc0 kfa_kernel_w456
    s_sub_u32 s48, s22, 1
    s_cmp_lt_u32 s48, 2
    s_cbranch_scc0 kfa_kernel_helper
        v_bfe_u32 v212, v210, 2, 1
        v_lshlrev_b32 v212, 3, v212
        v_bfe_u32 v209, v210, 3, 1
        v_lshl_add_u32 v212, v209, 2, v212
        v_and_b32 v209, 3, v210
        v_add_u32 v212, v212, v209
    v_cmp_gt_u32 vcc, 16, v210
    v_mov_b32 v209, 0
  s_nop 0
    v_cndmask_b32 v212, v209, v212, vcc
    v_mov_b32 v209, 16
    v_cmp_eq_u32 vcc, 16, v210
  s_nop 1
    v_cndmask_b32 v212, v212, v209, vcc
    v_mov_b32 v209, 17
    v_cmp_eq_u32 vcc, 20, v210
  s_nop 1
    v_cndmask_b32 v212, v212, v209, vcc
    v_lshl_add_u32 v207, v212, 4, v207
    s_mov_b32 s26, 14910976
    s_branch kfa_kernel_vrole
kfa_kernel_w456:
  s_branch kfa_kernel_helper
kfa_kernel_wq:
        v_bfe_u32 v212, v210, 2, 1
        v_lshlrev_b32 v212, 3, v212
        v_bfe_u32 v209, v210, 3, 1
        v_lshl_add_u32 v212, v209, 2, v212
        v_and_b32 v209, 3, v210
        v_add_u32 v212, v212, v209
    v_lshrrev_b32 v209, 4, v210
    s_lshl_b32 s34, s20, 1
    v_add_u32 v209, s34, v209
    v_mad_u32_u24 v212, v209, 18, v212
    v_lshl_add_u32 v207, v212, 4, v207
    s_branch kfa_kernel_main
kfa_kernel_w2:
    v_and_b32 v212, 3, v210
    v_mul_u32_u24 v212, 18, v212
    v_bfe_u32 v209, v210, 2, 1
    v_add3_u32 v212, v212, v209, 16
    s_cmp_eq_u32 s22, 0
    s_cbranch_scc1 kfa_kernel_w2k
    v_lshl_add_u32 v207, v212, 4, v207
    s_mov_b32 s42, 0xff
    s_mov_b32 s43, 0xff
    s_branch kfa_kernel_main
kfa_kernel_w2k:
  v_subrev_u32 v216, 8, v210
        v_bfe_u32 v217, v216, 2, 1
        v_lshlrev_b32 v217, 3, v217
        v_bfe_u32 v209, v216, 3, 1
        v_lshl_add_u32 v217, v209, 2, v217
        v_and_b32 v209, 3, v216
        v_add_u32 v217, v217, v209
    v_add_u32 v217, 576, v217
    v_cmp_gt_u32 vcc, 16, v216
  s_nop 1
    v_cndmask_b32 v212, v212, v217, vcc
    v_bfe_u32 v209, v210, 2, 1
    v_add_u32 v209, 592, v209
    v_cmp_le_u32 vcc, 24, v210
  s_nop 1
    v_cndmask_b32 v212, v212, v209, vcc
    v_lshl_add_u32 v207, v212, 4, v207
    s_branch kfa_kernel_main
kfa_kernel_main:
        s_mov_b32 m0, s25
        s_add_u32 s25, s25, 8192
        buffer_load_dwordx4 v206, s[8:11], s24 offen lds
        s_add_u32 s24, s24, 264192
        s_mov_b64 exec, s[42:43]
        buffer_load_dwordx4 v[8:11], v207, s[8:11], s26 offen
        s_mov_b64 exec, -1
        s_add_u32 s26, s26, s27
        s_mov_b64 exec, s[42:43]
        buffer_load_dwordx4 v[12:15], v207, s[8:11], s26 offen
        s_mov_b64 exec, -1
        s_add_u32 s26, s26, s27
        s_mov_b64 exec, s[42:43]
        buffer_load_dwordx4 v[16:19], v207, s[8:11], s26 offen
        s_mov_b64 exec, -1
        s_add_u32 s26, s26, s27
        s_mov_b64 exec, s[42:43]
        buffer_load_dwordx4 v[20:23], v207, s[8:11], s26 offen
        s_mov_b64 exec, -1
        s_add_u32 s26, s26, s27
  s_barrier
        s_mov_b32 m0, s25
        s_add_u32 s25, s25, 8192
        buffer_load_dwordx4 v206, s[8:11], s24 offen lds
        s_add_u32 s24, s24, 264192
        s_mov_b64 exec, s[42:43]
        buffer_load_dwordx4 v[24:27], v207, s[8:11], s26 offen
        s_mov_b64 exec, -1
        s_add_u32 s26, s26, s27
        s_mov_b64 exec, s[42:43]
        buffer_load_dwordx4 v[28:31], v207, s[8:11], s26 offen
        s_mov_b64 exec, -1
        s_add_u32 s26, s26, s27
        s_mov_b64 exec, s[42:43]
        buffer_load_dwordx4 v[32:35], v207, s[8:11], s26 offen
        s_mov_b64 exec, -1
        s_add_u32 s26, s26, s27
        s_mov_b64 exec, s[42:43]
        buffer_load_dwordx4 v[36:39], v207, s[8:11], s26 offen
        s_mov_b64 exec, -1
        s_add_u32 s26, s26, s27
  s_barrier
        s_mov_b32 m0, s25
        s_add_u32 s25, s25, 8192
        buffer_load_dwordx4 v206, s[8:11], s24 offen lds
        s_add_u32 s24, s24, 264192
        s_mov_b64 exec, s[42:43]
        buffer_load_dwordx4 v[40:43], v207, s[8:11], s26 offen
        s_mov_b64 exec, -1
        s_add_u32 s26, s26, s27
        s_mov_b64 exec, s[42:43]
        buffer_load_dwordx4 v[44:47], v207, s[8:11], s26 offen
        s_mov_b64 exec, -1
        s_add_u32 s26, s26, s27
        s_mov_b64 exec, s[42:43]
        buffer_load_dwordx4 v[48:51], v207, s[8:11], s26 offen
        s_mov_b64 exec, -1
        s_add_u32 s26, s26, s27
        s_mov_b64 exec, s[42:43]
        buffer_load_dwordx4 v[52:55], v207, s[8:11], s26 offen
        s_mov_b64 exec, -1
        s_add_u32 s26, s26, s27
        s_mov_b32 m0, s25
        s_add_u32 s25, s25, 8192
        buffer_load_dwordx4 v206, s[8:11], s24 offen lds
        s_add_u32 s24, s24, 264192
        s_mov_b64 exec, s[42:43]
        buffer_load_dwordx4 v[56:59], v207, s[8:11], s26 offen
        s_mov_b64 exec, -1
        s_add_u32 s26, s26, s27
        s_mov_b64 exec, s[42:43]
        buffer_load_dwordx4 v[60:63], v207, s[8:11], s26 offen
        s_mov_b64 exec, -1
        s_add_u32 s26, s26, s27
        s_mov_b64 exec, s[42:43]
        buffer_load_dwordx4 v[64:67], v207, s[8:11], s26 offen
        s_mov_b64 exec, -1
        s_add_u32 s26, s26, s27
        s_mov_b64 exec, s[42:43]
        buffer_load_dwordx4 v[68:71], v207, s[8:11], s26 offen
        s_mov_b64 exec, -1
        s_add_u32 s26, s26, s27
  s_waitcnt vmcnt(15)
  s_barrier
  ds_read2st64_b64 v[184:187], v204 offset0:0 offset1:2
  ds_read2st64_b64 v[188:191], v205 offset0:0 offset1:2
  ds_read2st64_b64 v[192:195], v204 offset0:4 offset1:6
  ds_read2st64_b64 v[196:199], v205 offset0:4 offset1:6
  ds_read2st64_b64 v[248:251], v204 offset0:8 offset1:10
  ds_read2st64_b64 v[252:255], v205 offset0:8 offset1:10
  s_waitcnt lgkmcnt(4)
  v_mfma_f32_32x32x16_bf16 v[152:167], v[8:11], v[184:187], 0
  v_mfma_f32_32x32x16_bf16 v[168:183], v[8:11], v[188:191], 0
        s_mov_b32 m0, s25
        s_add_u32 s25, s25, 8192
        buffer_load_dwordx4 v206, s[8:11], s24 offen lds
        s_add_u32 s24, s24, 264192
        s_mov_b64 exec, s[42:43]
        buffer_load_dwordx4 v[72:75], v207, s[8:11], s26 offen
        s_mov_b64 exec, -1
        s_add_u32 s26, s26, s27
  ds_read2st64_b64 v[184:187], v204 offset0:12 offset1:14
  ds_read2st64_b64 v[188:191], v205 offset0:12 offset1:14
  s_waitcnt lgkmcnt(4)
  v_mfma_f32_32x32x16_bf16 v[152:167], v[12:15], v[192:195], v[152:167]
  v_mfma_f32_32x32x16_bf16 v[168:183], v[12:15], v[196:199], v[168:183]
        s_mov_b64 exec, s[42:43]
        buffer_load_dwordx4 v[76:79], v207, s[8:11], s26 offen
        s_mov_b64 exec, -1
        s_add_u32 s26, s26, s27
  s_waitcnt vmcnt(13)
  s_barrier
  ds_read2st64_b64 v[192:195], v204 offset0:16 offset1:18
  ds_read2st64_b64 v[196:199], v205 offset0:16 offset1:18
  s_waitcnt lgkmcnt(4)
  v_mfma_f32_32x32x16_bf16 v[152:167], v[16:19], v[248:251], v[152:167]
  v_mfma_f32_32x32x16_bf16 v[168:183], v[16:19], v[252:255], v[168:183]
        s_mov_b64 exec, s[42:43]
        buffer_load_dwordx4 v[80:83], v207, s[8:11], s26 offen
        s_mov_b64 exec, -1
        s_add_u32 s26, s26, s27
  ds_read2st64_b64 v[248:251], v204 offset0:20 offset1:22
  ds_read2st64_b64 v[252:255], v205 offset0:20 offset1:22
  s_waitcnt lgkmcnt(4)
  v_mfma_f32_32x32x16_bf16 v[152:167], v[20:23], v[184:187], v[152:167]
  v_mfma_f32_32x32x16_bf16 v[168:183], v[20:23], v[188:191], v[168:183]
        s_mov_b64 exec, s[42:43]
        buffer_load_dwordx4 v[84:87], v207, s[8:11], s26 offen
        s_mov_b64 exec, -1
        s_add_u32 s26, s26, s27
  ds_read2st64_b64 v[184:187], v204 offset0:24 offset1:26
  ds_read2st64_b64 v[188:191], v205 offset0:24 offset1:26
  s_waitcnt lgkmcnt(4)
  v_mfma_f32_32x32x16_bf16 v[152:167], v[24:27], v[192:195], v[152:167]
  v_mfma_f32_32x32x16_bf16 v[168:183], v[24:27], v[196:199], v[168:183]
        s_mov_b32 m0, s25
        s_add_u32 s25, s25, 8192
        buffer_load_dwordx4 v206, s[8:11], s24 offen lds
        s_add_u32 s24, s24, 264192
        s_mov_b64 exec, s[42:43]
        buffer_load_dwordx4 v[88:91], v207, s[8:11], s26 offen
        s_mov_b64 exec, -1
        s_add_u32 s26, s26, s27
  ds_read2st64_b64 v[192:195], v204 offset0:28 offset1:30
  ds_read2st64_b64 v[196:199], v205 offset0:28 offset1:30
  s_waitcnt lgkmcnt(4)
  v_mfma_f32_32x32x16_bf16 v[152:167], v[28:31], v[248:251], v[152:167]
  v_mfma_f32_32x32x16_bf16 v[168:183], v[28:31], v[252:255], v[168:183]
        s_mov_b64 exec, s[42:43]
        buffer_load_dwordx4 v[92:95], v207, s[8:11], s26 offen
        s_mov_b64 exec, -1
        s_add_u32 s26, s26, s27
  s_waitcnt vmcnt(13)
  s_barrier
  ds_read2st64_b64 v[248:251], v204 offset0:32 offset1:34
  ds_read2st64_b64 v[252:255], v205 offset0:32 offset1:34
  s_waitcnt lgkmcnt(4)
  v_mfma_f32_32x32x16_bf16 v[152:167], v[32:35], v[184:187], v[152:167]
  v_mfma_f32_32x32x16_bf16 v[168:183], v[32:35], v[188:191], v[168:183]
        s_mov_b64 exec, s[42:43]
        buffer_load_dwordx4 v[96:99], v207, s[8:11], s26 offen
        s_mov_b64 exec, -1
        s_add_u32 s26, s26, s27
  ds_read2st64_b64 v[184:187], v204 offset0:36 offset1:38
  ds_read2st64_b64 v[188:191], v205 offset0:36 offset1:38
  s_waitcnt lgkmcnt(4)
  v_mfma_f32_32x32x16_bf16 v[152:167], v[36:39], v[192:195], v[152:167]
  v_mfma_f32_32x32x16_bf16 v[168:183], v[36:39], v[196:199], v[168:183]
        s_mov_b64 exec, s[42:43]
        buffer_load_dwordx4 v[100:103], v207, s[8:11], s26 offen
        s_mov_b64 exec, -1
        s_add_u32 s26, s26, s27
  ds_read2st64_b64 v[192:195], v204 offset0:40 offset1:42
  ds_read2st64_b64 v[196:199], v205 offset0:40 offset1:42
  s_waitcnt lgkmcnt(4)
  v_mfma_f32_32x32x16_bf16 v[152:167], v[40:43], v[248:251], v[152:167]
  v_mfma_f32_32x32x16_bf16 v[168:183], v[40:43], v[252:255], v[168:183]
        s_mov_b32 m0, s25
        s_add_u32 s25, s25, 8192
        buffer_load_dwordx4 v206, s[8:11], s24 offen lds
        s_add_u32 s24, s24, 264192
        s_mov_b64 exec, s[42:43]
        buffer_load_dwordx4 v[104:107], v207, s[8:11], s26 offen
        s_mov_b64 exec, -1
        s_add_u32 s26, s26, s27
  ds_read2st64_b64 v[248:251], v204 offset0:44 offset1:46
  ds_read2st64_b64 v[252:255], v205 offset0:44 offset1:46
  s_waitcnt lgkmcnt(4)
  v_mfma_f32_32x32x16_bf16 v[152:167], v[44:47], v[184:187], v[152:167]
  v_mfma_f32_32x32x16_bf16 v[168:183], v[44:47], v[188:191], v[168:183]
        s_mov_b64 exec, s[42:43]
        buffer_load_dwordx4 v[108:111], v207, s[8:11], s26 offen
        s_mov_b64 exec, -1
        s_add_u32 s26, s26, s27
  s_waitcnt vmcnt(13)
  s_barrier
  ds_read2st64_b64 v[184:187], v204 offset0:48 offset1:50
  ds_read2st64_b64 v[188:191], v205 offset0:48 offset1:50
  s_waitcnt lgkmcnt(4)
  v_mfma_f32_32x32x16_bf16 v[152:167], v[48:51], v[192:195], v[152:167]
  v_mfma_f32_32x32x16_bf16 v[168:183], v[48:51], v[196:199], v[168:183]
        s_mov_b64 exec, s[42:43]
        buffer_load_dwordx4 v[112:115], v207, s[8:11], s26 offen
        s_mov_b64 exec, -1
        s_add_u32 s26, s26, s27
  ds_read2st64_b64 v[192:195], v204 offset0:52 offset1:54
  ds_read2st64_b64 v[196:199], v205 offset0:52 offset1:54
  s_waitcnt lgkmcnt(4)
  v_mfma_f32_32x32x16_bf16 v[152:167], v[52:55], v[248:251], v[152:167]
  v_mfma_f32_32x32x16_bf16 v[168:183], v[52:55], v[252:255], v[168:183]
        s_mov_b64 exec, s[42:43]
        buffer_load_dwordx4 v[116:119], v207, s[8:11], s26 offen
        s_mov_b64 exec, -1
        s_add_u32 s26, s26, s27
  ds_read2st64_b64 v[248:251], v204 offset0:56 offset1:58
  ds_read2st64_b64 v[252:255], v205 offset0:56 offset1:58
  s_waitcnt lgkmcnt(4)
  v_mfma_f32_32x32x16_bf16 v[152:167], v[56:59], v[184:187], v[152:167]
  v_mfma_f32_32x32x16_bf16 v[168:183], v[56:59], v[188:191], v[168:183]
        s_mov_b32 m0, s25
        s_add_u32 s25, s25, 8192
        buffer_load_dwordx4 v206, s[8:11], s24 offen lds
        s_add_u32 s24, s24, 264192
        s_mov_b64 exec, s[42:43]
        buffer_load_dwordx4 v[120:123], v207, s[8:11], s26 offen
        s_mov_b64 exec, -1
        s_add_u32 s26, s26, s27
  ds_read2st64_b64 v[184:187], v204 offset0:60 offset1:62
  ds_read2st64_b64 v[188:191], v205 offset0:60 offset1:62
  s_waitcnt lgkmcnt(4)
  v_mfma_f32_32x32x16_bf16 v[152:167], v[60:63], v[192:195], v[152:167]
  v_mfma_f32_32x32x16_bf16 v[168:183], v[60:63], v[196:199], v[168:183]
        s_mov_b64 exec, s[42:43]
        buffer_load_dwordx4 v[124:127], v207, s[8:11], s26 offen
        s_mov_b64 exec, -1
        s_add_u32 s26, s26, s27
  s_waitcnt vmcnt(13)
  s_barrier
  ds_read2st64_b64 v[192:195], v204 offset0:64 offset1:66
  ds_read2st64_b64 v[196:199], v205 offset0:64 offset1:66
  s_waitcnt lgkmcnt(4)
  v_mfma_f32_32x32x16_bf16 v[152:167], v[64:67], v[248:251], v[152:167]
  v_mfma_f32_32x32x16_bf16 v[168:183], v[64:67], v[252:255], v[168:183]
        s_mov_b64 exec, s[42:43]
        buffer_load_dwordx4 v[128:131], v207, s[8:11], s26 offen
        s_mov_b64 exec, -1
        s_add_u32 s26, s26, s27
  ds_read2st64_b64 v[248:251], v204 offset0:68 offset1:70
  ds_read2st64_b64 v[252:255], v205 offset0:68 offset1:70
  s_waitcnt lgkmcnt(4)
  v_mfma_f32_32x32x16_bf16 v[152:167], v[68:71], v[184:187], v[152:167]
  v_mfma_f32_32x32x16_bf16 v[168:183], v[68:71], v[188:191], v[168:183]
        s_mov_b64 exec, s[42:43]
        buffer_load_dwordx4 v[132:135], v207, s[8:11], s26 offen
        s_mov_b64 exec, -1
        s_add_u32 s26, s26, s27
  ds_read2st64_b64 v[184:187], v204 offset0:72 offset1:74
  ds_read2st64_b64 v[188:191], v205 offset0:72 offset1:74
  s_waitcnt lgkmcnt(4)
  v_mfma_f32_32x32x16_bf16 v[152:167], v[72:75], v[192:195], v[152:167]
  v_mfma_f32_32x32x16_bf16 v[168:183], v[72:75], v[196:199], v[168:183]
        s_mov_b32 m0, s25
        s_add_u32 s25, s25, 8192
        buffer_load_dwordx4 v206, s[8:11], s24 offen lds
        s_add_u32 s24, s24, 264192
        s_mov_b64 exec, s[42:43]
        buffer_load_dwordx4 v[136:139], v207, s[8:11], s26 offen
        s_mov_b64 exec, -1
        s_add_u32 s26, s26, s27
  ds_read2st64_b64 v[192:195], v204 offset0:76 offset1:78
  ds_read2st64_b64 v[196:199], v205 offset0:76 offset1:78
  s_waitcnt lgkmcnt(4)
  v_mfma_f32_32x32x16_bf16 v[152:167], v[76:79], v[248:251], v[152:167]
  v_mfma_f32_32x32x16_bf16 v[168:183], v[76:79], v[252:255], v[168:183]
        s_mov_b64 exec, s[42:43]
        buffer_load_dwordx4 v[140:143], v207, s[8:11], s26 offen
        s_mov_b64 exec, -1
        s_add_u32 s26, s26, s27
  s_waitcnt vmcnt(13)
  s_barrier
  ds_read2st64_b64 v[248:251], v204 offset0:80 offset1:82
  ds_read2st64_b64 v[252:255], v205 offset0:80 offset1:82
  s_waitcnt lgkmcnt(4)
  v_mfma_f32_32x32x16_bf16 v[152:167], v[80:83], v[184:187], v[152:167]
  v_mfma_f32_32x32x16_bf16 v[168:183], v[80:83], v[188:191], v[168:183]
        s_mov_b64 exec, s[42:43]
        buffer_load_dwordx4 v[144:147], v207, s[8:11], s26 offen
        s_mov_b64 exec, -1
        s_add_u32 s26, s26, s27
  ds_read2st64_b64 v[184:187], v204 offset0:84 offset1:86
  ds_read2st64_b64 v[188:191], v205 offset0:84 offset1:86
  s_waitcnt lgkmcnt(4)
  v_mfma_f32_32x32x16_bf16 v[152:167], v[84:87], v[192:195], v[152:167]
  v_mfma_f32_32x32x16_bf16 v[168:183], v[84:87], v[196:199], v[168:183]
        s_mov_b64 exec, s[42:43]
        buffer_load_dwordx4 v[148:151], v207, s[8:11], s26 offen
        s_mov_b64 exec, -1
        s_add_u32 s26, s26, s27
  ds_read2st64_b64 v[192:195], v204 offset0:88 offset1:90
  ds_read2st64_b64 v[196:199], v205 offset0:88 offset1:90
  s_waitcnt lgkmcnt(4)
  v_mfma_f32_32x32x16_bf16 v[152:167], v[88:91], v[248:251], v[152:167]
  v_mfma_f32_32x32x16_bf16 v[168:183], v[88:91], v[252:255], v[168:183]
  ds_read2st64_b64 v[248:251], v204 offset0:92 offset1:94
  ds_read2st64_b64 v[252:255], v205 offset0:92 offset1:94
  s_waitcnt lgkmcnt(4)
  v_mfma_f32_32x32x16_bf16 v[152:167], v[92:95], v[184:187], v[152:167]
  v_mfma_f32_32x32x16_bf16 v[168:183], v[92:95], v[188:191], v[168:183]
  s_waitcnt vmcnt(10)
  s_barrier
  ds_read2st64_b64 v[184:187], v204 offset0:96 offset1:98
  ds_read2st64_b64 v[188:191], v205 offset0:96 offset1:98
  s_waitcnt lgkmcnt(4)
  v_mfma_f32_32x32x16_bf16 v[152:167], v[96:99], v[192:195], v[152:167]
  v_mfma_f32_32x32x16_bf16 v[168:183], v[96:99], v[196:199], v[168:183]
  ds_read2st64_b64 v[192:195], v204 offset0:100 offset1:102
  ds_read2st64_b64 v[196:199], v205 offset0:100 offset1:102
  s_waitcnt lgkmcnt(4)
  v_mfma_f32_32x32x16_bf16 v[152:167], v[100:103], v[248:251], v[152:167]
  v_mfma_f32_32x32x16_bf16 v[168:183], v[100:103], v[252:255], v[168:183]
  ds_read2st64_b64 v[248:251], v204 offset0:104 offset1:106
  ds_read2st64_b64 v[252:255], v205 offset0:104 offset1:106
  s_waitcnt lgkmcnt(4)
  v_mfma_f32_32x32x16_bf16 v[152:167], v[104:107], v[184:187], v[152:167]
  v_mfma_f32_32x32x16_bf16 v[168:183], v[104:107], v[188:191], v[168:183]
  ds_read2st64_b64 v[184:187], v204 offset0:108 offset1:110
  ds_read2st64_b64 v[188:191], v205 offset0:108 offset1:110
  s_waitcnt lgkmcnt(4)
  v_mfma_f32_32x32x16_bf16 v[152:167], v[108:111], v[192:195], v[152:167]
  v_mfma_f32_32x32x16_bf16 v[168:183], v[108:111], v[196:199], v[168:183]
  s_waitcnt vmcnt(5)
  s_barrier
  ds_read2st64_b64 v[192:195], v204 offset0:112 offset1:114
  ds_read2st64_b64 v[196:199], v205 offset0:112 offset1:114
  s_waitcnt lgkmcnt(4)
  v_mfma_f32_32x32x16_bf16 v[152:167], v[112:115], v[248:251], v[152:167]
  v_mfma_f32_32x32x16_bf16 v[168:183], v[112:115], v[252:255], v[168:183]
  ds_read2st64_b64 v[248:251], v204 offset0:116 offset1:118
  ds_read2st64_b64 v[252:255], v205 offset0:116 offset1:118
  s_waitcnt lgkmcnt(4)
  v_mfma_f32_32x32x16_bf16 v[152:167], v[116:119], v[184:187], v[152:167]
  v_mfma_f32_32x32x16_bf16 v[168:183], v[116:119], v[188:191], v[168:183]
  ds_read2st64_b64 v[184:187], v204 offset0:120 offset1:122
  ds_read2st64_b64 v[188:191], v205 offset0:120 offset1:122
  s_waitcnt lgkmcnt(4)
  v_mfma_f32_32x32x16_bf16 v[152:167], v[120:123], v[192:195], v[152:167]
  v_mfma_f32_32x32x16_bf16 v[168:183], v[120:123], v[196:199], v[168:183]
  ds_read2st64_b64 v[192:195], v204 offset0:124 offset1:126
  ds_read2st64_b64 v[196:199], v205 offset0:124 offset1:126
  s_waitcnt lgkmcnt(4)
  v_mfma_f32_32x32x16_bf16 v[152:167], v[124:127], v[248:251], v[152:167]
  v_mfma_f32_32x32x16_bf16 v[168:183], v[124:127], v[252:255], v[168:183]
  s_waitcnt vmcnt(0)
  s_barrier
  ds_read2st64_b64 v[248:251], v204 offset0:128 offset1:130
  ds_read2st64_b64 v[252:255], v205 offset0:128 offset1:130
  s_waitcnt lgkmcnt(4)
  v_mfma_f32_32x32x16_bf16 v[152:167], v[128:131], v[184:187], v[152:167]
  v_mfma_f32_32x32x16_bf16 v[168:183], v[128:131], v[188:191], v[168:183]
  ds_read2st64_b64 v[184:187], v204 offset0:132 offset1:134
  ds_read2st64_b64 v[188:191], v205 offset0:132 offset1:134
  s_waitcnt lgkmcnt(4)
  v_mfma_f32_32x32x16_bf16 v[152:167], v[132:135], v[192:195], v[152:167]
  v_mfma_f32_32x32x16_bf16 v[168:183], v[132:135], v[196:199], v[168:183]
  ds_read2st64_b64 v[192:195], v204 offset0:136 offset1:138
  ds_read2st64_b64 v[196:199], v205 offset0:136 offset1:138
  s_waitcnt lgkmcnt(4)
  v_mfma_f32_32x32x16_bf16 v[152:167], v[136:139], v[248:251], v[152:167]
  v_mfma_f32_32x32x16_bf16 v[168:183], v[136:139], v[252:255], v[168:183]
  ds_read2st64_b64 v[248:251], v204 offset0:140 offset1:142
  ds_read2st64_b64 v[252:255], v205 offset0:140 offset1:142
  s_waitcnt lgkmcnt(4)
  v_mfma_f32_32x32x16_bf16 v[152:167], v[140:143], v[184:187], v[152:167]
  v_mfma_f32_32x32x16_bf16 v[168:183], v[140:143], v[188:191], v[168:183]
  s_waitcnt lgkmcnt(2)
  v_mfma_f32_32x32x16_bf16 v[152:167], v[144:147], v[192:195], v[152:167]
  v_mfma_f32_32x32x16_bf16 v[168:183], v[144:147], v[196:199], v[168:183]
  s_waitcnt lgkmcnt(0)
  v_mfma_f32_32x32x16_bf16 v[152:167], v[148:151], v[248:251], v[152:167]
  v_mfma_f32_32x32x16_bf16 v[168:183], v[148:151], v[252:255], v[168:183]
  s_barrier
    v_and_b32 v209, 31, v208
    v_lshlrev_b32 v209, 2, v209
    v_add_u32 v209, 73728, v209
    ds_read_b32 v200, v209
    ds_read_b32 v201, v209 offset:128
    s_lshl_b32 s30, s21, 1
    s_waitcnt lgkmcnt(0)
    s_cmp_eq_u32 s20, 2
    s_cbranch_scc1 kfa_kernel_tail
    v_lshlrev_b32 v214, 4, v208
    s_lshl_b32 s31, s20, 11
    v_add_u32 v214, s31, v214
    v_add_u32 v214, 74240, v214
  v_mul_f32 v211, 0x3eae1a93, v200
  v_mul_f32 v152, v152, v211
  v_mul_f32 v153, v153, v211
  v_mul_f32 v154, v154, v211
  v_mul_f32 v155, v155, v211
  v_mul_f32 v156, v156, v211
  v_mul_f32 v157, v157, v211
  v_mul_f32 v158, v158, v211
  v_mul_f32 v159, v159, v211
  v_cvt_pk_bf16_f32 v216, v152, v153
  v_cvt_pk_bf16_f32 v217, v154, v155
  v_cvt_pk_bf16_f32 v218, v156, v157
  v_cvt_pk_bf16_f32 v219, v158, v159
  ds_write_b128 v214, v[216:219] offset:0
  v_mul_f32 v160, v160, v211
  v_mul_f32 v161, v161, v211
  v_mul_f32 v162, v162, v211
  v_mul_f32 v163, v163, v211
  v_mul_f32 v164, v164, v211
  v_mul_f32 v165, v165, v211
  v_mul_f32 v166, v166, v211
  v_mul_f32 v167, v167, v211
  v_cvt_pk_bf16_f32 v220, v160, v161
  v_cvt_pk_bf16_f32 v221, v162, v163
  v_cvt_pk_bf16_f32 v222, v164, v165
  v_cvt_pk_bf16_f32 v223, v166, v167
  ds_write_b128 v214, v[220:223] offset:1024
  v_mul_f32 v211, 0x3eae1a93, v201
  v_mul_f32 v168, v168, v211
  v_mul_f32 v169, v169, v211
  v_mul_f32 v170, v170, v211
  v_mul_f32 v171, v171, v211
  v_mul_f32 v172, v172, v211
  v_mul_f32 v173, v173, v211
  v_mul_f32 v174, v174, v211
  v_mul_f32 v175, v175, v211
  v_cvt_pk_bf16_f32 v224, v168, v169
  v_cvt_pk_bf16_f32 v225, v170, v171
  v_cvt_pk_bf16_f32 v226, v172, v173
  v_cvt_pk_bf16_f32 v227, v174, v175
  ds_write_b128 v214, v[224:227] offset:4096
  v_mul_f32 v176, v176, v211
  v_mul_f32 v177, v177, v211
  v_mul_f32 v178, v178, v211
  v_mul_f32 v179, v179, v211
  v_mul_f32 v180, v180, v211
  v_mul_f32 v181, v181, v211
  v_mul_f32 v182, v182, v211
  v_mul_f32 v183, v183, v211
  v_cvt_pk_bf16_f32 v228, v176, v177
  v_cvt_pk_bf16_f32 v229, v178, v179
  v_cvt_pk_bf16_f32 v230, v180, v181
  v_cvt_pk_bf16_f32 v231, v182, v183
  ds_write_b128 v214, v[228:231] offset:5120
  v_mul_f32 v232, v152, v152
  v_fmac_f32 v232, v153, v153
  v_fmac_f32 v232, v154, v154
  v_fmac_f32 v232, v155, v155
  v_fmac_f32 v232, v156, v156
  v_fmac_f32 v232, v157, v157
  v_fmac_f32 v232, v158, v158
  v_fmac_f32 v232, v159, v159
  v_mul_f32 v233, v160, v160
  v_fmac_f32 v233, v161, v161
  v_fmac_f32 v233, v162, v162
  v_fmac_f32 v233, v163, v163
  v_fmac_f32 v233, v164, v164
  v_fmac_f32 v233, v165, v165
  v_fmac_f32 v233, v166, v166
  v_fmac_f32 v233, v167, v167
  v_mul_f32 v234, v168, v168
  v_fmac_f32 v234, v169, v169
  v_fmac_f32 v234, v170, v170
  v_fmac_f32 v234, v171, v171
  v_fmac_f32 v234, v172, v172
  v_fmac_f32 v234, v173, v173
  v_fmac_f32 v234, v174, v174
  v_fmac_f32 v234, v175, v175
  v_mul_f32 v235, v176, v176
  v_fmac_f32 v235, v177, v177
  v_fmac_f32 v235, v178, v178
  v_fmac_f32 v235, v179, v179
  v_fmac_f32 v235, v180, v180
  v_fmac_f32 v235, v181, v181
  v_fmac_f32 v235, v182, v182
  v_fmac_f32 v235, v183, v183
    v_mov_b32 v209, v232
    v_mov_b32 v210, v232
  s_nop 1
    v_permlane32_swap_b32 v209, v210
    v_add_f32 v232, v209, v210
    v_mov_b32 v209, v233
    v_mov_b32 v210, v233
  s_nop 1
    v_permlane32_swap_b32 v209, v210
    v_add_f32 v233, v209, v210
    v_mov_b32 v209, v234
    v_mov_b32 v210, v234
  s_nop 1
    v_permlane32_swap_b32 v209, v210
    v_add_f32 v234, v209, v210
    v_mov_b32 v209, v235
    v_mov_b32 v210, v235
  s_nop 1
    v_permlane32_swap_b32 v209, v210
    v_add_f32 v235, v209, v210
  v_max3_f32 v212, v232, v233, v234
  v_max_f32 v212, v212, v235
  s_nop 1
  v_max_f32_dpp v212, v212, v212 row_ror:1 row_mask:0xf bank_mask:0xf
  s_nop 1
  v_max_f32_dpp v212, v212, v212 row_ror:2 row_mask:0xf bank_mask:0xf
  s_nop 1
  v_max_f32_dpp v212, v212, v212 row_ror:4 row_mask:0xf bank_mask:0xf
  s_nop 1
  v_max_f32_dpp v212, v212, v212 row_ror:8 row_mask:0xf bank_mask:0xf
    v_mov_b32 v209, v212
    v_mov_b32 v210, v212
  s_nop 1
    v_permlane16_swap_b32 v209, v210
    v_max_f32 v212, v209, v210
    v_mov_b32 v209, v212
    v_mov_b32 v210, v212
  s_nop 1
    v_permlane32_swap_b32 v209, v210
    v_max_f32 v212, v209, v210
    s_lshl_b32 s31, s20, 2
    s_add_u32 s31, s31, 83456
    v_mov_b32 v209, s31
    ds_write_b32 v209, v212
    s_branch kfa_kernel_adone
kfa_kernel_tail:
    s_cmp_lg_u32 s22, 0
    s_cbranch_scc1 kfa_kernel_nok
    s_lshr_b32 s34, s21, 2
    s_mul_i32 s34, s34, 19456
    s_add_u32 s34, s34, 18038784
    s_and_b32 s35, s21, 3
    s_lshl_b32 s35, s35, 1
    v_lshlrev_b32 v214, 4, v208
    v_lshlrev_b32 v204, 3, v208
  v_mul_f32 v156, v156, v200
  v_mul_f32 v157, v157, v200
  v_mul_f32 v158, v158, v200
  v_mul_f32 v159, v159, v200
  v_mul_f32 v160, v160, v200
  v_mul_f32 v161, v161, v200
  v_mul_f32 v162, v162, v200
  v_mul_f32 v163, v163, v200
  v_mul_f32 v164, v164, v200
  v_cvt_pk_bf16_f32 v220, v156, v157
  v_cvt_pk_bf16_f32 v221, v158, v159
  v_cvt_pk_bf16_f32 v222, v160, v161
  v_cvt_pk_bf16_f32 v223, v162, v163
        v_cvt_pk_bf16_f32 v228, v164, v164
        s_add_u32 s33, s35, 0
        s_lshl_b32 s38, s33, 10
        s_add_u32 s38, s38, s34
        buffer_store_dwordx4 v[220:223], v214, s[8:11], s38 offen sc1
        s_lshr_b32 s38, s33, 2
        s_lshl_b32 s38, s38, 9
        s_and_b32 s33, s33, 3
        s_lshl_b32 s33, s33, 1
        s_add_u32 s38, s38, s33
        s_add_u32 s38, s38, s34
        s_add_u32 s38, s38, 8192
        buffer_store_short v228, v204, s[8:11], s38 offen sc1
        v_mul_f32 v240, v156, v156
  v_fmac_f32 v240, v157, v157
  v_fmac_f32 v240, v158, v158
  v_fmac_f32 v240, v159, v159
  v_fmac_f32 v240, v160, v160
  v_fmac_f32 v240, v161, v161
  v_fmac_f32 v240, v162, v162
  v_fmac_f32 v240, v163, v163
  v_fmac_f32 v240, v164, v164
  v_mul_f32 v172, v172, v201
  v_mul_f32 v173, v173, v201
  v_mul_f32 v174, v174, v201
  v_mul_f32 v175, v175, v201
  v_mul_f32 v176, v176, v201
  v_mul_f32 v177, v177, v201
  v_mul_f32 v178, v178, v201
  v_mul_f32 v179, v179, v201
  v_mul_f32 v180, v180, v201
  v_cvt_pk_bf16_f32 v224, v172, v173
  v_cvt_pk_bf16_f32 v225, v174, v175
  v_cvt_pk_bf16_f32 v226, v176, v177
  v_cvt_pk_bf16_f32 v227, v178, v179
        v_cvt_pk_bf16_f32 v229, v180, v180
        s_add_u32 s33, s35, 1
        s_lshl_b32 s38, s33, 10
        s_add_u32 s38, s38, s34
        buffer_store_dwordx4 v[224:227], v214, s[8:11], s38 offen sc1
        s_lshr_b32 s38, s33, 2
        s_lshl_b32 s38, s38, 9
        s_and_b32 s33, s33, 3
        s_lshl_b32 s33, s33, 1
        s_add_u32 s38, s38, s33
        s_add_u32 s38, s38, s34
        s_add_u32 s38, s38, 8192
        buffer_store_short v229, v204, s[8:11], s38 offen sc1
        v_mul_f32 v241, v172, v172
  v_fmac_f32 v241, v173, v173
  v_fmac_f32 v241, v174, v174
  v_fmac_f32 v241, v175, v175
  v_fmac_f32 v241, v176, v176
  v_fmac_f32 v241, v177, v177
  v_fmac_f32 v241, v178, v178
  v_fmac_f32 v241, v179, v179
  v_fmac_f32 v241, v180, v180
    v_mov_b32 v209, v240
    v_mov_b32 v210, v240
  s_nop 1
    v_permlane32_swap_b32 v209, v210
    v_add_f32 v240, v209, v210
    v_mov_b32 v209, v241
    v_mov_b32 v210, v241
  s_nop 1
    v_permlane32_swap_b32 v209, v210
    v_add_f32 v241, v209, v210
  v_max_f32 v212, v240, v241
  s_nop 1
  v_max_f32_dpp v212, v212, v212 row_ror:1 row_mask:0xf bank_mask:0xf
  s_nop 1
  v_max_f32_dpp v212, v212, v212 row_ror:2 row_mask:0xf bank_mask:0xf
  s_nop 1
  v_max_f32_dpp v212, v212, v212 row_ror:4 row_mask:0xf bank_mask:0xf
  s_nop 1
  v_max_f32_dpp v212, v212, v212 row_ror:8 row_mask:0xf bank_mask:0xf
    v_mov_b32 v209, v212
    v_mov_b32 v210, v212
  s_nop 1
    v_permlane16_swap_b32 v209, v210
    v_max_f32 v212, v209, v210
    v_mov_b32 v209, v212
    v_mov_b32 v210, v212
  s_nop 1
    v_permlane32_swap_b32 v209, v210
    v_max_f32 v212, v209, v210
    s_lshl_b32 s33, s21, 2
    s_add_u32 s33, s33, 9539584
    v_mov_b32 v210, 0
    s_mov_b64 exec, 1
    buffer_store_dword v212, v210, s[8:11], s33 offen sc1
    s_mov_b64 exec, -1
  s_waitcnt vmcnt(0)
        v_lshlrev_b32 v209, 7, v208
        v_mov_b32 v210, 1
        s_and_b32 s33, s21, 7
        s_lshl_b32 s33, s33, 10
        s_add_u32 s33, s33, 26214400
        s_mov_b64 exec, 0xff
        buffer_atomic_add v210, v209, s[8:11], s33 offen sc1
        s_mov_b64 exec, -1
kfa_kernel_nok:
    v_lshlrev_b32 v214, 3, v208
    v_add_u32 v214, 82432, v214
  v_mul_f32 v211, 0x3eae1a93, v200
  v_mul_f32 v152, v152, v211
  v_mul_f32 v153, v153, v211
  v_mul_f32 v154, v154, v211
  v_mul_f32 v155, v155, v211
        v_cvt_pk_bf16_f32 v216, v152, v153
        v_cvt_pk_bf16_f32 v217, v154, v155
        ds_write_b64 v214, v[216:217] offset:0
  v_mul_f32 v232, v152, v152
  v_mul_f32 v233, v153, v153
  v_mul_f32 v234, v154, v154
  v_mul_f32 v235, v155, v155
  v_mul_f32 v211, 0x3eae1a93, v201
  v_mul_f32 v168, v168, v211
  v_mul_f32 v169, v169, v211
  v_mul_f32 v170, v170, v211
  v_mul_f32 v171, v171, v211
        v_cvt_pk_bf16_f32 v218, v168, v169
        v_cvt_pk_bf16_f32 v219, v170, v171
        ds_write_b64 v214, v[218:219] offset:512
  v_mul_f32 v236, v168, v168
  v_mul_f32 v237, v169, v169
  v_mul_f32 v238, v170, v170
  v_mul_f32 v239, v171, v171
    v_mov_b32 v209, v232
    v_mov_b32 v210, v232
  s_nop 1
    v_permlane32_swap_b32 v209, v210
    v_add_f32 v232, v209, v210
    v_mov_b32 v209, v233
    v_mov_b32 v210, v233
  s_nop 1
    v_permlane32_swap_b32 v209, v210
    v_add_f32 v233, v209, v210
    v_mov_b32 v209, v234
    v_mov_b32 v210, v234
  s_nop 1
    v_permlane32_swap_b32 v209, v210
    v_add_f32 v234, v209, v210
    v_mov_b32 v209, v235
    v_mov_b32 v210, v235
  s_nop 1
    v_permlane32_swap_b32 v209, v210
    v_add_f32 v235, v209, v210
    v_mov_b32 v209, v236
    v_mov_b32 v210, v236
  s_nop 1
    v_permlane32_swap_b32 v209, v210
    v_add_f32 v236, v209, v210
    v_mov_b32 v209, v237
    v_mov_b32 v210, v237
  s_nop 1
    v_permlane32_swap_b32 v209, v210
    v_add_f32 v237, v209, v210
    v_mov_b32 v209, v238
    v_mov_b32 v210, v238
  s_nop 1
    v_permlane32_swap_b32 v209, v210
    v_add_f32 v238, v209, v210
    v_mov_b32 v209, v239
    v_mov_b32 v210, v239
  s_nop 1
    v_permlane32_swap_b32 v209, v210
    v_add_f32 v239, v209, v210
    v_max3_f32 v212, v232, v233, v234
    v_max3_f32 v212, v212, v235, v236
    v_max3_f32 v212, v212, v237, v238
    v_max_f32 v212, v212, v239
  s_nop 1
  v_max_f32_dpp v212, v212, v212 row_ror:1 row_mask:0xf bank_mask:0xf
  s_nop 1
  v_max_f32_dpp v212, v212, v212 row_ror:2 row_mask:0xf bank_mask:0xf
  s_nop 1
  v_max_f32_dpp v212, v212, v212 row_ror:4 row_mask:0xf bank_mask:0xf
  s_nop 1
  v_max_f32_dpp v212, v212, v212 row_ror:8 row_mask:0xf bank_mask:0xf
    v_mov_b32 v209, v212
    v_mov_b32 v210, v212
  s_nop 1
    v_permlane16_swap_b32 v209, v210
    v_max_f32 v212, v209, v210
    v_mov_b32 v209, v212
    v_mov_b32 v210, v212
  s_nop 1
    v_permlane32_swap_b32 v209, v210
    v_max_f32 v212, v209, v210
    v_mov_b32 v209, 83464
    ds_write_b32 v209, v212
    s_branch kfa_kernel_adone
kfa_kernel_vrole:
    s_lshl_b32 s34, s48, 8
    v_add_u32 v204, s34, v204
        s_mov_b32 m0, s25
        s_add_u32 s25, s25, 8192
        buffer_load_dwordx4 v206, s[8:11], s24 offen lds
        s_add_u32 s24, s24, 264192
        s_mov_b64 exec, s[42:43]
        buffer_load_dwordx4 v[8:11], v207, s[8:11], s26 offen
        s_mov_b64 exec, -1
        s_add_u32 s26, s26, s27
        s_mov_b64 exec, s[42:43]
        buffer_load_dwordx4 v[12:15], v207, s[8:11], s26 offen
        s_mov_b64 exec, -1
        s_add_u32 s26, s26, s27
        s_mov_b64 exec, s[42:43]
        buffer_load_dwordx4 v[16:19], v207, s[8:11], s26 offen
        s_mov_b64 exec, -1
        s_add_u32 s26, s26, s27
        s_mov_b64 exec, s[42:43]
        buffer_load_dwordx4 v[20:23], v207, s[8:11], s26 offen
        s_mov_b64 exec, -1
        s_add_u32 s26, s26, s27
  s_barrier
        s_mov_b32 m0, s25
        s_add_u32 s25, s25, 8192
        buffer_load_dwordx4 v206, s[8:11], s24 offen lds
        s_add_u32 s24, s24, 264192
        s_mov_b64 exec, s[42:43]
        buffer_load_dwordx4 v[24:27], v207, s[8:11], s26 offen
        s_mov_b64 exec, -1
        s_add_u32 s26, s26, s27
        s_mov_b64 exec, s[42:43]
        buffer_load_dwordx4 v[28:31], v207, s[8:11], s26 offen
        s_mov_b64 exec, -1
        s_add_u32 s26, s26, s27
        s_mov_b64 exec, s[42:43]
        buffer_load_dwordx4 v[32:35], v207, s[8:11], s26 offen
        s_mov_b64 exec, -1
        s_add_u32 s26, s26, s27
        s_mov_b64 exec, s[42:43]
        buffer_load_dwordx4 v[36:39], v207, s[8:11], s26 offen
        s_mov_b64 exec, -1
        s_add_u32 s26, s26, s27
  s_barrier
        s_mov_b32 m0, s25
        s_add_u32 s25, s25, 8192
        buffer_load_dwordx4 v206, s[8:11], s24 offen lds
        s_add_u32 s24, s24, 264192
        s_mov_b64 exec, s[42:43]
        buffer_load_dwordx4 v[40:43], v207, s[8:11], s26 offen
        s_mov_b64 exec, -1
        s_add_u32 s26, s26, s27
        s_mov_b64 exec, s[42:43]
        buffer_load_dwordx4 v[44:47], v207, s[8:11], s26 offen
        s_mov_b64 exec, -1
        s_add_u32 s26, s26, s27
        s_mov_b64 exec, s[42:43]
        buffer_load_dwordx4 v[48:51], v207, s[8:11], s26 offen
        s_mov_b64 exec, -1
        s_add_u32 s26, s26, s27
        s_mov_b64 exec, s[42:43]
        buffer_load_dwordx4 v[52:55], v207, s[8:11], s26 offen
        s_mov_b64 exec, -1
        s_add_u32 s26, s26, s27
        s_mov_b32 m0, s25
        s_add_u32 s25, s25, 8192
        buffer_load_dwordx4 v206, s[8:11], s24 offen lds
        s_add_u32 s24, s24, 264192
        s_mov_b64 exec, s[42:43]
        buffer_load_dwordx4 v[56:59], v207, s[8:11], s26 offen
        s_mov_b64 exec, -1
        s_add_u32 s26, s26, s27
        s_mov_b64 exec, s[42:43]
        buffer_load_dwordx4 v[60:63], v207, s[8:11], s26 offen
        s_mov_b64 exec, -1
        s_add_u32 s26, s26, s27
        s_mov_b64 exec, s[42:43]
        buffer_load_dwordx4 v[64:67], v207, s[8:11], s26 offen
        s_mov_b64 exec, -1
        s_add_u32 s26, s26, s27
        s_mov_b64 exec, s[42:43]
        buffer_load_dwordx4 v[68:71], v207, s[8:11], s26 offen
        s_mov_b64 exec, -1
        s_add_u32 s26, s26, s27
        v_and_b32 v210, 31, v208
        v_lshrrev_b32 v211, 5, v208
        v_lshlrev_b32 v213, 4, v211
        s_lshl_b32 s34, s48, 7
        s_add_u32 s34, s34, 73728
        v_add_u32 v213, s34, v213
  v_mov_b32 v214, v210
  v_add_u32 v216, 6, v210
  v_subrev_u32 v217, 4, v210
  v_cmp_gt_u32 vcc, 8, v217
  s_nop 1
  v_cndmask_b32 v214, v214, v216, vcc
  v_subrev_u32 v216, 8, v210
  v_subrev_u32 v217, 12, v210
  v_cmp_gt_u32 vcc, 4, v217
  s_nop 1
  v_cndmask_b32 v214, v214, v216, vcc
  v_add_u32 v216, 2, v210
  v_subrev_u32 v217, 16, v210
  v_cmp_gt_u32 vcc, 2, v217
  s_nop 1
  v_cndmask_b32 v214, v214, v216, vcc
  v_subrev_u32 v216, 12, v210
  v_subrev_u32 v217, 20, v210
  v_cmp_gt_u32 vcc, 2, v217
  s_nop 1
  v_cndmask_b32 v214, v214, v216, vcc
  v_mov_b32 v216, 10
  v_subrev_u32 v217, 18, v210
  v_cmp_gt_u32 vcc, 2, v217
  s_nop 1
  v_cndmask_b32 v214, v214, v216, vcc
  v_mov_b32 v216, 10
  v_subrev_u32 v217, 28, v210
  v_cmp_gt_u32 vcc, 4, v217
  s_nop 1
  v_cndmask_b32 v214, v214, v216, vcc
  v_mov_b32 v216, 0
  v_subrev_u32 v217, 22, v210
  v_cmp_gt_u32 vcc, 6, v217
  s_nop 1
  v_cndmask_b32 v214, v214, v216, vcc
        v_lshlrev_b32 v214, 4, v214
        v_mul_u32_u24 v211, 320, v211
        v_add_u32 v214, v214, v211
        s_lshr_b32 s49, s21, 2
        s_mul_i32 s49, s49, 19456
        s_add_u32 s49, s49, 18048000
        s_and_b32 s35, s21, 3
        s_lshl_b32 s35, s35, 1
        s_add_u32 s35, s35, s48
        s_mul_i32 s35, s35, 1280
        s_add_u32 s49, s49, s35
        v_cmp_gt_u32 s[38:39], 18, v210
        v_subrev_u32 v211, 20, v210
        v_cmp_gt_u32 s[40:41], 2, v211
  s_nop 3
        s_or_b64 s[38:39], s[38:39], s[40:41]
        v_and_b32 v211, 27, v210
        v_cmp_eq_u32 s[40:41], 17, v211
        v_mov_b32 v212, 0x3f803f80
  s_waitcnt vmcnt(15)
  s_barrier
  ds_read2st64_b64 v[184:187], v204 offset0:0 offset1:2
  ds_read2st64_b64 v[192:195], v204 offset0:4 offset1:6
  ds_read2st64_b64 v[248:251], v204 offset0:8 offset1:10
  s_waitcnt lgkmcnt(2)
  v_mfma_f32_32x32x16_bf16 v[152:167], v[184:187], v[8:11], 0
        s_mov_b32 m0, s25
        s_add_u32 s25, s25, 8192
        buffer_load_dwordx4 v206, s[8:11], s24 offen lds
        s_add_u32 s24, s24, 264192
        s_mov_b64 exec, s[42:43]
        buffer_load_dwordx4 v[72:75], v207, s[8:11], s26 offen
        s_mov_b64 exec, -1
        s_add_u32 s26, s26, s27
  ds_read2st64_b64 v[184:187], v204 offset0:12 offset1:14
  s_waitcnt lgkmcnt(2)
  v_mfma_f32_32x32x16_bf16 v[168:183], v[192:195], v[12:15], 0
        s_mov_b64 exec, s[42:43]
        buffer_load_dwordx4 v[76:79], v207, s[8:11], s26 offen
        s_mov_b64 exec, -1
        s_add_u32 s26, s26, s27
  s_waitcnt vmcnt(13)
  s_barrier
  ds_read2st64_b64 v[192:195], v204 offset0:16 offset1:18
  s_waitcnt lgkmcnt(2)
  v_mfma_f32_32x32x16_bf16 v[152:167], v[248:251], v[16:19], v[152:167]
        s_mov_b64 exec, s[42:43]
        buffer_load_dwordx4 v[80:83], v207, s[8:11], s26 offen
        s_mov_b64 exec, -1
        s_add_u32 s26, s26, s27
  ds_read2st64_b64 v[248:251], v204 offset0:20 offset1:22
  s_waitcnt lgkmcnt(2)
  v_mfma_f32_32x32x16_bf16 v[168:183], v[184:187], v[20:23], v[168:183]
        s_mov_b64 exec, s[42:43]
        buffer_load_dwordx4 v[84:87], v207, s[8:11], s26 offen
        s_mov_b64 exec, -1
        s_add_u32 s26, s26, s27
  ds_read2st64_b64 v[184:187], v204 offset0:24 offset1:26
  s_waitcnt lgkmcnt(2)
  v_mfma_f32_32x32x16_bf16 v[152:167], v[192:195], v[24:27], v[152:167]
        s_mov_b32 m0, s25
        s_add_u32 s25, s25, 8192
        buffer_load_dwordx4 v206, s[8:11], s24 offen lds
        s_add_u32 s24, s24, 264192
        s_mov_b64 exec, s[42:43]
        buffer_load_dwordx4 v[88:91], v207, s[8:11], s26 offen
        s_mov_b64 exec, -1
        s_add_u32 s26, s26, s27
  ds_read2st64_b64 v[192:195], v204 offset0:28 offset1:30
  s_waitcnt lgkmcnt(2)
  v_mfma_f32_32x32x16_bf16 v[168:183], v[248:251], v[28:31], v[168:183]
        s_mov_b64 exec, s[42:43]
        buffer_load_dwordx4 v[92:95], v207, s[8:11], s26 offen
        s_mov_b64 exec, -1
        s_add_u32 s26, s26, s27
  s_waitcnt vmcnt(13)
  s_barrier
  ds_read2st64_b64 v[248:251], v204 offset0:32 offset1:34
  s_waitcnt lgkmcnt(2)
  v_mfma_f32_32x32x16_bf16 v[152:167], v[184:187], v[32:35], v[152:167]
        s_mov_b64 exec, s[42:43]
        buffer_load_dwordx4 v[96:99], v207, s[8:11], s26 offen
        s_mov_b64 exec, -1
        s_add_u32 s26, s26, s27
  ds_read2st64_b64 v[184:187], v204 offset0:36 offset1:38
  s_waitcnt lgkmcnt(2)
  v_mfma_f32_32x32x16_bf16 v[168:183], v[192:195], v[36:39], v[168:183]
        s_mov_b64 exec, s[42:43]
        buffer_load_dwordx4 v[100:103], v207, s[8:11], s26 offen
        s_mov_b64 exec, -1
        s_add_u32 s26, s26, s27
  ds_read2st64_b64 v[192:195], v204 offset0:40 offset1:42
  s_waitcnt lgkmcnt(2)
  v_mfma_f32_32x32x16_bf16 v[152:167], v[248:251], v[40:43], v[152:167]
        s_mov_b32 m0, s25
        s_add_u32 s25, s25, 8192
        buffer_load_dwordx4 v206, s[8:11], s24 offen lds
        s_add_u32 s24, s24, 264192
        s_mov_b64 exec, s[42:43]
        buffer_load_dwordx4 v[104:107], v207, s[8:11], s26 offen
        s_mov_b64 exec, -1
        s_add_u32 s26, s26, s27
  ds_read2st64_b64 v[248:251], v204 offset0:44 offset1:46
  s_waitcnt lgkmcnt(2)
  v_mfma_f32_32x32x16_bf16 v[168:183], v[184:187], v[44:47], v[168:183]
        s_mov_b64 exec, s[42:43]
        buffer_load_dwordx4 v[108:111], v207, s[8:11], s26 offen
        s_mov_b64 exec, -1
        s_add_u32 s26, s26, s27
  s_waitcnt vmcnt(13)
  s_barrier
  ds_read2st64_b64 v[184:187], v204 offset0:48 offset1:50
  s_waitcnt lgkmcnt(2)
  v_mfma_f32_32x32x16_bf16 v[152:167], v[192:195], v[48:51], v[152:167]
        s_mov_b64 exec, s[42:43]
        buffer_load_dwordx4 v[112:115], v207, s[8:11], s26 offen
        s_mov_b64 exec, -1
        s_add_u32 s26, s26, s27
  ds_read2st64_b64 v[192:195], v204 offset0:52 offset1:54
  s_waitcnt lgkmcnt(2)
  v_mfma_f32_32x32x16_bf16 v[168:183], v[248:251], v[52:55], v[168:183]
        s_mov_b64 exec, s[42:43]
        buffer_load_dwordx4 v[116:119], v207, s[8:11], s26 offen
        s_mov_b64 exec, -1
        s_add_u32 s26, s26, s27
  ds_read2st64_b64 v[248:251], v204 offset0:56 offset1:58
  s_waitcnt lgkmcnt(2)
  v_mfma_f32_32x32x16_bf16 v[152:167], v[184:187], v[56:59], v[152:167]
        s_mov_b32 m0, s25
        s_add_u32 s25, s25, 8192
        buffer_load_dwordx4 v206, s[8:11], s24 offen lds
        s_add_u32 s24, s24, 264192
        s_mov_b64 exec, s[42:43]
        buffer_load_dwordx4 v[120:123], v207, s[8:11], s26 offen
        s_mov_b64 exec, -1
        s_add_u32 s26, s26, s27
  ds_read2st64_b64 v[184:187], v204 offset0:60 offset1:62
  s_waitcnt lgkmcnt(2)
  v_mfma_f32_32x32x16_bf16 v[168:183], v[192:195], v[60:63], v[168:183]
        s_mov_b64 exec, s[42:43]
        buffer_load_dwordx4 v[124:127], v207, s[8:11], s26 offen
        s_mov_b64 exec, -1
        s_add_u32 s26, s26, s27
  s_waitcnt vmcnt(13)
  s_barrier
  ds_read2st64_b64 v[192:195], v204 offset0:64 offset1:66
  s_waitcnt lgkmcnt(2)
  v_mfma_f32_32x32x16_bf16 v[152:167], v[248:251], v[64:67], v[152:167]
        s_mov_b64 exec, s[42:43]
        buffer_load_dwordx4 v[128:131], v207, s[8:11], s26 offen
        s_mov_b64 exec, -1
        s_add_u32 s26, s26, s27
  ds_read2st64_b64 v[248:251], v204 offset0:68 offset1:70
  s_waitcnt lgkmcnt(2)
  v_mfma_f32_32x32x16_bf16 v[168:183], v[184:187], v[68:71], v[168:183]
        s_mov_b64 exec, s[42:43]
        buffer_load_dwordx4 v[132:135], v207, s[8:11], s26 offen
        s_mov_b64 exec, -1
        s_add_u32 s26, s26, s27
  ds_read2st64_b64 v[184:187], v204 offset0:72 offset1:74
  s_waitcnt lgkmcnt(2)
  v_mfma_f32_32x32x16_bf16 v[152:167], v[192:195], v[72:75], v[152:167]
        s_mov_b32 m0, s25
        s_add_u32 s25, s25, 8192
        buffer_load_dwordx4 v206, s[8:11], s24 offen lds
        s_add_u32 s24, s24, 264192
        s_mov_b64 exec, s[42:43]
        buffer_load_dwordx4 v[136:139], v207, s[8:11], s26 offen
        s_mov_b64 exec, -1
        s_add_u32 s26, s26, s27
  ds_read2st64_b64 v[192:195], v204 offset0:76 offset1:78
  s_waitcnt lgkmcnt(2)
  v_mfma_f32_32x32x16_bf16 v[168:183], v[248:251], v[76:79], v[168:183]
        s_mov_b64 exec, s[42:43]
        buffer_load_dwordx4 v[140:143], v207, s[8:11], s26 offen
        s_mov_b64 exec, -1
        s_add_u32 s26, s26, s27
  s_waitcnt vmcnt(13)
  s_barrier
  ds_read2st64_b64 v[248:251], v204 offset0:80 offset1:82
  s_waitcnt lgkmcnt(2)
  v_mfma_f32_32x32x16_bf16 v[152:167], v[184:187], v[80:83], v[152:167]
        s_mov_b64 exec, s[42:43]
        buffer_load_dwordx4 v[144:147], v207, s[8:11], s26 offen
        s_mov_b64 exec, -1
        s_add_u32 s26, s26, s27
  ds_read2st64_b64 v[184:187], v204 offset0:84 offset1:86
  s_waitcnt lgkmcnt(2)
  v_mfma_f32_32x32x16_bf16 v[168:183], v[192:195], v[84:87], v[168:183]
        s_mov_b64 exec, s[42:43]
        buffer_load_dwordx4 v[148:151], v207, s[8:11], s26 offen
        s_mov_b64 exec, -1
        s_add_u32 s26, s26, s27
  ds_read2st64_b64 v[192:195], v204 offset0:88 offset1:90
  s_waitcnt lgkmcnt(2)
  v_mfma_f32_32x32x16_bf16 v[152:167], v[248:251], v[88:91], v[152:167]
  ds_read2st64_b64 v[248:251], v204 offset0:92 offset1:94
  s_waitcnt lgkmcnt(2)
  v_mfma_f32_32x32x16_bf16 v[168:183], v[184:187], v[92:95], v[168:183]
  s_waitcnt vmcnt(10)
  s_barrier
  ds_read2st64_b64 v[184:187], v204 offset0:96 offset1:98
  s_waitcnt lgkmcnt(2)
  v_mfma_f32_32x32x16_bf16 v[152:167], v[192:195], v[96:99], v[152:167]
  ds_read2st64_b64 v[192:195], v204 offset0:100 offset1:102
  s_waitcnt lgkmcnt(2)
  v_mfma_f32_32x32x16_bf16 v[168:183], v[248:251], v[100:103], v[168:183]
  ds_read2st64_b64 v[248:251], v204 offset0:104 offset1:106
  s_waitcnt lgkmcnt(2)
  v_mfma_f32_32x32x16_bf16 v[152:167], v[184:187], v[104:107], v[152:167]
  ds_read2st64_b64 v[184:187], v204 offset0:108 offset1:110
  s_waitcnt lgkmcnt(2)
  v_mfma_f32_32x32x16_bf16 v[168:183], v[192:195], v[108:111], v[168:183]
  s_waitcnt vmcnt(5)
  s_barrier
  ds_read2st64_b64 v[192:195], v204 offset0:112 offset1:114
  s_waitcnt lgkmcnt(2)
  v_mfma_f32_32x32x16_bf16 v[152:167], v[248:251], v[112:115], v[152:167]
  ds_read2st64_b64 v[248:251], v204 offset0:116 offset1:118
  s_waitcnt lgkmcnt(2)
  v_mfma_f32_32x32x16_bf16 v[168:183], v[184:187], v[116:119], v[168:183]
  ds_read2st64_b64 v[184:187], v204 offset0:120 offset1:122
  s_waitcnt lgkmcnt(2)
  v_mfma_f32_32x32x16_bf16 v[152:167], v[192:195], v[120:123], v[152:167]
  ds_read2st64_b64 v[192:195], v204 offset0:124 offset1:126
  s_waitcnt lgkmcnt(2)
  v_mfma_f32_32x32x16_bf16 v[168:183], v[248:251], v[124:127], v[168:183]
  s_waitcnt vmcnt(0)
  s_barrier
  ds_read2st64_b64 v[248:251], v204 offset0:128 offset1:130
  s_waitcnt lgkmcnt(2)
  v_mfma_f32_32x32x16_bf16 v[152:167], v[184:187], v[128:131], v[152:167]
  ds_read2st64_b64 v[184:187], v204 offset0:132 offset1:134
  s_waitcnt lgkmcnt(2)
  v_mfma_f32_32x32x16_bf16 v[168:183], v[192:195], v[132:135], v[168:183]
  ds_read2st64_b64 v[192:195], v204 offset0:136 offset1:138
  s_waitcnt lgkmcnt(2)
  v_mfma_f32_32x32x16_bf16 v[152:167], v[248:251], v[136:139], v[152:167]
  ds_read2st64_b64 v[248:251], v204 offset0:140 offset1:142
  s_waitcnt lgkmcnt(2)
  v_mfma_f32_32x32x16_bf16 v[168:183], v[184:187], v[140:143], v[168:183]
  s_waitcnt lgkmcnt(1)
  v_mfma_f32_32x32x16_bf16 v[152:167], v[192:195], v[144:147], v[152:167]
  s_waitcnt lgkmcnt(0)
  v_mfma_f32_32x32x16_bf16 v[168:183], v[248:251], v[148:151], v[168:183]
  s_nop 11
  v_add_f32 v152, v152, v168
  v_add_f32 v153, v153, v169
  v_add_f32 v154, v154, v170
  v_add_f32 v155, v155, v171
  v_add_f32 v156, v156, v172
  v_add_f32 v157, v157, v173
  v_add_f32 v158, v158, v174
  v_add_f32 v159, v159, v175
  v_add_f32 v160, v160, v176
  v_add_f32 v161, v161, v177
  v_add_f32 v162, v162, v178
  v_add_f32 v163, v163, v179
  v_add_f32 v164, v164, v180
  v_add_f32 v165, v165, v181
  v_add_f32 v166, v166, v182
  v_add_f32 v167, v167, v183
  s_barrier
  ds_read_b128 v[8:11], v213 offset:0
  ds_read_b128 v[12:15], v213 offset:32
  ds_read_b128 v[16:19], v213 offset:64
  ds_read_b128 v[20:23], v213 offset:96
  s_waitcnt lgkmcnt(0)
  v_mul_f32 v152, v152, v8
  v_mul_f32 v153, v153, v9
  v_mul_f32 v154, v154, v10
  v_mul_f32 v155, v155, v11
  v_mul_f32 v156, v156, v12
  v_mul_f32 v157, v157, v13
  v_mul_f32 v158, v158, v14
  v_mul_f32 v159, v159, v15
  v_mul_f32 v160, v160, v16
  v_mul_f32 v161, v161, v17
  v_mul_f32 v162, v162, v18
  v_mul_f32 v163, v163, v19
  v_mul_f32 v164, v164, v20
  v_mul_f32 v165, v165, v21
  v_mul_f32 v166, v166, v22
  v_mul_f32 v167, v167, v23
  v_cvt_pk_bf16_f32 v216, v152, v153
  v_cndmask_b32 v216, v216, v212, s[40:41]
  v_cvt_pk_bf16_f32 v217, v154, v155
  v_cndmask_b32 v217, v217, v212, s[40:41]
  v_cvt_pk_bf16_f32 v218, v156, v157
  v_cndmask_b32 v218, v218, v212, s[40:41]
  v_cvt_pk_bf16_f32 v219, v158, v159
  v_cndmask_b32 v219, v219, v212, s[40:41]
  v_cvt_pk_bf16_f32 v220, v160, v161
  v_cndmask_b32 v220, v220, v212, s[40:41]
  v_cvt_pk_bf16_f32 v221, v162, v163
  v_cndmask_b32 v221, v221, v212, s[40:41]
  v_cvt_pk_bf16_f32 v222, v164, v165
  v_cndmask_b32 v222, v222, v212, s[40:41]
  v_cvt_pk_bf16_f32 v223, v166, v167
  v_cndmask_b32 v223, v223, v212, s[40:41]
  s_mov_b64 exec, s[38:39]
  buffer_store_dwordx4 v[216:219], v214, s[8:11], s49 offen offset:0 sc1
  buffer_store_dwordx4 v[220:223], v214, s[8:11], s49 offen offset:640 sc1
  s_mov_b64 exec, -1
  s_waitcnt vmcnt(0)
        v_lshlrev_b32 v209, 7, v208
        v_mov_b32 v210, 1
        s_and_b32 s33, s21, 7
        s_lshl_b32 s33, s33, 10
        s_add_u32 s33, s33, 26214400
        s_mov_b64 exec, 0xff
        buffer_atomic_add v210, v209, s[8:11], s33 offen sc1
        s_mov_b64 exec, -1
  s_branch kfa_kernel_adone
kfa_kernel_stats:
    v_lshlrev_b32 v204, 4, v208
    v_add_u32 v202, 36864, v204
    v_lshrrev_b32 v211, 5, v208
    v_cmp_eq_u32 vcc, 0, v211
    v_mov_b32 v213, -1
    v_mov_b32 v212, 0xffff0000
    v_cndmask_b32 v213, v213, v212, vcc
  v_mov_b32 v232, 0
  v_mov_b32 v233, 0
  v_mov_b32 v234, 0
  v_mov_b32 v235, 0
  v_mov_b32 v236, 0
  v_mov_b32 v237, 0
  v_mov_b32 v238, 0
  v_mov_b32 v239, 0
        s_mov_b32 m0, s25
        s_add_u32 s25, s25, 8192
        buffer_load_dwordx4 v206, s[8:11], s24 offen lds
        s_add_u32 s24, s24, 264192
  s_barrier
        s_mov_b32 m0, s25
        s_add_u32 s25, s25, 8192
        buffer_load_dwordx4 v206, s[8:11], s24 offen lds
        s_add_u32 s24, s24, 264192
  s_barrier
        s_mov_b32 m0, s25
        s_add_u32 s25, s25, 8192
        buffer_load_dwordx4 v206, s[8:11], s24 offen lds
        s_add_u32 s24, s24, 264192
        s_mov_b32 m0, s25
        s_add_u32 s25, s25, 8192
        buffer_load_dwordx4 v206, s[8:11], s24 offen lds
        s_add_u32 s24, s24, 264192
  s_waitcnt vmcnt(3)
  s_barrier
  ds_read_b128 v[184:187], v204 offset:0
  ds_read_b128 v[188:191], v204 offset:1024
  ds_read_b128 v[192:195], v204 offset:2048
  ds_read_b128 v[196:199], v204 offset:3072
  ds_read_b128 v[248:251], v204 offset:4096
  ds_read_b128 v[252:255], v204 offset:5120
  s_waitcnt lgkmcnt(4)
  v_and_b32 v184, v213, v184
  v_and_b32 v186, v213, v186
  v_dot2c_f32_bf16 v232, v184, v184
  v_dot2c_f32_bf16 v233, v185, v185
  v_dot2c_f32_bf16 v234, v186, v186
  v_dot2c_f32_bf16 v235, v187, v187
  v_dot2c_f32_bf16 v236, v188, v188
  v_dot2c_f32_bf16 v237, v189, v189
  v_dot2c_f32_bf16 v238, v190, v190
  v_dot2c_f32_bf16 v239, v191, v191
        s_mov_b32 m0, s25
        s_add_u32 s25, s25, 8192
        buffer_load_dwordx4 v206, s[8:11], s24 offen lds
        s_add_u32 s24, s24, 264192
  ds_read_b128 v[184:187], v204 offset:6144
  ds_read_b128 v[188:191], v204 offset:7168
  s_waitcnt lgkmcnt(4)
  v_dot2c_f32_bf16 v232, v192, v192
  v_dot2c_f32_bf16 v233, v193, v193
  v_dot2c_f32_bf16 v234, v194, v194
  v_dot2c_f32_bf16 v235, v195, v195
  v_dot2c_f32_bf16 v236, v196, v196
  v_dot2c_f32_bf16 v237, v197, v197
  v_dot2c_f32_bf16 v238, v198, v198
  v_dot2c_f32_bf16 v239, v199, v199
  s_waitcnt vmcnt(3)
  s_barrier
  ds_read_b128 v[192:195], v204 offset:8192
  ds_read_b128 v[196:199], v204 offset:9216
  s_waitcnt lgkmcnt(4)
  v_dot2c_f32_bf16 v232, v248, v248
  v_dot2c_f32_bf16 v233, v249, v249
  v_dot2c_f32_bf16 v234, v250, v250
  v_dot2c_f32_bf16 v235, v251, v251
  v_dot2c_f32_bf16 v236, v252, v252
  v_dot2c_f32_bf16 v237, v253, v253
  v_dot2c_f32_bf16 v238, v254, v254
  v_dot2c_f32_bf16 v239, v255, v255
  ds_read_b128 v[248:251], v204 offset:10240
  ds_read_b128 v[252:255], v204 offset:11264
  s_waitcnt lgkmcnt(4)
  v_dot2c_f32_bf16 v232, v184, v184
  v_dot2c_f32_bf16 v233, v185, v185
  v_dot2c_f32_bf16 v234, v186, v186
  v_dot2c_f32_bf16 v235, v187, v187
  v_dot2c_f32_bf16 v236, v188, v188
  v_dot2c_f32_bf16 v237, v189, v189
  v_dot2c_f32_bf16 v238, v190, v190
  v_dot2c_f32_bf16 v239, v191, v191
  ds_read_b128 v[184:187], v204 offset:12288
  ds_read_b128 v[188:191], v204 offset:13312
  s_waitcnt lgkmcnt(4)
  v_dot2c_f32_bf16 v232, v192, v192
  v_dot2c_f32_bf16 v233, v193, v193
  v_dot2c_f32_bf16 v234, v194, v194
  v_dot2c_f32_bf16 v235, v195, v195
  v_dot2c_f32_bf16 v236, v196, v196
  v_dot2c_f32_bf16 v237, v197, v197
  v_dot2c_f32_bf16 v238, v198, v198
  v_dot2c_f32_bf16 v239, v199, v199
        s_mov_b32 m0, s25
        s_add_u32 s25, s25, 8192
        buffer_load_dwordx4 v206, s[8:11], s24 offen lds
        s_add_u32 s24, s24, 264192
  ds_read_b128 v[192:195], v204 offset:14336
  ds_read_b128 v[196:199], v204 offset:15360
  s_waitcnt lgkmcnt(4)
  v_dot2c_f32_bf16 v232, v248, v248
  v_dot2c_f32_bf16 v233, v249, v249
  v_dot2c_f32_bf16 v234, v250, v250
  v_dot2c_f32_bf16 v235, v251, v251
  v_dot2c_f32_bf16 v236, v252, v252
  v_dot2c_f32_bf16 v237, v253, v253
  v_dot2c_f32_bf16 v238, v254, v254
  v_dot2c_f32_bf16 v239, v255, v255
  s_waitcnt vmcnt(3)
  s_barrier
  ds_read_b128 v[248:251], v204 offset:16384
  ds_read_b128 v[252:255], v204 offset:17408
  s_waitcnt lgkmcnt(4)
  v_dot2c_f32_bf16 v232, v184, v184
  v_dot2c_f32_bf16 v233, v185, v185
  v_dot2c_f32_bf16 v234, v186, v186
  v_dot2c_f32_bf16 v235, v187, v187
  v_dot2c_f32_bf16 v236, v188, v188
  v_dot2c_f32_bf16 v237, v189, v189
  v_dot2c_f32_bf16 v238, v190, v190
  v_dot2c_f32_bf16 v239, v191, v191
  ds_read_b128 v[184:187], v204 offset:18432
  ds_read_b128 v[188:191], v204 offset:19456
  s_waitcnt lgkmcnt(4)
  v_dot2c_f32_bf16 v232, v192, v192
  v_dot2c_f32_bf16 v233, v193, v193
  v_dot2c_f32_bf16 v234, v194, v194
  v_dot2c_f32_bf16 v235, v195, v195
  v_dot2c_f32_bf16 v236, v196, v196
  v_dot2c_f32_bf16 v237, v197, v197
  v_dot2c_f32_bf16 v238, v198, v198
  v_dot2c_f32_bf16 v239, v199, v199
  ds_read_b128 v[192:195], v204 offset:20480
  ds_read_b128 v[196:199], v204 offset:21504
  s_waitcnt lgkmcnt(4)
  v_dot2c_f32_bf16 v232, v248, v248
  v_dot2c_f32_bf16 v233, v249, v249
  v_dot2c_f32_bf16 v234, v250, v250
  v_dot2c_f32_bf16 v235, v251, v251
  v_dot2c_f32_bf16 v236, v252, v252
  v_dot2c_f32_bf16 v237, v253, v253
  v_dot2c_f32_bf16 v238, v254, v254
  v_dot2c_f32_bf16 v239, v255, v255
        s_mov_b32 m0, s25
        s_add_u32 s25, s25, 8192
        buffer_load_dwordx4 v206, s[8:11], s24 offen lds
        s_add_u32 s24, s24, 264192
  ds_read_b128 v[248:251], v204 offset:22528
  ds_read_b128 v[252:255], v204 offset:23552
  s_waitcnt lgkmcnt(4)
  v_dot2c_f32_bf16 v232, v184, v184
  v_dot2c_f32_bf16 v233, v185, v185
  v_dot2c_f32_bf16 v234, v186, v186
  v_dot2c_f32_bf16 v235, v187, v187
  v_dot2c_f32_bf16 v236, v188, v188
  v_dot2c_f32_bf16 v237, v189, v189
  v_dot2c_f32_bf16 v238, v190, v190
  v_dot2c_f32_bf16 v239, v191, v191
  s_waitcnt vmcnt(3)
  s_barrier
  ds_read_b128 v[184:187], v204 offset:24576
  ds_read_b128 v[188:191], v204 offset:25600
  s_waitcnt lgkmcnt(4)
  v_dot2c_f32_bf16 v232, v192, v192
  v_dot2c_f32_bf16 v233, v193, v193
  v_dot2c_f32_bf16 v234, v194, v194
  v_dot2c_f32_bf16 v235, v195, v195
  v_dot2c_f32_bf16 v236, v196, v196
  v_dot2c_f32_bf16 v237, v197, v197
  v_dot2c_f32_bf16 v238, v198, v198
  v_dot2c_f32_bf16 v239, v199, v199
  ds_read_b128 v[192:195], v204 offset:26624
  ds_read_b128 v[196:199], v204 offset:27648
  s_waitcnt lgkmcnt(4)
  v_dot2c_f32_bf16 v232, v248, v248
  v_dot2c_f32_bf16 v233, v249, v249
  v_dot2c_f32_bf16 v234, v250, v250
  v_dot2c_f32_bf16 v235, v251, v251
  v_dot2c_f32_bf16 v236, v252, v252
  v_dot2c_f32_bf16 v237, v253, v253
  v_dot2c_f32_bf16 v238, v254, v254
  v_dot2c_f32_bf16 v239, v255, v255
  ds_read_b128 v[248:251], v204 offset:28672
  ds_read_b128 v[252:255], v204 offset:29696
  s_waitcnt lgkmcnt(4)
  v_dot2c_f32_bf16 v232, v184, v184
  v_dot2c_f32_bf16 v233, v185, v185
  v_dot2c_f32_bf16 v234, v186, v186
  v_dot2c_f32_bf16 v235, v187, v187
  v_dot2c_f32_bf16 v236, v188, v188
  v_dot2c_f32_bf16 v237, v189, v189
  v_dot2c_f32_bf16 v238, v190, v190
  v_dot2c_f32_bf16 v239, v191, v191
        s_mov_b32 m0, s25
        s_add_u32 s25, s25, 8192
        buffer_load_dwordx4 v206, s[8:11], s24 offen lds
        s_add_u32 s24, s24, 264192
  ds_read_b128 v[184:187], v204 offset:30720
  ds_read_b128 v[188:191], v204 offset:31744
  s_waitcnt lgkmcnt(4)
  v_dot2c_f32_bf16 v232, v192, v192
  v_dot2c_f32_bf16 v233, v193, v193
  v_dot2c_f32_bf16 v234, v194, v194
  v_dot2c_f32_bf16 v235, v195, v195
  v_dot2c_f32_bf16 v236, v196, v196
  v_dot2c_f32_bf16 v237, v197, v197
  v_dot2c_f32_bf16 v238, v198, v198
  v_dot2c_f32_bf16 v239, v199, v199
  s_waitcnt vmcnt(3)
  s_barrier
  ds_read_b128 v[192:195], v204 offset:32768
  ds_read_b128 v[196:199], v204 offset:33792
  s_waitcnt lgkmcnt(4)
  v_dot2c_f32_bf16 v232, v248, v248
  v_dot2c_f32_bf16 v233, v249, v249
  v_dot2c_f32_bf16 v234, v250, v250
  v_dot2c_f32_bf16 v235, v251, v251
  v_dot2c_f32_bf16 v236, v252, v252
  v_dot2c_f32_bf16 v237, v253, v253
  v_dot2c_f32_bf16 v238, v254, v254
  v_dot2c_f32_bf16 v239, v255, v255
  ds_read_b128 v[248:251], v204 offset:34816
  ds_read_b128 v[252:255], v204 offset:35840
  s_waitcnt lgkmcnt(4)
  v_dot2c_f32_bf16 v232, v184, v184
  v_dot2c_f32_bf16 v233, v185, v185
  v_dot2c_f32_bf16 v234, v186, v186
  v_dot2c_f32_bf16 v235, v187, v187
  v_dot2c_f32_bf16 v236, v188, v188
  v_dot2c_f32_bf16 v237, v189, v189
  v_dot2c_f32_bf16 v238, v190, v190
  v_dot2c_f32_bf16 v239, v191, v191
  ds_read_b128 v[184:187], v202 offset:0
  ds_read_b128 v[188:191], v202 offset:1024
  s_waitcnt lgkmcnt(4)
  v_dot2c_f32_bf16 v232, v192, v192
  v_dot2c_f32_bf16 v233, v193, v193
  v_dot2c_f32_bf16 v234, v194, v194
  v_dot2c_f32_bf16 v235, v195, v195
  v_dot2c_f32_bf16 v236, v196, v196
  v_dot2c_f32_bf16 v237, v197, v197
  v_dot2c_f32_bf16 v238, v198, v198
  v_dot2c_f32_bf16 v239, v199, v199
        s_mov_b32 m0, s25
        s_add_u32 s25, s25, 8192
        buffer_load_dwordx4 v206, s[8:11], s24 offen lds
        s_add_u32 s24, s24, 264192
  ds_read_b128 v[192:195], v202 offset:2048
  ds_read_b128 v[196:199], v202 offset:3072
  s_waitcnt lgkmcnt(4)
  v_dot2c_f32_bf16 v232, v248, v248
  v_dot2c_f32_bf16 v233, v249, v249
  v_dot2c_f32_bf16 v234, v250, v250
  v_dot2c_f32_bf16 v235, v251, v251
  v_dot2c_f32_bf16 v236, v252, v252
  v_dot2c_f32_bf16 v237, v253, v253
  v_dot2c_f32_bf16 v238, v254, v254
  v_dot2c_f32_bf16 v239, v255, v255
  s_waitcnt vmcnt(3)
  s_barrier
  ds_read_b128 v[248:251], v202 offset:4096
  ds_read_b128 v[252:255], v202 offset:5120
  s_waitcnt lgkmcnt(4)
  v_dot2c_f32_bf16 v232, v184, v184
  v_dot2c_f32_bf16 v233, v185, v185
  v_dot2c_f32_bf16 v234, v186, v186
  v_dot2c_f32_bf16 v235, v187, v187
  v_dot2c_f32_bf16 v236, v188, v188
  v_dot2c_f32_bf16 v237, v189, v189
  v_dot2c_f32_bf16 v238, v190, v190
  v_dot2c_f32_bf16 v239, v191, v191
  ds_read_b128 v[184:187], v202 offset:6144
  ds_read_b128 v[188:191], v202 offset:7168
  s_waitcnt lgkmcnt(4)
  v_dot2c_f32_bf16 v232, v192, v192
  v_dot2c_f32_bf16 v233, v193, v193
  v_dot2c_f32_bf16 v234, v194, v194
  v_dot2c_f32_bf16 v235, v195, v195
  v_dot2c_f32_bf16 v236, v196, v196
  v_dot2c_f32_bf16 v237, v197, v197
  v_dot2c_f32_bf16 v238, v198, v198
  v_dot2c_f32_bf16 v239, v199, v199
  ds_read_b128 v[192:195], v202 offset:8192
  ds_read_b128 v[196:199], v202 offset:9216
  s_waitcnt lgkmcnt(4)
  v_dot2c_f32_bf16 v232, v248, v248
  v_dot2c_f32_bf16 v233, v249, v249
  v_dot2c_f32_bf16 v234, v250, v250
  v_dot2c_f32_bf16 v235, v251, v251
  v_dot2c_f32_bf16 v236, v252, v252
  v_dot2c_f32_bf16 v237, v253, v253
  v_dot2c_f32_bf16 v238, v254, v254
  v_dot2c_f32_bf16 v239, v255, v255
  ds_read_b128 v[248:251], v202 offset:10240
  ds_read_b128 v[252:255], v202 offset:11264
  s_waitcnt lgkmcnt(4)
  v_dot2c_f32_bf16 v232, v184, v184
  v_dot2c_f32_bf16 v233, v185, v185
  v_dot2c_f32_bf16 v234, v186, v186
  v_dot2c_f32_bf16 v235, v187, v187
  v_dot2c_f32_bf16 v236, v188, v188
  v_dot2c_f32_bf16 v237, v189, v189
  v_dot2c_f32_bf16 v238, v190, v190
  v_dot2c_f32_bf16 v239, v191, v191
  s_waitcnt vmcnt(2)
  s_barrier
  ds_read_b128 v[184:187], v202 offset:12288
  ds_read_b128 v[188:191], v202 offset:13312
  s_waitcnt lgkmcnt(4)
  v_dot2c_f32_bf16 v232, v192, v192
  v_dot2c_f32_bf16 v233, v193, v193
  v_dot2c_f32_bf16 v234, v194, v194
  v_dot2c_f32_bf16 v235, v195, v195
  v_dot2c_f32_bf16 v236, v196, v196
  v_dot2c_f32_bf16 v237, v197, v197
  v_dot2c_f32_bf16 v238, v198, v198
  v_dot2c_f32_bf16 v239, v199, v199
  ds_read_b128 v[192:195], v202 offset:14336
  ds_read_b128 v[196:199], v202 offset:15360
  s_waitcnt lgkmcnt(4)
  v_dot2c_f32_bf16 v232, v248, v248
  v_dot2c_f32_bf16 v233, v249, v249
  v_dot2c_f32_bf16 v234, v250, v250
  v_dot2c_f32_bf16 v235, v251, v251
  v_dot2c_f32_bf16 v236, v252, v252
  v_dot2c_f32_bf16 v237, v253, v253
  v_dot2c_f32_bf16 v238, v254, v254
  v_dot2c_f32_bf16 v239, v255, v255
  ds_read_b128 v[248:251], v202 offset:16384
  ds_read_b128 v[252:255], v202 offset:17408
  s_waitcnt lgkmcnt(4)
  v_dot2c_f32_bf16 v232, v184, v184
  v_dot2c_f32_bf16 v233, v185, v185
  v_dot2c_f32_bf16 v234, v186, v186
  v_dot2c_f32_bf16 v235, v187, v187
  v_dot2c_f32_bf16 v236, v188, v188
  v_dot2c_f32_bf16 v237, v189, v189
  v_dot2c_f32_bf16 v238, v190, v190
  v_dot2c_f32_bf16 v239, v191, v191
  ds_read_b128 v[184:187], v202 offset:18432
  ds_read_b128 v[188:191], v202 offset:19456
  s_waitcnt lgkmcnt(4)
  v_dot2c_f32_bf16 v232, v192, v192
  v_dot2c_f32_bf16 v233, v193, v193
  v_dot2c_f32_bf16 v234, v194, v194
  v_dot2c_f32_bf16 v235, v195, v195
  v_dot2c_f32_bf16 v236, v196, v196
  v_dot2c_f32_bf16 v237, v197, v197
  v_dot2c_f32_bf16 v238, v198, v198
  v_dot2c_f32_bf16 v239, v199, v199
  s_waitcnt vmcnt(1)
  s_barrier
  ds_read_b128 v[192:195], v202 offset:20480
  ds_read_b128 v[196:199], v202 offset:21504
  s_waitcnt lgkmcnt(4)
  v_dot2c_f32_bf16 v232, v248, v248
  v_dot2c_f32_bf16 v233, v249, v249
  v_dot2c_f32_bf16 v234, v250, v250
  v_dot2c_f32_bf16 v235, v251, v251
  v_dot2c_f32_bf16 v236, v252, v252
  v_dot2c_f32_bf16 v237, v253, v253
  v_dot2c_f32_bf16 v238, v254, v254
  v_dot2c_f32_bf16 v239, v255, v255
  ds_read_b128 v[248:251], v202 offset:22528
  ds_read_b128 v[252:255], v202 offset:23552
  s_waitcnt lgkmcnt(4)
  v_dot2c_f32_bf16 v232, v184, v184
  v_dot2c_f32_bf16 v233, v185, v185
  v_dot2c_f32_bf16 v234, v186, v186
  v_dot2c_f32_bf16 v235, v187, v187
  v_dot2c_f32_bf16 v236, v188, v188
  v_dot2c_f32_bf16 v237, v189, v189
  v_dot2c_f32_bf16 v238, v190, v190
  v_dot2c_f32_bf16 v239, v191, v191
  ds_read_b128 v[184:187], v202 offset:24576
  ds_read_b128 v[188:191], v202 offset:25600
  s_waitcnt lgkmcnt(4)
  v_dot2c_f32_bf16 v232, v192, v192
  v_dot2c_f32_bf16 v233, v193, v193
  v_dot2c_f32_bf16 v234, v194, v194
  v_dot2c_f32_bf16 v235, v195, v195
  v_dot2c_f32_bf16 v236, v196, v196
  v_dot2c_f32_bf16 v237, v197, v197
  v_dot2c_f32_bf16 v238, v198, v198
  v_dot2c_f32_bf16 v239, v199, v199
  ds_read_b128 v[192:195], v202 offset:26624
  ds_read_b128 v[196:199], v202 offset:27648
  s_waitcnt lgkmcnt(4)
  v_dot2c_f32_bf16 v232, v248, v248
  v_dot2c_f32_bf16 v233, v249, v249
  v_dot2c_f32_bf16 v234, v250, v250
  v_dot2c_f32_bf16 v235, v251, v251
  v_dot2c_f32_bf16 v236, v252, v252
  v_dot2c_f32_bf16 v237, v253, v253
  v_dot2c_f32_bf16 v238, v254, v254
  v_dot2c_f32_bf16 v239, v255, v255
  s_waitcnt vmcnt(0)
  s_barrier
  ds_read_b128 v[248:251], v202 offset:28672
  ds_read_b128 v[252:255], v202 offset:29696
  s_waitcnt lgkmcnt(4)
  v_dot2c_f32_bf16 v232, v184, v184
  v_dot2c_f32_bf16 v233, v185, v185
  v_dot2c_f32_bf16 v234, v186, v186
  v_dot2c_f32_bf16 v235, v187, v187
  v_dot2c_f32_bf16 v236, v188, v188
  v_dot2c_f32_bf16 v237, v189, v189
  v_dot2c_f32_bf16 v238, v190, v190
  v_dot2c_f32_bf16 v239, v191, v191
  ds_read_b128 v[184:187], v202 offset:30720
  ds_read_b128 v[188:191], v202 offset:31744
  s_waitcnt lgkmcnt(4)
  v_dot2c_f32_bf16 v232, v192, v192
  v_dot2c_f32_bf16 v233, v193, v193
  v_dot2c_f32_bf16 v234, v194, v194
  v_dot2c_f32_bf16 v235, v195, v195
  v_dot2c_f32_bf16 v236, v196, v196
  v_dot2c_f32_bf16 v237, v197, v197
  v_dot2c_f32_bf16 v238, v198, v198
  v_dot2c_f32_bf16 v239, v199, v199
  ds_read_b128 v[192:195], v202 offset:32768
  ds_read_b128 v[196:199], v202 offset:33792
  s_waitcnt lgkmcnt(4)
  v_dot2c_f32_bf16 v232, v248, v248
  v_dot2c_f32_bf16 v233, v249, v249
  v_dot2c_f32_bf16 v234, v250, v250
  v_dot2c_f32_bf16 v235, v251, v251
  v_dot2c_f32_bf16 v236, v252, v252
  v_dot2c_f32_bf16 v237, v253, v253
  v_dot2c_f32_bf16 v238, v254, v254
  v_dot2c_f32_bf16 v239, v255, v255
  ds_read_b128 v[248:251], v202 offset:34816
  ds_read_b128 v[252:255], v202 offset:35840
  s_waitcnt lgkmcnt(4)
  v_dot2c_f32_bf16 v232, v184, v184
  v_dot2c_f32_bf16 v233, v185, v185
  v_dot2c_f32_bf16 v234, v186, v186
  v_dot2c_f32_bf16 v235, v187, v187
  v_dot2c_f32_bf16 v236, v188, v188
  v_dot2c_f32_bf16 v237, v189, v189
  v_dot2c_f32_bf16 v238, v190, v190
  v_dot2c_f32_bf16 v239, v191, v191
  s_waitcnt lgkmcnt(2)
  v_dot2c_f32_bf16 v232, v192, v192
  v_dot2c_f32_bf16 v233, v193, v193
  v_dot2c_f32_bf16 v234, v194, v194
  v_dot2c_f32_bf16 v235, v195, v195
  v_dot2c_f32_bf16 v236, v196, v196
  v_dot2c_f32_bf16 v237, v197, v197
  v_dot2c_f32_bf16 v238, v198, v198
  v_dot2c_f32_bf16 v239, v199, v199
  s_waitcnt lgkmcnt(0)
  v_dot2c_f32_bf16 v232, v248, v248
  v_dot2c_f32_bf16 v233, v249, v249
  v_dot2c_f32_bf16 v234, v250, v250
  v_dot2c_f32_bf16 v235, v251, v251
  v_dot2c_f32_bf16 v236, v252, v252
  v_dot2c_f32_bf16 v237, v253, v253
  v_dot2c_f32_bf16 v238, v254, v254
  v_dot2c_f32_bf16 v239, v255, v255
    v_add_f32 v232, v232, v233
    v_add_f32 v234, v234, v235
    v_add_f32 v236, v236, v237
    v_add_f32 v238, v238, v239
    v_add_f32 v232, v232, v236
    v_add_f32 v233, v234, v238
    v_mov_b32 v209, v232
    v_mov_b32 v210, v232
  s_nop 1
    v_permlane32_swap_b32 v209, v210
    v_add_f32 v232, v209, v210
    v_mov_b32 v209, v233
    v_mov_b32 v210, v233
  s_nop 1
    v_permlane32_swap_b32 v209, v210
    v_add_f32 v233, v209, v210
  s_mov_b32 s29, 0x3ae38e39
  v_mov_b32 v211, 0x3727c5ac
  v_fma_f32 v200, v232, s29, v211
  v_fma_f32 v201, v233, s29, v211
  v_rsq_f32 v200, v200
  v_rsq_f32 v201, v201
    v_and_b32 v209, 31, v208
    v_lshlrev_b32 v209, 3, v209
    v_add_u32 v209, 73728, v209
    ds_write_b64 v209, v[200:201]
    s_waitcnt lgkmcnt(0)
    s_barrier
    s_branch kfa_kernel_adone
kfa_kernel_helper:
        s_mov_b32 m0, s25
        s_add_u32 s25, s25, 8192
        buffer_load_dwordx4 v206, s[8:11], s24 offen lds
        s_add_u32 s24, s24, 264192
  s_barrier
        s_mov_b32 m0, s25
        s_add_u32 s25, s25, 8192
        buffer_load_dwordx4 v206, s[8:11], s24 offen lds
        s_add_u32 s24, s24, 264192
  s_barrier
        s_mov_b32 m0, s25
        s_add_u32 s25, s25, 8192
        buffer_load_dwordx4 v206, s[8:11], s24 offen lds
        s_add_u32 s24, s24, 264192
        s_mov_b32 m0, s25
        s_add_u32 s25, s25, 8192
        buffer_load_dwordx4 v206, s[8:11], s24 offen lds
        s_add_u32 s24, s24, 264192
        s_mov_b32 m0, s25
        s_add_u32 s25, s25, 8192
        buffer_load_dwordx4 v206, s[8:11], s24 offen lds
        s_add_u32 s24, s24, 264192
        s_mov_b32 m0, s25
        s_add_u32 s25, s25, 8192
        buffer_load_dwordx4 v206, s[8:11], s24 offen lds
        s_add_u32 s24, s24, 264192
        s_mov_b32 m0, s25
        s_add_u32 s25, s25, 8192
        buffer_load_dwordx4 v206, s[8:11], s24 offen lds
        s_add_u32 s24, s24, 264192
        s_mov_b32 m0, s25
        s_add_u32 s25, s25, 8192
        buffer_load_dwordx4 v206, s[8:11], s24 offen lds
        s_add_u32 s24, s24, 264192
        s_mov_b32 m0, s25
        s_add_u32 s25, s25, 8192
        buffer_load_dwordx4 v206, s[8:11], s24 offen lds
        s_add_u32 s24, s24, 264192
  s_waitcnt vmcnt(8)
  s_barrier
  s_waitcnt vmcnt(7)
  s_barrier
  s_waitcnt vmcnt(6)
  s_barrier
  s_waitcnt vmcnt(5)
  s_barrier
  s_waitcnt vmcnt(4)
  s_barrier
  s_waitcnt vmcnt(3)
  s_barrier
  s_waitcnt vmcnt(2)
  s_barrier
  s_waitcnt vmcnt(1)
  s_barrier
  s_waitcnt vmcnt(0)
  s_barrier
  s_barrier
kfa_kernel_adone:
    v_mov_b32 v107, v208
    v_lshlrev_b32 v104, 4, v208
    v_lshlrev_b32 v108, 4, v208
    v_lshlrev_b32 v105, 3, v208
    s_lshl_b32 s35, s20, 10
    s_add_u32 s36, s35, 18038784
    s_and_b32 s24, s20, 1
    s_lshr_b32 s23, s20, 1
    s_mul_i32 s26, s22, 1152
    s_lshl_b32 s27, s23, 9
    s_add_u32 s26, s26, s27
    s_add_u32 s26, s26, 14163968
    v_and_b32 v2, 31, v107
  v_mov_b32 v106, v2
  v_add_u32 v109, 6, v2
  v_subrev_u32 v110, 4, v2
  v_cmp_gt_u32 vcc, 8, v110
  s_nop 1
  v_cndmask_b32 v106, v106, v109, vcc
  v_subrev_u32 v109, 8, v2
  v_subrev_u32 v110, 12, v2
  v_cmp_gt_u32 vcc, 4, v110
  s_nop 1
  v_cndmask_b32 v106, v106, v109, vcc
  v_add_u32 v109, 2, v2
  v_subrev_u32 v110, 16, v2
  v_cmp_gt_u32 vcc, 2, v110
  s_nop 1
  v_cndmask_b32 v106, v106, v109, vcc
  v_subrev_u32 v109, 12, v2
  v_subrev_u32 v110, 20, v2
  v_cmp_gt_u32 vcc, 2, v110
  s_nop 1
  v_cndmask_b32 v106, v106, v109, vcc
  v_mov_b32 v109, 10
  v_subrev_u32 v110, 18, v2
  v_cmp_gt_u32 vcc, 2, v110
  s_nop 1
  v_cndmask_b32 v106, v106, v109, vcc
  v_mov_b32 v109, 10
  v_subrev_u32 v110, 28, v2
  v_cmp_gt_u32 vcc, 4, v110
  s_nop 1
  v_cndmask_b32 v106, v106, v109, vcc
  v_mov_b32 v109, 0
  v_subrev_u32 v110, 22, v2
  v_cmp_gt_u32 vcc, 6, v110
  s_nop 1
  v_cndmask_b32 v106, v106, v109, vcc
    v_lshlrev_b32 v106, 4, v106
    v_lshrrev_b32 v109, 5, v107
    v_mul_u32_u24 v110, 320, v109
    v_add_u32 v106, v106, v110
    v_mul_u32_u24 v111, 9216, v109
    v_lshl_add_u32 v111, v2, 4, v111
  v_mov_b32 v16, 0
  v_mov_b32 v64, 0
  v_mov_b32 v17, 0
  v_mov_b32 v65, 0
  v_mov_b32 v18, 0
  v_mov_b32 v66, 0
  v_mov_b32 v19, 0
  v_mov_b32 v67, 0
  v_mov_b32 v20, 0
  v_mov_b32 v68, 0
  v_mov_b32 v21, 0
  v_mov_b32 v69, 0
  v_mov_b32 v22, 0
  v_mov_b32 v70, 0
  v_mov_b32 v23, 0
  v_mov_b32 v71, 0
  v_mov_b32 v24, 0
  v_mov_b32 v72, 0
  v_mov_b32 v25, 0
  v_mov_b32 v73, 0
  v_mov_b32 v26, 0
  v_mov_b32 v74, 0
  v_mov_b32 v27, 0
  v_mov_b32 v75, 0
  v_mov_b32 v28, 0
  v_mov_b32 v76, 0
  v_mov_b32 v29, 0
  v_mov_b32 v77, 0
  v_mov_b32 v30, 0
  v_mov_b32 v78, 0
  v_mov_b32 v31, 0
  v_mov_b32 v79, 0
  v_mov_b32 v9, 0
  v_mov_b32 v11, 0
  v_mov_b32 v12, 0
  v_mov_b32 v14, 0
  v_mov_b32 v84, 0
  v_mov_b32 v85, 0
  v_mov_b32 v86, 0
  v_mov_b32 v87, 0
    s_lshr_b32 s53, s22, 1
    s_mul_i32 s53, s53, 9
    s_and_b32 s38, s22, 1
    s_lshl_b32 s52, s38, 2
    s_add_u32 s52, s52, s53
    s_add_u32 s52, s52, s23
    s_add_u32 s53, s53, 8
    s_mul_i32 s40, s21, 36
    s_add_u32 s52, s52, s40
    s_add_u32 s53, s53, s40
    s_lshl_b32 s52, s52, 1
    s_lshl_b32 s53, s53, 1
    s_add_u32 s52, s52, s24
    s_add_u32 s53, s53, s24
    s_lshl_b32 s52, s52, 10
    s_lshl_b32 s53, s53, 10
    s_add_u32 s52, s52, 18350080
    s_add_u32 s53, s53, 18350080
    s_lshl_b32 s38, s38, 9
    s_lshl_b32 s40, s23, 2
    s_add_u32 s38, s38, s40
    s_add_u32 s53, s53, s38
    s_lshl_b32 s54, s21, 7
    s_add_u32 s54, s54, 26222592
    s_mul_i32 s46, s21, 73728
    s_lshl_b32 s47, s20, 10
    s_add_u32 s46, s46, s47
    s_add_u32 s46, s46, 18350080
        s_mul_i32 s30, s22, 297216
        s_mul_i32 s31, s23, 132096
        s_add_u32 s30, s30, s31
        s_lshl_b32 s31, s21, 9
        s_add_u32 s30, s30, s31
        s_lshl_b32 s31, s24, 8
        s_add_u32 s30, s30, s31
        s_add_u32 s31, s30, 2379776
        s_add_u32 s30, s30, 4759552
    s_lshl_b32 s37, s24, 12
    s_lshl_b32 s38, s23, 10
    s_add_u32 s37, s37, s38
    s_add_u32 s37, s37, 74240
    v_add_u32 v32, s37, v104
    s_lshl_b32 s37, s24, 9
    s_lshl_b32 s38, s23, 1
    s_add_u32 s37, s37, s38
    s_add_u32 s37, s37, 82432
    v_add_u32 v33, s37, v105
    v_mov_b32 v34, 83456
    v_lshlrev_b32 v35, 2, v107
    v_and_b32 v35, 0x7c, v35
    s_mov_b32 s37, 9539584
    s_cmp_eq_u32 s20, 7
    s_cbranch_scc0 kfa_kernel_nopoll
    s_and_b32 s33, s2, 7
    s_lshl_b32 s33, s33, 7
    s_add_u32 s33, s33, 26214400
  s_mov_b32 s44, 0
  s_mov_b32 s45, 12
  v_lshlrev_b32 v109, 10, v107
  s_mov_b64 exec, 0xff
kfa_kernel_pollkv:
        buffer_load_dword v110, v109, s[8:11], s33 offen sc1
        s_waitcnt vmcnt(0)
        v_cmp_le_u32 vcc, s45, v110
        s_add_u32 s44, s44, 1
        s_cmp_ge_u32 s44, 262144
        s_cbranch_scc1 kfa_kernel_pdkv
  s_nop 0
        s_cmp_eq_u64 vcc, exec
        s_cbranch_scc1 kfa_kernel_pdkv
        s_sleep 1
        s_branch kfa_kernel_pollkv
kfa_kernel_pdkv:
  s_mov_b64 exec, -1
kfa_kernel_nopoll:
  s_waitcnt lgkmcnt(0)
  s_barrier
  buffer_load_dword v1, v35, s[8:11], s37 offen sc1
        s_mov_b32 m0, s35
        s_add_u32 s35, s35, 8192
        buffer_load_dwordx4 v104, s[8:11], s36 offen sc1 lds
        s_add_u32 s36, s36, 8192
        s_mov_b32 m0, s35
        s_add_u32 s35, s35, 8192
        buffer_load_dwordx4 v104, s[8:11], s36 offen sc1 lds
        s_add_u32 s36, s36, 8192
        s_mov_b32 m0, s35
        s_add_u32 s35, s35, 8192
        buffer_load_dwordx4 v104, s[8:11], s36 offen sc1 lds
        s_add_u32 s36, s36, 8192
    ds_read_b128 v[4:7], v32
    ds_read_u16 v8, v33
    ds_read_b96 v[48:50], v34
    s_waitcnt lgkmcnt(0)
    v_max_f32 v3, v48, v49
    v_add_f32 v3, v3, v50
    v_lshlrev_b32 v10, 16, v8
    v_mov_b32 v13, v8
    v_mov_b32 v15, v10
    s_waitcnt vmcnt(3)
  v_max_f32_dpp v1, v1, v1 row_ror:1 row_mask:0xf bank_mask:0xf
  s_nop 1
  v_max_f32_dpp v1, v1, v1 row_ror:2 row_mask:0xf bank_mask:0xf
  s_nop 1
  v_max_f32_dpp v1, v1, v1 row_ror:4 row_mask:0xf bank_mask:0xf
  s_nop 1
  v_max_f32_dpp v1, v1, v1 row_ror:8 row_mask:0xf bank_mask:0xf
    v_mov_b32 v109, v1
    v_mov_b32 v110, v1
  s_nop 1
    v_permlane16_swap_b32 v109, v110
    v_max_f32 v1, v109, v110
    v_mov_b32 v109, v1
    v_mov_b32 v110, v1
  s_nop 1
    v_permlane32_swap_b32 v109, v110
    v_max_f32 v1, v109, v110
    v_mul_f32 v109, v3, v1
    v_mov_b32 v110, 0x45610000
    v_cmp_le_f32 vcc, v109, v110
    s_waitcnt vmcnt(0)
    s_barrier
  s_nop 1
    s_cbranch_vccnz kfa_kernel_fast
        s_mov_b32 m0, s35
        s_add_u32 s35, s35, 8192
        buffer_load_dwordx4 v104, s[8:11], s36 offen sc1 lds
        s_add_u32 s36, s36, 8192
        s_mov_b32 m0, s35
        s_add_u32 s35, s35, 8192
        buffer_load_dwordx4 v104, s[8:11], s36 offen sc1 lds
        s_add_u32 s36, s36, 8192
        s_mov_b32 m0, s35
        s_add_u32 s35, s35, 8192
        buffer_load_dwordx4 v104, s[8:11], s36 offen sc1 lds
        s_add_u32 s36, s36, 8192
        s_mov_b32 m0, s35
        s_add_u32 s35, s35, 8192
        buffer_load_dwordx4 v104, s[8:11], s36 offen sc1 lds
        s_add_u32 s36, s36, 8192
        s_mov_b32 m0, s35
        s_add_u32 s35, s35, 8192
        buffer_load_dwordx4 v104, s[8:11], s36 offen sc1 lds
        s_add_u32 s36, s36, 8192
        s_mov_b32 m0, s35
        s_add_u32 s35, s35, 8192
        buffer_load_dwordx4 v104, s[8:11], s36 offen sc1 lds
        s_add_u32 s36, s36, 8192
        s_mov_b32 m0, s35
        s_add_u32 s35, s35, 8192
        buffer_load_dwordx4 v104, s[8:11], s36 offen sc1 lds
        s_add_u32 s36, s36, 8192
        s_mov_b32 m0, s35
        s_add_u32 s35, s35, 8192
        buffer_load_dwordx4 v104, s[8:11], s36 offen sc1 lds
        s_add_u32 s36, s36, 8192
        s_mov_b32 m0, s35
        s_add_u32 s35, s35, 8192
        buffer_load_dwordx4 v104, s[8:11], s36 offen sc1 lds
        s_add_u32 s36, s36, 8192
        s_mov_b32 m0, s35
        s_add_u32 s35, s35, 8192
        buffer_load_dwordx4 v104, s[8:11], s36 offen sc1 lds
        s_add_u32 s36, s36, 8192
        s_mov_b32 m0, s35
        s_add_u32 s35, s35, 8192
        buffer_load_dwordx4 v104, s[8:11], s36 offen sc1 lds
        s_add_u32 s36, s36, 8192
        s_mov_b32 m0, s35
        s_add_u32 s35, s35, 8192
        buffer_load_dwordx4 v104, s[8:11], s36 offen sc1 lds
        s_add_u32 s36, s36, 8192
        s_mov_b32 m0, s35
        s_add_u32 s35, s35, 8192
        buffer_load_dwordx4 v104, s[8:11], s36 offen sc1 lds
        s_add_u32 s36, s36, 8192
        s_mov_b32 m0, s35
        s_add_u32 s35, s35, 8192
        buffer_load_dwordx4 v104, s[8:11], s36 offen sc1 lds
        s_add_u32 s36, s36, 8192
        s_mov_b32 m0, s35
        s_add_u32 s35, s35, 8192
        buffer_load_dwordx4 v104, s[8:11], s36 offen sc1 lds
        s_add_u32 s36, s36, 8192
        s_mov_b32 m0, s35
        s_add_u32 s35, s35, 8192
        buffer_load_dwordx4 v104, s[8:11], s36 offen sc1 lds
        s_add_u32 s36, s36, 8192
    s_waitcnt vmcnt(0)
    s_barrier
    v_mov_b32 v2, 0xff800000
    v_mov_b32 v48, v104
    v_mov_b32 v49, v105
    s_mov_b32 s25, 0
kfa_kernel_mx:
  ds_read_b64 v[92:93], v49 offset:8192
        ds_read_b128 v[88:91], v48 offset:0
        s_waitcnt lgkmcnt(0)
        v_mfma_f32_32x32x16_bf16 v[32:47], v[88:91], v[4:7], 0
        v_mfma_f32_32x32x8_bf16 v[32:47], v[92:93], v[8:9], v[32:47]
  s_nop 11
  v_max3_f32 v2, v32, v33, v2
  v_max3_f32 v2, v34, v35, v2
  v_max3_f32 v2, v36, v37, v2
  v_max3_f32 v2, v38, v39, v2
  v_max3_f32 v2, v40, v41, v2
  v_max3_f32 v2, v42, v43, v2
  v_max3_f32 v2, v44, v45, v2
  v_max3_f32 v2, v46, v47, v2
        ds_read_b128 v[88:91], v48 offset:1024
        s_waitcnt lgkmcnt(0)
        v_mfma_f32_32x32x16_bf16 v[32:47], v[88:91], v[4:7], 0
        v_mfma_f32_32x32x8_bf16 v[32:47], v[92:93], v[10:11], v[32:47]
  s_nop 11
  v_max3_f32 v2, v32, v33, v2
  v_max3_f32 v2, v34, v35, v2
  v_max3_f32 v2, v36, v37, v2
  v_max3_f32 v2, v38, v39, v2
  v_max3_f32 v2, v40, v41, v2
  v_max3_f32 v2, v42, v43, v2
  v_max3_f32 v2, v44, v45, v2
  v_max3_f32 v2, v46, v47, v2
        ds_read_b128 v[88:91], v48 offset:2048
        s_waitcnt lgkmcnt(0)
        v_mfma_f32_32x32x16_bf16 v[32:47], v[88:91], v[4:7], 0
        v_mfma_f32_32x32x8_bf16 v[32:47], v[92:93], v[12:13], v[32:47]
  s_nop 11
  v_max3_f32 v2, v32, v33, v2
  v_max3_f32 v2, v34, v35, v2
  v_max3_f32 v2, v36, v37, v2
  v_max3_f32 v2, v38, v39, v2
  v_max3_f32 v2, v40, v41, v2
  v_max3_f32 v2, v42, v43, v2
  v_max3_f32 v2, v44, v45, v2
  v_max3_f32 v2, v46, v47, v2
        ds_read_b128 v[88:91], v48 offset:3072
        s_waitcnt lgkmcnt(0)
        v_mfma_f32_32x32x16_bf16 v[32:47], v[88:91], v[4:7], 0
        v_mfma_f32_32x32x8_bf16 v[32:47], v[92:93], v[14:15], v[32:47]
  s_nop 11
  v_max3_f32 v2, v32, v33, v2
  v_max3_f32 v2, v34, v35, v2
  v_max3_f32 v2, v36, v37, v2
  v_max3_f32 v2, v38, v39, v2
  v_max3_f32 v2, v40, v41, v2
  v_max3_f32 v2, v42, v43, v2
  v_max3_f32 v2, v44, v45, v2
  v_max3_f32 v2, v46, v47, v2
  ds_read_b64 v[92:93], v49 offset:8704
        ds_read_b128 v[88:91], v48 offset:4096
        s_waitcnt lgkmcnt(0)
        v_mfma_f32_32x32x16_bf16 v[32:47], v[88:91], v[4:7], 0
        v_mfma_f32_32x32x8_bf16 v[32:47], v[92:93], v[8:9], v[32:47]
  s_nop 11
  v_max3_f32 v2, v32, v33, v2
  v_max3_f32 v2, v34, v35, v2
  v_max3_f32 v2, v36, v37, v2
  v_max3_f32 v2, v38, v39, v2
  v_max3_f32 v2, v40, v41, v2
  v_max3_f32 v2, v42, v43, v2
  v_max3_f32 v2, v44, v45, v2
  v_max3_f32 v2, v46, v47, v2
        ds_read_b128 v[88:91], v48 offset:5120
        s_waitcnt lgkmcnt(0)
        v_mfma_f32_32x32x16_bf16 v[32:47], v[88:91], v[4:7], 0
        v_mfma_f32_32x32x8_bf16 v[32:47], v[92:93], v[10:11], v[32:47]
  s_nop 11
  v_max3_f32 v2, v32, v33, v2
  v_max3_f32 v2, v34, v35, v2
  v_max3_f32 v2, v36, v37, v2
  v_max3_f32 v2, v38, v39, v2
  v_max3_f32 v2, v40, v41, v2
  v_max3_f32 v2, v42, v43, v2
  v_max3_f32 v2, v44, v45, v2
  v_max3_f32 v2, v46, v47, v2
        ds_read_b128 v[88:91], v48 offset:6144
        s_waitcnt lgkmcnt(0)
        v_mfma_f32_32x32x16_bf16 v[32:47], v[88:91], v[4:7], 0
        v_mfma_f32_32x32x8_bf16 v[32:47], v[92:93], v[12:13], v[32:47]
  s_nop 11
  v_max3_f32 v2, v32, v33, v2
  v_max3_f32 v2, v34, v35, v2
  v_max3_f32 v2, v36, v37, v2
  v_max3_f32 v2, v38, v39, v2
  v_max3_f32 v2, v40, v41, v2
  v_max3_f32 v2, v42, v43, v2
  v_max3_f32 v2, v44, v45, v2
  v_max3_f32 v2, v46, v47, v2
        ds_read_b128 v[88:91], v48 offset:7168
        s_waitcnt lgkmcnt(0)
        v_mfma_f32_32x32x16_bf16 v[32:47], v[88:91], v[4:7], 0
        v_mfma_f32_32x32x8_bf16 v[32:47], v[92:93], v[14:15], v[32:47]
  s_nop 11
  v_max3_f32 v2, v32, v33, v2
  v_max3_f32 v2, v34, v35, v2
  v_max3_f32 v2, v36, v37, v2
  v_max3_f32 v2, v38, v39, v2
  v_max3_f32 v2, v40, v41, v2
  v_max3_f32 v2, v42, v43, v2
  v_max3_f32 v2, v44, v45, v2
  v_max3_f32 v2, v46, v47, v2
    v_add_u32 v48, 19456, v48
    v_add_u32 v49, 19456, v49
    s_add_u32 s25, s25, 1
    s_cmp_lt_u32 s25, 8
    s_cbranch_scc1 kfa_kernel_mx
    v_mov_b32 v109, v2
    v_mov_b32 v110, v2
  s_nop 1
    v_permlane32_swap_b32 v109, v110
    v_max_f32 v2, v109, v110
  v_sub_f32 v16, 0, v2
  v_sub_f32 v17, 0, v2
  v_sub_f32 v18, 0, v2
  v_sub_f32 v19, 0, v2
  v_sub_f32 v20, 0, v2
  v_sub_f32 v21, 0, v2
  v_sub_f32 v22, 0, v2
  v_sub_f32 v23, 0, v2
  v_sub_f32 v24, 0, v2
  v_sub_f32 v25, 0, v2
  v_sub_f32 v26, 0, v2
  v_sub_f32 v27, 0, v2
  v_sub_f32 v28, 0, v2
  v_sub_f32 v29, 0, v2
  v_sub_f32 v30, 0, v2
  v_sub_f32 v31, 0, v2
  s_mov_b32 s41, 1
  s_branch kfa_kernel_go
kfa_kernel_fast:
  s_mov_b32 s41, 0
kfa_kernel_go:
    ds_read_b128 v[88:91], v104
    ds_read_b64 v[92:93], v105 offset:8192
    s_cmp_ge_u32 s20, 4
    s_cbranch_scc0 kfa_kernel_np
    s_setprio 1
kfa_kernel_np:
    s_waitcnt lgkmcnt(0)
    v_mfma_f32_32x32x16_bf16 v[32:47], v[88:91], v[4:7], v[16:31]
    v_mfma_f32_32x32x8_bf16 v[32:47], v[92:93], v[8:9], v[32:47]
    ds_read_b128 v[88:91], v104 offset:1024
    ds_read_b128 v[100:103], v106 offset:9856
    ds_read_b128 v[96:99], v106 offset:9216
    s_nop 7
  s_cmp_eq_u32 s41, 0
  s_cbranch_scc0 kfa_kernel_nodma0
        s_mov_b32 m0, s35
        s_add_u32 s35, s35, 8192
        buffer_load_dwordx4 v108, s[8:11], s36 offen sc1 lds
        s_add_u32 s36, s36, 8192
kfa_kernel_nodma0:
  v_exp_f32 v32, v32
  s_waitcnt lgkmcnt(0)
  v_mfma_f32_32x32x16_bf16 v[48:63], v[88:91], v[4:7], v[16:31]
  v_exp_f32 v33, v33
  v_exp_f32 v34, v34
  v_cvt_pk_bf16_f32 v80, v32, v33
  v_exp_f32 v35, v35
  v_exp_f32 v36, v36
  v_cvt_pk_bf16_f32 v81, v34, v35
  v_exp_f32 v37, v37
  v_exp_f32 v38, v38
  v_mfma_f32_32x32x8_bf16 v[48:63], v[92:93], v[10:11], v[48:63]
  ds_read_b128 v[88:91], v104 offset:2048
  ds_read_b128 v[0:3], v106 offset:10496
  v_cvt_pk_bf16_f32 v82, v36, v37
  v_exp_f32 v39, v39
  v_exp_f32 v40, v40
  v_cvt_pk_bf16_f32 v83, v38, v39
  v_exp_f32 v41, v41
  v_exp_f32 v42, v42
  v_mfma_f32_32x32x16_bf16 v[64:79], v[100:103], v[84:87], v[64:79]
  ds_read_b128 v[100:103], v106 offset:9856
  v_cvt_pk_bf16_f32 v84, v40, v41
  v_exp_f32 v43, v43
  v_exp_f32 v44, v44
  v_cvt_pk_bf16_f32 v85, v42, v43
  v_exp_f32 v45, v45
  v_mfma_f32_32x32x16_bf16 v[64:79], v[96:99], v[80:83], v[64:79]
  v_exp_f32 v46, v46
  v_exp_f32 v47, v47
  v_cvt_pk_bf16_f32 v86, v44, v45
  v_cvt_pk_bf16_f32 v87, v46, v47
  s_cmp_eq_u32 s41, 0
  s_cbranch_scc0 kfa_kernel_nodma1
        s_mov_b32 m0, s35
        s_add_u32 s35, s35, 8192
        buffer_load_dwordx4 v108, s[8:11], s36 offen sc1 lds
        s_add_u32 s36, s36, 8192
kfa_kernel_nodma1:
  v_exp_f32 v48, v48
  s_waitcnt lgkmcnt(0)
  v_mfma_f32_32x32x16_bf16 v[32:47], v[88:91], v[4:7], v[16:31]
  v_exp_f32 v49, v49
  v_exp_f32 v50, v50
  v_cvt_pk_bf16_f32 v80, v48, v49
  v_exp_f32 v51, v51
  v_exp_f32 v52, v52
  v_cvt_pk_bf16_f32 v81, v50, v51
  v_exp_f32 v53, v53
  v_exp_f32 v54, v54
  v_mfma_f32_32x32x8_bf16 v[32:47], v[92:93], v[12:13], v[32:47]
  ds_read_b128 v[88:91], v104 offset:3072
  ds_read_b128 v[96:99], v106 offset:11776
  v_cvt_pk_bf16_f32 v82, v52, v53
  v_exp_f32 v55, v55
  v_exp_f32 v56, v56
  v_cvt_pk_bf16_f32 v83, v54, v55
  v_exp_f32 v57, v57
  v_exp_f32 v58, v58
  v_mfma_f32_32x32x16_bf16 v[64:79], v[100:103], v[84:87], v[64:79]
  ds_read_b128 v[100:103], v106 offset:11136
  v_cvt_pk_bf16_f32 v84, v56, v57
  v_exp_f32 v59, v59
  v_exp_f32 v60, v60
  v_cvt_pk_bf16_f32 v85, v58, v59
  v_exp_f32 v61, v61
  v_mfma_f32_32x32x16_bf16 v[64:79], v[0:3], v[80:83], v[64:79]
  v_exp_f32 v62, v62
  v_exp_f32 v63, v63
  v_cvt_pk_bf16_f32 v86, v60, v61
  v_cvt_pk_bf16_f32 v87, v62, v63
  s_cmp_eq_u32 s41, 0
  s_cbranch_scc0 kfa_kernel_nodma2
        s_mov_b32 m0, s35
        s_add_u32 s35, s35, 8192
        buffer_load_dwordx4 v108, s[8:11], s36 offen sc1 lds
        s_add_u32 s36, s36, 8192
kfa_kernel_nodma2:
  v_exp_f32 v32, v32
  s_waitcnt lgkmcnt(0)
  v_mfma_f32_32x32x16_bf16 v[48:63], v[88:91], v[4:7], v[16:31]
  v_exp_f32 v33, v33
  v_exp_f32 v34, v34
  v_cvt_pk_bf16_f32 v80, v32, v33
  v_exp_f32 v35, v35
  v_exp_f32 v36, v36
  v_cvt_pk_bf16_f32 v81, v34, v35
  v_exp_f32 v37, v37
  v_exp_f32 v38, v38
  v_mfma_f32_32x32x8_bf16 v[48:63], v[92:93], v[14:15], v[48:63]
  ds_read_b64 v[94:95], v105 offset:8704
  ds_read_b128 v[88:91], v104 offset:4096
  ds_read_b128 v[0:3], v106 offset:13056
  v_cvt_pk_bf16_f32 v82, v36, v37
  v_exp_f32 v39, v39
  v_exp_f32 v40, v40
  v_cvt_pk_bf16_f32 v83, v38, v39
  v_exp_f32 v41, v41
  v_exp_f32 v42, v42
  v_mfma_f32_32x32x16_bf16 v[64:79], v[100:103], v[84:87], v[64:79]
  ds_read_b128 v[100:103], v106 offset:12416
  v_cvt_pk_bf16_f32 v84, v40, v41
  v_exp_f32 v43, v43
  v_exp_f32 v44, v44
  v_cvt_pk_bf16_f32 v85, v42, v43
  v_exp_f32 v45, v45
  v_mfma_f32_32x32x16_bf16 v[64:79], v[96:99], v[80:83], v[64:79]
  v_exp_f32 v46, v46
  v_exp_f32 v47, v47
  v_cvt_pk_bf16_f32 v86, v44, v45
  v_cvt_pk_bf16_f32 v87, v46, v47
  s_cmp_eq_u32 s41, 0
  s_cbranch_scc0 kfa_kernel_nodma3
        s_mov_b32 m0, s35
        s_add_u32 s35, s35, 8192
        buffer_load_dwordx4 v108, s[8:11], s36 offen sc1 lds
        s_add_u32 s36, s36, 8192
kfa_kernel_nodma3:
  v_exp_f32 v48, v48
  s_waitcnt lgkmcnt(0)
  v_mfma_f32_32x32x16_bf16 v[32:47], v[88:91], v[4:7], v[16:31]
  v_exp_f32 v49, v49
  v_exp_f32 v50, v50
  v_cvt_pk_bf16_f32 v80, v48, v49
  v_exp_f32 v51, v51
  v_exp_f32 v52, v52
  v_cvt_pk_bf16_f32 v81, v50, v51
  v_exp_f32 v53, v53
  v_exp_f32 v54, v54
  v_mfma_f32_32x32x8_bf16 v[32:47], v[94:95], v[8:9], v[32:47]
  ds_read_b128 v[88:91], v104 offset:5120
  ds_read_b128 v[96:99], v106 offset:14336
  v_cvt_pk_bf16_f32 v82, v52, v53
  v_exp_f32 v55, v55
  v_exp_f32 v56, v56
  v_cvt_pk_bf16_f32 v83, v54, v55
  v_exp_f32 v57, v57
  v_exp_f32 v58, v58
  v_mfma_f32_32x32x16_bf16 v[64:79], v[100:103], v[84:87], v[64:79]
  ds_read_b128 v[100:103], v106 offset:13696
  v_cvt_pk_bf16_f32 v84, v56, v57
  v_exp_f32 v59, v59
  v_exp_f32 v60, v60
  v_cvt_pk_bf16_f32 v85, v58, v59
  v_exp_f32 v61, v61
  v_mfma_f32_32x32x16_bf16 v[64:79], v[0:3], v[80:83], v[64:79]
  v_exp_f32 v62, v62
  v_exp_f32 v63, v63
  v_cvt_pk_bf16_f32 v86, v60, v61
  v_cvt_pk_bf16_f32 v87, v62, v63
  s_cmp_eq_u32 s41, 0
  s_cbranch_scc0 kfa_kernel_nodma4
        s_mov_b32 m0, s35
        s_add_u32 s35, s35, 8192
        buffer_load_dwordx4 v108, s[8:11], s36 offen sc1 lds
        s_add_u32 s36, s36, 8192
kfa_kernel_nodma4:
  v_exp_f32 v32, v32
  s_waitcnt lgkmcnt(0)
  v_mfma_f32_32x32x16_bf16 v[48:63], v[88:91], v[4:7], v[16:31]
  v_exp_f32 v33, v33
  v_exp_f32 v34, v34
  v_cvt_pk_bf16_f32 v80, v32, v33
  v_exp_f32 v35, v35
  v_exp_f32 v36, v36
  v_cvt_pk_bf16_f32 v81, v34, v35
  v_exp_f32 v37, v37
  v_exp_f32 v38, v38
  v_mfma_f32_32x32x8_bf16 v[48:63], v[94:95], v[10:11], v[48:63]
  ds_read_b128 v[88:91], v104 offset:6144
  ds_read_b128 v[0:3], v106 offset:15616
  v_cvt_pk_bf16_f32 v82, v36, v37
  v_exp_f32 v39, v39
  v_exp_f32 v40, v40
  v_cvt_pk_bf16_f32 v83, v38, v39
  v_exp_f32 v41, v41
  v_exp_f32 v42, v42
  v_mfma_f32_32x32x16_bf16 v[64:79], v[100:103], v[84:87], v[64:79]
  ds_read_b128 v[100:103], v106 offset:14976
  v_cvt_pk_bf16_f32 v84, v40, v41
  v_exp_f32 v43, v43
  v_exp_f32 v44, v44
  v_cvt_pk_bf16_f32 v85, v42, v43
  v_exp_f32 v45, v45
  v_mfma_f32_32x32x16_bf16 v[64:79], v[96:99], v[80:83], v[64:79]
  v_exp_f32 v46, v46
  v_exp_f32 v47, v47
  v_cvt_pk_bf16_f32 v86, v44, v45
  v_cvt_pk_bf16_f32 v87, v46, v47
  s_cmp_eq_u32 s41, 0
  s_cbranch_scc0 kfa_kernel_nodma5
        s_mov_b32 m0, s35
        s_add_u32 s35, s35, 8192
        buffer_load_dwordx4 v108, s[8:11], s36 offen sc1 lds
        s_add_u32 s36, s36, 8192
kfa_kernel_nodma5:
  s_waitcnt vmcnt(4)
  s_barrier
  v_exp_f32 v48, v48
  s_waitcnt lgkmcnt(0)
  v_mfma_f32_32x32x16_bf16 v[32:47], v[88:91], v[4:7], v[16:31]
  v_exp_f32 v49, v49
  v_exp_f32 v50, v50
  v_cvt_pk_bf16_f32 v80, v48, v49
  v_exp_f32 v51, v51
  v_exp_f32 v52, v52
  v_cvt_pk_bf16_f32 v81, v50, v51
  v_exp_f32 v53, v53
  v_exp_f32 v54, v54
  v_mfma_f32_32x32x8_bf16 v[32:47], v[94:95], v[12:13], v[32:47]
  ds_read_b128 v[88:91], v104 offset:7168
  ds_read_b128 v[96:99], v106 offset:16896
  v_cvt_pk_bf16_f32 v82, v52, v53
  v_exp_f32 v55, v55
  v_exp_f32 v56, v56
  v_cvt_pk_bf16_f32 v83, v54, v55
  v_exp_f32 v57, v57
  v_exp_f32 v58, v58
  v_mfma_f32_32x32x16_bf16 v[64:79], v[100:103], v[84:87], v[64:79]
  ds_read_b128 v[100:103], v106 offset:16256
  v_cvt_pk_bf16_f32 v84, v56, v57
  v_exp_f32 v59, v59
  v_exp_f32 v60, v60
  v_cvt_pk_bf16_f32 v85, v58, v59
  v_exp_f32 v61, v61
  v_mfma_f32_32x32x16_bf16 v[64:79], v[0:3], v[80:83], v[64:79]
  v_exp_f32 v62, v62
  v_exp_f32 v63, v63
  v_cvt_pk_bf16_f32 v86, v60, v61
  v_cvt_pk_bf16_f32 v87, v62, v63
  s_cmp_eq_u32 s41, 0
  s_cbranch_scc0 kfa_kernel_nodma6
        s_mov_b32 m0, s35
        s_add_u32 s35, s35, 8192
        buffer_load_dwordx4 v108, s[8:11], s36 offen sc1 lds
        s_add_u32 s36, s36, 8192
kfa_kernel_nodma6:
  v_exp_f32 v32, v32
  s_waitcnt lgkmcnt(0)
  v_mfma_f32_32x32x16_bf16 v[48:63], v[88:91], v[4:7], v[16:31]
  v_exp_f32 v33, v33
  v_exp_f32 v34, v34
  v_cvt_pk_bf16_f32 v80, v32, v33
  v_exp_f32 v35, v35
  v_exp_f32 v36, v36
  v_cvt_pk_bf16_f32 v81, v34, v35
  v_exp_f32 v37, v37
  v_exp_f32 v38, v38
  v_mfma_f32_32x32x8_bf16 v[48:63], v[94:95], v[14:15], v[48:63]
  ds_read_b64 v[92:93], v105 offset:27648
  ds_read_b128 v[88:91], v104 offset:19456
  ds_read_b128 v[0:3], v106 offset:18176
  v_cvt_pk_bf16_f32 v82, v36, v37
  v_exp_f32 v39, v39
  v_exp_f32 v40, v40
  v_cvt_pk_bf16_f32 v83, v38, v39
  v_exp_f32 v41, v41
  v_exp_f32 v42, v42
  v_mfma_f32_32x32x16_bf16 v[64:79], v[100:103], v[84:87], v[64:79]
  ds_read_b128 v[100:103], v106 offset:17536
  v_cvt_pk_bf16_f32 v84, v40, v41
  v_exp_f32 v43, v43
  v_exp_f32 v44, v44
  v_cvt_pk_bf16_f32 v85, v42, v43
  v_exp_f32 v45, v45
  v_mfma_f32_32x32x16_bf16 v[64:79], v[96:99], v[80:83], v[64:79]
  v_exp_f32 v46, v46
  v_exp_f32 v47, v47
  v_cvt_pk_bf16_f32 v86, v44, v45
  v_cvt_pk_bf16_f32 v87, v46, v47
  s_cmp_eq_u32 s41, 0
  s_cbranch_scc0 kfa_kernel_nodma7
        s_mov_b32 m0, s35
        s_add_u32 s35, s35, 8192
        buffer_load_dwordx4 v108, s[8:11], s36 offen sc1 lds
        s_add_u32 s36, s36, 8192
kfa_kernel_nodma7:
  v_exp_f32 v48, v48
  s_waitcnt lgkmcnt(0)
  v_mfma_f32_32x32x16_bf16 v[32:47], v[88:91], v[4:7], v[16:31]
  v_exp_f32 v49, v49
  v_exp_f32 v50, v50
  v_cvt_pk_bf16_f32 v80, v48, v49
  v_exp_f32 v51, v51
  v_exp_f32 v52, v52
  v_cvt_pk_bf16_f32 v81, v50, v51
  v_exp_f32 v53, v53
  v_exp_f32 v54, v54
  v_mfma_f32_32x32x8_bf16 v[32:47], v[92:93], v[8:9], v[32:47]
  ds_read_b128 v[88:91], v104 offset:20480
  ds_read_b128 v[96:99], v106 offset:28672
  v_cvt_pk_bf16_f32 v82, v52, v53
  v_exp_f32 v55, v55
  v_exp_f32 v56, v56
  v_cvt_pk_bf16_f32 v83, v54, v55
  v_exp_f32 v57, v57
  v_exp_f32 v58, v58
  v_mfma_f32_32x32x16_bf16 v[64:79], v[100:103], v[84:87], v[64:79]
  ds_read_b128 v[100:103], v106 offset:18816
  v_cvt_pk_bf16_f32 v84, v56, v57
  v_exp_f32 v59, v59
  v_exp_f32 v60, v60
  v_cvt_pk_bf16_f32 v85, v58, v59
  v_exp_f32 v61, v61
  v_mfma_f32_32x32x16_bf16 v[64:79], v[0:3], v[80:83], v[64:79]
  v_exp_f32 v62, v62
  v_exp_f32 v63, v63
  v_cvt_pk_bf16_f32 v86, v60, v61
  v_cvt_pk_bf16_f32 v87, v62, v63
  s_cmp_eq_u32 s41, 0
  s_cbranch_scc0 kfa_kernel_nodma8
        s_mov_b32 m0, s35
        s_add_u32 s35, s35, 8192
        buffer_load_dwordx4 v108, s[8:11], s36 offen sc1 lds
        s_add_u32 s36, s36, 8192
kfa_kernel_nodma8:
  v_exp_f32 v32, v32
  s_waitcnt lgkmcnt(0)
  v_mfma_f32_32x32x16_bf16 v[48:63], v[88:91], v[4:7], v[16:31]
  v_exp_f32 v33, v33
  v_exp_f32 v34, v34
  v_cvt_pk_bf16_f32 v80, v32, v33
  v_exp_f32 v35, v35
  v_exp_f32 v36, v36
  v_cvt_pk_bf16_f32 v81, v34, v35
  v_exp_f32 v37, v37
  v_exp_f32 v38, v38
  v_mfma_f32_32x32x8_bf16 v[48:63], v[92:93], v[10:11], v[48:63]
  ds_read_b128 v[88:91], v104 offset:21504
  ds_read_b128 v[0:3], v106 offset:29952
  v_cvt_pk_bf16_f32 v82, v36, v37
  v_exp_f32 v39, v39
  v_exp_f32 v40, v40
  v_cvt_pk_bf16_f32 v83, v38, v39
  v_exp_f32 v41, v41
  v_exp_f32 v42, v42
  v_mfma_f32_32x32x16_bf16 v[64:79], v[100:103], v[84:87], v[64:79]
  ds_read_b128 v[100:103], v106 offset:29312
  v_cvt_pk_bf16_f32 v84, v40, v41
  v_exp_f32 v43, v43
  v_exp_f32 v44, v44
  v_cvt_pk_bf16_f32 v85, v42, v43
  v_exp_f32 v45, v45
  v_mfma_f32_32x32x16_bf16 v[64:79], v[96:99], v[80:83], v[64:79]
  v_exp_f32 v46, v46
  v_exp_f32 v47, v47
  v_cvt_pk_bf16_f32 v86, v44, v45
  v_cvt_pk_bf16_f32 v87, v46, v47
  s_cmp_eq_u32 s41, 0
  s_cbranch_scc0 kfa_kernel_nodma9
        s_mov_b32 m0, s35
        s_add_u32 s35, s35, 8192
        buffer_load_dwordx4 v108, s[8:11], s36 offen sc1 lds
        s_add_u32 s36, s36, 8192
kfa_kernel_nodma9:
  v_exp_f32 v48, v48
  s_waitcnt lgkmcnt(0)
  v_mfma_f32_32x32x16_bf16 v[32:47], v[88:91], v[4:7], v[16:31]
  v_exp_f32 v49, v49
  v_exp_f32 v50, v50
  v_cvt_pk_bf16_f32 v80, v48, v49
  v_exp_f32 v51, v51
  v_exp_f32 v52, v52
  v_cvt_pk_bf16_f32 v81, v50, v51
  v_exp_f32 v53, v53
  v_exp_f32 v54, v54
  v_mfma_f32_32x32x8_bf16 v[32:47], v[92:93], v[12:13], v[32:47]
  ds_read_b128 v[88:91], v104 offset:22528
  ds_read_b128 v[96:99], v106 offset:31232
  v_cvt_pk_bf16_f32 v82, v52, v53
  v_exp_f32 v55, v55
  v_exp_f32 v56, v56
  v_cvt_pk_bf16_f32 v83, v54, v55
  v_exp_f32 v57, v57
  v_exp_f32 v58, v58
  v_mfma_f32_32x32x16_bf16 v[64:79], v[100:103], v[84:87], v[64:79]
  ds_read_b128 v[100:103], v106 offset:30592
  v_cvt_pk_bf16_f32 v84, v56, v57
  v_exp_f32 v59, v59
  v_exp_f32 v60, v60
  v_cvt_pk_bf16_f32 v85, v58, v59
  v_exp_f32 v61, v61
  v_mfma_f32_32x32x16_bf16 v[64:79], v[0:3], v[80:83], v[64:79]
  v_exp_f32 v62, v62
  v_exp_f32 v63, v63
  v_cvt_pk_bf16_f32 v86, v60, v61
  v_cvt_pk_bf16_f32 v87, v62, v63
  s_cmp_eq_u32 s41, 0
  s_cbranch_scc0 kfa_kernel_nodma10
        s_mov_b32 m0, s35
        s_add_u32 s35, s35, 8192
        buffer_load_dwordx4 v108, s[8:11], s36 offen sc1 lds
        s_add_u32 s36, s36, 8192
kfa_kernel_nodma10:
  v_exp_f32 v32, v32
  s_waitcnt lgkmcnt(0)
  v_mfma_f32_32x32x16_bf16 v[48:63], v[88:91], v[4:7], v[16:31]
  v_exp_f32 v33, v33
  v_exp_f32 v34, v34
  v_cvt_pk_bf16_f32 v80, v32, v33
  v_exp_f32 v35, v35
  v_exp_f32 v36, v36
  v_cvt_pk_bf16_f32 v81, v34, v35
  v_exp_f32 v37, v37
  v_exp_f32 v38, v38
  v_mfma_f32_32x32x8_bf16 v[48:63], v[92:93], v[14:15], v[48:63]
  ds_read_b64 v[94:95], v105 offset:28160
  ds_read_b128 v[88:91], v104 offset:23552
  ds_read_b128 v[0:3], v106 offset:32512
  v_cvt_pk_bf16_f32 v82, v36, v37
  v_exp_f32 v39, v39
  v_exp_f32 v40, v40
  v_cvt_pk_bf16_f32 v83, v38, v39
  v_exp_f32 v41, v41
  v_exp_f32 v42, v42
  v_mfma_f32_32x32x16_bf16 v[64:79], v[100:103], v[84:87], v[64:79]
  ds_read_b128 v[100:103], v106 offset:31872
  v_cvt_pk_bf16_f32 v84, v40, v41
  v_exp_f32 v43, v43
  v_exp_f32 v44, v44
  v_cvt_pk_bf16_f32 v85, v42, v43
  v_exp_f32 v45, v45
  v_mfma_f32_32x32x16_bf16 v[64:79], v[96:99], v[80:83], v[64:79]
  v_exp_f32 v46, v46
  v_exp_f32 v47, v47
  v_cvt_pk_bf16_f32 v86, v44, v45
  v_cvt_pk_bf16_f32 v87, v46, v47
  s_cmp_eq_u32 s41, 0
  s_cbranch_scc0 kfa_kernel_nodma11
        s_mov_b32 m0, s35
        s_add_u32 s35, s35, 8192
        buffer_load_dwordx4 v108, s[8:11], s36 offen sc1 lds
        s_add_u32 s36, s36, 8192
kfa_kernel_nodma11:
  v_exp_f32 v48, v48
  s_waitcnt lgkmcnt(0)
  v_mfma_f32_32x32x16_bf16 v[32:47], v[88:91], v[4:7], v[16:31]
  v_exp_f32 v49, v49
  v_exp_f32 v50, v50
  v_cvt_pk_bf16_f32 v80, v48, v49
  v_exp_f32 v51, v51
  v_exp_f32 v52, v52
  v_cvt_pk_bf16_f32 v81, v50, v51
  v_exp_f32 v53, v53
  v_exp_f32 v54, v54
  v_mfma_f32_32x32x8_bf16 v[32:47], v[94:95], v[8:9], v[32:47]
  ds_read_b128 v[88:91], v104 offset:24576
  ds_read_b128 v[96:99], v106 offset:33792
  v_cvt_pk_bf16_f32 v82, v52, v53
  v_exp_f32 v55, v55
  v_exp_f32 v56, v56
  v_cvt_pk_bf16_f32 v83, v54, v55
  v_exp_f32 v57, v57
  v_exp_f32 v58, v58
  v_mfma_f32_32x32x16_bf16 v[64:79], v[100:103], v[84:87], v[64:79]
  ds_read_b128 v[100:103], v106 offset:33152
  v_cvt_pk_bf16_f32 v84, v56, v57
  v_exp_f32 v59, v59
  v_exp_f32 v60, v60
  v_cvt_pk_bf16_f32 v85, v58, v59
  v_exp_f32 v61, v61
  v_mfma_f32_32x32x16_bf16 v[64:79], v[0:3], v[80:83], v[64:79]
  v_exp_f32 v62, v62
  v_exp_f32 v63, v63
  v_cvt_pk_bf16_f32 v86, v60, v61
  v_cvt_pk_bf16_f32 v87, v62, v63
  s_cmp_eq_u32 s41, 0
  s_cbranch_scc0 kfa_kernel_nodma12
        s_mov_b32 m0, s35
        s_add_u32 s35, s35, 8192
        buffer_load_dwordx4 v108, s[8:11], s36 offen sc1 lds
        s_add_u32 s36, s36, 8192
kfa_kernel_nodma12:
  v_exp_f32 v32, v32
  s_waitcnt lgkmcnt(0)
  v_mfma_f32_32x32x16_bf16 v[48:63], v[88:91], v[4:7], v[16:31]
  v_exp_f32 v33, v33
  v_exp_f32 v34, v34
  v_cvt_pk_bf16_f32 v80, v32, v33
  v_exp_f32 v35, v35
  v_exp_f32 v36, v36
  v_cvt_pk_bf16_f32 v81, v34, v35
  v_exp_f32 v37, v37
  v_exp_f32 v38, v38
  v_mfma_f32_32x32x8_bf16 v[48:63], v[94:95], v[10:11], v[48:63]
  ds_read_b128 v[88:91], v104 offset:25600
  ds_read_b128 v[0:3], v106 offset:35072
  v_cvt_pk_bf16_f32 v82, v36, v37
  v_exp_f32 v39, v39
  v_exp_f32 v40, v40
  v_cvt_pk_bf16_f32 v83, v38, v39
  v_exp_f32 v41, v41
  v_exp_f32 v42, v42
  v_mfma_f32_32x32x16_bf16 v[64:79], v[100:103], v[84:87], v[64:79]
  ds_read_b128 v[100:103], v106 offset:34432
  v_cvt_pk_bf16_f32 v84, v40, v41
  v_exp_f32 v43, v43
  v_exp_f32 v44, v44
  v_cvt_pk_bf16_f32 v85, v42, v43
  v_exp_f32 v45, v45
  v_mfma_f32_32x32x16_bf16 v[64:79], v[96:99], v[80:83], v[64:79]
  v_exp_f32 v46, v46
  v_exp_f32 v47, v47
  v_cvt_pk_bf16_f32 v86, v44, v45
  v_cvt_pk_bf16_f32 v87, v46, v47
  s_cmp_eq_u32 s41, 0
  s_cbranch_scc0 kfa_kernel_nodma13
        s_mov_b32 m0, s35
        s_add_u32 s35, s35, 8192
        buffer_load_dwordx4 v108, s[8:11], s36 offen sc1 lds
        s_add_u32 s36, s36, 8192
kfa_kernel_nodma13:
  s_waitcnt vmcnt(9)
  s_barrier
  v_exp_f32 v48, v48
  s_waitcnt lgkmcnt(0)
  v_mfma_f32_32x32x16_bf16 v[32:47], v[88:91], v[4:7], v[16:31]
  v_exp_f32 v49, v49
  v_exp_f32 v50, v50
  v_cvt_pk_bf16_f32 v80, v48, v49
  v_exp_f32 v51, v51
  v_exp_f32 v52, v52
  v_cvt_pk_bf16_f32 v81, v50, v51
  v_exp_f32 v53, v53
  v_exp_f32 v54, v54
  v_mfma_f32_32x32x8_bf16 v[32:47], v[94:95], v[12:13], v[32:47]
  ds_read_b128 v[88:91], v104 offset:26624
  ds_read_b128 v[96:99], v106 offset:36352
  v_cvt_pk_bf16_f32 v82, v52, v53
  v_exp_f32 v55, v55
  v_exp_f32 v56, v56
  v_cvt_pk_bf16_f32 v83, v54, v55
  v_exp_f32 v57, v57
  v_exp_f32 v58, v58
  v_mfma_f32_32x32x16_bf16 v[64:79], v[100:103], v[84:87], v[64:79]
  ds_read_b128 v[100:103], v106 offset:35712
  v_cvt_pk_bf16_f32 v84, v56, v57
  v_exp_f32 v59, v59
  v_exp_f32 v60, v60
  v_cvt_pk_bf16_f32 v85, v58, v59
  v_exp_f32 v61, v61
  v_mfma_f32_32x32x16_bf16 v[64:79], v[0:3], v[80:83], v[64:79]
  v_exp_f32 v62, v62
  v_exp_f32 v63, v63
  v_cvt_pk_bf16_f32 v86, v60, v61
  v_cvt_pk_bf16_f32 v87, v62, v63
  s_cmp_eq_u32 s41, 0
  s_cbranch_scc0 kfa_kernel_nodma14
        s_mov_b32 m0, s35
        s_add_u32 s35, s35, 8192
        buffer_load_dwordx4 v108, s[8:11], s36 offen sc1 lds
        s_add_u32 s36, s36, 8192
kfa_kernel_nodma14:
  v_exp_f32 v32, v32
  s_waitcnt lgkmcnt(0)
  v_mfma_f32_32x32x16_bf16 v[48:63], v[88:91], v[4:7], v[16:31]
  v_exp_f32 v33, v33
  v_exp_f32 v34, v34
  v_cvt_pk_bf16_f32 v80, v32, v33
  v_exp_f32 v35, v35
  v_exp_f32 v36, v36
  v_cvt_pk_bf16_f32 v81, v34, v35
  v_exp_f32 v37, v37
  v_exp_f32 v38, v38
  v_mfma_f32_32x32x8_bf16 v[48:63], v[94:95], v[14:15], v[48:63]
  ds_read_b64 v[92:93], v105 offset:47104
  ds_read_b128 v[88:91], v104 offset:38912
  ds_read_b128 v[0:3], v106 offset:37632
  v_cvt_pk_bf16_f32 v82, v36, v37
  v_exp_f32 v39, v39
  v_exp_f32 v40, v40
  v_cvt_pk_bf16_f32 v83, v38, v39
  v_exp_f32 v41, v41
  v_exp_f32 v42, v42
  v_mfma_f32_32x32x16_bf16 v[64:79], v[100:103], v[84:87], v[64:79]
  ds_read_b128 v[100:103], v106 offset:36992
  v_cvt_pk_bf16_f32 v84, v40, v41
  v_exp_f32 v43, v43
  v_exp_f32 v44, v44
  v_cvt_pk_bf16_f32 v85, v42, v43
  v_exp_f32 v45, v45
  v_mfma_f32_32x32x16_bf16 v[64:79], v[96:99], v[80:83], v[64:79]
  v_exp_f32 v46, v46
  v_exp_f32 v47, v47
  v_cvt_pk_bf16_f32 v86, v44, v45
  v_cvt_pk_bf16_f32 v87, v46, v47
  s_cmp_eq_u32 s41, 0
  s_cbranch_scc0 kfa_kernel_nodma15
        s_mov_b32 m0, s35
        s_add_u32 s35, s35, 8192
        buffer_load_dwordx4 v108, s[8:11], s36 offen sc1 lds
        s_add_u32 s36, s36, 8192
kfa_kernel_nodma15:
  v_exp_f32 v48, v48
  s_waitcnt lgkmcnt(0)
  v_mfma_f32_32x32x16_bf16 v[32:47], v[88:91], v[4:7], v[16:31]
  v_exp_f32 v49, v49
  v_exp_f32 v50, v50
  v_cvt_pk_bf16_f32 v80, v48, v49
  v_exp_f32 v51, v51
  v_exp_f32 v52, v52
  v_cvt_pk_bf16_f32 v81, v50, v51
  v_exp_f32 v53, v53
  v_exp_f32 v54, v54
  v_mfma_f32_32x32x8_bf16 v[32:47], v[92:93], v[8:9], v[32:47]
  ds_read_b128 v[88:91], v104 offset:39936
  ds_read_b128 v[96:99], v106 offset:48128
  v_cvt_pk_bf16_f32 v82, v52, v53
  v_exp_f32 v55, v55
  v_exp_f32 v56, v56
  v_cvt_pk_bf16_f32 v83, v54, v55
  v_exp_f32 v57, v57
  v_exp_f32 v58, v58
  v_mfma_f32_32x32x16_bf16 v[64:79], v[100:103], v[84:87], v[64:79]
  ds_read_b128 v[100:103], v106 offset:38272
  v_cvt_pk_bf16_f32 v84, v56, v57
  v_exp_f32 v59, v59
  v_exp_f32 v60, v60
  v_cvt_pk_bf16_f32 v85, v58, v59
  v_exp_f32 v61, v61
  v_mfma_f32_32x32x16_bf16 v[64:79], v[0:3], v[80:83], v[64:79]
  v_exp_f32 v62, v62
  v_exp_f32 v63, v63
  v_cvt_pk_bf16_f32 v86, v60, v61
  v_cvt_pk_bf16_f32 v87, v62, v63
  v_add_u32 v104, 38912, v104
  v_add_u32 v105, 38912, v105
  v_add_u32 v106, 38912, v106
  v_exp_f32 v32, v32
  s_waitcnt lgkmcnt(0)
  v_mfma_f32_32x32x16_bf16 v[48:63], v[88:91], v[4:7], v[16:31]
  v_exp_f32 v33, v33
  v_exp_f32 v34, v34
  v_cvt_pk_bf16_f32 v80, v32, v33
  v_exp_f32 v35, v35
  v_exp_f32 v36, v36
  v_cvt_pk_bf16_f32 v81, v34, v35
  v_exp_f32 v37, v37
  v_exp_f32 v38, v38
  v_mfma_f32_32x32x8_bf16 v[48:63], v[92:93], v[10:11], v[48:63]
  ds_read_b128 v[88:91], v104 offset:2048
  ds_read_b128 v[0:3], v106 offset:10496
  v_cvt_pk_bf16_f32 v82, v36, v37
  v_exp_f32 v39, v39
  v_exp_f32 v40, v40
  v_cvt_pk_bf16_f32 v83, v38, v39
  v_exp_f32 v41, v41
  v_exp_f32 v42, v42
  v_mfma_f32_32x32x16_bf16 v[64:79], v[100:103], v[84:87], v[64:79]
  ds_read_b128 v[100:103], v106 offset:9856
  v_cvt_pk_bf16_f32 v84, v40, v41
  v_exp_f32 v43, v43
  v_exp_f32 v44, v44
  v_cvt_pk_bf16_f32 v85, v42, v43
  v_exp_f32 v45, v45
  v_mfma_f32_32x32x16_bf16 v[64:79], v[96:99], v[80:83], v[64:79]
  v_exp_f32 v46, v46
  v_exp_f32 v47, v47
  v_cvt_pk_bf16_f32 v86, v44, v45
  v_cvt_pk_bf16_f32 v87, v46, v47
  v_exp_f32 v48, v48
  s_waitcnt lgkmcnt(0)
  v_mfma_f32_32x32x16_bf16 v[32:47], v[88:91], v[4:7], v[16:31]
  v_exp_f32 v49, v49
  v_exp_f32 v50, v50
  v_cvt_pk_bf16_f32 v80, v48, v49
  v_exp_f32 v51, v51
  v_exp_f32 v52, v52
  v_cvt_pk_bf16_f32 v81, v50, v51
  v_exp_f32 v53, v53
  v_exp_f32 v54, v54
  v_mfma_f32_32x32x8_bf16 v[32:47], v[92:93], v[12:13], v[32:47]
  ds_read_b128 v[88:91], v104 offset:3072
  ds_read_b128 v[96:99], v106 offset:11776
  v_cvt_pk_bf16_f32 v82, v52, v53
  v_exp_f32 v55, v55
  v_exp_f32 v56, v56
  v_cvt_pk_bf16_f32 v83, v54, v55
  v_exp_f32 v57, v57
  v_exp_f32 v58, v58
  v_mfma_f32_32x32x16_bf16 v[64:79], v[100:103], v[84:87], v[64:79]
  ds_read_b128 v[100:103], v106 offset:11136
  v_cvt_pk_bf16_f32 v84, v56, v57
  v_exp_f32 v59, v59
  v_exp_f32 v60, v60
  v_cvt_pk_bf16_f32 v85, v58, v59
  v_exp_f32 v61, v61
  v_mfma_f32_32x32x16_bf16 v[64:79], v[0:3], v[80:83], v[64:79]
  v_exp_f32 v62, v62
  v_exp_f32 v63, v63
  v_cvt_pk_bf16_f32 v86, v60, v61
  v_cvt_pk_bf16_f32 v87, v62, v63
  v_exp_f32 v32, v32
  s_waitcnt lgkmcnt(0)
  v_mfma_f32_32x32x16_bf16 v[48:63], v[88:91], v[4:7], v[16:31]
  v_exp_f32 v33, v33
  v_exp_f32 v34, v34
  v_cvt_pk_bf16_f32 v80, v32, v33
  v_exp_f32 v35, v35
  v_exp_f32 v36, v36
  v_cvt_pk_bf16_f32 v81, v34, v35
  v_exp_f32 v37, v37
  v_exp_f32 v38, v38
  v_mfma_f32_32x32x8_bf16 v[48:63], v[92:93], v[14:15], v[48:63]
  ds_read_b64 v[94:95], v105 offset:8704
  ds_read_b128 v[88:91], v104 offset:4096
  ds_read_b128 v[0:3], v106 offset:13056
  v_cvt_pk_bf16_f32 v82, v36, v37
  v_exp_f32 v39, v39
  v_exp_f32 v40, v40
  v_cvt_pk_bf16_f32 v83, v38, v39
  v_exp_f32 v41, v41
  v_exp_f32 v42, v42
  v_mfma_f32_32x32x16_bf16 v[64:79], v[100:103], v[84:87], v[64:79]
  ds_read_b128 v[100:103], v106 offset:12416
  v_cvt_pk_bf16_f32 v84, v40, v41
  v_exp_f32 v43, v43
  v_exp_f32 v44, v44
  v_cvt_pk_bf16_f32 v85, v42, v43
  v_exp_f32 v45, v45
  v_mfma_f32_32x32x16_bf16 v[64:79], v[96:99], v[80:83], v[64:79]
  v_exp_f32 v46, v46
  v_exp_f32 v47, v47
  v_cvt_pk_bf16_f32 v86, v44, v45
  v_cvt_pk_bf16_f32 v87, v46, v47
  v_exp_f32 v48, v48
  s_waitcnt lgkmcnt(0)
  v_mfma_f32_32x32x16_bf16 v[32:47], v[88:91], v[4:7], v[16:31]
  v_exp_f32 v49, v49
  v_exp_f32 v50, v50
  v_cvt_pk_bf16_f32 v80, v48, v49
  v_exp_f32 v51, v51
  v_exp_f32 v52, v52
  v_cvt_pk_bf16_f32 v81, v50, v51
  v_exp_f32 v53, v53
  v_exp_f32 v54, v54
  v_mfma_f32_32x32x8_bf16 v[32:47], v[94:95], v[8:9], v[32:47]
  ds_read_b128 v[88:91], v104 offset:5120
  ds_read_b128 v[96:99], v106 offset:14336
  v_cvt_pk_bf16_f32 v82, v52, v53
  v_exp_f32 v55, v55
  v_exp_f32 v56, v56
  v_cvt_pk_bf16_f32 v83, v54, v55
  v_exp_f32 v57, v57
  v_exp_f32 v58, v58
  v_mfma_f32_32x32x16_bf16 v[64:79], v[100:103], v[84:87], v[64:79]
  ds_read_b128 v[100:103], v106 offset:13696
  v_cvt_pk_bf16_f32 v84, v56, v57
  v_exp_f32 v59, v59
  v_exp_f32 v60, v60
  v_cvt_pk_bf16_f32 v85, v58, v59
  v_exp_f32 v61, v61
  v_mfma_f32_32x32x16_bf16 v[64:79], v[0:3], v[80:83], v[64:79]
  v_exp_f32 v62, v62
  v_exp_f32 v63, v63
  v_cvt_pk_bf16_f32 v86, v60, v61
  v_cvt_pk_bf16_f32 v87, v62, v63
  v_exp_f32 v32, v32
  s_waitcnt lgkmcnt(0)
  v_mfma_f32_32x32x16_bf16 v[48:63], v[88:91], v[4:7], v[16:31]
  v_exp_f32 v33, v33
  v_exp_f32 v34, v34
  v_cvt_pk_bf16_f32 v80, v32, v33
  v_exp_f32 v35, v35
  v_exp_f32 v36, v36
  v_cvt_pk_bf16_f32 v81, v34, v35
  v_exp_f32 v37, v37
  v_exp_f32 v38, v38
  v_mfma_f32_32x32x8_bf16 v[48:63], v[94:95], v[10:11], v[48:63]
  ds_read_b128 v[88:91], v104 offset:6144
  ds_read_b128 v[0:3], v106 offset:15616
  v_cvt_pk_bf16_f32 v82, v36, v37
  v_exp_f32 v39, v39
  v_exp_f32 v40, v40
  v_cvt_pk_bf16_f32 v83, v38, v39
  v_exp_f32 v41, v41
  v_exp_f32 v42, v42
  v_mfma_f32_32x32x16_bf16 v[64:79], v[100:103], v[84:87], v[64:79]
  ds_read_b128 v[100:103], v106 offset:14976
  v_cvt_pk_bf16_f32 v84, v40, v41
  v_exp_f32 v43, v43
  v_exp_f32 v44, v44
  v_cvt_pk_bf16_f32 v85, v42, v43
  v_exp_f32 v45, v45
  v_mfma_f32_32x32x16_bf16 v[64:79], v[96:99], v[80:83], v[64:79]
  v_exp_f32 v46, v46
  v_exp_f32 v47, v47
  v_cvt_pk_bf16_f32 v86, v44, v45
  v_cvt_pk_bf16_f32 v87, v46, v47
  s_waitcnt vmcnt(0)
  s_barrier
  v_exp_f32 v48, v48
  s_waitcnt lgkmcnt(0)
  v_mfma_f32_32x32x16_bf16 v[32:47], v[88:91], v[4:7], v[16:31]
  v_exp_f32 v49, v49
  v_exp_f32 v50, v50
  v_cvt_pk_bf16_f32 v80, v48, v49
  v_exp_f32 v51, v51
  v_exp_f32 v52, v52
  v_cvt_pk_bf16_f32 v81, v50, v51
  v_exp_f32 v53, v53
  v_exp_f32 v54, v54
  v_mfma_f32_32x32x8_bf16 v[32:47], v[94:95], v[12:13], v[32:47]
  ds_read_b128 v[88:91], v104 offset:7168
  ds_read_b128 v[96:99], v106 offset:16896
  v_cvt_pk_bf16_f32 v82, v52, v53
  v_exp_f32 v55, v55
  v_exp_f32 v56, v56
  v_cvt_pk_bf16_f32 v83, v54, v55
  v_exp_f32 v57, v57
  v_exp_f32 v58, v58
  v_mfma_f32_32x32x16_bf16 v[64:79], v[100:103], v[84:87], v[64:79]
  ds_read_b128 v[100:103], v106 offset:16256
  v_cvt_pk_bf16_f32 v84, v56, v57
  v_exp_f32 v59, v59
  v_exp_f32 v60, v60
  v_cvt_pk_bf16_f32 v85, v58, v59
  v_exp_f32 v61, v61
  v_mfma_f32_32x32x16_bf16 v[64:79], v[0:3], v[80:83], v[64:79]
  v_exp_f32 v62, v62
  v_exp_f32 v63, v63
  v_cvt_pk_bf16_f32 v86, v60, v61
  v_cvt_pk_bf16_f32 v87, v62, v63
  v_exp_f32 v32, v32
  s_waitcnt lgkmcnt(0)
  v_mfma_f32_32x32x16_bf16 v[48:63], v[88:91], v[4:7], v[16:31]
  v_exp_f32 v33, v33
  v_exp_f32 v34, v34
  v_cvt_pk_bf16_f32 v80, v32, v33
  v_exp_f32 v35, v35
  v_exp_f32 v36, v36
  v_cvt_pk_bf16_f32 v81, v34, v35
  v_exp_f32 v37, v37
  v_exp_f32 v38, v38
  v_mfma_f32_32x32x8_bf16 v[48:63], v[94:95], v[14:15], v[48:63]
  ds_read_b64 v[92:93], v105 offset:27648
  ds_read_b128 v[88:91], v104 offset:19456
  ds_read_b128 v[0:3], v106 offset:18176
  v_cvt_pk_bf16_f32 v82, v36, v37
  v_exp_f32 v39, v39
  v_exp_f32 v40, v40
  v_cvt_pk_bf16_f32 v83, v38, v39
  v_exp_f32 v41, v41
  v_exp_f32 v42, v42
  v_mfma_f32_32x32x16_bf16 v[64:79], v[100:103], v[84:87], v[64:79]
  ds_read_b128 v[100:103], v106 offset:17536
  v_cvt_pk_bf16_f32 v84, v40, v41
  v_exp_f32 v43, v43
  v_exp_f32 v44, v44
  v_cvt_pk_bf16_f32 v85, v42, v43
  v_exp_f32 v45, v45
  v_mfma_f32_32x32x16_bf16 v[64:79], v[96:99], v[80:83], v[64:79]
  v_exp_f32 v46, v46
  v_exp_f32 v47, v47
  v_cvt_pk_bf16_f32 v86, v44, v45
  v_cvt_pk_bf16_f32 v87, v46, v47
  v_exp_f32 v48, v48
  s_waitcnt lgkmcnt(0)
  v_mfma_f32_32x32x16_bf16 v[32:47], v[88:91], v[4:7], v[16:31]
  v_exp_f32 v49, v49
  v_exp_f32 v50, v50
  v_cvt_pk_bf16_f32 v80, v48, v49
  v_exp_f32 v51, v51
  v_exp_f32 v52, v52
  v_cvt_pk_bf16_f32 v81, v50, v51
  v_exp_f32 v53, v53
  v_exp_f32 v54, v54
  v_mfma_f32_32x32x8_bf16 v[32:47], v[92:93], v[8:9], v[32:47]
  ds_read_b128 v[88:91], v104 offset:20480
  ds_read_b128 v[96:99], v106 offset:28672
  v_cvt_pk_bf16_f32 v82, v52, v53
  v_exp_f32 v55, v55
  v_exp_f32 v56, v56
  v_cvt_pk_bf16_f32 v83, v54, v55
  v_exp_f32 v57, v57
  v_exp_f32 v58, v58
  v_mfma_f32_32x32x16_bf16 v[64:79], v[100:103], v[84:87], v[64:79]
  ds_read_b128 v[100:103], v106 offset:18816
  v_cvt_pk_bf16_f32 v84, v56, v57
  v_exp_f32 v59, v59
  v_exp_f32 v60, v60
  v_cvt_pk_bf16_f32 v85, v58, v59
  v_exp_f32 v61, v61
  v_mfma_f32_32x32x16_bf16 v[64:79], v[0:3], v[80:83], v[64:79]
  v_exp_f32 v62, v62
  v_exp_f32 v63, v63
  v_cvt_pk_bf16_f32 v86, v60, v61
  v_cvt_pk_bf16_f32 v87, v62, v63
  buffer_load_dwordx4 v[112:115], v111, s[8:11], s26 offen
  s_add_u32 s26, s26, 18432
  v_exp_f32 v32, v32
  s_waitcnt lgkmcnt(0)
  v_mfma_f32_32x32x16_bf16 v[48:63], v[88:91], v[4:7], v[16:31]
  v_exp_f32 v33, v33
  v_exp_f32 v34, v34
  v_cvt_pk_bf16_f32 v80, v32, v33
  v_exp_f32 v35, v35
  v_exp_f32 v36, v36
  v_cvt_pk_bf16_f32 v81, v34, v35
  v_exp_f32 v37, v37
  v_exp_f32 v38, v38
  v_mfma_f32_32x32x8_bf16 v[48:63], v[92:93], v[10:11], v[48:63]
  ds_read_b128 v[88:91], v104 offset:21504
  ds_read_b128 v[0:3], v106 offset:29952
  v_cvt_pk_bf16_f32 v82, v36, v37
  v_exp_f32 v39, v39
  v_exp_f32 v40, v40
  v_cvt_pk_bf16_f32 v83, v38, v39
  v_exp_f32 v41, v41
  v_exp_f32 v42, v42
  v_mfma_f32_32x32x16_bf16 v[64:79], v[100:103], v[84:87], v[64:79]
  ds_read_b128 v[100:103], v106 offset:29312
  v_cvt_pk_bf16_f32 v84, v40, v41
  v_exp_f32 v43, v43
  v_exp_f32 v44, v44
  v_cvt_pk_bf16_f32 v85, v42, v43
  v_exp_f32 v45, v45
  v_mfma_f32_32x32x16_bf16 v[64:79], v[96:99], v[80:83], v[64:79]
  v_exp_f32 v46, v46
  v_exp_f32 v47, v47
  v_cvt_pk_bf16_f32 v86, v44, v45
  v_cvt_pk_bf16_f32 v87, v46, v47
  buffer_load_dwordx4 v[116:119], v111, s[8:11], s26 offen
  s_add_u32 s26, s26, 18432
  v_exp_f32 v48, v48
  s_waitcnt lgkmcnt(0)
  v_mfma_f32_32x32x16_bf16 v[32:47], v[88:91], v[4:7], v[16:31]
  v_exp_f32 v49, v49
  v_exp_f32 v50, v50
  v_cvt_pk_bf16_f32 v80, v48, v49
  v_exp_f32 v51, v51
  v_exp_f32 v52, v52
  v_cvt_pk_bf16_f32 v81, v50, v51
  v_exp_f32 v53, v53
  v_exp_f32 v54, v54
  v_mfma_f32_32x32x8_bf16 v[32:47], v[92:93], v[12:13], v[32:47]
  ds_read_b128 v[88:91], v104 offset:22528
  ds_read_b128 v[96:99], v106 offset:31232
  v_cvt_pk_bf16_f32 v82, v52, v53
  v_exp_f32 v55, v55
  v_exp_f32 v56, v56
  v_cvt_pk_bf16_f32 v83, v54, v55
  v_exp_f32 v57, v57
  v_exp_f32 v58, v58
  v_mfma_f32_32x32x16_bf16 v[64:79], v[100:103], v[84:87], v[64:79]
  ds_read_b128 v[100:103], v106 offset:30592
  v_cvt_pk_bf16_f32 v84, v56, v57
  v_exp_f32 v59, v59
  v_exp_f32 v60, v60
  v_cvt_pk_bf16_f32 v85, v58, v59
  v_exp_f32 v61, v61
  v_mfma_f32_32x32x16_bf16 v[64:79], v[0:3], v[80:83], v[64:79]
  v_exp_f32 v62, v62
  v_exp_f32 v63, v63
  v_cvt_pk_bf16_f32 v86, v60, v61
  v_cvt_pk_bf16_f32 v87, v62, v63
  buffer_load_dwordx4 v[120:123], v111, s[8:11], s26 offen
  s_add_u32 s26, s26, 18432
  v_exp_f32 v32, v32
  s_waitcnt lgkmcnt(0)
  v_mfma_f32_32x32x16_bf16 v[48:63], v[88:91], v[4:7], v[16:31]
  v_exp_f32 v33, v33
  v_exp_f32 v34, v34
  v_cvt_pk_bf16_f32 v80, v32, v33
  v_exp_f32 v35, v35
  v_exp_f32 v36, v36
  v_cvt_pk_bf16_f32 v81, v34, v35
  v_exp_f32 v37, v37
  v_exp_f32 v38, v38
  v_mfma_f32_32x32x8_bf16 v[48:63], v[92:93], v[14:15], v[48:63]
  ds_read_b64 v[94:95], v105 offset:28160
  ds_read_b128 v[88:91], v104 offset:23552
  ds_read_b128 v[0:3], v106 offset:32512
  v_cvt_pk_bf16_f32 v82, v36, v37
  v_exp_f32 v39, v39
  v_exp_f32 v40, v40
  v_cvt_pk_bf16_f32 v83, v38, v39
  v_exp_f32 v41, v41
  v_exp_f32 v42, v42
  v_mfma_f32_32x32x16_bf16 v[64:79], v[100:103], v[84:87], v[64:79]
  ds_read_b128 v[100:103], v106 offset:31872
  v_cvt_pk_bf16_f32 v84, v40, v41
  v_exp_f32 v43, v43
  v_exp_f32 v44, v44
  v_cvt_pk_bf16_f32 v85, v42, v43
  v_exp_f32 v45, v45
  v_mfma_f32_32x32x16_bf16 v[64:79], v[96:99], v[80:83], v[64:79]
  v_exp_f32 v46, v46
  v_exp_f32 v47, v47
  v_cvt_pk_bf16_f32 v86, v44, v45
  v_cvt_pk_bf16_f32 v87, v46, v47
  buffer_load_dwordx4 v[124:127], v111, s[8:11], s26 offen
  s_add_u32 s26, s26, 18432
  v_exp_f32 v48, v48
  s_waitcnt lgkmcnt(0)
  v_mfma_f32_32x32x16_bf16 v[32:47], v[88:91], v[4:7], v[16:31]
  v_exp_f32 v49, v49
  v_exp_f32 v50, v50
  v_cvt_pk_bf16_f32 v80, v48, v49
  v_exp_f32 v51, v51
  v_exp_f32 v52, v52
  v_cvt_pk_bf16_f32 v81, v50, v51
  v_exp_f32 v53, v53
  v_exp_f32 v54, v54
  v_mfma_f32_32x32x8_bf16 v[32:47], v[94:95], v[8:9], v[32:47]
  ds_read_b128 v[88:91], v104 offset:24576
  ds_read_b128 v[96:99], v106 offset:33792
  v_cvt_pk_bf16_f32 v82, v52, v53
  v_exp_f32 v55, v55
  v_exp_f32 v56, v56
  v_cvt_pk_bf16_f32 v83, v54, v55
  v_exp_f32 v57, v57
  v_exp_f32 v58, v58
  v_mfma_f32_32x32x16_bf16 v[64:79], v[100:103], v[84:87], v[64:79]
  ds_read_b128 v[100:103], v106 offset:33152
  v_cvt_pk_bf16_f32 v84, v56, v57
  v_exp_f32 v59, v59
  v_exp_f32 v60, v60
  v_cvt_pk_bf16_f32 v85, v58, v59
  v_exp_f32 v61, v61
  v_mfma_f32_32x32x16_bf16 v[64:79], v[0:3], v[80:83], v[64:79]
  v_exp_f32 v62, v62
  v_exp_f32 v63, v63
  v_cvt_pk_bf16_f32 v86, v60, v61
  v_cvt_pk_bf16_f32 v87, v62, v63
  buffer_load_dwordx4 v[128:131], v111, s[8:11], s26 offen
  s_add_u32 s26, s26, 18432
  v_exp_f32 v32, v32
  s_waitcnt lgkmcnt(0)
  v_mfma_f32_32x32x16_bf16 v[48:63], v[88:91], v[4:7], v[16:31]
  v_exp_f32 v33, v33
  v_exp_f32 v34, v34
  v_cvt_pk_bf16_f32 v80, v32, v33
  v_exp_f32 v35, v35
  v_exp_f32 v36, v36
  v_cvt_pk_bf16_f32 v81, v34, v35
  v_exp_f32 v37, v37
  v_exp_f32 v38, v38
  v_mfma_f32_32x32x8_bf16 v[48:63], v[94:95], v[10:11], v[48:63]
  ds_read_b128 v[88:91], v104 offset:25600
  ds_read_b128 v[0:3], v106 offset:35072
  v_cvt_pk_bf16_f32 v82, v36, v37
  v_exp_f32 v39, v39
  v_exp_f32 v40, v40
  v_cvt_pk_bf16_f32 v83, v38, v39
  v_exp_f32 v41, v41
  v_exp_f32 v42, v42
  v_mfma_f32_32x32x16_bf16 v[64:79], v[100:103], v[84:87], v[64:79]
  ds_read_b128 v[100:103], v106 offset:34432
  v_cvt_pk_bf16_f32 v84, v40, v41
  v_exp_f32 v43, v43
  v_exp_f32 v44, v44
  v_cvt_pk_bf16_f32 v85, v42, v43
  v_exp_f32 v45, v45
  v_mfma_f32_32x32x16_bf16 v[64:79], v[96:99], v[80:83], v[64:79]
  v_exp_f32 v46, v46
  v_exp_f32 v47, v47
  v_cvt_pk_bf16_f32 v86, v44, v45
  v_cvt_pk_bf16_f32 v87, v46, v47
  buffer_load_dwordx4 v[132:135], v111, s[8:11], s26 offen
  s_add_u32 s26, s26, 18432
  v_exp_f32 v48, v48
  s_waitcnt lgkmcnt(0)
  v_mfma_f32_32x32x16_bf16 v[32:47], v[88:91], v[4:7], v[16:31]
  v_exp_f32 v49, v49
  v_exp_f32 v50, v50
  v_cvt_pk_bf16_f32 v80, v48, v49
  v_exp_f32 v51, v51
  v_exp_f32 v52, v52
  v_cvt_pk_bf16_f32 v81, v50, v51
  v_exp_f32 v53, v53
  v_exp_f32 v54, v54
  v_mfma_f32_32x32x8_bf16 v[32:47], v[94:95], v[12:13], v[32:47]
  ds_read_b128 v[88:91], v104 offset:26624
  ds_read_b128 v[96:99], v106 offset:36352
  v_cvt_pk_bf16_f32 v82, v52, v53
  v_exp_f32 v55, v55
  v_exp_f32 v56, v56
  v_cvt_pk_bf16_f32 v83, v54, v55
  v_exp_f32 v57, v57
  v_exp_f32 v58, v58
  v_mfma_f32_32x32x16_bf16 v[64:79], v[100:103], v[84:87], v[64:79]
  ds_read_b128 v[100:103], v106 offset:35712
  v_cvt_pk_bf16_f32 v84, v56, v57
  v_exp_f32 v59, v59
  v_exp_f32 v60, v60
  v_cvt_pk_bf16_f32 v85, v58, v59
  v_exp_f32 v61, v61
  v_mfma_f32_32x32x16_bf16 v[64:79], v[0:3], v[80:83], v[64:79]
  v_exp_f32 v62, v62
  v_exp_f32 v63, v63
  v_cvt_pk_bf16_f32 v86, v60, v61
  v_cvt_pk_bf16_f32 v87, v62, v63
  buffer_load_dwordx4 v[136:139], v111, s[8:11], s26 offen
  s_add_u32 s26, s26, 18432
  v_exp_f32 v32, v32
  s_waitcnt lgkmcnt(0)
  v_mfma_f32_32x32x16_bf16 v[48:63], v[88:91], v[4:7], v[16:31]
  v_exp_f32 v33, v33
  v_exp_f32 v34, v34
  v_cvt_pk_bf16_f32 v80, v32, v33
  v_exp_f32 v35, v35
  v_exp_f32 v36, v36
  v_cvt_pk_bf16_f32 v81, v34, v35
  v_exp_f32 v37, v37
  v_exp_f32 v38, v38
  v_mfma_f32_32x32x8_bf16 v[48:63], v[94:95], v[14:15], v[48:63]
  ds_read_b64 v[92:93], v105 offset:47104
  ds_read_b128 v[88:91], v104 offset:38912
  ds_read_b128 v[0:3], v106 offset:37632
  v_cvt_pk_bf16_f32 v82, v36, v37
  v_exp_f32 v39, v39
  v_exp_f32 v40, v40
  v_cvt_pk_bf16_f32 v83, v38, v39
  v_exp_f32 v41, v41
  v_exp_f32 v42, v42
  v_mfma_f32_32x32x16_bf16 v[64:79], v[100:103], v[84:87], v[64:79]
  ds_read_b128 v[100:103], v106 offset:36992
  v_cvt_pk_bf16_f32 v84, v40, v41
  v_exp_f32 v43, v43
  v_exp_f32 v44, v44
  v_cvt_pk_bf16_f32 v85, v42, v43
  v_exp_f32 v45, v45
  v_mfma_f32_32x32x16_bf16 v[64:79], v[96:99], v[80:83], v[64:79]
  v_exp_f32 v46, v46
  v_exp_f32 v47, v47
  v_cvt_pk_bf16_f32 v86, v44, v45
  v_cvt_pk_bf16_f32 v87, v46, v47
  buffer_load_dwordx4 v[140:143], v111, s[8:11], s26 offen
  s_add_u32 s26, s26, 18432
  v_exp_f32 v48, v48
  s_waitcnt lgkmcnt(0)
  v_mfma_f32_32x32x16_bf16 v[32:47], v[88:91], v[4:7], v[16:31]
  v_exp_f32 v49, v49
  v_exp_f32 v50, v50
  v_cvt_pk_bf16_f32 v80, v48, v49
  v_exp_f32 v51, v51
  v_exp_f32 v52, v52
  v_cvt_pk_bf16_f32 v81, v50, v51
  v_exp_f32 v53, v53
  v_exp_f32 v54, v54
  v_mfma_f32_32x32x8_bf16 v[32:47], v[92:93], v[8:9], v[32:47]
  ds_read_b128 v[88:91], v104 offset:39936
  ds_read_b128 v[96:99], v106 offset:48128
  v_cvt_pk_bf16_f32 v82, v52, v53
  v_exp_f32 v55, v55
  v_exp_f32 v56, v56
  v_cvt_pk_bf16_f32 v83, v54, v55
  v_exp_f32 v57, v57
  v_exp_f32 v58, v58
  v_mfma_f32_32x32x16_bf16 v[64:79], v[100:103], v[84:87], v[64:79]
  ds_read_b128 v[100:103], v106 offset:38272
  v_cvt_pk_bf16_f32 v84, v56, v57
  v_exp_f32 v59, v59
  v_exp_f32 v60, v60
  v_cvt_pk_bf16_f32 v85, v58, v59
  v_exp_f32 v61, v61
  v_mfma_f32_32x32x16_bf16 v[64:79], v[0:3], v[80:83], v[64:79]
  v_exp_f32 v62, v62
  v_exp_f32 v63, v63
  v_cvt_pk_bf16_f32 v86, v60, v61
  v_cvt_pk_bf16_f32 v87, v62, v63
  v_add_u32 v104, 38912, v104
  v_add_u32 v105, 38912, v105
  v_add_u32 v106, 38912, v106
  buffer_load_dwordx4 v[144:147], v111, s[8:11], s26 offen
  s_add_u32 s26, s26, 18432
  v_exp_f32 v32, v32
  s_waitcnt lgkmcnt(0)
  v_mfma_f32_32x32x16_bf16 v[48:63], v[88:91], v[4:7], v[16:31]
  v_exp_f32 v33, v33
  v_exp_f32 v34, v34
  v_cvt_pk_bf16_f32 v80, v32, v33
  v_exp_f32 v35, v35
  v_exp_f32 v36, v36
  v_cvt_pk_bf16_f32 v81, v34, v35
  v_exp_f32 v37, v37
  v_exp_f32 v38, v38
  v_mfma_f32_32x32x8_bf16 v[48:63], v[92:93], v[10:11], v[48:63]
  ds_read_b128 v[88:91], v104 offset:2048
  ds_read_b128 v[0:3], v106 offset:10496
  v_cvt_pk_bf16_f32 v82, v36, v37
  v_exp_f32 v39, v39
  v_exp_f32 v40, v40
  v_cvt_pk_bf16_f32 v83, v38, v39
  v_exp_f32 v41, v41
  v_exp_f32 v42, v42
  v_mfma_f32_32x32x16_bf16 v[64:79], v[100:103], v[84:87], v[64:79]
  ds_read_b128 v[100:103], v106 offset:9856
  v_cvt_pk_bf16_f32 v84, v40, v41
  v_exp_f32 v43, v43
  v_exp_f32 v44, v44
  v_cvt_pk_bf16_f32 v85, v42, v43
  v_exp_f32 v45, v45
  v_mfma_f32_32x32x16_bf16 v[64:79], v[96:99], v[80:83], v[64:79]
  v_exp_f32 v46, v46
  v_exp_f32 v47, v47
  v_cvt_pk_bf16_f32 v86, v44, v45
  v_cvt_pk_bf16_f32 v87, v46, v47
  buffer_load_dwordx4 v[148:151], v111, s[8:11], s26 offen
  s_add_u32 s26, s26, 18432
  v_exp_f32 v48, v48
  s_waitcnt lgkmcnt(0)
  v_mfma_f32_32x32x16_bf16 v[32:47], v[88:91], v[4:7], v[16:31]
  v_exp_f32 v49, v49
  v_exp_f32 v50, v50
  v_cvt_pk_bf16_f32 v80, v48, v49
  v_exp_f32 v51, v51
  v_exp_f32 v52, v52
  v_cvt_pk_bf16_f32 v81, v50, v51
  v_exp_f32 v53, v53
  v_exp_f32 v54, v54
  v_mfma_f32_32x32x8_bf16 v[32:47], v[92:93], v[12:13], v[32:47]
  ds_read_b128 v[88:91], v104 offset:3072
  ds_read_b128 v[96:99], v106 offset:11776
  v_cvt_pk_bf16_f32 v82, v52, v53
  v_exp_f32 v55, v55
  v_exp_f32 v56, v56
  v_cvt_pk_bf16_f32 v83, v54, v55
  v_exp_f32 v57, v57
  v_exp_f32 v58, v58
  v_mfma_f32_32x32x16_bf16 v[64:79], v[100:103], v[84:87], v[64:79]
  ds_read_b128 v[100:103], v106 offset:11136
  v_cvt_pk_bf16_f32 v84, v56, v57
  v_exp_f32 v59, v59
  v_exp_f32 v60, v60
  v_cvt_pk_bf16_f32 v85, v58, v59
  v_exp_f32 v61, v61
  v_mfma_f32_32x32x16_bf16 v[64:79], v[0:3], v[80:83], v[64:79]
  v_exp_f32 v62, v62
  v_exp_f32 v63, v63
  v_cvt_pk_bf16_f32 v86, v60, v61
  v_cvt_pk_bf16_f32 v87, v62, v63
  buffer_load_dwordx4 v[152:155], v111, s[8:11], s26 offen
  s_add_u32 s26, s26, 18432
  v_exp_f32 v32, v32
  s_waitcnt lgkmcnt(0)
  v_mfma_f32_32x32x16_bf16 v[48:63], v[88:91], v[4:7], v[16:31]
  v_exp_f32 v33, v33
  v_exp_f32 v34, v34
  v_cvt_pk_bf16_f32 v80, v32, v33
  v_exp_f32 v35, v35
  v_exp_f32 v36, v36
  v_cvt_pk_bf16_f32 v81, v34, v35
  v_exp_f32 v37, v37
  v_exp_f32 v38, v38
  v_mfma_f32_32x32x8_bf16 v[48:63], v[92:93], v[14:15], v[48:63]
  ds_read_b64 v[94:95], v105 offset:8704
  ds_read_b128 v[88:91], v104 offset:4096
  ds_read_b128 v[0:3], v106 offset:13056
  v_cvt_pk_bf16_f32 v82, v36, v37
  v_exp_f32 v39, v39
  v_exp_f32 v40, v40
  v_cvt_pk_bf16_f32 v83, v38, v39
  v_exp_f32 v41, v41
  v_exp_f32 v42, v42
  v_mfma_f32_32x32x16_bf16 v[64:79], v[100:103], v[84:87], v[64:79]
  ds_read_b128 v[100:103], v106 offset:12416
  v_cvt_pk_bf16_f32 v84, v40, v41
  v_exp_f32 v43, v43
  v_exp_f32 v44, v44
  v_cvt_pk_bf16_f32 v85, v42, v43
  v_exp_f32 v45, v45
  v_mfma_f32_32x32x16_bf16 v[64:79], v[96:99], v[80:83], v[64:79]
  v_exp_f32 v46, v46
  v_exp_f32 v47, v47
  v_cvt_pk_bf16_f32 v86, v44, v45
  v_cvt_pk_bf16_f32 v87, v46, v47
  buffer_load_dwordx4 v[156:159], v111, s[8:11], s26 offen
  s_add_u32 s26, s26, 18432
  v_exp_f32 v48, v48
  s_waitcnt lgkmcnt(0)
  v_mfma_f32_32x32x16_bf16 v[32:47], v[88:91], v[4:7], v[16:31]
  v_exp_f32 v49, v49
  v_exp_f32 v50, v50
  v_cvt_pk_bf16_f32 v80, v48, v49
  v_exp_f32 v51, v51
  v_exp_f32 v52, v52
  v_cvt_pk_bf16_f32 v81, v50, v51
  v_exp_f32 v53, v53
  v_exp_f32 v54, v54
  v_mfma_f32_32x32x8_bf16 v[32:47], v[94:95], v[8:9], v[32:47]
  ds_read_b128 v[88:91], v104 offset:5120
  ds_read_b128 v[96:99], v106 offset:14336
  v_cvt_pk_bf16_f32 v82, v52, v53
  v_exp_f32 v55, v55
  v_exp_f32 v56, v56
  v_cvt_pk_bf16_f32 v83, v54, v55
  v_exp_f32 v57, v57
  v_exp_f32 v58, v58
  v_mfma_f32_32x32x16_bf16 v[64:79], v[100:103], v[84:87], v[64:79]
  ds_read_b128 v[100:103], v106 offset:13696
  v_cvt_pk_bf16_f32 v84, v56, v57
  v_exp_f32 v59, v59
  v_exp_f32 v60, v60
  v_cvt_pk_bf16_f32 v85, v58, v59
  v_exp_f32 v61, v61
  v_mfma_f32_32x32x16_bf16 v[64:79], v[0:3], v[80:83], v[64:79]
  v_exp_f32 v62, v62
  v_exp_f32 v63, v63
  v_cvt_pk_bf16_f32 v86, v60, v61
  v_cvt_pk_bf16_f32 v87, v62, v63
  buffer_load_dwordx4 v[160:163], v111, s[8:11], s26 offen
  s_add_u32 s26, s26, 18432
  v_exp_f32 v32, v32
  s_waitcnt lgkmcnt(0)
  v_mfma_f32_32x32x16_bf16 v[48:63], v[88:91], v[4:7], v[16:31]
  v_exp_f32 v33, v33
  v_exp_f32 v34, v34
  v_cvt_pk_bf16_f32 v80, v32, v33
  v_exp_f32 v35, v35
  v_exp_f32 v36, v36
  v_cvt_pk_bf16_f32 v81, v34, v35
  v_exp_f32 v37, v37
  v_exp_f32 v38, v38
  v_mfma_f32_32x32x8_bf16 v[48:63], v[94:95], v[10:11], v[48:63]
  ds_read_b128 v[88:91], v104 offset:6144
  ds_read_b128 v[0:3], v106 offset:15616
  v_cvt_pk_bf16_f32 v82, v36, v37
  v_exp_f32 v39, v39
  v_exp_f32 v40, v40
  v_cvt_pk_bf16_f32 v83, v38, v39
  v_exp_f32 v41, v41
  v_exp_f32 v42, v42
  v_mfma_f32_32x32x16_bf16 v[64:79], v[100:103], v[84:87], v[64:79]
  ds_read_b128 v[100:103], v106 offset:14976
  v_cvt_pk_bf16_f32 v84, v40, v41
  v_exp_f32 v43, v43
  v_exp_f32 v44, v44
  v_cvt_pk_bf16_f32 v85, v42, v43
  v_exp_f32 v45, v45
  v_mfma_f32_32x32x16_bf16 v[64:79], v[96:99], v[80:83], v[64:79]
  v_exp_f32 v46, v46
  v_exp_f32 v47, v47
  v_cvt_pk_bf16_f32 v86, v44, v45
  v_cvt_pk_bf16_f32 v87, v46, v47
  buffer_load_dwordx4 v[164:167], v111, s[8:11], s26 offen
  s_add_u32 s26, s26, 18432
  v_exp_f32 v48, v48
  s_waitcnt lgkmcnt(0)
  v_mfma_f32_32x32x16_bf16 v[32:47], v[88:91], v[4:7], v[16:31]
  v_exp_f32 v49, v49
  v_exp_f32 v50, v50
  v_cvt_pk_bf16_f32 v80, v48, v49
  v_exp_f32 v51, v51
  v_exp_f32 v52, v52
  v_cvt_pk_bf16_f32 v81, v50, v51
  v_exp_f32 v53, v53
  v_exp_f32 v54, v54
  v_mfma_f32_32x32x8_bf16 v[32:47], v[94:95], v[12:13], v[32:47]
  ds_read_b128 v[88:91], v104 offset:7168
  ds_read_b128 v[96:99], v106 offset:16896
  v_cvt_pk_bf16_f32 v82, v52, v53
  v_exp_f32 v55, v55
  v_exp_f32 v56, v56
  v_cvt_pk_bf16_f32 v83, v54, v55
  v_exp_f32 v57, v57
  v_exp_f32 v58, v58
  v_mfma_f32_32x32x16_bf16 v[64:79], v[100:103], v[84:87], v[64:79]
  ds_read_b128 v[100:103], v106 offset:16256
  v_cvt_pk_bf16_f32 v84, v56, v57
  v_exp_f32 v59, v59
  v_exp_f32 v60, v60
  v_cvt_pk_bf16_f32 v85, v58, v59
  v_exp_f32 v61, v61
  v_mfma_f32_32x32x16_bf16 v[64:79], v[0:3], v[80:83], v[64:79]
  v_exp_f32 v62, v62
  v_exp_f32 v63, v63
  v_cvt_pk_bf16_f32 v86, v60, v61
  v_cvt_pk_bf16_f32 v87, v62, v63
  buffer_load_dwordx4 v[168:171], v111, s[8:11], s26 offen
  s_add_u32 s26, s26, 18432
  v_exp_f32 v32, v32
  s_waitcnt lgkmcnt(0)
  v_mfma_f32_32x32x16_bf16 v[48:63], v[88:91], v[4:7], v[16:31]
  v_exp_f32 v33, v33
  v_exp_f32 v34, v34
  v_cvt_pk_bf16_f32 v80, v32, v33
  v_exp_f32 v35, v35
  v_exp_f32 v36, v36
  v_cvt_pk_bf16_f32 v81, v34, v35
  v_exp_f32 v37, v37
  v_exp_f32 v38, v38
  v_mfma_f32_32x32x8_bf16 v[48:63], v[94:95], v[14:15], v[48:63]
  ds_read_b64 v[92:93], v105 offset:27648
  ds_read_b128 v[88:91], v104 offset:19456
  ds_read_b128 v[0:3], v106 offset:18176
  v_cvt_pk_bf16_f32 v82, v36, v37
  v_exp_f32 v39, v39
  v_exp_f32 v40, v40
  v_cvt_pk_bf16_f32 v83, v38, v39
  v_exp_f32 v41, v41
  v_exp_f32 v42, v42
  v_mfma_f32_32x32x16_bf16 v[64:79], v[100:103], v[84:87], v[64:79]
  ds_read_b128 v[100:103], v106 offset:17536
  v_cvt_pk_bf16_f32 v84, v40, v41
  v_exp_f32 v43, v43
  v_exp_f32 v44, v44
  v_cvt_pk_bf16_f32 v85, v42, v43
  v_exp_f32 v45, v45
  v_mfma_f32_32x32x16_bf16 v[64:79], v[96:99], v[80:83], v[64:79]
  v_exp_f32 v46, v46
  v_exp_f32 v47, v47
  v_cvt_pk_bf16_f32 v86, v44, v45
  v_cvt_pk_bf16_f32 v87, v46, v47
  buffer_load_dwordx4 v[172:175], v111, s[8:11], s26 offen
  s_add_u32 s26, s26, 18432
  v_exp_f32 v48, v48
  s_waitcnt lgkmcnt(0)
  v_mfma_f32_32x32x16_bf16 v[32:47], v[88:91], v[4:7], v[16:31]
  v_exp_f32 v49, v49
  v_exp_f32 v50, v50
  v_cvt_pk_bf16_f32 v80, v48, v49
  v_exp_f32 v51, v51
  v_exp_f32 v52, v52
  v_cvt_pk_bf16_f32 v81, v50, v51
  v_exp_f32 v53, v53
  v_exp_f32 v54, v54
  v_mfma_f32_32x32x8_bf16 v[32:47], v[92:93], v[8:9], v[32:47]
  ds_read_b128 v[88:91], v104 offset:20480
  ds_read_b128 v[96:99], v106 offset:28672
  v_cvt_pk_bf16_f32 v82, v52, v53
  v_exp_f32 v55, v55
  v_exp_f32 v56, v56
  v_cvt_pk_bf16_f32 v83, v54, v55
  v_exp_f32 v57, v57
  v_exp_f32 v58, v58
  v_mfma_f32_32x32x16_bf16 v[64:79], v[100:103], v[84:87], v[64:79]
  ds_read_b128 v[100:103], v106 offset:18816
  v_cvt_pk_bf16_f32 v84, v56, v57
  v_exp_f32 v59, v59
  v_exp_f32 v60, v60
  v_cvt_pk_bf16_f32 v85, v58, v59
  v_exp_f32 v61, v61
  v_mfma_f32_32x32x16_bf16 v[64:79], v[0:3], v[80:83], v[64:79]
  v_exp_f32 v62, v62
  v_exp_f32 v63, v63
  v_cvt_pk_bf16_f32 v86, v60, v61
  v_cvt_pk_bf16_f32 v87, v62, v63
  buffer_load_dwordx4 v[176:179], v111, s[8:11], s26 offen
  s_add_u32 s26, s26, 18432
  v_exp_f32 v32, v32
  s_waitcnt lgkmcnt(0)
  v_mfma_f32_32x32x16_bf16 v[48:63], v[88:91], v[4:7], v[16:31]
  v_exp_f32 v33, v33
  v_exp_f32 v34, v34
  v_cvt_pk_bf16_f32 v80, v32, v33
  v_exp_f32 v35, v35
  v_exp_f32 v36, v36
  v_cvt_pk_bf16_f32 v81, v34, v35
  v_exp_f32 v37, v37
  v_exp_f32 v38, v38
  v_mfma_f32_32x32x8_bf16 v[48:63], v[92:93], v[10:11], v[48:63]
  ds_read_b128 v[88:91], v104 offset:21504
  ds_read_b128 v[0:3], v106 offset:29952
  v_cvt_pk_bf16_f32 v82, v36, v37
  v_exp_f32 v39, v39
  v_exp_f32 v40, v40
  v_cvt_pk_bf16_f32 v83, v38, v39
  v_exp_f32 v41, v41
  v_exp_f32 v42, v42
  v_mfma_f32_32x32x16_bf16 v[64:79], v[100:103], v[84:87], v[64:79]
  ds_read_b128 v[100:103], v106 offset:29312
  v_cvt_pk_bf16_f32 v84, v40, v41
  v_exp_f32 v43, v43
  v_exp_f32 v44, v44
  v_cvt_pk_bf16_f32 v85, v42, v43
  v_exp_f32 v45, v45
  v_mfma_f32_32x32x16_bf16 v[64:79], v[96:99], v[80:83], v[64:79]
  v_exp_f32 v46, v46
  v_exp_f32 v47, v47
  v_cvt_pk_bf16_f32 v86, v44, v45
  v_cvt_pk_bf16_f32 v87, v46, v47
  buffer_load_dwordx4 v[180:183], v111, s[8:11], s26 offen
  s_add_u32 s26, s26, 18432
  v_exp_f32 v48, v48
  s_waitcnt lgkmcnt(0)
  v_mfma_f32_32x32x16_bf16 v[32:47], v[88:91], v[4:7], v[16:31]
  v_exp_f32 v49, v49
  v_exp_f32 v50, v50
  v_cvt_pk_bf16_f32 v80, v48, v49
  v_exp_f32 v51, v51
  v_exp_f32 v52, v52
  v_cvt_pk_bf16_f32 v81, v50, v51
  v_exp_f32 v53, v53
  v_exp_f32 v54, v54
  v_mfma_f32_32x32x8_bf16 v[32:47], v[92:93], v[12:13], v[32:47]
  ds_read_b128 v[88:91], v104 offset:22528
  ds_read_b128 v[96:99], v106 offset:31232
  v_cvt_pk_bf16_f32 v82, v52, v53
  v_exp_f32 v55, v55
  v_exp_f32 v56, v56
  v_cvt_pk_bf16_f32 v83, v54, v55
  v_exp_f32 v57, v57
  v_exp_f32 v58, v58
  v_mfma_f32_32x32x16_bf16 v[64:79], v[100:103], v[84:87], v[64:79]
  ds_read_b128 v[100:103], v106 offset:30592
  v_cvt_pk_bf16_f32 v84, v56, v57
  v_exp_f32 v59, v59
  v_exp_f32 v60, v60
  v_cvt_pk_bf16_f32 v85, v58, v59
  v_exp_f32 v61, v61
  v_mfma_f32_32x32x16_bf16 v[64:79], v[0:3], v[80:83], v[64:79]
  v_exp_f32 v62, v62
  v_exp_f32 v63, v63
  v_cvt_pk_bf16_f32 v86, v60, v61
  v_cvt_pk_bf16_f32 v87, v62, v63
  buffer_load_dwordx4 v[184:187], v111, s[8:11], s26 offen
  s_add_u32 s26, s26, 18432
  v_exp_f32 v32, v32
  s_waitcnt lgkmcnt(0)
  v_mfma_f32_32x32x16_bf16 v[48:63], v[88:91], v[4:7], v[16:31]
  v_exp_f32 v33, v33
  v_exp_f32 v34, v34
  v_cvt_pk_bf16_f32 v80, v32, v33
  v_exp_f32 v35, v35
  v_exp_f32 v36, v36
  v_cvt_pk_bf16_f32 v81, v34, v35
  v_exp_f32 v37, v37
  v_exp_f32 v38, v38
  v_mfma_f32_32x32x8_bf16 v[48:63], v[92:93], v[14:15], v[48:63]
  ds_read_b64 v[94:95], v105 offset:28160
  ds_read_b128 v[88:91], v104 offset:23552
  ds_read_b128 v[0:3], v106 offset:32512
  v_cvt_pk_bf16_f32 v82, v36, v37
  v_exp_f32 v39, v39
  v_exp_f32 v40, v40
  v_cvt_pk_bf16_f32 v83, v38, v39
  v_exp_f32 v41, v41
  v_exp_f32 v42, v42
  v_mfma_f32_32x32x16_bf16 v[64:79], v[100:103], v[84:87], v[64:79]
  ds_read_b128 v[100:103], v106 offset:31872
  v_cvt_pk_bf16_f32 v84, v40, v41
  v_exp_f32 v43, v43
  v_exp_f32 v44, v44
  v_cvt_pk_bf16_f32 v85, v42, v43
  v_exp_f32 v45, v45
  v_mfma_f32_32x32x16_bf16 v[64:79], v[96:99], v[80:83], v[64:79]
  v_exp_f32 v46, v46
  v_exp_f32 v47, v47
  v_cvt_pk_bf16_f32 v86, v44, v45
  v_cvt_pk_bf16_f32 v87, v46, v47
  buffer_load_dwordx4 v[188:191], v111, s[8:11], s26 offen
  s_add_u32 s26, s26, 18432
  v_exp_f32 v48, v48
  s_waitcnt lgkmcnt(0)
  v_mfma_f32_32x32x16_bf16 v[32:47], v[88:91], v[4:7], v[16:31]
  v_exp_f32 v49, v49
  v_exp_f32 v50, v50
  v_cvt_pk_bf16_f32 v80, v48, v49
  v_exp_f32 v51, v51
  v_exp_f32 v52, v52
  v_cvt_pk_bf16_f32 v81, v50, v51
  v_exp_f32 v53, v53
  v_exp_f32 v54, v54
  v_mfma_f32_32x32x8_bf16 v[32:47], v[94:95], v[8:9], v[32:47]
  ds_read_b128 v[88:91], v104 offset:24576
  ds_read_b128 v[96:99], v106 offset:33792
  v_cvt_pk_bf16_f32 v82, v52, v53
  v_exp_f32 v55, v55
  v_exp_f32 v56, v56
  v_cvt_pk_bf16_f32 v83, v54, v55
  v_exp_f32 v57, v57
  v_exp_f32 v58, v58
  v_mfma_f32_32x32x16_bf16 v[64:79], v[100:103], v[84:87], v[64:79]
  ds_read_b128 v[100:103], v106 offset:33152
  v_cvt_pk_bf16_f32 v84, v56, v57
  v_exp_f32 v59, v59
  v_exp_f32 v60, v60
  v_cvt_pk_bf16_f32 v85, v58, v59
  v_exp_f32 v61, v61
  v_mfma_f32_32x32x16_bf16 v[64:79], v[0:3], v[80:83], v[64:79]
  v_exp_f32 v62, v62
  v_exp_f32 v63, v63
  v_cvt_pk_bf16_f32 v86, v60, v61
  v_cvt_pk_bf16_f32 v87, v62, v63
  buffer_load_dwordx4 v[192:195], v111, s[8:11], s26 offen
  s_add_u32 s26, s26, 18432
  v_exp_f32 v32, v32
  s_waitcnt lgkmcnt(0)
  v_mfma_f32_32x32x16_bf16 v[48:63], v[88:91], v[4:7], v[16:31]
  v_exp_f32 v33, v33
  v_exp_f32 v34, v34
  v_cvt_pk_bf16_f32 v80, v32, v33
  v_exp_f32 v35, v35
  v_exp_f32 v36, v36
  v_cvt_pk_bf16_f32 v81, v34, v35
  v_exp_f32 v37, v37
  v_exp_f32 v38, v38
  v_mfma_f32_32x32x8_bf16 v[48:63], v[94:95], v[10:11], v[48:63]
  ds_read_b128 v[88:91], v104 offset:25600
  ds_read_b128 v[0:3], v106 offset:35072
  v_cvt_pk_bf16_f32 v82, v36, v37
  v_exp_f32 v39, v39
  v_exp_f32 v40, v40
  v_cvt_pk_bf16_f32 v83, v38, v39
  v_exp_f32 v41, v41
  v_exp_f32 v42, v42
  v_mfma_f32_32x32x16_bf16 v[64:79], v[100:103], v[84:87], v[64:79]
  ds_read_b128 v[100:103], v106 offset:34432
  v_cvt_pk_bf16_f32 v84, v40, v41
  v_exp_f32 v43, v43
  v_exp_f32 v44, v44
  v_cvt_pk_bf16_f32 v85, v42, v43
  v_exp_f32 v45, v45
  v_mfma_f32_32x32x16_bf16 v[64:79], v[96:99], v[80:83], v[64:79]
  v_exp_f32 v46, v46
  v_exp_f32 v47, v47
  v_cvt_pk_bf16_f32 v86, v44, v45
  v_cvt_pk_bf16_f32 v87, v46, v47
  buffer_load_dwordx4 v[196:199], v111, s[8:11], s26 offen
  s_add_u32 s26, s26, 18432
  v_exp_f32 v48, v48
  s_waitcnt lgkmcnt(0)
  v_mfma_f32_32x32x16_bf16 v[32:47], v[88:91], v[4:7], v[16:31]
  v_exp_f32 v49, v49
  v_exp_f32 v50, v50
  v_cvt_pk_bf16_f32 v80, v48, v49
  v_exp_f32 v51, v51
  v_exp_f32 v52, v52
  v_cvt_pk_bf16_f32 v81, v50, v51
  v_exp_f32 v53, v53
  v_exp_f32 v54, v54
  v_mfma_f32_32x32x8_bf16 v[32:47], v[94:95], v[12:13], v[32:47]
  ds_read_b128 v[88:91], v104 offset:26624
  ds_read_b128 v[96:99], v106 offset:36352
  v_cvt_pk_bf16_f32 v82, v52, v53
  v_exp_f32 v55, v55
  v_exp_f32 v56, v56
  v_cvt_pk_bf16_f32 v83, v54, v55
  v_exp_f32 v57, v57
  v_exp_f32 v58, v58
  v_mfma_f32_32x32x16_bf16 v[64:79], v[100:103], v[84:87], v[64:79]
  ds_read_b128 v[100:103], v106 offset:35712
  v_cvt_pk_bf16_f32 v84, v56, v57
  v_exp_f32 v59, v59
  v_exp_f32 v60, v60
  v_cvt_pk_bf16_f32 v85, v58, v59
  v_exp_f32 v61, v61
  v_mfma_f32_32x32x16_bf16 v[64:79], v[0:3], v[80:83], v[64:79]
  v_exp_f32 v62, v62
  v_exp_f32 v63, v63
  v_cvt_pk_bf16_f32 v86, v60, v61
  v_cvt_pk_bf16_f32 v87, v62, v63
  buffer_load_dwordx4 v[200:203], v111, s[8:11], s26 offen
  s_add_u32 s26, s26, 18432
  v_exp_f32 v32, v32
  s_waitcnt lgkmcnt(0)
  v_mfma_f32_32x32x16_bf16 v[48:63], v[88:91], v[4:7], v[16:31]
  v_exp_f32 v33, v33
  v_exp_f32 v34, v34
  v_cvt_pk_bf16_f32 v80, v32, v33
  v_exp_f32 v35, v35
  v_exp_f32 v36, v36
  v_cvt_pk_bf16_f32 v81, v34, v35
  v_exp_f32 v37, v37
  v_exp_f32 v38, v38
  v_mfma_f32_32x32x8_bf16 v[48:63], v[94:95], v[14:15], v[48:63]
  ds_read_b64 v[92:93], v105 offset:47104
  ds_read_b128 v[88:91], v104 offset:38912
  ds_read_b128 v[0:3], v106 offset:37632
  v_cvt_pk_bf16_f32 v82, v36, v37
  v_exp_f32 v39, v39
  v_exp_f32 v40, v40
  v_cvt_pk_bf16_f32 v83, v38, v39
  v_exp_f32 v41, v41
  v_exp_f32 v42, v42
  v_mfma_f32_32x32x16_bf16 v[64:79], v[100:103], v[84:87], v[64:79]
  ds_read_b128 v[100:103], v106 offset:36992
  v_cvt_pk_bf16_f32 v84, v40, v41
  v_exp_f32 v43, v43
  v_exp_f32 v44, v44
  v_cvt_pk_bf16_f32 v85, v42, v43
  v_exp_f32 v45, v45
  v_mfma_f32_32x32x16_bf16 v[64:79], v[96:99], v[80:83], v[64:79]
  v_exp_f32 v46, v46
  v_exp_f32 v47, v47
  v_cvt_pk_bf16_f32 v86, v44, v45
  v_cvt_pk_bf16_f32 v87, v46, v47
  buffer_load_dwordx4 v[204:207], v111, s[8:11], s26 offen
  s_add_u32 s26, s26, 18432
  v_exp_f32 v48, v48
  s_waitcnt lgkmcnt(0)
  v_mfma_f32_32x32x16_bf16 v[32:47], v[88:91], v[4:7], v[16:31]
  v_exp_f32 v49, v49
  v_exp_f32 v50, v50
  v_cvt_pk_bf16_f32 v80, v48, v49
  v_exp_f32 v51, v51
  v_exp_f32 v52, v52
  v_cvt_pk_bf16_f32 v81, v50, v51
  v_exp_f32 v53, v53
  v_exp_f32 v54, v54
  v_mfma_f32_32x32x8_bf16 v[32:47], v[92:93], v[8:9], v[32:47]
  ds_read_b128 v[88:91], v104 offset:39936
  ds_read_b128 v[96:99], v106 offset:48128
  v_cvt_pk_bf16_f32 v82, v52, v53
  v_exp_f32 v55, v55
  v_exp_f32 v56, v56
  v_cvt_pk_bf16_f32 v83, v54, v55
  v_exp_f32 v57, v57
  v_exp_f32 v58, v58
  v_mfma_f32_32x32x16_bf16 v[64:79], v[100:103], v[84:87], v[64:79]
  ds_read_b128 v[100:103], v106 offset:38272
  v_cvt_pk_bf16_f32 v84, v56, v57
  v_exp_f32 v59, v59
  v_exp_f32 v60, v60
  v_cvt_pk_bf16_f32 v85, v58, v59
  v_exp_f32 v61, v61
  v_mfma_f32_32x32x16_bf16 v[64:79], v[0:3], v[80:83], v[64:79]
  v_exp_f32 v62, v62
  v_exp_f32 v63, v63
  v_cvt_pk_bf16_f32 v86, v60, v61
  v_cvt_pk_bf16_f32 v87, v62, v63
  v_add_u32 v104, 38912, v104
  v_add_u32 v105, 38912, v105
  v_add_u32 v106, 38912, v106
  buffer_load_dwordx4 v[208:211], v111, s[8:11], s26 offen
  s_add_u32 s26, s26, 18432
  s_setprio 0
  v_exp_f32 v32, v32
  s_waitcnt lgkmcnt(0)
  v_mfma_f32_32x32x16_bf16 v[48:63], v[88:91], v[4:7], v[16:31]
  v_exp_f32 v33, v33
  v_exp_f32 v34, v34
  v_cvt_pk_bf16_f32 v80, v32, v33
  v_exp_f32 v35, v35
  v_exp_f32 v36, v36
  v_cvt_pk_bf16_f32 v81, v34, v35
  v_exp_f32 v37, v37
  v_exp_f32 v38, v38
  v_mfma_f32_32x32x8_bf16 v[48:63], v[92:93], v[10:11], v[48:63]
  ds_read_b128 v[88:91], v104 offset:2048
  ds_read_b128 v[0:3], v106 offset:10496
  v_cvt_pk_bf16_f32 v82, v36, v37
  v_exp_f32 v39, v39
  v_exp_f32 v40, v40
  v_cvt_pk_bf16_f32 v83, v38, v39
  v_exp_f32 v41, v41
  v_exp_f32 v42, v42
  v_mfma_f32_32x32x16_bf16 v[64:79], v[100:103], v[84:87], v[64:79]
  ds_read_b128 v[100:103], v106 offset:9856
  v_cvt_pk_bf16_f32 v84, v40, v41
  v_exp_f32 v43, v43
  v_exp_f32 v44, v44
  v_cvt_pk_bf16_f32 v85, v42, v43
  v_exp_f32 v45, v45
  v_mfma_f32_32x32x16_bf16 v[64:79], v[96:99], v[80:83], v[64:79]
  v_exp_f32 v46, v46
  v_exp_f32 v47, v47
  v_cvt_pk_bf16_f32 v86, v44, v45
  v_cvt_pk_bf16_f32 v87, v46, v47
  buffer_load_dwordx4 v[212:215], v111, s[8:11], s26 offen
  s_add_u32 s26, s26, 18432
  v_exp_f32 v48, v48
  s_waitcnt lgkmcnt(0)
  v_mfma_f32_32x32x16_bf16 v[32:47], v[88:91], v[4:7], v[16:31]
  v_exp_f32 v49, v49
  v_exp_f32 v50, v50
  v_cvt_pk_bf16_f32 v80, v48, v49
  v_exp_f32 v51, v51
  v_exp_f32 v52, v52
  v_cvt_pk_bf16_f32 v81, v50, v51
  v_exp_f32 v53, v53
  v_exp_f32 v54, v54
  v_mfma_f32_32x32x8_bf16 v[32:47], v[92:93], v[12:13], v[32:47]
  ds_read_b128 v[88:91], v104 offset:3072
  ds_read_b128 v[96:99], v106 offset:11776
  v_cvt_pk_bf16_f32 v82, v52, v53
  v_exp_f32 v55, v55
  v_exp_f32 v56, v56
  v_cvt_pk_bf16_f32 v83, v54, v55
  v_exp_f32 v57, v57
  v_exp_f32 v58, v58
  v_mfma_f32_32x32x16_bf16 v[64:79], v[100:103], v[84:87], v[64:79]
  ds_read_b128 v[100:103], v106 offset:11136
  v_cvt_pk_bf16_f32 v84, v56, v57
  v_exp_f32 v59, v59
  v_exp_f32 v60, v60
  v_cvt_pk_bf16_f32 v85, v58, v59
  v_exp_f32 v61, v61
  v_mfma_f32_32x32x16_bf16 v[64:79], v[0:3], v[80:83], v[64:79]
  v_exp_f32 v62, v62
  v_exp_f32 v63, v63
  v_cvt_pk_bf16_f32 v86, v60, v61
  v_cvt_pk_bf16_f32 v87, v62, v63
  buffer_load_dwordx4 v[216:219], v111, s[8:11], s26 offen
  s_add_u32 s26, s26, 18432
  v_exp_f32 v32, v32
  s_waitcnt lgkmcnt(0)
  v_mfma_f32_32x32x16_bf16 v[48:63], v[88:91], v[4:7], v[16:31]
  v_exp_f32 v33, v33
  v_exp_f32 v34, v34
  v_cvt_pk_bf16_f32 v80, v32, v33
  v_exp_f32 v35, v35
  v_exp_f32 v36, v36
  v_cvt_pk_bf16_f32 v81, v34, v35
  v_exp_f32 v37, v37
  v_exp_f32 v38, v38
  v_mfma_f32_32x32x8_bf16 v[48:63], v[92:93], v[14:15], v[48:63]
  ds_read_b64 v[94:95], v105 offset:8704
  ds_read_b128 v[88:91], v104 offset:4096
  ds_read_b128 v[0:3], v106 offset:13056
  v_cvt_pk_bf16_f32 v82, v36, v37
  v_exp_f32 v39, v39
  v_exp_f32 v40, v40
  v_cvt_pk_bf16_f32 v83, v38, v39
  v_exp_f32 v41, v41
  v_exp_f32 v42, v42
  v_mfma_f32_32x32x16_bf16 v[64:79], v[100:103], v[84:87], v[64:79]
  ds_read_b128 v[100:103], v106 offset:12416
  v_cvt_pk_bf16_f32 v84, v40, v41
  v_exp_f32 v43, v43
  v_exp_f32 v44, v44
  v_cvt_pk_bf16_f32 v85, v42, v43
  v_exp_f32 v45, v45
  v_mfma_f32_32x32x16_bf16 v[64:79], v[96:99], v[80:83], v[64:79]
  v_exp_f32 v46, v46
  v_exp_f32 v47, v47
  v_cvt_pk_bf16_f32 v86, v44, v45
  v_cvt_pk_bf16_f32 v87, v46, v47
  buffer_load_dwordx4 v[220:223], v111, s[8:11], s26 offen
  s_add_u32 s26, s26, 18432
  v_exp_f32 v48, v48
  s_waitcnt lgkmcnt(0)
  v_mfma_f32_32x32x16_bf16 v[32:47], v[88:91], v[4:7], v[16:31]
  v_exp_f32 v49, v49
  v_exp_f32 v50, v50
  v_cvt_pk_bf16_f32 v80, v48, v49
  v_exp_f32 v51, v51
  v_exp_f32 v52, v52
  v_cvt_pk_bf16_f32 v81, v50, v51
  v_exp_f32 v53, v53
  v_exp_f32 v54, v54
  v_mfma_f32_32x32x8_bf16 v[32:47], v[94:95], v[8:9], v[32:47]
  ds_read_b128 v[88:91], v104 offset:5120
  ds_read_b128 v[96:99], v106 offset:14336
  v_cvt_pk_bf16_f32 v82, v52, v53
  v_exp_f32 v55, v55
  v_exp_f32 v56, v56
  v_cvt_pk_bf16_f32 v83, v54, v55
  v_exp_f32 v57, v57
  v_exp_f32 v58, v58
  v_mfma_f32_32x32x16_bf16 v[64:79], v[100:103], v[84:87], v[64:79]
  ds_read_b128 v[100:103], v106 offset:13696
  v_cvt_pk_bf16_f32 v84, v56, v57
  v_exp_f32 v59, v59
  v_exp_f32 v60, v60
  v_cvt_pk_bf16_f32 v85, v58, v59
  v_exp_f32 v61, v61
  v_mfma_f32_32x32x16_bf16 v[64:79], v[0:3], v[80:83], v[64:79]
  v_exp_f32 v62, v62
  v_exp_f32 v63, v63
  v_cvt_pk_bf16_f32 v86, v60, v61
  v_cvt_pk_bf16_f32 v87, v62, v63
  buffer_load_dwordx4 v[224:227], v111, s[8:11], s26 offen
  s_add_u32 s26, s26, 18432
  v_exp_f32 v32, v32
  s_waitcnt lgkmcnt(0)
  v_mfma_f32_32x32x16_bf16 v[48:63], v[88:91], v[4:7], v[16:31]
  v_exp_f32 v33, v33
  v_exp_f32 v34, v34
  v_cvt_pk_bf16_f32 v80, v32, v33
  v_exp_f32 v35, v35
  v_exp_f32 v36, v36
  v_cvt_pk_bf16_f32 v81, v34, v35
  v_exp_f32 v37, v37
  v_exp_f32 v38, v38
  v_mfma_f32_32x32x8_bf16 v[48:63], v[94:95], v[10:11], v[48:63]
  ds_read_b128 v[88:91], v104 offset:6144
  ds_read_b128 v[0:3], v106 offset:15616
  v_cvt_pk_bf16_f32 v82, v36, v37
  v_exp_f32 v39, v39
  v_exp_f32 v40, v40
  v_cvt_pk_bf16_f32 v83, v38, v39
  v_exp_f32 v41, v41
  v_exp_f32 v42, v42
  v_mfma_f32_32x32x16_bf16 v[64:79], v[100:103], v[84:87], v[64:79]
  ds_read_b128 v[100:103], v106 offset:14976
  v_cvt_pk_bf16_f32 v84, v40, v41
  v_exp_f32 v43, v43
  v_exp_f32 v44, v44
  v_cvt_pk_bf16_f32 v85, v42, v43
  v_exp_f32 v45, v45
  v_mfma_f32_32x32x16_bf16 v[64:79], v[96:99], v[80:83], v[64:79]
  v_exp_f32 v46, v46
  v_exp_f32 v47, v47
  v_cvt_pk_bf16_f32 v86, v44, v45
  v_cvt_pk_bf16_f32 v87, v46, v47
  buffer_load_dwordx4 v[228:231], v111, s[8:11], s26 offen
  s_add_u32 s26, s26, 18432
  v_exp_f32 v48, v48
  s_waitcnt lgkmcnt(0)
  v_mfma_f32_32x32x16_bf16 v[32:47], v[88:91], v[4:7], v[16:31]
  v_exp_f32 v49, v49
  v_exp_f32 v50, v50
  v_cvt_pk_bf16_f32 v80, v48, v49
  v_exp_f32 v51, v51
  v_exp_f32 v52, v52
  v_cvt_pk_bf16_f32 v81, v50, v51
  v_exp_f32 v53, v53
  v_exp_f32 v54, v54
  v_mfma_f32_32x32x8_bf16 v[32:47], v[94:95], v[12:13], v[32:47]
  ds_read_b128 v[88:91], v104 offset:7168
  ds_read_b128 v[96:99], v106 offset:16896
  v_cvt_pk_bf16_f32 v82, v52, v53
  v_exp_f32 v55, v55
  v_exp_f32 v56, v56
  v_cvt_pk_bf16_f32 v83, v54, v55
  v_exp_f32 v57, v57
  v_exp_f32 v58, v58
  v_mfma_f32_32x32x16_bf16 v[64:79], v[100:103], v[84:87], v[64:79]
  ds_read_b128 v[100:103], v106 offset:16256
  v_cvt_pk_bf16_f32 v84, v56, v57
  v_exp_f32 v59, v59
  v_exp_f32 v60, v60
  v_cvt_pk_bf16_f32 v85, v58, v59
  v_exp_f32 v61, v61
  v_mfma_f32_32x32x16_bf16 v[64:79], v[0:3], v[80:83], v[64:79]
  v_exp_f32 v62, v62
  v_exp_f32 v63, v63
  v_cvt_pk_bf16_f32 v86, v60, v61
  v_cvt_pk_bf16_f32 v87, v62, v63
  buffer_load_dwordx4 v[232:235], v111, s[8:11], s26 offen
  s_add_u32 s26, s26, 18432
  v_exp_f32 v32, v32
  s_waitcnt lgkmcnt(0)
  v_mfma_f32_32x32x16_bf16 v[48:63], v[88:91], v[4:7], v[16:31]
  v_exp_f32 v33, v33
  v_exp_f32 v34, v34
  v_cvt_pk_bf16_f32 v80, v32, v33
  v_exp_f32 v35, v35
  v_exp_f32 v36, v36
  v_cvt_pk_bf16_f32 v81, v34, v35
  v_exp_f32 v37, v37
  v_exp_f32 v38, v38
  v_mfma_f32_32x32x8_bf16 v[48:63], v[94:95], v[14:15], v[48:63]
  ds_read_b64 v[92:93], v105 offset:27648
  ds_read_b128 v[88:91], v104 offset:19456
  ds_read_b128 v[0:3], v106 offset:18176
  v_cvt_pk_bf16_f32 v82, v36, v37
  v_exp_f32 v39, v39
  v_exp_f32 v40, v40
  v_cvt_pk_bf16_f32 v83, v38, v39
  v_exp_f32 v41, v41
  v_exp_f32 v42, v42
  v_mfma_f32_32x32x16_bf16 v[64:79], v[100:103], v[84:87], v[64:79]
  ds_read_b128 v[100:103], v106 offset:17536
  v_cvt_pk_bf16_f32 v84, v40, v41
  v_exp_f32 v43, v43
  v_exp_f32 v44, v44
  v_cvt_pk_bf16_f32 v85, v42, v43
  v_exp_f32 v45, v45
  v_mfma_f32_32x32x16_bf16 v[64:79], v[96:99], v[80:83], v[64:79]
  v_exp_f32 v46, v46
  v_exp_f32 v47, v47
  v_cvt_pk_bf16_f32 v86, v44, v45
  v_cvt_pk_bf16_f32 v87, v46, v47
  buffer_load_dwordx4 v[236:239], v111, s[8:11], s26 offen
  s_add_u32 s26, s26, 18432
  v_exp_f32 v48, v48
  s_waitcnt lgkmcnt(0)
  v_mfma_f32_32x32x16_bf16 v[32:47], v[88:91], v[4:7], v[16:31]
  v_exp_f32 v49, v49
  v_exp_f32 v50, v50
  v_cvt_pk_bf16_f32 v80, v48, v49
  v_exp_f32 v51, v51
  v_exp_f32 v52, v52
  v_cvt_pk_bf16_f32 v81, v50, v51
  v_exp_f32 v53, v53
  v_exp_f32 v54, v54
  v_mfma_f32_32x32x8_bf16 v[32:47], v[92:93], v[8:9], v[32:47]
  ds_read_b128 v[88:91], v104 offset:20480
  ds_read_b128 v[96:99], v106 offset:28672
  v_cvt_pk_bf16_f32 v82, v52, v53
  v_exp_f32 v55, v55
  v_exp_f32 v56, v56
  v_cvt_pk_bf16_f32 v83, v54, v55
  v_exp_f32 v57, v57
  v_exp_f32 v58, v58
  v_mfma_f32_32x32x16_bf16 v[64:79], v[100:103], v[84:87], v[64:79]
  ds_read_b128 v[100:103], v106 offset:18816
  v_cvt_pk_bf16_f32 v84, v56, v57
  v_exp_f32 v59, v59
  v_exp_f32 v60, v60
  v_cvt_pk_bf16_f32 v85, v58, v59
  v_exp_f32 v61, v61
  v_mfma_f32_32x32x16_bf16 v[64:79], v[0:3], v[80:83], v[64:79]
  v_exp_f32 v62, v62
  v_exp_f32 v63, v63
  v_cvt_pk_bf16_f32 v86, v60, v61
  v_cvt_pk_bf16_f32 v87, v62, v63
  buffer_load_dwordx4 v[240:243], v111, s[8:11], s26 offen
  s_add_u32 s26, s26, 18432
  v_exp_f32 v32, v32
  s_waitcnt lgkmcnt(0)
  v_mfma_f32_32x32x16_bf16 v[48:63], v[88:91], v[4:7], v[16:31]
  v_exp_f32 v33, v33
  v_exp_f32 v34, v34
  v_cvt_pk_bf16_f32 v80, v32, v33
  v_exp_f32 v35, v35
  v_exp_f32 v36, v36
  v_cvt_pk_bf16_f32 v81, v34, v35
  v_exp_f32 v37, v37
  v_exp_f32 v38, v38
  v_mfma_f32_32x32x8_bf16 v[48:63], v[92:93], v[10:11], v[48:63]
  ds_read_b128 v[88:91], v104 offset:21504
  ds_read_b128 v[0:3], v106 offset:29952
  v_cvt_pk_bf16_f32 v82, v36, v37
  v_exp_f32 v39, v39
  v_exp_f32 v40, v40
  v_cvt_pk_bf16_f32 v83, v38, v39
  v_exp_f32 v41, v41
  v_exp_f32 v42, v42
  v_mfma_f32_32x32x16_bf16 v[64:79], v[100:103], v[84:87], v[64:79]
  ds_read_b128 v[100:103], v106 offset:29312
  v_cvt_pk_bf16_f32 v84, v40, v41
  v_exp_f32 v43, v43
  v_exp_f32 v44, v44
  v_cvt_pk_bf16_f32 v85, v42, v43
  v_exp_f32 v45, v45
  v_mfma_f32_32x32x16_bf16 v[64:79], v[96:99], v[80:83], v[64:79]
  v_exp_f32 v46, v46
  v_exp_f32 v47, v47
  v_cvt_pk_bf16_f32 v86, v44, v45
  v_cvt_pk_bf16_f32 v87, v46, v47
  buffer_load_dwordx4 v[244:247], v111, s[8:11], s26 offen
  s_add_u32 s26, s26, 18432
  v_exp_f32 v48, v48
  s_waitcnt lgkmcnt(0)
  v_mfma_f32_32x32x16_bf16 v[32:47], v[88:91], v[4:7], v[16:31]
  v_exp_f32 v49, v49
  v_exp_f32 v50, v50
  v_cvt_pk_bf16_f32 v80, v48, v49
  v_exp_f32 v51, v51
  v_exp_f32 v52, v52
  v_cvt_pk_bf16_f32 v81, v50, v51
  v_exp_f32 v53, v53
  v_exp_f32 v54, v54
  v_mfma_f32_32x32x8_bf16 v[32:47], v[92:93], v[12:13], v[32:47]
  ds_read_b128 v[88:91], v104 offset:22528
  ds_read_b128 v[96:99], v106 offset:31232
  v_cvt_pk_bf16_f32 v82, v52, v53
  v_exp_f32 v55, v55
  v_exp_f32 v56, v56
  v_cvt_pk_bf16_f32 v83, v54, v55
  v_exp_f32 v57, v57
  v_exp_f32 v58, v58
  v_mfma_f32_32x32x16_bf16 v[64:79], v[100:103], v[84:87], v[64:79]
  ds_read_b128 v[100:103], v106 offset:30592
  v_cvt_pk_bf16_f32 v84, v56, v57
  v_exp_f32 v59, v59
  v_exp_f32 v60, v60
  v_cvt_pk_bf16_f32 v85, v58, v59
  v_exp_f32 v61, v61
  v_mfma_f32_32x32x16_bf16 v[64:79], v[0:3], v[80:83], v[64:79]
  v_exp_f32 v62, v62
  v_exp_f32 v63, v63
  v_cvt_pk_bf16_f32 v86, v60, v61
  v_cvt_pk_bf16_f32 v87, v62, v63
  buffer_load_dwordx4 v[248:251], v111, s[8:11], s26 offen
  s_add_u32 s26, s26, 18432
  v_exp_f32 v32, v32
  s_waitcnt lgkmcnt(0)
  v_mfma_f32_32x32x16_bf16 v[48:63], v[88:91], v[4:7], v[16:31]
  v_exp_f32 v33, v33
  v_exp_f32 v34, v34
  v_cvt_pk_bf16_f32 v80, v32, v33
  v_exp_f32 v35, v35
  v_exp_f32 v36, v36
  v_cvt_pk_bf16_f32 v81, v34, v35
  v_exp_f32 v37, v37
  v_exp_f32 v38, v38
  v_mfma_f32_32x32x8_bf16 v[48:63], v[92:93], v[14:15], v[48:63]
  ds_read_b64 v[94:95], v105 offset:28160
  ds_read_b128 v[88:91], v104 offset:23552
  ds_read_b128 v[0:3], v106 offset:32512
  v_cvt_pk_bf16_f32 v82, v36, v37
  v_exp_f32 v39, v39
  v_exp_f32 v40, v40
  v_cvt_pk_bf16_f32 v83, v38, v39
  v_exp_f32 v41, v41
  v_exp_f32 v42, v42
  v_mfma_f32_32x32x16_bf16 v[64:79], v[100:103], v[84:87], v[64:79]
  ds_read_b128 v[100:103], v106 offset:31872
  v_cvt_pk_bf16_f32 v84, v40, v41
  v_exp_f32 v43, v43
  v_exp_f32 v44, v44
  v_cvt_pk_bf16_f32 v85, v42, v43
  v_exp_f32 v45, v45
  v_mfma_f32_32x32x16_bf16 v[64:79], v[96:99], v[80:83], v[64:79]
  v_exp_f32 v46, v46
  v_exp_f32 v47, v47
  v_cvt_pk_bf16_f32 v86, v44, v45
  v_cvt_pk_bf16_f32 v87, v46, v47
  buffer_load_dwordx4 v[252:255], v111, s[8:11], s26 offen
  s_add_u32 s26, s26, 18432
  v_exp_f32 v48, v48
  s_waitcnt lgkmcnt(0)
  v_mfma_f32_32x32x16_bf16 v[32:47], v[88:91], v[4:7], v[16:31]
  v_exp_f32 v49, v49
  v_exp_f32 v50, v50
  v_cvt_pk_bf16_f32 v80, v48, v49
  v_exp_f32 v51, v51
  v_exp_f32 v52, v52
  v_cvt_pk_bf16_f32 v81, v50, v51
  v_exp_f32 v53, v53
  v_exp_f32 v54, v54
  v_mfma_f32_32x32x8_bf16 v[32:47], v[94:95], v[8:9], v[32:47]
  ds_read_b128 v[88:91], v104 offset:24576
  ds_read_b128 v[96:99], v106 offset:33792
  v_cvt_pk_bf16_f32 v82, v52, v53
  v_exp_f32 v55, v55
  v_exp_f32 v56, v56
  v_cvt_pk_bf16_f32 v83, v54, v55
  v_exp_f32 v57, v57
  v_exp_f32 v58, v58
  v_mfma_f32_32x32x16_bf16 v[64:79], v[100:103], v[84:87], v[64:79]
  ds_read_b128 v[100:103], v106 offset:33152
  v_cvt_pk_bf16_f32 v84, v56, v57
  v_exp_f32 v59, v59
  v_exp_f32 v60, v60
  v_cvt_pk_bf16_f32 v85, v58, v59
  v_exp_f32 v61, v61
  v_mfma_f32_32x32x16_bf16 v[64:79], v[0:3], v[80:83], v[64:79]
  v_exp_f32 v62, v62
  v_exp_f32 v63, v63
  v_cvt_pk_bf16_f32 v86, v60, v61
  v_cvt_pk_bf16_f32 v87, v62, v63
  v_exp_f32 v32, v32
  s_waitcnt lgkmcnt(0)
  v_mfma_f32_32x32x16_bf16 v[48:63], v[88:91], v[4:7], v[16:31]
  v_exp_f32 v33, v33
  v_exp_f32 v34, v34
  v_cvt_pk_bf16_f32 v80, v32, v33
  v_exp_f32 v35, v35
  v_exp_f32 v36, v36
  v_cvt_pk_bf16_f32 v81, v34, v35
  v_exp_f32 v37, v37
  v_exp_f32 v38, v38
  v_mfma_f32_32x32x8_bf16 v[48:63], v[94:95], v[10:11], v[48:63]
  ds_read_b128 v[88:91], v104 offset:25600
  ds_read_b128 v[0:3], v106 offset:35072
  v_cvt_pk_bf16_f32 v82, v36, v37
  v_exp_f32 v39, v39
  v_exp_f32 v40, v40
  v_cvt_pk_bf16_f32 v83, v38, v39
  v_exp_f32 v41, v41
  v_exp_f32 v42, v42
  v_mfma_f32_32x32x16_bf16 v[64:79], v[100:103], v[84:87], v[64:79]
  ds_read_b128 v[100:103], v106 offset:34432
  v_cvt_pk_bf16_f32 v84, v40, v41
  v_exp_f32 v43, v43
  v_exp_f32 v44, v44
  v_cvt_pk_bf16_f32 v85, v42, v43
  v_exp_f32 v45, v45
  v_mfma_f32_32x32x16_bf16 v[64:79], v[96:99], v[80:83], v[64:79]
  v_exp_f32 v46, v46
  v_exp_f32 v47, v47
  v_cvt_pk_bf16_f32 v86, v44, v45
  v_cvt_pk_bf16_f32 v87, v46, v47
  v_exp_f32 v48, v48
  s_waitcnt lgkmcnt(0)
  v_mfma_f32_32x32x16_bf16 v[32:47], v[88:91], v[4:7], v[16:31]
  v_exp_f32 v49, v49
  v_exp_f32 v50, v50
  v_cvt_pk_bf16_f32 v80, v48, v49
  v_exp_f32 v51, v51
  v_exp_f32 v52, v52
  v_cvt_pk_bf16_f32 v81, v50, v51
  v_exp_f32 v53, v53
  v_exp_f32 v54, v54
  v_mfma_f32_32x32x8_bf16 v[32:47], v[94:95], v[12:13], v[32:47]
  ds_read_b128 v[88:91], v104 offset:26624
  ds_read_b128 v[96:99], v106 offset:36352
  v_cvt_pk_bf16_f32 v82, v52, v53
  v_exp_f32 v55, v55
  v_exp_f32 v56, v56
  v_cvt_pk_bf16_f32 v83, v54, v55
  v_exp_f32 v57, v57
  v_exp_f32 v58, v58
  v_mfma_f32_32x32x16_bf16 v[64:79], v[100:103], v[84:87], v[64:79]
  ds_read_b128 v[100:103], v106 offset:35712
  v_cvt_pk_bf16_f32 v84, v56, v57
  v_exp_f32 v59, v59
  v_exp_f32 v60, v60
  v_cvt_pk_bf16_f32 v85, v58, v59
  v_exp_f32 v61, v61
  v_mfma_f32_32x32x16_bf16 v[64:79], v[0:3], v[80:83], v[64:79]
  v_exp_f32 v62, v62
  v_exp_f32 v63, v63
  v_cvt_pk_bf16_f32 v86, v60, v61
  v_cvt_pk_bf16_f32 v87, v62, v63
  v_exp_f32 v32, v32
  s_waitcnt lgkmcnt(0)
  v_mfma_f32_32x32x16_bf16 v[48:63], v[88:91], v[4:7], v[16:31]
  v_exp_f32 v33, v33
  v_exp_f32 v34, v34
  v_cvt_pk_bf16_f32 v80, v32, v33
  v_exp_f32 v35, v35
  v_exp_f32 v36, v36
  v_cvt_pk_bf16_f32 v81, v34, v35
  v_exp_f32 v37, v37
  v_exp_f32 v38, v38
  v_mfma_f32_32x32x8_bf16 v[48:63], v[94:95], v[14:15], v[48:63]
  ds_read_b64 v[92:93], v105 offset:47104
  ds_read_b128 v[88:91], v104 offset:38912
  ds_read_b128 v[0:3], v106 offset:37632
  v_cvt_pk_bf16_f32 v82, v36, v37
  v_exp_f32 v39, v39
  v_exp_f32 v40, v40
  v_cvt_pk_bf16_f32 v83, v38, v39
  v_exp_f32 v41, v41
  v_exp_f32 v42, v42
  v_mfma_f32_32x32x16_bf16 v[64:79], v[100:103], v[84:87], v[64:79]
  ds_read_b128 v[100:103], v106 offset:36992
  v_cvt_pk_bf16_f32 v84, v40, v41
  v_exp_f32 v43, v43
  v_exp_f32 v44, v44
  v_cvt_pk_bf16_f32 v85, v42, v43
  v_exp_f32 v45, v45
  v_mfma_f32_32x32x16_bf16 v[64:79], v[96:99], v[80:83], v[64:79]
  v_exp_f32 v46, v46
  v_exp_f32 v47, v47
  v_cvt_pk_bf16_f32 v86, v44, v45
  v_cvt_pk_bf16_f32 v87, v46, v47
  v_exp_f32 v48, v48
  s_waitcnt lgkmcnt(0)
  v_mfma_f32_32x32x16_bf16 v[32:47], v[88:91], v[4:7], v[16:31]
  v_exp_f32 v49, v49
  v_exp_f32 v50, v50
  v_cvt_pk_bf16_f32 v80, v48, v49
  v_exp_f32 v51, v51
  v_exp_f32 v52, v52
  v_cvt_pk_bf16_f32 v81, v50, v51
  v_exp_f32 v53, v53
  v_exp_f32 v54, v54
  v_mfma_f32_32x32x8_bf16 v[32:47], v[92:93], v[8:9], v[32:47]
  ds_read_b128 v[88:91], v104 offset:39936
  ds_read_b128 v[96:99], v106 offset:48128
  v_cvt_pk_bf16_f32 v82, v52, v53
  v_exp_f32 v55, v55
  v_exp_f32 v56, v56
  v_cvt_pk_bf16_f32 v83, v54, v55
  v_exp_f32 v57, v57
  v_exp_f32 v58, v58
  v_mfma_f32_32x32x16_bf16 v[64:79], v[100:103], v[84:87], v[64:79]
  ds_read_b128 v[100:103], v106 offset:38272
  v_cvt_pk_bf16_f32 v84, v56, v57
  v_exp_f32 v59, v59
  v_exp_f32 v60, v60
  v_cvt_pk_bf16_f32 v85, v58, v59
  v_exp_f32 v61, v61
  v_mfma_f32_32x32x16_bf16 v[64:79], v[0:3], v[80:83], v[64:79]
  v_exp_f32 v62, v62
  v_exp_f32 v63, v63
  v_cvt_pk_bf16_f32 v86, v60, v61
  v_cvt_pk_bf16_f32 v87, v62, v63
    s_waitcnt lgkmcnt(0)
  s_nop 0
    v_mfma_f32_32x32x16_bf16 v[64:79], v[100:103], v[84:87], v[64:79]
    s_setprio 0
    v_and_b32 v3, 31, v107
    v_lshrrev_b32 v2, 5, v107
    v_lshlrev_b32 v110, 4, v3
    v_lshl_add_u32 v110, v2, 1, v110
  s_nop 6
    v_rcp_f32 v109, v73
  s_nop 0
  v_mul_f32 v64, v64, v109
  v_mul_f32 v65, v65, v109
  v_mul_f32 v66, v66, v109
  v_mul_f32 v67, v67, v109
  v_mul_f32 v68, v68, v109
  v_mul_f32 v69, v69, v109
  v_mul_f32 v70, v70, v109
  v_mul_f32 v71, v71, v109
  v_mul_f32 v72, v72, v109
  v_cvt_pk_bf16_f32 v80, v64, v65
  v_cvt_pk_bf16_f32 v81, v66, v67
  v_cvt_pk_bf16_f32 v82, v68, v69
  v_cvt_pk_bf16_f32 v83, v70, v71
    v_cvt_pk_bf16_f32 v84, v72, v72
    buffer_store_dwordx4 v[80:83], v108, s[8:11], s52 offen sc1
    buffer_store_short v84, v110, s[8:11], s53 offen sc1
    v_add_u32 v5, 36864, v108
    s_waitcnt vmcnt(0)
    s_barrier
    s_cmp_eq_u32 s20, 0
    s_cbranch_scc0 kfa_kernel_nf
    v_mov_b32 v109, 0
    v_mov_b32 v110, 1
    s_mov_b64 exec, 1
    buffer_atomic_add v110, v109, s[8:11], s54 offen sc1
    s_mov_b64 exec, -1
kfa_kernel_nf:
        v_mul_u32_u24 v4, 16512, v2
        v_lshl_add_u32 v4, v3, 3, v4
  s_add_u32 s34, s31, 0
  buffer_load_dwordx2 v[44:45], v4, s[8:11], s34 offen
  s_add_u32 s34, s31, 33024
  buffer_load_dwordx2 v[46:47], v4, s[8:11], s34 offen
  s_add_u32 s34, s31, 66048
  buffer_load_dwordx2 v[48:49], v4, s[8:11], s34 offen
  s_add_u32 s34, s31, 99072
  buffer_load_dwordx2 v[50:51], v4, s[8:11], s34 offen
  s_cmp_eq_u32 s20, 7
  s_cbranch_scc0 kfa_kernel_np5
  s_mov_b32 s44, 0
  s_mov_b32 s45, 8
  v_lshlrev_b32 v109, 10, v107
  s_mov_b64 exec, 0x1
kfa_kernel_pollo:
        buffer_load_dword v110, v109, s[8:11], s54 offen sc1
        s_waitcnt vmcnt(0)
        v_cmp_le_u32 vcc, s45, v110
        s_add_u32 s44, s44, 1
        s_cmp_ge_u32 s44, 262144
        s_cbranch_scc1 kfa_kernel_pdo
  s_nop 0
        s_cmp_eq_u64 vcc, exec
        s_cbranch_scc1 kfa_kernel_pdo
        s_sleep 1
        s_branch kfa_kernel_pollo
kfa_kernel_pdo:
  s_mov_b64 exec, -1
kfa_kernel_np5:
  s_barrier
    s_lshl_b32 s34, s24, 10
    v_add_u32 v104, s34, v108
    v_add_u32 v5, s34, v5
    s_cmp_ge_u32 s20, 6
    s_cbranch_scc1 kfa_kernel_help5
        s_mov_b32 m0, s47
        s_add_u32 s47, s47, 8192
        buffer_load_dwordx4 v108, s[8:11], s46 offen sc1 lds
        s_add_u32 s46, s46, 8192
  s_barrier
        s_mov_b32 m0, s47
        s_add_u32 s47, s47, 8192
        buffer_load_dwordx4 v108, s[8:11], s46 offen sc1 lds
        s_add_u32 s46, s46, 8192
        s_mov_b32 m0, s47
        s_add_u32 s47, s47, 8192
        buffer_load_dwordx4 v108, s[8:11], s46 offen sc1 lds
        s_add_u32 s46, s46, 8192
        s_mov_b32 m0, s47
        s_add_u32 s47, s47, 8192
        buffer_load_dwordx4 v108, s[8:11], s46 offen sc1 lds
        s_add_u32 s46, s46, 8192
        s_mov_b32 m0, s47
        s_add_u32 s47, s47, 8192
        buffer_load_dwordx4 v108, s[8:11], s46 offen sc1 lds
        s_add_u32 s46, s46, 8192
        s_mov_b32 m0, s47
        s_add_u32 s47, s47, 8192
        buffer_load_dwordx4 v108, s[8:11], s46 offen sc1 lds
        s_add_u32 s46, s46, 8192
        s_mov_b32 m0, s47
        s_add_u32 s47, s47, 8192
        buffer_load_dwordx4 v108, s[8:11], s46 offen sc1 lds
        s_add_u32 s46, s46, 8192
        s_mov_b32 m0, s47
        s_add_u32 s47, s47, 8192
        buffer_load_dwordx4 v108, s[8:11], s46 offen sc1 lds
        s_add_u32 s46, s46, 8192
        s_mov_b32 m0, s47
        s_add_u32 s47, s47, 8192
        buffer_load_dwordx4 v108, s[8:11], s46 offen sc1 lds
        s_add_u32 s46, s46, 8192
  s_waitcnt vmcnt(8)
  s_barrier
  ds_read_b128 v[32:35], v104 offset:0
  ds_read_b128 v[36:39], v104 offset:2048
  v_lshlrev_b32 v16, 16, v44
  v_and_b32 v17, 0xffff0000, v44
  v_lshlrev_b32 v18, 16, v45
  v_and_b32 v19, 0xffff0000, v45
  v_lshlrev_b32 v20, 16, v46
  v_and_b32 v21, 0xffff0000, v46
  v_lshlrev_b32 v22, 16, v47
  v_and_b32 v23, 0xffff0000, v47
  v_lshlrev_b32 v24, 16, v48
  v_and_b32 v25, 0xffff0000, v48
  v_lshlrev_b32 v26, 16, v49
  v_and_b32 v27, 0xffff0000, v49
  v_lshlrev_b32 v28, 16, v50
  v_and_b32 v29, 0xffff0000, v50
  v_lshlrev_b32 v30, 16, v51
  v_and_b32 v31, 0xffff0000, v51
  ds_read_b128 v[40:43], v104 offset:4096
  s_waitcnt lgkmcnt(2)
  v_mfma_f32_32x32x16_bf16 v[16:31], v[112:115], v[32:35], v[16:31]
  ds_read_b128 v[32:35], v104 offset:6144
  s_waitcnt lgkmcnt(2)
  v_mfma_f32_32x32x16_bf16 v[80:95], v[116:119], v[36:39], 0
  s_waitcnt vmcnt(7)
  s_barrier
  ds_read_b128 v[36:39], v104 offset:8192
  s_waitcnt lgkmcnt(2)
  v_mfma_f32_32x32x16_bf16 v[16:31], v[120:123], v[40:43], v[16:31]
  ds_read_b128 v[40:43], v104 offset:10240
  s_waitcnt lgkmcnt(2)
  v_mfma_f32_32x32x16_bf16 v[80:95], v[124:127], v[32:35], v[80:95]
  ds_read_b128 v[32:35], v104 offset:12288
  s_waitcnt lgkmcnt(2)
  v_mfma_f32_32x32x16_bf16 v[16:31], v[128:131], v[36:39], v[16:31]
  ds_read_b128 v[36:39], v104 offset:14336
  s_waitcnt lgkmcnt(2)
  v_mfma_f32_32x32x16_bf16 v[80:95], v[132:135], v[40:43], v[80:95]
  s_waitcnt vmcnt(6)
  s_barrier
  ds_read_b128 v[40:43], v104 offset:16384
  s_waitcnt lgkmcnt(2)
  v_mfma_f32_32x32x16_bf16 v[16:31], v[136:139], v[32:35], v[16:31]
  ds_read_b128 v[32:35], v104 offset:18432
  s_waitcnt lgkmcnt(2)
  v_mfma_f32_32x32x16_bf16 v[80:95], v[140:143], v[36:39], v[80:95]
  ds_read_b128 v[36:39], v104 offset:20480
  s_waitcnt lgkmcnt(2)
  v_mfma_f32_32x32x16_bf16 v[16:31], v[144:147], v[40:43], v[16:31]
  ds_read_b128 v[40:43], v104 offset:22528
  s_waitcnt lgkmcnt(2)
  v_mfma_f32_32x32x16_bf16 v[80:95], v[148:151], v[32:35], v[80:95]
  s_waitcnt vmcnt(5)
  s_barrier
  ds_read_b128 v[32:35], v104 offset:24576
  s_waitcnt lgkmcnt(2)
  v_mfma_f32_32x32x16_bf16 v[16:31], v[152:155], v[36:39], v[16:31]
  ds_read_b128 v[36:39], v104 offset:26624
  s_waitcnt lgkmcnt(2)
  v_mfma_f32_32x32x16_bf16 v[80:95], v[156:159], v[40:43], v[80:95]
  ds_read_b128 v[40:43], v104 offset:28672
  s_waitcnt lgkmcnt(2)
  v_mfma_f32_32x32x16_bf16 v[16:31], v[160:163], v[32:35], v[16:31]
  ds_read_b128 v[32:35], v104 offset:30720
  s_waitcnt lgkmcnt(2)
  v_mfma_f32_32x32x16_bf16 v[80:95], v[164:167], v[36:39], v[80:95]
  s_waitcnt vmcnt(4)
  s_barrier
  ds_read_b128 v[36:39], v104 offset:32768
  s_waitcnt lgkmcnt(2)
  v_mfma_f32_32x32x16_bf16 v[16:31], v[168:171], v[40:43], v[16:31]
  ds_read_b128 v[40:43], v104 offset:34816
  s_waitcnt lgkmcnt(2)
  v_mfma_f32_32x32x16_bf16 v[80:95], v[172:175], v[32:35], v[80:95]
  ds_read_b128 v[32:35], v5 offset:0
  s_waitcnt lgkmcnt(2)
  v_mfma_f32_32x32x16_bf16 v[16:31], v[176:179], v[36:39], v[16:31]
  ds_read_b128 v[36:39], v5 offset:2048
  s_waitcnt lgkmcnt(2)
  v_mfma_f32_32x32x16_bf16 v[80:95], v[180:183], v[40:43], v[80:95]
  s_waitcnt vmcnt(3)
  s_barrier
  ds_read_b128 v[40:43], v5 offset:4096
  s_waitcnt lgkmcnt(2)
  v_mfma_f32_32x32x16_bf16 v[16:31], v[184:187], v[32:35], v[16:31]
  ds_read_b128 v[32:35], v5 offset:6144
  s_waitcnt lgkmcnt(2)
  v_mfma_f32_32x32x16_bf16 v[80:95], v[188:191], v[36:39], v[80:95]
  ds_read_b128 v[36:39], v5 offset:8192
  s_waitcnt lgkmcnt(2)
  v_mfma_f32_32x32x16_bf16 v[16:31], v[192:195], v[40:43], v[16:31]
  ds_read_b128 v[40:43], v5 offset:10240
  s_waitcnt lgkmcnt(2)
  v_mfma_f32_32x32x16_bf16 v[80:95], v[196:199], v[32:35], v[80:95]
  s_waitcnt vmcnt(2)
  s_barrier
  ds_read_b128 v[32:35], v5 offset:12288
  s_waitcnt lgkmcnt(2)
  v_mfma_f32_32x32x16_bf16 v[16:31], v[200:203], v[36:39], v[16:31]
  ds_read_b128 v[36:39], v5 offset:14336
  s_waitcnt lgkmcnt(2)
  v_mfma_f32_32x32x16_bf16 v[80:95], v[204:207], v[40:43], v[80:95]
  ds_read_b128 v[40:43], v5 offset:16384
  s_waitcnt lgkmcnt(2)
  v_mfma_f32_32x32x16_bf16 v[16:31], v[208:211], v[32:35], v[16:31]
  ds_read_b128 v[32:35], v5 offset:18432
  s_waitcnt lgkmcnt(2)
  v_mfma_f32_32x32x16_bf16 v[80:95], v[212:215], v[36:39], v[80:95]
  s_waitcnt vmcnt(1)
  s_barrier
  ds_read_b128 v[36:39], v5 offset:20480
  s_waitcnt lgkmcnt(2)
  v_mfma_f32_32x32x16_bf16 v[16:31], v[216:219], v[40:43], v[16:31]
  ds_read_b128 v[40:43], v5 offset:22528
  s_waitcnt lgkmcnt(2)
  v_mfma_f32_32x32x16_bf16 v[80:95], v[220:223], v[32:35], v[80:95]
  ds_read_b128 v[32:35], v5 offset:24576
  s_waitcnt lgkmcnt(2)
  v_mfma_f32_32x32x16_bf16 v[16:31], v[224:227], v[36:39], v[16:31]
  ds_read_b128 v[36:39], v5 offset:26624
  s_waitcnt lgkmcnt(2)
  v_mfma_f32_32x32x16_bf16 v[80:95], v[228:231], v[40:43], v[80:95]
  s_waitcnt vmcnt(0)
  s_barrier
  ds_read_b128 v[40:43], v5 offset:28672
  s_waitcnt lgkmcnt(2)
  v_mfma_f32_32x32x16_bf16 v[16:31], v[232:235], v[32:35], v[16:31]
  ds_read_b128 v[32:35], v5 offset:30720
  s_waitcnt lgkmcnt(2)
  v_mfma_f32_32x32x16_bf16 v[80:95], v[236:239], v[36:39], v[80:95]
  ds_read_b128 v[36:39], v5 offset:32768
  s_waitcnt lgkmcnt(2)
  v_mfma_f32_32x32x16_bf16 v[16:31], v[240:243], v[40:43], v[16:31]
  ds_read_b128 v[40:43], v5 offset:34816
  s_waitcnt lgkmcnt(2)
  v_mfma_f32_32x32x16_bf16 v[80:95], v[244:247], v[32:35], v[80:95]
  s_waitcnt lgkmcnt(1)
  v_mfma_f32_32x32x16_bf16 v[16:31], v[248:251], v[36:39], v[16:31]
  s_waitcnt lgkmcnt(0)
  v_mfma_f32_32x32x16_bf16 v[80:95], v[252:255], v[40:43], v[80:95]
  s_nop 11
  v_add_f32 v16, v16, v80
  v_add_f32 v17, v17, v81
  v_add_f32 v18, v18, v82
  v_add_f32 v19, v19, v83
  v_add_f32 v20, v20, v84
  v_add_f32 v21, v21, v85
  v_add_f32 v22, v22, v86
  v_add_f32 v23, v23, v87
  v_add_f32 v24, v24, v88
  v_add_f32 v25, v25, v89
  v_add_f32 v26, v26, v90
  v_add_f32 v27, v27, v91
  v_add_f32 v28, v28, v92
  v_add_f32 v29, v29, v93
  v_add_f32 v30, v30, v94
  v_add_f32 v31, v31, v95
  s_cmp_eq_u32 s23, 2
  s_cbranch_scc1 kfa_kernel_ep8
  v_cvt_pk_bf16_f32 v56, v16, v17
  v_cvt_pk_bf16_f32 v57, v18, v19
  s_add_u32 s34, s30, 0
  buffer_store_dwordx2 v[56:57], v4, s[8:11], s34 offen sc1
  v_cvt_pk_bf16_f32 v58, v20, v21
  v_cvt_pk_bf16_f32 v59, v22, v23
  s_add_u32 s34, s30, 33024
  buffer_store_dwordx2 v[58:59], v4, s[8:11], s34 offen sc1
  v_cvt_pk_bf16_f32 v60, v24, v25
  v_cvt_pk_bf16_f32 v61, v26, v27
  s_add_u32 s34, s30, 66048
  buffer_store_dwordx2 v[60:61], v4, s[8:11], s34 offen sc1
  v_cvt_pk_bf16_f32 v62, v28, v29
  v_cvt_pk_bf16_f32 v63, v30, v31
  s_add_u32 s34, s30, 99072
  buffer_store_dwordx2 v[62:63], v4, s[8:11], s34 offen sc1
            s_or_b32 s34, s22, s23
            s_cmp_eq_u32 s34, 0
            s_cbranch_scc0 kfa_kernel_nodc4
            v_mov_b32 v2, 0
            v_cmp_gt_u32 vcc, 32, v107
  s_nop 1
            v_cndmask_b32 v16, v16, v2, vcc
kfa_kernel_nodc4:
  v_mul_f32 v64, v16, v16
  v_fmac_f32 v64, v17, v17
  v_fmac_f32 v64, v18, v18
  v_fmac_f32 v64, v19, v19
  v_fmac_f32 v64, v20, v20
  v_fmac_f32 v64, v21, v21
  v_fmac_f32 v64, v22, v22
  v_fmac_f32 v64, v23, v23
  v_fmac_f32 v64, v24, v24
  v_fmac_f32 v64, v25, v25
  v_fmac_f32 v64, v26, v26
  v_fmac_f32 v64, v27, v27
  v_fmac_f32 v64, v28, v28
  v_fmac_f32 v64, v29, v29
  v_fmac_f32 v64, v30, v30
  v_fmac_f32 v64, v31, v31
    v_mov_b32 v109, v64
    v_mov_b32 v110, v64
  s_nop 1
    v_permlane32_swap_b32 v109, v110
    v_add_f32 v64, v109, v110
            v_and_b32 v109, 31, v107
            v_lshlrev_b32 v109, 2, v109
            s_lshl_b32 s34, s21, 8
            s_lshl_b32 s35, s24, 7
            s_add_u32 s34, s34, s35
            s_add_u32 s34, s34, 9527296
            s_mov_b32 exec_hi, 0
            buffer_atomic_add_f32 v64, v109, s[8:11], s34 offen sc1
            s_mov_b64 exec, -1
  s_branch kfa_kernel_fin
kfa_kernel_ep8:
  v_cvt_pk_bf16_f32 v56, v16, v17
  v_cvt_pk_bf16_f32 v57, v18, v19
  s_add_u32 s34, s30, 0
  buffer_store_dwordx2 v[56:57], v4, s[8:11], s34 offen sc1
            s_or_b32 s34, s22, s23
            s_cmp_eq_u32 s34, 0
            s_cbranch_scc0 kfa_kernel_nodc1
            v_mov_b32 v2, 0
            v_cmp_gt_u32 vcc, 32, v107
  s_nop 1
            v_cndmask_b32 v16, v16, v2, vcc
kfa_kernel_nodc1:
  v_mul_f32 v64, v16, v16
  v_fmac_f32 v64, v17, v17
  v_fmac_f32 v64, v18, v18
  v_fmac_f32 v64, v19, v19
    v_mov_b32 v109, v64
    v_mov_b32 v110, v64
  s_nop 1
    v_permlane32_swap_b32 v109, v110
    v_add_f32 v64, v109, v110
            v_and_b32 v109, 31, v107
            v_lshlrev_b32 v109, 2, v109
            s_lshl_b32 s34, s21, 8
            s_lshl_b32 s35, s24, 7
            s_add_u32 s34, s34, s35
            s_add_u32 s34, s34, 9527296
            s_mov_b32 exec_hi, 0
            buffer_atomic_add_f32 v64, v109, s[8:11], s34 offen sc1
            s_mov_b64 exec, -1
  s_branch kfa_kernel_fin
kfa_kernel_help5:
        s_mov_b32 m0, s47
        s_add_u32 s47, s47, 8192
        buffer_load_dwordx4 v108, s[8:11], s46 offen sc1 lds
        s_add_u32 s46, s46, 8192
  s_barrier
        s_mov_b32 m0, s47
        s_add_u32 s47, s47, 8192
        buffer_load_dwordx4 v108, s[8:11], s46 offen sc1 lds
        s_add_u32 s46, s46, 8192
        s_mov_b32 m0, s47
        s_add_u32 s47, s47, 8192
        buffer_load_dwordx4 v108, s[8:11], s46 offen sc1 lds
        s_add_u32 s46, s46, 8192
        s_mov_b32 m0, s47
        s_add_u32 s47, s47, 8192
        buffer_load_dwordx4 v108, s[8:11], s46 offen sc1 lds
        s_add_u32 s46, s46, 8192
        s_mov_b32 m0, s47
        s_add_u32 s47, s47, 8192
        buffer_load_dwordx4 v108, s[8:11], s46 offen sc1 lds
        s_add_u32 s46, s46, 8192
        s_mov_b32 m0, s47
        s_add_u32 s47, s47, 8192
        buffer_load_dwordx4 v108, s[8:11], s46 offen sc1 lds
        s_add_u32 s46, s46, 8192
        s_mov_b32 m0, s47
        s_add_u32 s47, s47, 8192
        buffer_load_dwordx4 v108, s[8:11], s46 offen sc1 lds
        s_add_u32 s46, s46, 8192
        s_mov_b32 m0, s47
        s_add_u32 s47, s47, 8192
        buffer_load_dwordx4 v108, s[8:11], s46 offen sc1 lds
        s_add_u32 s46, s46, 8192
        s_mov_b32 m0, s47
        s_add_u32 s47, s47, 8192
        buffer_load_dwordx4 v108, s[8:11], s46 offen sc1 lds
        s_add_u32 s46, s46, 8192
  s_waitcnt vmcnt(8)
  s_barrier
  s_waitcnt vmcnt(7)
  s_barrier
  s_waitcnt vmcnt(6)
  s_barrier
  s_waitcnt vmcnt(5)
  s_barrier
  s_waitcnt vmcnt(4)
  s_barrier
  s_waitcnt vmcnt(3)
  s_barrier
  s_waitcnt vmcnt(2)
  s_barrier
  s_waitcnt vmcnt(1)
  s_barrier
  s_waitcnt vmcnt(0)
  s_barrier
kfa_kernel_fin:
  s_waitcnt vmcnt(0)
kfa_kernel_end:
  s_endpgm
.p2align 8
.type k2b_kernel,@function
k2b_kernel:
  s_cmp_ge_u32 s2, 252
  s_cbranch_scc1 k2b_kernel_end
  s_load_dwordx2 s[4:5], s[0:1], 80
  s_cmp_ge_u32 s2, 144
  s_cbranch_scc1 k2b_kernel_extra
    v_lshrrev_b32 v233, 6, v0
    v_and_b32 v237, 63, v0
    v_readfirstlane_b32 s22, v233
    s_mul_i32 s23, s2, 16512
    v_lshlrev_b32 v231, 4, v237
    v_lshlrev_b32 v232, 3, v237
  s_nop 0
    s_and_b32 s20, s22, 3
    s_lshr_b32 s21, s22, 2
    s_lshl_b32 s22, s20, 12
    s_add_u32 s23, s23, s22
    s_add_u32 s24, s23, 7139328
    s_add_u32 s23, s23, 4759552
    s_lshl_b32 s25, s20, 11
    s_add_u32 s25, s25, 9527296
    s_lshl_b32 s26, s2, 14
    s_lshl_b32 s27, s20, 10
    s_add_u32 s26, s26, s27
    s_lshl_b32 s27, s21, 13
    s_add_u32 s26, s26, s27
    s_add_u32 s26, s26, 9551872
    s_waitcnt lgkmcnt(0)
    s_mov_b32 s8, s4
    s_mov_b32 s9, s5
    s_mov_b32 s10, 0x10000000
    s_mov_b32 s11, 0x20000
    s_lshl_b32 s27, s21, 10
    s_add_u32 s25, s25, s27
    s_lshl_b32 s27, s21, 11
    s_add_u32 s23, s23, s27
  buffer_load_dwordx2 v[20:21], v232, s[8:11], s25 offen offset:0
  buffer_load_dwordx2 v[22:23], v232, s[8:11], s25 offen offset:512
  buffer_load_dwordx4 v[4:7], v231, s[8:11], s23 offen offset:0
  buffer_load_dwordx4 v[8:11], v231, s[8:11], s23 offen offset:1024
    v_and_b32 v233, 15, v237
    v_lshrrev_b32 v234, 4, v237
    v_cvt_f32_u32 v240, v233
    v_cvt_f32_u32 v239, v234
    s_lshl_b32 s28, s20, 4
    v_add_u32 v235, s28, v233
    v_cvt_f32_u32 v238, v235
    v_lshrrev_b32 v235, 1, v233
    v_and_b32 v235, 7, v235
    v_lshlrev_b32 v236, 7, v233
    s_lshl_b32 s29, s21, 13
    v_add_u32 v236, s29, v236
    v_xor_b32 v229, v234, v235
    v_lshl_add_u32 v229, v229, 4, v236
    v_xor_b32 v230, 64, v229
    v_lshrrev_b32 v228, 1, v234
    s_lshl_b32 s29, s20, 1
    v_add_u32 v228, s29, v228
    v_xor_b32 v228, v228, v235
    v_lshl_add_u32 v228, v228, 4, v236
    v_and_b32 v235, 1, v234
    v_lshl_add_u32 v228, v235, 3, v228
    s_lshl_b32 s29, s21, 13
    v_subrev_u32 v246, s29, v228
    s_lshl_b32 s29, s21, 11
    v_add_u32 v246, s29, v246
    s_lshl_b32 s29, s20, 11
    v_lshlrev_b32 v241, 2, v237
    v_add_u32 v241, s29, v241
    v_add_u32 v241, 32768, v241
    v_mul_f32 v233, 0x3c800000, v238
    v_mul_f32 v234, 0x41000000, v239
    v_mul_f32 v234, v234, v233
    v_mul_f32 v235, 0x42000000, v233
    v_add_f32 v235, v235, v234
    v_cos_f32 v242, v233
    v_sin_f32 v243, v233
    v_cos_f32 v148, v234
    v_sin_f32 v149, v234
    v_cos_f32 v164, v235
    v_sin_f32 v165, v235
  v_pk_mul_f32 v[150:151], v[148:149], v[242:243] op_sel:[0,0] op_sel_hi:[1,0]
  v_pk_mul_f32 v[166:167], v[164:165], v[242:243] op_sel:[0,0] op_sel_hi:[1,0]
  v_pk_fma_f32 v[150:151], v[148:149], v[242:243], v[150:151] op_sel:[1,1,0] op_sel_hi:[0,1,1] neg_lo:[1,0,0]
  v_pk_fma_f32 v[166:167], v[164:165], v[242:243], v[166:167] op_sel:[1,1,0] op_sel_hi:[0,1,1] neg_lo:[1,0,0]
  v_pk_mul_f32 v[152:153], v[150:151], v[242:243] op_sel:[0,0] op_sel_hi:[1,0]
  v_pk_mul_f32 v[168:169], v[166:167], v[242:243] op_sel:[0,0] op_sel_hi:[1,0]
  v_pk_fma_f32 v[152:153], v[150:151], v[242:243], v[152:153] op_sel:[1,1,0] op_sel_hi:[0,1,1] neg_lo:[1,0,0]
  v_pk_fma_f32 v[168:169], v[166:167], v[242:243], v[168:169] op_sel:[1,1,0] op_sel_hi:[0,1,1] neg_lo:[1,0,0]
  v_pk_mul_f32 v[154:155], v[152:153], v[242:243] op_sel:[0,0] op_sel_hi:[1,0]
  v_pk_mul_f32 v[170:171], v[168:169], v[242:243] op_sel:[0,0] op_sel_hi:[1,0]
  v_pk_fma_f32 v[154:155], v[152:153], v[242:243], v[154:155] op_sel:[1,1,0] op_sel_hi:[0,1,1] neg_lo:[1,0,0]
  v_pk_fma_f32 v[170:171], v[168:169], v[242:243], v[170:171] op_sel:[1,1,0] op_sel_hi:[0,1,1] neg_lo:[1,0,0]
  v_pk_mul_f32 v[156:157], v[154:155], v[242:243] op_sel:[0,0] op_sel_hi:[1,0]
  v_pk_mul_f32 v[172:173], v[170:171], v[242:243] op_sel:[0,0] op_sel_hi:[1,0]
  v_pk_fma_f32 v[156:157], v[154:155], v[242:243], v[156:157] op_sel:[1,1,0] op_sel_hi:[0,1,1] neg_lo:[1,0,0]
  v_pk_fma_f32 v[172:173], v[170:171], v[242:243], v[172:173] op_sel:[1,1,0] op_sel_hi:[0,1,1] neg_lo:[1,0,0]
  v_pk_mul_f32 v[158:159], v[156:157], v[242:243] op_sel:[0,0] op_sel_hi:[1,0]
  v_pk_mul_f32 v[174:175], v[172:173], v[242:243] op_sel:[0,0] op_sel_hi:[1,0]
  v_pk_fma_f32 v[158:159], v[156:157], v[242:243], v[158:159] op_sel:[1,1,0] op_sel_hi:[0,1,1] neg_lo:[1,0,0]
  v_pk_fma_f32 v[174:175], v[172:173], v[242:243], v[174:175] op_sel:[1,1,0] op_sel_hi:[0,1,1] neg_lo:[1,0,0]
  v_pk_mul_f32 v[160:161], v[158:159], v[242:243] op_sel:[0,0] op_sel_hi:[1,0]
  v_pk_mul_f32 v[176:177], v[174:175], v[242:243] op_sel:[0,0] op_sel_hi:[1,0]
  v_pk_fma_f32 v[160:161], v[158:159], v[242:243], v[160:161] op_sel:[1,1,0] op_sel_hi:[0,1,1] neg_lo:[1,0,0]
  v_pk_fma_f32 v[176:177], v[174:175], v[242:243], v[176:177] op_sel:[1,1,0] op_sel_hi:[0,1,1] neg_lo:[1,0,0]
  v_pk_mul_f32 v[162:163], v[160:161], v[242:243] op_sel:[0,0] op_sel_hi:[1,0]
  v_pk_mul_f32 v[178:179], v[176:177], v[242:243] op_sel:[0,0] op_sel_hi:[1,0]
  v_pk_fma_f32 v[162:163], v[160:161], v[242:243], v[162:163] op_sel:[1,1,0] op_sel_hi:[0,1,1] neg_lo:[1,0,0]
  v_pk_fma_f32 v[178:179], v[176:177], v[242:243], v[178:179] op_sel:[1,1,0] op_sel_hi:[0,1,1] neg_lo:[1,0,0]
  v_cvt_pk_bf16_f32 v36, v148, v150
  v_cvt_pk_bf16_f32 v44, v149, v151
  v_cvt_pk_bf16_f32 v37, v152, v154
  v_cvt_pk_bf16_f32 v45, v153, v155
  v_cvt_pk_bf16_f32 v38, v156, v158
  v_cvt_pk_bf16_f32 v46, v157, v159
  v_cvt_pk_bf16_f32 v39, v160, v162
  v_cvt_pk_bf16_f32 v47, v161, v163
  v_cvt_pk_bf16_f32 v40, v164, v166
  v_cvt_pk_bf16_f32 v48, v165, v167
  v_cvt_pk_bf16_f32 v41, v168, v170
  v_cvt_pk_bf16_f32 v49, v169, v171
  v_cvt_pk_bf16_f32 v42, v172, v174
  v_cvt_pk_bf16_f32 v50, v173, v175
  v_cvt_pk_bf16_f32 v43, v176, v178
  v_cvt_pk_bf16_f32 v51, v177, v179
  v_xor_b32 v52, 0x80008000, v44
  v_xor_b32 v53, 0x80008000, v45
  v_xor_b32 v54, 0x80008000, v46
  v_xor_b32 v55, 0x80008000, v47
  v_xor_b32 v56, 0x80008000, v48
  v_xor_b32 v57, 0x80008000, v49
  v_xor_b32 v58, 0x80008000, v50
  v_xor_b32 v59, 0x80008000, v51
    v_mul_f32 v233, 0x3a000000, v238
    v_mul_f32 v234, 4.0, v239
    v_mul_f32 v234, v234, v233
    v_mul_f32 v235, 0x41800000, v233
    v_add_f32 v235, v235, v234
  v_cos_f32 v84, v234
  v_sin_f32 v92, v234
  v_add_f32 v234, v234, v233
  v_cos_f32 v88, v235
  v_sin_f32 v96, v235
  v_add_f32 v235, v235, v233
  v_cos_f32 v85, v234
  v_sin_f32 v93, v234
  v_add_f32 v234, v234, v233
  v_cos_f32 v89, v235
  v_sin_f32 v97, v235
  v_add_f32 v235, v235, v233
  v_cos_f32 v86, v234
  v_sin_f32 v94, v234
  v_add_f32 v234, v234, v233
  v_cos_f32 v90, v235
  v_sin_f32 v98, v235
  v_add_f32 v235, v235, v233
  v_cos_f32 v87, v234
  v_sin_f32 v95, v234
  v_cos_f32 v91, v235
  v_sin_f32 v99, v235
  buffer_load_dwordx4 v[28:31], v231, s[8:11], s26 offen
  s_add_u32 s27, s26, 4096
  buffer_load_dwordx4 v[32:35], v231, s[8:11], s27 offen
  s_mov_b32 s29, 0x3ae38e39
  v_mov_b32 v233, 0x3727c5ac
  s_waitcnt vmcnt(4)
  v_fma_f32 v20, v20, s29, v233
  v_fma_f32 v21, v21, s29, v233
  v_fma_f32 v22, v22, s29, v233
  v_fma_f32 v23, v23, s29, v233
  v_rsq_f32 v20, v20
  v_rsq_f32 v21, v21
  v_rsq_f32 v22, v22
  v_rsq_f32 v23, v23
  s_waitcnt vmcnt(2)
  v_lshlrev_b32 v116, 16, v4
  v_and_b32 v120, 0xffff0000, v4
  v_lshlrev_b32 v117, 16, v6
  v_and_b32 v121, 0xffff0000, v6
  v_lshlrev_b32 v118, 16, v8
  v_and_b32 v122, 0xffff0000, v8
  v_lshlrev_b32 v119, 16, v10
  v_and_b32 v123, 0xffff0000, v10
  v_lshlrev_b32 v124, 16, v5
  v_and_b32 v128, 0xffff0000, v5
  v_lshlrev_b32 v125, 16, v7
  v_and_b32 v129, 0xffff0000, v7
  v_lshlrev_b32 v126, 16, v9
  v_and_b32 v130, 0xffff0000, v9
  v_lshlrev_b32 v127, 16, v11
  v_and_b32 v131, 0xffff0000, v11
  s_cmp_eq_u32 s21, 0
  s_cbranch_scc0 k2b_kernel_rb
  v_mov_b32 v132, v116
  v_mov_b32 v133, v117
  v_mov_b32 v134, v118
  v_mov_b32 v135, v119
  v_mov_b32 v136, v120
  v_mov_b32 v137, v121
  v_mov_b32 v138, v122
  v_mov_b32 v139, v123
  ds_write_b32 v241, v5 offset:0
  ds_write_b32 v241, v7 offset:256
  ds_write_b32 v241, v9 offset:512
  ds_write_b32 v241, v11 offset:768
  s_branch k2b_kernel_rd
k2b_kernel_rb:
  v_mov_b32 v140, v124
  v_mov_b32 v141, v125
  v_mov_b32 v142, v126
  v_mov_b32 v143, v127
  v_mov_b32 v144, v128
  v_mov_b32 v145, v129
  v_mov_b32 v146, v130
  v_mov_b32 v147, v131
  ds_write_b32 v241, v4 offset:1024
  ds_write_b32 v241, v6 offset:1280
  ds_write_b32 v241, v8 offset:1536
  ds_write_b32 v241, v10 offset:1792
k2b_kernel_rd:
  v_pk_mul_f32 v[116:117], v[116:117], v[20:21]
  v_pk_mul_f32 v[118:119], v[118:119], v[22:23]
  v_pk_mul_f32 v[120:121], v[120:121], v[20:21]
  v_pk_mul_f32 v[122:123], v[122:123], v[22:23]
  v_pk_mul_f32 v[124:125], v[124:125], v[20:21]
  v_pk_mul_f32 v[126:127], v[126:127], v[22:23]
  v_pk_mul_f32 v[128:129], v[128:129], v[20:21]
  v_pk_mul_f32 v[130:131], v[130:131], v[22:23]
  s_cmp_lg_u32 s2, 0
  s_cbranch_scc1 k2b_kernel_n0
  v_mov_b32 v116, v120
  v_mov_b32 v120, 0
  v_mov_b32 v117, v121
  v_mov_b32 v121, 0
  v_mov_b32 v118, v122
  v_mov_b32 v122, 0
  v_mov_b32 v119, v123
  v_mov_b32 v123, 0
k2b_kernel_n0:
  s_or_b32 s33, s2, s21
  v_cvt_pk_bf16_f32 v180, v116, v117
  v_cvt_pk_bf16_f32 v181, v118, v119
  ds_write_b64 v246, v[180:181] offset:0
  v_cvt_pk_bf16_f32 v182, v120, v121
  v_cvt_pk_bf16_f32 v183, v122, v123
  ds_write_b64 v246, v[182:183] offset:4096
  v_cvt_pk_bf16_f32 v184, v124, v125
  v_cvt_pk_bf16_f32 v185, v126, v127
  ds_write_b64 v246, v[184:185] offset:8192
  v_cvt_pk_bf16_f32 v186, v128, v129
  v_cvt_pk_bf16_f32 v187, v130, v131
  ds_write_b64 v246, v[186:187] offset:12288
            v_add_f32 v233, 0x0, v240
            v_mul_f32 v233, 0x3d000000, v233
            v_mul_f32 v234, 4.0, v239
            v_mul_f32 v234, v234, v233
            v_mul_f32 v235, 0x41800000, v233
            v_add_f32 v235, v235, v234
            v_cos_f32 v242, v233
            v_sin_f32 v243, v233
            v_cos_f32 v148, v234
            v_sin_f32 v149, v234
            v_cos_f32 v156, v235
            v_sin_f32 v157, v235
  v_pk_mul_f32 v[150:151], v[148:149], v[242:243] op_sel:[0,0] op_sel_hi:[1,0]
  v_pk_mul_f32 v[158:159], v[156:157], v[242:243] op_sel:[0,0] op_sel_hi:[1,0]
  v_pk_fma_f32 v[150:151], v[148:149], v[242:243], v[150:151] op_sel:[1,1,0] op_sel_hi:[0,1,1] neg_lo:[1,0,0]
  v_pk_fma_f32 v[158:159], v[156:157], v[242:243], v[158:159] op_sel:[1,1,0] op_sel_hi:[0,1,1] neg_lo:[1,0,0]
  v_pk_mul_f32 v[152:153], v[150:151], v[242:243] op_sel:[0,0] op_sel_hi:[1,0]
  v_pk_mul_f32 v[160:161], v[158:159], v[242:243] op_sel:[0,0] op_sel_hi:[1,0]
  v_pk_fma_f32 v[152:153], v[150:151], v[242:243], v[152:153] op_sel:[1,1,0] op_sel_hi:[0,1,1] neg_lo:[1,0,0]
  v_pk_fma_f32 v[160:161], v[158:159], v[242:243], v[160:161] op_sel:[1,1,0] op_sel_hi:[0,1,1] neg_lo:[1,0,0]
  v_pk_mul_f32 v[154:155], v[152:153], v[242:243] op_sel:[0,0] op_sel_hi:[1,0]
  v_pk_mul_f32 v[162:163], v[160:161], v[242:243] op_sel:[0,0] op_sel_hi:[1,0]
  v_pk_fma_f32 v[154:155], v[152:153], v[242:243], v[154:155] op_sel:[1,1,0] op_sel_hi:[0,1,1] neg_lo:[1,0,0]
  v_pk_fma_f32 v[162:163], v[160:161], v[242:243], v[162:163] op_sel:[1,1,0] op_sel_hi:[0,1,1] neg_lo:[1,0,0]
            v_add_f32 v233, 0x41800000, v240
            v_mul_f32 v233, 0x3d000000, v233
            v_mul_f32 v234, 4.0, v239
            v_mul_f32 v234, v234, v233
            v_mul_f32 v235, 0x41800000, v233
            v_add_f32 v235, v235, v234
            v_cos_f32 v244, v233
            v_sin_f32 v245, v233
            v_cos_f32 v164, v234
            v_sin_f32 v165, v234
            v_cos_f32 v172, v235
            v_sin_f32 v173, v235
  v_pk_mul_f32 v[166:167], v[164:165], v[244:245] op_sel:[0,0] op_sel_hi:[1,0]
  v_pk_mul_f32 v[174:175], v[172:173], v[244:245] op_sel:[0,0] op_sel_hi:[1,0]
  v_pk_fma_f32 v[166:167], v[164:165], v[244:245], v[166:167] op_sel:[1,1,0] op_sel_hi:[0,1,1] neg_lo:[1,0,0]
  v_pk_fma_f32 v[174:175], v[172:173], v[244:245], v[174:175] op_sel:[1,1,0] op_sel_hi:[0,1,1] neg_lo:[1,0,0]
  v_pk_mul_f32 v[168:169], v[166:167], v[244:245] op_sel:[0,0] op_sel_hi:[1,0]
  v_pk_mul_f32 v[176:177], v[174:175], v[244:245] op_sel:[0,0] op_sel_hi:[1,0]
  v_pk_fma_f32 v[168:169], v[166:167], v[244:245], v[168:169] op_sel:[1,1,0] op_sel_hi:[0,1,1] neg_lo:[1,0,0]
  v_pk_fma_f32 v[176:177], v[174:175], v[244:245], v[176:177] op_sel:[1,1,0] op_sel_hi:[0,1,1] neg_lo:[1,0,0]
  v_pk_mul_f32 v[170:171], v[168:169], v[244:245] op_sel:[0,0] op_sel_hi:[1,0]
  v_pk_mul_f32 v[178:179], v[176:177], v[244:245] op_sel:[0,0] op_sel_hi:[1,0]
  v_pk_fma_f32 v[170:171], v[168:169], v[244:245], v[170:171] op_sel:[1,1,0] op_sel_hi:[0,1,1] neg_lo:[1,0,0]
  v_pk_fma_f32 v[178:179], v[176:177], v[244:245], v[178:179] op_sel:[1,1,0] op_sel_hi:[0,1,1] neg_lo:[1,0,0]
  v_cvt_pk_bf16_f32 v60, v148, v150
  v_cvt_pk_bf16_f32 v68, v149, v151
  v_cvt_pk_bf16_f32 v61, v152, v154
  v_cvt_pk_bf16_f32 v69, v153, v155
  v_cvt_pk_bf16_f32 v62, v156, v158
  v_cvt_pk_bf16_f32 v70, v157, v159
  v_cvt_pk_bf16_f32 v63, v160, v162
  v_cvt_pk_bf16_f32 v71, v161, v163
  v_cvt_pk_bf16_f32 v64, v164, v166
  v_cvt_pk_bf16_f32 v72, v165, v167
  v_cvt_pk_bf16_f32 v65, v168, v170
  v_cvt_pk_bf16_f32 v73, v169, v171
  v_cvt_pk_bf16_f32 v66, v172, v174
  v_cvt_pk_bf16_f32 v74, v173, v175
  v_cvt_pk_bf16_f32 v67, v176, v178
  v_cvt_pk_bf16_f32 v75, v177, v179
  v_xor_b32 v76, 0x80008000, v68
  v_xor_b32 v77, 0x80008000, v69
  v_xor_b32 v78, 0x80008000, v70
  v_xor_b32 v79, 0x80008000, v71
  v_xor_b32 v80, 0x80008000, v72
  v_xor_b32 v81, 0x80008000, v73
  v_xor_b32 v82, 0x80008000, v74
  v_xor_b32 v83, 0x80008000, v75
  s_waitcnt lgkmcnt(0)
  s_barrier
  ds_read_b128 v[148:151], v229 offset:0
  ds_read_b128 v[152:155], v229 offset:4096
  ds_read_b128 v[156:159], v230 offset:0
  ds_read_b128 v[160:163], v230 offset:4096
  ds_read_b128 v[164:167], v229 offset:2048
  ds_read_b128 v[168:171], v229 offset:6144
  ds_read_b128 v[172:175], v230 offset:2048
  ds_read_b128 v[176:179], v230 offset:6144
  s_cmp_eq_u32 s21, 0
  s_cbranch_scc0 k2b_kernel_xr1
  ds_read_b32 v220, v241 offset:1024
  ds_read_b32 v221, v241 offset:1280
  ds_read_b32 v222, v241 offset:1536
  ds_read_b32 v223, v241 offset:1792
  s_branch k2b_kernel_xr2
k2b_kernel_xr1:
  ds_read_b32 v220, v241 offset:0
  ds_read_b32 v221, v241 offset:256
  ds_read_b32 v222, v241 offset:512
  ds_read_b32 v223, v241 offset:768
k2b_kernel_xr2:
  s_mov_b32 s30, 0x3a000000
  s_mov_b32 s31, 0x3a000000
  v_cvt_f32_u32 v236, s28
  v_fma_f32 v236, v239, 4.0, v236
  v_add_f32 v233, 0x0, v240
  v_mul_f32 v233, 0x3a000000, v233
  v_mul_f32 v234, v233, v236
  v_add_f32 v232, 0x41800000, v240
  v_mul_f32 v232, 0x3a000000, v232
  v_mul_f32 v235, v232, v236
  v_cos_f32 v100, v234
  v_sin_f32 v108, v234
  v_add_f32 v234, v234, v233
  v_cos_f32 v104, v235
  s_waitcnt lgkmcnt(0)
  v_mfma_f32_16x16x32_bf16 v[116:119], v[148:151], v[36:39], 0
  v_sin_f32 v112, v235
  v_add_f32 v235, v235, v232
  v_mfma_f32_16x16x32_bf16 v[120:123], v[152:155], v[36:39], 0
  v_cos_f32 v101, v234
  v_sin_f32 v109, v234
  v_mfma_f32_16x16x32_bf16 v[116:119], v[152:155], v[44:47], v[116:119]
  v_add_f32 v234, v234, v233
  v_cos_f32 v105, v235
  v_mfma_f32_16x16x32_bf16 v[120:123], v[148:151], v[52:55], v[120:123]
  v_sin_f32 v113, v235
  v_add_f32 v235, v235, v232
  v_mfma_f32_16x16x32_bf16 v[116:119], v[156:159], v[40:43], v[116:119]
  v_cos_f32 v102, v234
  v_sin_f32 v110, v234
  v_mfma_f32_16x16x32_bf16 v[120:123], v[160:163], v[40:43], v[120:123]
  v_add_f32 v234, v234, v233
  v_cos_f32 v106, v235
  v_mfma_f32_16x16x32_bf16 v[116:119], v[160:163], v[48:51], v[116:119]
  v_sin_f32 v114, v235
  v_add_f32 v235, v235, v232
  v_mfma_f32_16x16x32_bf16 v[120:123], v[156:159], v[56:59], v[120:123]
  v_cos_f32 v103, v234
  v_sin_f32 v111, v234
  v_cos_f32 v107, v235
  v_mfma_f32_16x16x32_bf16 v[124:127], v[164:167], v[36:39], 0
  v_sin_f32 v115, v235
  v_mul_f32 v100, s30, v100
  v_mfma_f32_16x16x32_bf16 v[128:131], v[168:171], v[36:39], 0
  v_mul_f32 v108, s30, v108
  v_mul_f32 v101, s30, v101
  v_mfma_f32_16x16x32_bf16 v[124:127], v[168:171], v[44:47], v[124:127]
  v_mul_f32 v109, s30, v109
  v_mul_f32 v102, s30, v102
  v_mfma_f32_16x16x32_bf16 v[128:131], v[164:167], v[52:55], v[128:131]
  v_mul_f32 v110, s30, v110
  v_mul_f32 v103, s30, v103
  v_mfma_f32_16x16x32_bf16 v[124:127], v[172:175], v[40:43], v[124:127]
  v_mul_f32 v111, s30, v111
  v_mul_f32 v104, s30, v104
  v_mfma_f32_16x16x32_bf16 v[128:131], v[176:179], v[40:43], v[128:131]
  v_mul_f32 v112, s30, v112
  v_mul_f32 v105, s30, v105
  v_mfma_f32_16x16x32_bf16 v[124:127], v[176:179], v[48:51], v[124:127]
  v_mul_f32 v113, s30, v113
  v_mul_f32 v106, s30, v106
  v_mfma_f32_16x16x32_bf16 v[128:131], v[172:175], v[56:59], v[128:131]
  v_mul_f32 v114, s30, v114
  v_mul_f32 v107, s30, v107
  v_mul_f32 v115, s30, v115
  s_cmp_eq_u32 s21, 0
  s_cbranch_scc0 k2b_kernel_xu1
  v_lshlrev_b32 v140, 16, v220
  v_and_b32 v144, 0xffff0000, v220
  v_lshlrev_b32 v141, 16, v221
  v_and_b32 v145, 0xffff0000, v221
  v_lshlrev_b32 v142, 16, v222
  v_and_b32 v146, 0xffff0000, v222
  v_lshlrev_b32 v143, 16, v223
  v_and_b32 v147, 0xffff0000, v223
  s_branch k2b_kernel_xu2
k2b_kernel_xu1:
  v_lshlrev_b32 v132, 16, v220
  v_and_b32 v136, 0xffff0000, v220
  v_lshlrev_b32 v133, 16, v221
  v_and_b32 v137, 0xffff0000, v221
  v_lshlrev_b32 v134, 16, v222
  v_and_b32 v138, 0xffff0000, v222
  v_lshlrev_b32 v135, 16, v223
  v_and_b32 v139, 0xffff0000, v223
k2b_kernel_xu2:
  v_pk_mul_f32 v[180:181], v[116:117], v[84:85]
  v_pk_mul_f32 v[182:183], v[120:121], v[84:85]
  v_pk_mul_f32 v[184:185], v[118:119], v[86:87]
  v_pk_mul_f32 v[186:187], v[122:123], v[86:87]
  v_pk_mul_f32 v[188:189], v[124:125], v[88:89]
  v_pk_mul_f32 v[190:191], v[128:129], v[88:89]
  v_pk_mul_f32 v[192:193], v[126:127], v[90:91]
  v_pk_mul_f32 v[194:195], v[130:131], v[90:91]
  v_pk_fma_f32 v[180:181], v[120:121], v[92:93], v[180:181]
  v_pk_fma_f32 v[182:183], v[116:117], v[92:93], v[182:183] neg_lo:[0,1,0] neg_hi:[0,1,0]
  v_pk_fma_f32 v[184:185], v[122:123], v[94:95], v[184:185]
  v_pk_fma_f32 v[186:187], v[118:119], v[94:95], v[186:187] neg_lo:[0,1,0] neg_hi:[0,1,0]
  v_pk_fma_f32 v[188:189], v[128:129], v[96:97], v[188:189]
  v_pk_fma_f32 v[190:191], v[124:125], v[96:97], v[190:191] neg_lo:[0,1,0] neg_hi:[0,1,0]
  v_pk_fma_f32 v[192:193], v[130:131], v[98:99], v[192:193]
  v_pk_fma_f32 v[194:195], v[126:127], v[98:99], v[194:195] neg_lo:[0,1,0] neg_hi:[0,1,0]
  v_cvt_pk_bf16_f32 v196, v180, v181
  v_cvt_pk_bf16_f32 v200, v182, v183
  v_cvt_pk_bf16_f32 v197, v184, v185
  v_cvt_pk_bf16_f32 v201, v186, v187
  v_cvt_pk_bf16_f32 v198, v188, v189
  v_cvt_pk_bf16_f32 v202, v190, v191
  v_cvt_pk_bf16_f32 v199, v192, v193
  v_cvt_pk_bf16_f32 v203, v194, v195
  s_waitcnt vmcnt(0)
  v_mfma_f32_16x16x32_bf16 v[116:119], v[60:63], v[196:199], 0
  v_lshlrev_b32 v204, 16, v28
  v_and_b32 v212, 0xffff0000, v28
  v_mfma_f32_16x16x32_bf16 v[120:123], v[60:63], v[200:203], 0
  v_lshlrev_b32 v205, 16, v29
  v_and_b32 v213, 0xffff0000, v29
  v_mfma_f32_16x16x32_bf16 v[116:119], v[68:71], v[200:203], v[116:119]
  v_lshlrev_b32 v206, 16, v30
  v_and_b32 v214, 0xffff0000, v30
  v_mfma_f32_16x16x32_bf16 v[120:123], v[76:79], v[196:199], v[120:123]
  v_lshlrev_b32 v207, 16, v31
  v_and_b32 v215, 0xffff0000, v31
  v_mfma_f32_16x16x32_bf16 v[124:127], v[64:67], v[196:199], 0
  v_lshlrev_b32 v208, 16, v32
  v_and_b32 v216, 0xffff0000, v32
  v_mfma_f32_16x16x32_bf16 v[128:131], v[64:67], v[200:203], 0
  v_lshlrev_b32 v209, 16, v33
  v_and_b32 v217, 0xffff0000, v33
  v_mfma_f32_16x16x32_bf16 v[124:127], v[72:75], v[200:203], v[124:127]
  v_lshlrev_b32 v210, 16, v34
  v_and_b32 v218, 0xffff0000, v34
  v_mfma_f32_16x16x32_bf16 v[128:131], v[80:83], v[196:199], v[128:131]
  v_lshlrev_b32 v211, 16, v35
  v_and_b32 v219, 0xffff0000, v35
  v_pk_mul_f32 v[180:181], v[116:117], v[204:205]
  v_pk_mul_f32 v[182:183], v[120:121], v[204:205]
  v_pk_mul_f32 v[184:185], v[118:119], v[206:207]
  v_pk_mul_f32 v[186:187], v[122:123], v[206:207]
  v_pk_mul_f32 v[188:189], v[124:125], v[208:209]
  s_nop 0
  v_pk_mul_f32 v[190:191], v[128:129], v[208:209]
  v_pk_mul_f32 v[192:193], v[126:127], v[210:211]
  v_pk_mul_f32 v[194:195], v[130:131], v[210:211]
  v_pk_fma_f32 v[180:181], v[120:121], v[212:213], v[180:181] neg_lo:[0,1,0] neg_hi:[0,1,0]
  v_pk_fma_f32 v[182:183], v[116:117], v[212:213], v[182:183]
  v_pk_fma_f32 v[184:185], v[122:123], v[214:215], v[184:185] neg_lo:[0,1,0] neg_hi:[0,1,0]
  v_pk_fma_f32 v[186:187], v[118:119], v[214:215], v[186:187]
  v_pk_fma_f32 v[188:189], v[128:129], v[216:217], v[188:189] neg_lo:[0,1,0] neg_hi:[0,1,0]
  v_pk_fma_f32 v[190:191], v[124:125], v[216:217], v[190:191]
  v_pk_fma_f32 v[192:193], v[130:131], v[218:219], v[192:193] neg_lo:[0,1,0] neg_hi:[0,1,0]
  v_pk_fma_f32 v[194:195], v[126:127], v[218:219], v[194:195]
  v_cvt_pk_bf16_f32 v196, v180, v181
  v_cvt_pk_bf16_f32 v200, v182, v183
  v_cvt_pk_bf16_f32 v197, v184, v185
  v_cvt_pk_bf16_f32 v201, v186, v187
  v_cvt_pk_bf16_f32 v198, v188, v189
  v_cvt_pk_bf16_f32 v202, v190, v191
  v_cvt_pk_bf16_f32 v199, v192, v193
  v_cvt_pk_bf16_f32 v203, v194, v195
  s_nop 0
  v_mfma_f32_16x16x32_bf16 v[116:119], v[196:199], v[60:63], 0
  v_mfma_f32_16x16x32_bf16 v[120:123], v[200:203], v[60:63], 0
  v_mfma_f32_16x16x32_bf16 v[116:119], v[200:203], v[76:79], v[116:119]
  v_mfma_f32_16x16x32_bf16 v[120:123], v[196:199], v[68:71], v[120:123]
  v_mfma_f32_16x16x32_bf16 v[124:127], v[196:199], v[64:67], 0
  v_mfma_f32_16x16x32_bf16 v[128:131], v[200:203], v[64:67], 0
  v_mfma_f32_16x16x32_bf16 v[124:127], v[200:203], v[80:83], v[124:127]
  v_mfma_f32_16x16x32_bf16 v[128:131], v[196:199], v[72:75], v[128:131]
  s_nop 2
  v_pk_mul_f32 v[180:181], v[116:117], v[100:101]
  v_pk_mul_f32 v[182:183], v[120:121], v[100:101]
  v_pk_mul_f32 v[184:185], v[118:119], v[102:103]
  v_pk_mul_f32 v[186:187], v[122:123], v[102:103]
  v_pk_mul_f32 v[188:189], v[124:125], v[104:105]
  v_pk_mul_f32 v[190:191], v[128:129], v[104:105]
  v_pk_mul_f32 v[192:193], v[126:127], v[106:107]
  v_pk_mul_f32 v[194:195], v[130:131], v[106:107]
  v_pk_fma_f32 v[180:181], v[120:121], v[108:109], v[180:181] neg_lo:[0,1,0] neg_hi:[0,1,0]
  v_pk_fma_f32 v[182:183], v[116:117], v[108:109], v[182:183]
  v_pk_fma_f32 v[184:185], v[122:123], v[110:111], v[184:185] neg_lo:[0,1,0] neg_hi:[0,1,0]
  v_pk_fma_f32 v[186:187], v[118:119], v[110:111], v[186:187]
  v_pk_fma_f32 v[188:189], v[128:129], v[112:113], v[188:189] neg_lo:[0,1,0] neg_hi:[0,1,0]
  v_pk_fma_f32 v[190:191], v[124:125], v[112:113], v[190:191]
  v_pk_fma_f32 v[192:193], v[130:131], v[114:115], v[192:193] neg_lo:[0,1,0] neg_hi:[0,1,0]
  v_pk_fma_f32 v[194:195], v[126:127], v[114:115], v[194:195]
  v_cvt_pk_bf16_f32 v196, v180, v181
  v_cvt_pk_bf16_f32 v200, v182, v183
  v_cvt_pk_bf16_f32 v197, v184, v185
  v_cvt_pk_bf16_f32 v201, v186, v187
  v_cvt_pk_bf16_f32 v198, v188, v189
  v_cvt_pk_bf16_f32 v202, v190, v191
  v_cvt_pk_bf16_f32 v199, v192, v193
  v_cvt_pk_bf16_f32 v203, v194, v195
  ds_write_b64 v228, v[196:197] offset:16384
  ds_write_b64 v228, v[198:199] offset:18432
  ds_write_b64 v228, v[200:201] offset:20480
  ds_write_b64 v228, v[202:203] offset:22528
  s_waitcnt lgkmcnt(0)
  s_barrier
  ds_read_b128 v[148:151], v229 offset:16384
  ds_read_b128 v[152:155], v229 offset:20480
  ds_read_b128 v[156:159], v230 offset:16384
  ds_read_b128 v[160:163], v230 offset:20480
  ds_read_b128 v[164:167], v229 offset:18432
  ds_read_b128 v[168:171], v229 offset:22528
  ds_read_b128 v[172:175], v230 offset:18432
  ds_read_b128 v[176:179], v230 offset:22528
  s_waitcnt lgkmcnt(0)
  s_cmp_lg_u32 s33, 0
  s_cbranch_scc1 k2b_kernel_f0
  v_mfma_f32_16x16x32_bf16 v[136:139], v[36:39], v[148:151], v[136:139]
  v_mfma_f32_16x16x32_bf16 v[136:139], v[52:55], v[152:155], v[136:139]
  v_mfma_f32_16x16x32_bf16 v[136:139], v[40:43], v[156:159], v[136:139]
  v_mfma_f32_16x16x32_bf16 v[136:139], v[56:59], v[160:163], v[136:139]
  v_mfma_f32_16x16x32_bf16 v[144:147], v[36:39], v[164:167], v[144:147]
  v_mfma_f32_16x16x32_bf16 v[144:147], v[52:55], v[168:171], v[144:147]
  v_mfma_f32_16x16x32_bf16 v[144:147], v[40:43], v[172:175], v[144:147]
  v_mfma_f32_16x16x32_bf16 v[144:147], v[56:59], v[176:179], v[144:147]
  s_branch k2b_kernel_f1
k2b_kernel_f0:
  v_mfma_f32_16x16x32_bf16 v[132:135], v[36:39], v[148:151], v[132:135]
  v_mfma_f32_16x16x32_bf16 v[136:139], v[36:39], v[152:155], v[136:139]
  v_mfma_f32_16x16x32_bf16 v[132:135], v[52:55], v[152:155], v[132:135]
  v_mfma_f32_16x16x32_bf16 v[136:139], v[44:47], v[148:151], v[136:139]
  v_mfma_f32_16x16x32_bf16 v[132:135], v[40:43], v[156:159], v[132:135]
  v_mfma_f32_16x16x32_bf16 v[136:139], v[40:43], v[160:163], v[136:139]
  v_mfma_f32_16x16x32_bf16 v[132:135], v[56:59], v[160:163], v[132:135]
  v_mfma_f32_16x16x32_bf16 v[136:139], v[48:51], v[156:159], v[136:139]
  v_mfma_f32_16x16x32_bf16 v[140:143], v[36:39], v[164:167], v[140:143]
  v_mfma_f32_16x16x32_bf16 v[144:147], v[36:39], v[168:171], v[144:147]
  v_mfma_f32_16x16x32_bf16 v[140:143], v[52:55], v[168:171], v[140:143]
  v_mfma_f32_16x16x32_bf16 v[144:147], v[44:47], v[164:167], v[144:147]
  v_mfma_f32_16x16x32_bf16 v[140:143], v[40:43], v[172:175], v[140:143]
  v_mfma_f32_16x16x32_bf16 v[144:147], v[40:43], v[176:179], v[144:147]
  v_mfma_f32_16x16x32_bf16 v[140:143], v[56:59], v[176:179], v[140:143]
  v_mfma_f32_16x16x32_bf16 v[144:147], v[48:51], v[172:175], v[144:147]
k2b_kernel_f1:
  s_nop 7
  v_cvt_pk_bf16_f32 v220, v132, v136
  v_cvt_pk_bf16_f32 v221, v133, v137
  v_cvt_pk_bf16_f32 v222, v134, v138
  v_cvt_pk_bf16_f32 v223, v135, v139
  v_cvt_pk_bf16_f32 v224, v140, v144
  v_cvt_pk_bf16_f32 v225, v141, v145
  v_cvt_pk_bf16_f32 v226, v142, v146
  v_cvt_pk_bf16_f32 v227, v143, v147
  s_cmp_eq_u32 s21, 0
  s_cbranch_scc0 k2b_kernel_xb
  ds_write_b32 v241, v224 offset:0
  ds_write_b32 v241, v225 offset:256
  ds_write_b32 v241, v226 offset:512
  ds_write_b32 v241, v227 offset:768
  v_mov_b32 v148, v220
  v_mov_b32 v150, v221
  v_mov_b32 v152, v222
  v_mov_b32 v154, v223
  s_waitcnt lgkmcnt(0)
  s_barrier
  ds_read_b32 v149, v241 offset:1024
  ds_read_b32 v151, v241 offset:1280
  ds_read_b32 v153, v241 offset:1536
  ds_read_b32 v155, v241 offset:1792
  s_branch k2b_kernel_xs
k2b_kernel_xb:
  ds_write_b32 v241, v220 offset:1024
  ds_write_b32 v241, v221 offset:1280
  ds_write_b32 v241, v222 offset:1536
  ds_write_b32 v241, v223 offset:1792
  v_mov_b32 v149, v224
  v_mov_b32 v151, v225
  v_mov_b32 v153, v226
  v_mov_b32 v155, v227
  s_waitcnt lgkmcnt(0)
  s_barrier
  ds_read_b32 v148, v241 offset:0
  ds_read_b32 v150, v241 offset:256
  ds_read_b32 v152, v241 offset:512
  ds_read_b32 v154, v241 offset:768
  s_add_u32 s24, s24, 2048
k2b_kernel_xs:
  s_waitcnt lgkmcnt(0)
  buffer_store_dwordx4 v[148:151], v231, s[8:11], s24 offen offset:0 sc1
  buffer_store_dwordx4 v[152:155], v231, s[8:11], s24 offen offset:1024 sc1
  s_waitcnt vmcnt(0)
  s_branch k2b_kernel_fin
k2b_kernel_extra:
    s_waitcnt lgkmcnt(0)
    s_mov_b32 s8, s4
    s_mov_b32 s9, s5
    s_mov_b32 s10, 0x10000000
    s_mov_b32 s11, 0x20000
  v_cmp_gt_u32 vcc, 256, v0
  s_nop 3
  s_cbranch_vccz k2b_kernel_end
    s_load_dwordx2 s[46:47], s[0:1], 56
    s_sub_u32 s21, s2, 144
    s_mov_b32 s40, 0
    s_cmp_lt_u32 s21, 54
    s_cbranch_scc1 k2b_kernel_sty
    s_sub_u32 s21, s21, 54
    s_mov_b32 s40, 1
k2b_kernel_sty:
    s_mul_i32 s21, s21, 768
    s_waitcnt lgkmcnt(0)
    s_mov_b32 s12, s46
    s_mov_b32 s13, s47
    s_mov_b32 s14, 663552
    s_mov_b32 s15, 0x20000
    s_cmp_eq_u32 s40, 1
    s_cbranch_scc1 k2b_kernel_swot
  s_add_u32 s34, s21, 0
  v_add_u32 v9, s34, v0
  s_mov_b32 s3, 58255
  v_mul_u32_u24 v10, s3, v9
  v_lshrrev_b32 v10, 25, v10
  v_mul_u32_u24 v11, 576, v10
  v_sub_u32 v11, v9, v11
  v_lshlrev_b32 v9, 4, v9
        v_cvt_f32_u32 v11, v11
        v_lshrrev_b32 v4, 1, v10
        v_lshlrev_b32 v4, 4, v4
        v_and_b32 v5, 1, v10
        v_lshl_add_u32 v8, v5, 2, v4
  v_add_u32 v15, 0, v8
    v_lshrrev_b32 v4, 1, v15
    v_mov_b32 v5, 288
    v_cmp_eq_u32 vcc, 1, v15
  s_nop 1
    v_cndmask_b32 v4, v4, v5, vcc
    v_cvt_f32_u32 v12, v4
    v_mul_f32 v12, 0x3ae38e39, v12
    v_and_b32 v4, 1, v15
    v_cvt_f32_u32 v13, v4
    v_mul_f32 v13, 0x3e800000, v13
    v_mov_b32 v5, 0
    v_cndmask_b32 v13, v13, v5, vcc
    v_mov_b32 v14, 0x3d715bef
    v_mov_b32 v5, 0x3d2aaaab
    v_cmp_gt_u32 vcc, 2, v15
  s_nop 1
    v_cndmask_b32 v14, v14, v5, vcc
            v_fma_f32 v6, v11, v12, v13
            v_fract_f32 v6, v6
            v_cos_f32 v6, v6
            s_nop 0
            v_mul_f32 v16, v6, v14
  v_add_u32 v15, 1, v8
    v_lshrrev_b32 v4, 1, v15
    v_mov_b32 v5, 288
    v_cmp_eq_u32 vcc, 1, v15
  s_nop 1
    v_cndmask_b32 v4, v4, v5, vcc
    v_cvt_f32_u32 v12, v4
    v_mul_f32 v12, 0x3ae38e39, v12
    v_and_b32 v4, 1, v15
    v_cvt_f32_u32 v13, v4
    v_mul_f32 v13, 0x3e800000, v13
    v_mov_b32 v5, 0
    v_cndmask_b32 v13, v13, v5, vcc
    v_mov_b32 v14, 0x3d715bef
    v_mov_b32 v5, 0x3d2aaaab
    v_cmp_gt_u32 vcc, 2, v15
  s_nop 1
    v_cndmask_b32 v14, v14, v5, vcc
            v_fma_f32 v6, v11, v12, v13
            v_fract_f32 v6, v6
            v_cos_f32 v6, v6
            s_nop 0
            v_mul_f32 v17, v6, v14
  v_add_u32 v15, 2, v8
    v_lshrrev_b32 v4, 1, v15
    v_mov_b32 v5, 288
    v_cmp_eq_u32 vcc, 1, v15
  s_nop 1
    v_cndmask_b32 v4, v4, v5, vcc
    v_cvt_f32_u32 v12, v4
    v_mul_f32 v12, 0x3ae38e39, v12
    v_and_b32 v4, 1, v15
    v_cvt_f32_u32 v13, v4
    v_mul_f32 v13, 0x3e800000, v13
    v_mov_b32 v5, 0
    v_cndmask_b32 v13, v13, v5, vcc
    v_mov_b32 v14, 0x3d715bef
    v_mov_b32 v5, 0x3d2aaaab
    v_cmp_gt_u32 vcc, 2, v15
  s_nop 1
    v_cndmask_b32 v14, v14, v5, vcc
            v_fma_f32 v6, v11, v12, v13
            v_fract_f32 v6, v6
            v_cos_f32 v6, v6
            s_nop 0
            v_mul_f32 v18, v6, v14
  v_add_u32 v15, 3, v8
    v_lshrrev_b32 v4, 1, v15
    v_mov_b32 v5, 288
    v_cmp_eq_u32 vcc, 1, v15
  s_nop 1
    v_cndmask_b32 v4, v4, v5, vcc
    v_cvt_f32_u32 v12, v4
    v_mul_f32 v12, 0x3ae38e39, v12
    v_and_b32 v4, 1, v15
    v_cvt_f32_u32 v13, v4
    v_mul_f32 v13, 0x3e800000, v13
    v_mov_b32 v5, 0
    v_cndmask_b32 v13, v13, v5, vcc
    v_mov_b32 v14, 0x3d715bef
    v_mov_b32 v5, 0x3d2aaaab
    v_cmp_gt_u32 vcc, 2, v15
  s_nop 1
    v_cndmask_b32 v14, v14, v5, vcc
            v_fma_f32 v6, v11, v12, v13
            v_fract_f32 v6, v6
            v_cos_f32 v6, v6
            s_nop 0
            v_mul_f32 v19, v6, v14
  v_add_u32 v15, 8, v8
    v_lshrrev_b32 v4, 1, v15
    v_mov_b32 v5, 288
    v_cmp_eq_u32 vcc, 1, v15
  s_nop 1
    v_cndmask_b32 v4, v4, v5, vcc
    v_cvt_f32_u32 v12, v4
    v_mul_f32 v12, 0x3ae38e39, v12
    v_and_b32 v4, 1, v15
    v_cvt_f32_u32 v13, v4
    v_mul_f32 v13, 0x3e800000, v13
    v_mov_b32 v5, 0
    v_cndmask_b32 v13, v13, v5, vcc
    v_mov_b32 v14, 0x3d715bef
    v_mov_b32 v5, 0x3d2aaaab
    v_cmp_gt_u32 vcc, 2, v15
  s_nop 1
    v_cndmask_b32 v14, v14, v5, vcc
            v_fma_f32 v6, v11, v12, v13
            v_fract_f32 v6, v6
            v_cos_f32 v6, v6
            s_nop 0
            v_mul_f32 v20, v6, v14
  v_add_u32 v15, 9, v8
    v_lshrrev_b32 v4, 1, v15
    v_mov_b32 v5, 288
    v_cmp_eq_u32 vcc, 1, v15
  s_nop 1
    v_cndmask_b32 v4, v4, v5, vcc
    v_cvt_f32_u32 v12, v4
    v_mul_f32 v12, 0x3ae38e39, v12
    v_and_b32 v4, 1, v15
    v_cvt_f32_u32 v13, v4
    v_mul_f32 v13, 0x3e800000, v13
    v_mov_b32 v5, 0
    v_cndmask_b32 v13, v13, v5, vcc
    v_mov_b32 v14, 0x3d715bef
    v_mov_b32 v5, 0x3d2aaaab
    v_cmp_gt_u32 vcc, 2, v15
  s_nop 1
    v_cndmask_b32 v14, v14, v5, vcc
            v_fma_f32 v6, v11, v12, v13
            v_fract_f32 v6, v6
            v_cos_f32 v6, v6
            s_nop 0
            v_mul_f32 v21, v6, v14
  v_add_u32 v15, 10, v8
    v_lshrrev_b32 v4, 1, v15
    v_mov_b32 v5, 288
    v_cmp_eq_u32 vcc, 1, v15
  s_nop 1
    v_cndmask_b32 v4, v4, v5, vcc
    v_cvt_f32_u32 v12, v4
    v_mul_f32 v12, 0x3ae38e39, v12
    v_and_b32 v4, 1, v15
    v_cvt_f32_u32 v13, v4
    v_mul_f32 v13, 0x3e800000, v13
    v_mov_b32 v5, 0
    v_cndmask_b32 v13, v13, v5, vcc
    v_mov_b32 v14, 0x3d715bef
    v_mov_b32 v5, 0x3d2aaaab
    v_cmp_gt_u32 vcc, 2, v15
  s_nop 1
    v_cndmask_b32 v14, v14, v5, vcc
            v_fma_f32 v6, v11, v12, v13
            v_fract_f32 v6, v6
            v_cos_f32 v6, v6
            s_nop 0
            v_mul_f32 v22, v6, v14
  v_add_u32 v15, 11, v8
    v_lshrrev_b32 v4, 1, v15
    v_mov_b32 v5, 288
    v_cmp_eq_u32 vcc, 1, v15
  s_nop 1
    v_cndmask_b32 v4, v4, v5, vcc
    v_cvt_f32_u32 v12, v4
    v_mul_f32 v12, 0x3ae38e39, v12
    v_and_b32 v4, 1, v15
    v_cvt_f32_u32 v13, v4
    v_mul_f32 v13, 0x3e800000, v13
    v_mov_b32 v5, 0
    v_cndmask_b32 v13, v13, v5, vcc
    v_mov_b32 v14, 0x3d715bef
    v_mov_b32 v5, 0x3d2aaaab
    v_cmp_gt_u32 vcc, 2, v15
  s_nop 1
    v_cndmask_b32 v14, v14, v5, vcc
            v_fma_f32 v6, v11, v12, v13
            v_fract_f32 v6, v6
            v_cos_f32 v6, v6
            s_nop 0
            v_mul_f32 v23, v6, v14
  v_cvt_pk_bf16_f32 v24, v16, v17
  v_cvt_pk_bf16_f32 v25, v18, v19
  v_cvt_pk_bf16_f32 v26, v20, v21
  v_cvt_pk_bf16_f32 v27, v22, v23
  s_mov_b32 s34, 12836864
  buffer_store_dwordx4 v[24:27], v9, s[8:11], s34 offen sc1
  s_add_u32 s34, s21, 256
  s_nop 0
  v_add_u32 v9, s34, v0
  s_mov_b32 s3, 58255
  v_mul_u32_u24 v10, s3, v9
  v_lshrrev_b32 v10, 25, v10
  v_mul_u32_u24 v11, 576, v10
  v_sub_u32 v11, v9, v11
  v_lshlrev_b32 v9, 4, v9
        v_cvt_f32_u32 v11, v11
        v_lshrrev_b32 v4, 1, v10
        v_lshlrev_b32 v4, 4, v4
        v_and_b32 v5, 1, v10
        v_lshl_add_u32 v8, v5, 2, v4
  v_add_u32 v15, 0, v8
    v_lshrrev_b32 v4, 1, v15
    v_mov_b32 v5, 288
    v_cmp_eq_u32 vcc, 1, v15
  s_nop 1
    v_cndmask_b32 v4, v4, v5, vcc
    v_cvt_f32_u32 v12, v4
    v_mul_f32 v12, 0x3ae38e39, v12
    v_and_b32 v4, 1, v15
    v_cvt_f32_u32 v13, v4
    v_mul_f32 v13, 0x3e800000, v13
    v_mov_b32 v5, 0
    v_cndmask_b32 v13, v13, v5, vcc
    v_mov_b32 v14, 0x3d715bef
    v_mov_b32 v5, 0x3d2aaaab
    v_cmp_gt_u32 vcc, 2, v15
  s_nop 1
    v_cndmask_b32 v14, v14, v5, vcc
            v_fma_f32 v6, v11, v12, v13
            v_fract_f32 v6, v6
            v_cos_f32 v6, v6
            s_nop 0
            v_mul_f32 v16, v6, v14
  v_add_u32 v15, 1, v8
    v_lshrrev_b32 v4, 1, v15
    v_mov_b32 v5, 288
    v_cmp_eq_u32 vcc, 1, v15
  s_nop 1
    v_cndmask_b32 v4, v4, v5, vcc
    v_cvt_f32_u32 v12, v4
    v_mul_f32 v12, 0x3ae38e39, v12
    v_and_b32 v4, 1, v15
    v_cvt_f32_u32 v13, v4
    v_mul_f32 v13, 0x3e800000, v13
    v_mov_b32 v5, 0
    v_cndmask_b32 v13, v13, v5, vcc
    v_mov_b32 v14, 0x3d715bef
    v_mov_b32 v5, 0x3d2aaaab
    v_cmp_gt_u32 vcc, 2, v15
  s_nop 1
    v_cndmask_b32 v14, v14, v5, vcc
            v_fma_f32 v6, v11, v12, v13
            v_fract_f32 v6, v6
            v_cos_f32 v6, v6
            s_nop 0
            v_mul_f32 v17, v6, v14
  v_add_u32 v15, 2, v8
    v_lshrrev_b32 v4, 1, v15
    v_mov_b32 v5, 288
    v_cmp_eq_u32 vcc, 1, v15
  s_nop 1
    v_cndmask_b32 v4, v4, v5, vcc
    v_cvt_f32_u32 v12, v4
    v_mul_f32 v12, 0x3ae38e39, v12
    v_and_b32 v4, 1, v15
    v_cvt_f32_u32 v13, v4
    v_mul_f32 v13, 0x3e800000, v13
    v_mov_b32 v5, 0
    v_cndmask_b32 v13, v13, v5, vcc
    v_mov_b32 v14, 0x3d715bef
    v_mov_b32 v5, 0x3d2aaaab
    v_cmp_gt_u32 vcc, 2, v15
  s_nop 1
    v_cndmask_b32 v14, v14, v5, vcc
            v_fma_f32 v6, v11, v12, v13
            v_fract_f32 v6, v6
            v_cos_f32 v6, v6
            s_nop 0
            v_mul_f32 v18, v6, v14
  v_add_u32 v15, 3, v8
    v_lshrrev_b32 v4, 1, v15
    v_mov_b32 v5, 288
    v_cmp_eq_u32 vcc, 1, v15
  s_nop 1
    v_cndmask_b32 v4, v4, v5, vcc
    v_cvt_f32_u32 v12, v4
    v_mul_f32 v12, 0x3ae38e39, v12
    v_and_b32 v4, 1, v15
    v_cvt_f32_u32 v13, v4
    v_mul_f32 v13, 0x3e800000, v13
    v_mov_b32 v5, 0
    v_cndmask_b32 v13, v13, v5, vcc
    v_mov_b32 v14, 0x3d715bef
    v_mov_b32 v5, 0x3d2aaaab
    v_cmp_gt_u32 vcc, 2, v15
  s_nop 1
    v_cndmask_b32 v14, v14, v5, vcc
            v_fma_f32 v6, v11, v12, v13
            v_fract_f32 v6, v6
            v_cos_f32 v6, v6
            s_nop 0
            v_mul_f32 v19, v6, v14
  v_add_u32 v15, 8, v8
    v_lshrrev_b32 v4, 1, v15
    v_mov_b32 v5, 288
    v_cmp_eq_u32 vcc, 1, v15
  s_nop 1
    v_cndmask_b32 v4, v4, v5, vcc
    v_cvt_f32_u32 v12, v4
    v_mul_f32 v12, 0x3ae38e39, v12
    v_and_b32 v4, 1, v15
    v_cvt_f32_u32 v13, v4
    v_mul_f32 v13, 0x3e800000, v13
    v_mov_b32 v5, 0
    v_cndmask_b32 v13, v13, v5, vcc
    v_mov_b32 v14, 0x3d715bef
    v_mov_b32 v5, 0x3d2aaaab
    v_cmp_gt_u32 vcc, 2, v15
  s_nop 1
    v_cndmask_b32 v14, v14, v5, vcc
            v_fma_f32 v6, v11, v12, v13
            v_fract_f32 v6, v6
            v_cos_f32 v6, v6
            s_nop 0
            v_mul_f32 v20, v6, v14
  v_add_u32 v15, 9, v8
    v_lshrrev_b32 v4, 1, v15
    v_mov_b32 v5, 288
    v_cmp_eq_u32 vcc, 1, v15
  s_nop 1
    v_cndmask_b32 v4, v4, v5, vcc
    v_cvt_f32_u32 v12, v4
    v_mul_f32 v12, 0x3ae38e39, v12
    v_and_b32 v4, 1, v15
    v_cvt_f32_u32 v13, v4
    v_mul_f32 v13, 0x3e800000, v13
    v_mov_b32 v5, 0
    v_cndmask_b32 v13, v13, v5, vcc
    v_mov_b32 v14, 0x3d715bef
    v_mov_b32 v5, 0x3d2aaaab
    v_cmp_gt_u32 vcc, 2, v15
  s_nop 1
    v_cndmask_b32 v14, v14, v5, vcc
            v_fma_f32 v6, v11, v12, v13
            v_fract_f32 v6, v6
            v_cos_f32 v6, v6
            s_nop 0
            v_mul_f32 v21, v6, v14
  v_add_u32 v15, 10, v8
    v_lshrrev_b32 v4, 1, v15
    v_mov_b32 v5, 288
    v_cmp_eq_u32 vcc, 1, v15
  s_nop 1
    v_cndmask_b32 v4, v4, v5, vcc
    v_cvt_f32_u32 v12, v4
    v_mul_f32 v12, 0x3ae38e39, v12
    v_and_b32 v4, 1, v15
    v_cvt_f32_u32 v13, v4
    v_mul_f32 v13, 0x3e800000, v13
    v_mov_b32 v5, 0
    v_cndmask_b32 v13, v13, v5, vcc
    v_mov_b32 v14, 0x3d715bef
    v_mov_b32 v5, 0x3d2aaaab
    v_cmp_gt_u32 vcc, 2, v15
  s_nop 1
    v_cndmask_b32 v14, v14, v5, vcc
            v_fma_f32 v6, v11, v12, v13
            v_fract_f32 v6, v6
            v_cos_f32 v6, v6
            s_nop 0
            v_mul_f32 v22, v6, v14
  v_add_u32 v15, 11, v8
    v_lshrrev_b32 v4, 1, v15
    v_mov_b32 v5, 288
    v_cmp_eq_u32 vcc, 1, v15
  s_nop 1
    v_cndmask_b32 v4, v4, v5, vcc
    v_cvt_f32_u32 v12, v4
    v_mul_f32 v12, 0x3ae38e39, v12
    v_and_b32 v4, 1, v15
    v_cvt_f32_u32 v13, v4
    v_mul_f32 v13, 0x3e800000, v13
    v_mov_b32 v5, 0
    v_cndmask_b32 v13, v13, v5, vcc
    v_mov_b32 v14, 0x3d715bef
    v_mov_b32 v5, 0x3d2aaaab
    v_cmp_gt_u32 vcc, 2, v15
  s_nop 1
    v_cndmask_b32 v14, v14, v5, vcc
            v_fma_f32 v6, v11, v12, v13
            v_fract_f32 v6, v6
            v_cos_f32 v6, v6
            s_nop 0
            v_mul_f32 v23, v6, v14
  v_cvt_pk_bf16_f32 v24, v16, v17
  v_cvt_pk_bf16_f32 v25, v18, v19
  v_cvt_pk_bf16_f32 v26, v20, v21
  v_cvt_pk_bf16_f32 v27, v22, v23
  s_mov_b32 s34, 12836864
  buffer_store_dwordx4 v[24:27], v9, s[8:11], s34 offen sc1
  s_add_u32 s34, s21, 512
  s_nop 0
  v_add_u32 v9, s34, v0
  s_mov_b32 s3, 58255
  v_mul_u32_u24 v10, s3, v9
  v_lshrrev_b32 v10, 25, v10
  v_mul_u32_u24 v11, 576, v10
  v_sub_u32 v11, v9, v11
  v_lshlrev_b32 v9, 4, v9
        v_cvt_f32_u32 v11, v11
        v_lshrrev_b32 v4, 1, v10
        v_lshlrev_b32 v4, 4, v4
        v_and_b32 v5, 1, v10
        v_lshl_add_u32 v8, v5, 2, v4
  v_add_u32 v15, 0, v8
    v_lshrrev_b32 v4, 1, v15
    v_mov_b32 v5, 288
    v_cmp_eq_u32 vcc, 1, v15
  s_nop 1
    v_cndmask_b32 v4, v4, v5, vcc
    v_cvt_f32_u32 v12, v4
    v_mul_f32 v12, 0x3ae38e39, v12
    v_and_b32 v4, 1, v15
    v_cvt_f32_u32 v13, v4
    v_mul_f32 v13, 0x3e800000, v13
    v_mov_b32 v5, 0
    v_cndmask_b32 v13, v13, v5, vcc
    v_mov_b32 v14, 0x3d715bef
    v_mov_b32 v5, 0x3d2aaaab
    v_cmp_gt_u32 vcc, 2, v15
  s_nop 1
    v_cndmask_b32 v14, v14, v5, vcc
            v_fma_f32 v6, v11, v12, v13
            v_fract_f32 v6, v6
            v_cos_f32 v6, v6
            s_nop 0
            v_mul_f32 v16, v6, v14
  v_add_u32 v15, 1, v8
    v_lshrrev_b32 v4, 1, v15
    v_mov_b32 v5, 288
    v_cmp_eq_u32 vcc, 1, v15
  s_nop 1
    v_cndmask_b32 v4, v4, v5, vcc
    v_cvt_f32_u32 v12, v4
    v_mul_f32 v12, 0x3ae38e39, v12
    v_and_b32 v4, 1, v15
    v_cvt_f32_u32 v13, v4
    v_mul_f32 v13, 0x3e800000, v13
    v_mov_b32 v5, 0
    v_cndmask_b32 v13, v13, v5, vcc
    v_mov_b32 v14, 0x3d715bef
    v_mov_b32 v5, 0x3d2aaaab
    v_cmp_gt_u32 vcc, 2, v15
  s_nop 1
    v_cndmask_b32 v14, v14, v5, vcc
            v_fma_f32 v6, v11, v12, v13
            v_fract_f32 v6, v6
            v_cos_f32 v6, v6
            s_nop 0
            v_mul_f32 v17, v6, v14
  v_add_u32 v15, 2, v8
    v_lshrrev_b32 v4, 1, v15
    v_mov_b32 v5, 288
    v_cmp_eq_u32 vcc, 1, v15
  s_nop 1
    v_cndmask_b32 v4, v4, v5, vcc
    v_cvt_f32_u32 v12, v4
    v_mul_f32 v12, 0x3ae38e39, v12
    v_and_b32 v4, 1, v15
    v_cvt_f32_u32 v13, v4
    v_mul_f32 v13, 0x3e800000, v13
    v_mov_b32 v5, 0
    v_cndmask_b32 v13, v13, v5, vcc
    v_mov_b32 v14, 0x3d715bef
    v_mov_b32 v5, 0x3d2aaaab
    v_cmp_gt_u32 vcc, 2, v15
  s_nop 1
    v_cndmask_b32 v14, v14, v5, vcc
            v_fma_f32 v6, v11, v12, v13
            v_fract_f32 v6, v6
            v_cos_f32 v6, v6
            s_nop 0
            v_mul_f32 v18, v6, v14
  v_add_u32 v15, 3, v8
    v_lshrrev_b32 v4, 1, v15
    v_mov_b32 v5, 288
    v_cmp_eq_u32 vcc, 1, v15
  s_nop 1
    v_cndmask_b32 v4, v4, v5, vcc
    v_cvt_f32_u32 v12, v4
    v_mul_f32 v12, 0x3ae38e39, v12
    v_and_b32 v4, 1, v15
    v_cvt_f32_u32 v13, v4
    v_mul_f32 v13, 0x3e800000, v13
    v_mov_b32 v5, 0
    v_cndmask_b32 v13, v13, v5, vcc
    v_mov_b32 v14, 0x3d715bef
    v_mov_b32 v5, 0x3d2aaaab
    v_cmp_gt_u32 vcc, 2, v15
  s_nop 1
    v_cndmask_b32 v14, v14, v5, vcc
            v_fma_f32 v6, v11, v12, v13
            v_fract_f32 v6, v6
            v_cos_f32 v6, v6
            s_nop 0
            v_mul_f32 v19, v6, v14
  v_add_u32 v15, 8, v8
    v_lshrrev_b32 v4, 1, v15
    v_mov_b32 v5, 288
    v_cmp_eq_u32 vcc, 1, v15
  s_nop 1
    v_cndmask_b32 v4, v4, v5, vcc
    v_cvt_f32_u32 v12, v4
    v_mul_f32 v12, 0x3ae38e39, v12
    v_and_b32 v4, 1, v15
    v_cvt_f32_u32 v13, v4
    v_mul_f32 v13, 0x3e800000, v13
    v_mov_b32 v5, 0
    v_cndmask_b32 v13, v13, v5, vcc
    v_mov_b32 v14, 0x3d715bef
    v_mov_b32 v5, 0x3d2aaaab
    v_cmp_gt_u32 vcc, 2, v15
  s_nop 1
    v_cndmask_b32 v14, v14, v5, vcc
            v_fma_f32 v6, v11, v12, v13
            v_fract_f32 v6, v6
            v_cos_f32 v6, v6
            s_nop 0
            v_mul_f32 v20, v6, v14
  v_add_u32 v15, 9, v8
    v_lshrrev_b32 v4, 1, v15
    v_mov_b32 v5, 288
    v_cmp_eq_u32 vcc, 1, v15
  s_nop 1
    v_cndmask_b32 v4, v4, v5, vcc
    v_cvt_f32_u32 v12, v4
    v_mul_f32 v12, 0x3ae38e39, v12
    v_and_b32 v4, 1, v15
    v_cvt_f32_u32 v13, v4
    v_mul_f32 v13, 0x3e800000, v13
    v_mov_b32 v5, 0
    v_cndmask_b32 v13, v13, v5, vcc
    v_mov_b32 v14, 0x3d715bef
    v_mov_b32 v5, 0x3d2aaaab
    v_cmp_gt_u32 vcc, 2, v15
  s_nop 1
    v_cndmask_b32 v14, v14, v5, vcc
            v_fma_f32 v6, v11, v12, v13
            v_fract_f32 v6, v6
            v_cos_f32 v6, v6
            s_nop 0
            v_mul_f32 v21, v6, v14
  v_add_u32 v15, 10, v8
    v_lshrrev_b32 v4, 1, v15
    v_mov_b32 v5, 288
    v_cmp_eq_u32 vcc, 1, v15
  s_nop 1
    v_cndmask_b32 v4, v4, v5, vcc
    v_cvt_f32_u32 v12, v4
    v_mul_f32 v12, 0x3ae38e39, v12
    v_and_b32 v4, 1, v15
    v_cvt_f32_u32 v13, v4
    v_mul_f32 v13, 0x3e800000, v13
    v_mov_b32 v5, 0
    v_cndmask_b32 v13, v13, v5, vcc
    v_mov_b32 v14, 0x3d715bef
    v_mov_b32 v5, 0x3d2aaaab
    v_cmp_gt_u32 vcc, 2, v15
  s_nop 1
    v_cndmask_b32 v14, v14, v5, vcc
            v_fma_f32 v6, v11, v12, v13
            v_fract_f32 v6, v6
            v_cos_f32 v6, v6
            s_nop 0
            v_mul_f32 v22, v6, v14
  v_add_u32 v15, 11, v8
    v_lshrrev_b32 v4, 1, v15
    v_mov_b32 v5, 288
    v_cmp_eq_u32 vcc, 1, v15
  s_nop 1
    v_cndmask_b32 v4, v4, v5, vcc
    v_cvt_f32_u32 v12, v4
    v_mul_f32 v12, 0x3ae38e39, v12
    v_and_b32 v4, 1, v15
    v_cvt_f32_u32 v13, v4
    v_mul_f32 v13, 0x3e800000, v13
    v_mov_b32 v5, 0
    v_cndmask_b32 v13, v13, v5, vcc
    v_mov_b32 v14, 0x3d715bef
    v_mov_b32 v5, 0x3d2aaaab
    v_cmp_gt_u32 vcc, 2, v15
  s_nop 1
    v_cndmask_b32 v14, v14, v5, vcc
            v_fma_f32 v6, v11, v12, v13
            v_fract_f32 v6, v6
            v_cos_f32 v6, v6
            s_nop 0
            v_mul_f32 v23, v6, v14
  v_cvt_pk_bf16_f32 v24, v16, v17
  v_cvt_pk_bf16_f32 v25, v18, v19
  v_cvt_pk_bf16_f32 v26, v20, v21
  v_cvt_pk_bf16_f32 v27, v22, v23
  s_mov_b32 s34, 12836864
  buffer_store_dwordx4 v[24:27], v9, s[8:11], s34 offen sc1
  s_branch k2b_kernel_sfin
k2b_kernel_swot:
  s_add_u32 s34, s21, 0
  v_add_u32 v9, s34, v0
  s_mov_b32 s3, 58255
  v_mul_u32_u24 v10, s3, v9
  v_lshrrev_b32 v10, 25, v10
  v_mul_u32_u24 v11, 576, v10
  v_sub_u32 v11, v9, v11
  v_lshlrev_b32 v9, 4, v9
        v_lshrrev_b32 v4, 1, v10
        v_and_b32 v5, 1, v10
  s_mov_b32 s3, 29
  v_mul_u32_u24 v6, s3, v4
  v_lshrrev_b32 v6, 8, v6
        v_mul_u32_u24 v7, 9, v6
        v_sub_u32 v4, v4, v7
        v_mul_u32_u24 v6, 144, v6
        v_lshrrev_b32 v7, 2, v4
        v_mul_u32_u24 v7, 72, v7
        v_and_b32 v8, 3, v4
        v_mul_u32_u24 v8, 18, v8
        v_add_u32 v7, v7, v8
        v_lshl_add_u32 v7, v5, 3, v7
        v_mul_u32_u24 v8, 72, v5
        v_add_u32 v8, 16, v8
        v_cmp_eq_u32 s[38:39], 8, v4
        v_lshlrev_b32 v11, 1, v11
            v_add_u32 v12, 0, v7
            v_add_u32 v13, 0, v8
            v_cndmask_b32 v12, v12, v13, s[38:39]
            v_add_u32 v12, v12, v6
            v_mul_u32_u24 v12, 1152, v12
            v_add_u32 v12, v12, v11
            buffer_load_ushort v32, v12, s[12:15], 0 offen
            v_add_u32 v12, 1, v7
            v_add_u32 v13, 1, v8
            v_cndmask_b32 v12, v12, v13, s[38:39]
            v_add_u32 v12, v12, v6
            v_mul_u32_u24 v12, 1152, v12
            v_add_u32 v12, v12, v11
            buffer_load_ushort v33, v12, s[12:15], 0 offen
            v_add_u32 v12, 2, v7
            v_add_u32 v13, 18, v8
            v_cndmask_b32 v12, v12, v13, s[38:39]
            v_add_u32 v12, v12, v6
            v_mul_u32_u24 v12, 1152, v12
            v_add_u32 v12, v12, v11
            buffer_load_ushort v34, v12, s[12:15], 0 offen
            v_add_u32 v12, 3, v7
            v_add_u32 v13, 19, v8
            v_cndmask_b32 v12, v12, v13, s[38:39]
            v_add_u32 v12, v12, v6
            v_mul_u32_u24 v12, 1152, v12
            v_add_u32 v12, v12, v11
            buffer_load_ushort v35, v12, s[12:15], 0 offen
            v_add_u32 v12, 4, v7
            v_add_u32 v13, 36, v8
            v_cndmask_b32 v12, v12, v13, s[38:39]
            v_add_u32 v12, v12, v6
            v_mul_u32_u24 v12, 1152, v12
            v_add_u32 v12, v12, v11
            buffer_load_ushort v36, v12, s[12:15], 0 offen
            v_add_u32 v12, 5, v7
            v_add_u32 v13, 37, v8
            v_cndmask_b32 v12, v12, v13, s[38:39]
            v_add_u32 v12, v12, v6
            v_mul_u32_u24 v12, 1152, v12
            v_add_u32 v12, v12, v11
            buffer_load_ushort v37, v12, s[12:15], 0 offen
            v_add_u32 v12, 6, v7
            v_add_u32 v13, 54, v8
            v_cndmask_b32 v12, v12, v13, s[38:39]
            v_add_u32 v12, v12, v6
            v_mul_u32_u24 v12, 1152, v12
            v_add_u32 v12, v12, v11
            buffer_load_ushort v38, v12, s[12:15], 0 offen
            v_add_u32 v12, 7, v7
            v_add_u32 v13, 55, v8
            v_cndmask_b32 v12, v12, v13, s[38:39]
            v_add_u32 v12, v12, v6
            v_mul_u32_u24 v12, 1152, v12
            v_add_u32 v12, v12, v11
            buffer_load_ushort v39, v12, s[12:15], 0 offen
  s_waitcnt vmcnt(0)
  v_lshl_or_b32 v24, v33, 16, v32
  v_lshl_or_b32 v25, v35, 16, v34
  v_lshl_or_b32 v26, v37, 16, v36
  v_lshl_or_b32 v27, v39, 16, v38
  s_mov_b32 s34, 13500416
  buffer_store_dwordx4 v[24:27], v9, s[8:11], s34 offen sc1
  s_add_u32 s34, s21, 256
  s_nop 0
  v_add_u32 v9, s34, v0
  s_mov_b32 s3, 58255
  v_mul_u32_u24 v10, s3, v9
  v_lshrrev_b32 v10, 25, v10
  v_mul_u32_u24 v11, 576, v10
  v_sub_u32 v11, v9, v11
  v_lshlrev_b32 v9, 4, v9
        v_lshrrev_b32 v4, 1, v10
        v_and_b32 v5, 1, v10
  s_mov_b32 s3, 29
  v_mul_u32_u24 v6, s3, v4
  v_lshrrev_b32 v6, 8, v6
        v_mul_u32_u24 v7, 9, v6
        v_sub_u32 v4, v4, v7
        v_mul_u32_u24 v6, 144, v6
        v_lshrrev_b32 v7, 2, v4
        v_mul_u32_u24 v7, 72, v7
        v_and_b32 v8, 3, v4
        v_mul_u32_u24 v8, 18, v8
        v_add_u32 v7, v7, v8
        v_lshl_add_u32 v7, v5, 3, v7
        v_mul_u32_u24 v8, 72, v5
        v_add_u32 v8, 16, v8
        v_cmp_eq_u32 s[38:39], 8, v4
        v_lshlrev_b32 v11, 1, v11
            v_add_u32 v12, 0, v7
            v_add_u32 v13, 0, v8
            v_cndmask_b32 v12, v12, v13, s[38:39]
            v_add_u32 v12, v12, v6
            v_mul_u32_u24 v12, 1152, v12
            v_add_u32 v12, v12, v11
            buffer_load_ushort v32, v12, s[12:15], 0 offen
            v_add_u32 v12, 1, v7
            v_add_u32 v13, 1, v8
            v_cndmask_b32 v12, v12, v13, s[38:39]
            v_add_u32 v12, v12, v6
            v_mul_u32_u24 v12, 1152, v12
            v_add_u32 v12, v12, v11
            buffer_load_ushort v33, v12, s[12:15], 0 offen
            v_add_u32 v12, 2, v7
            v_add_u32 v13, 18, v8
            v_cndmask_b32 v12, v12, v13, s[38:39]
            v_add_u32 v12, v12, v6
            v_mul_u32_u24 v12, 1152, v12
            v_add_u32 v12, v12, v11
            buffer_load_ushort v34, v12, s[12:15], 0 offen
            v_add_u32 v12, 3, v7
            v_add_u32 v13, 19, v8
            v_cndmask_b32 v12, v12, v13, s[38:39]
            v_add_u32 v12, v12, v6
            v_mul_u32_u24 v12, 1152, v12
            v_add_u32 v12, v12, v11
            buffer_load_ushort v35, v12, s[12:15], 0 offen
            v_add_u32 v12, 4, v7
            v_add_u32 v13, 36, v8
            v_cndmask_b32 v12, v12, v13, s[38:39]
            v_add_u32 v12, v12, v6
            v_mul_u32_u24 v12, 1152, v12
            v_add_u32 v12, v12, v11
            buffer_load_ushort v36, v12, s[12:15], 0 offen
            v_add_u32 v12, 5, v7
            v_add_u32 v13, 37, v8
            v_cndmask_b32 v12, v12, v13, s[38:39]
            v_add_u32 v12, v12, v6
            v_mul_u32_u24 v12, 1152, v12
            v_add_u32 v12, v12, v11
            buffer_load_ushort v37, v12, s[12:15], 0 offen
            v_add_u32 v12, 6, v7
            v_add_u32 v13, 54, v8
            v_cndmask_b32 v12, v12, v13, s[38:39]
            v_add_u32 v12, v12, v6
            v_mul_u32_u24 v12, 1152, v12
            v_add_u32 v12, v12, v11
            buffer_load_ushort v38, v12, s[12:15], 0 offen
            v_add_u32 v12, 7, v7
            v_add_u32 v13, 55, v8
            v_cndmask_b32 v12, v12, v13, s[38:39]
            v_add_u32 v12, v12, v6
            v_mul_u32_u24 v12, 1152, v12
            v_add_u32 v12, v12, v11
            buffer_load_ushort v39, v12, s[12:15], 0 offen
  s_waitcnt vmcnt(0)
  v_lshl_or_b32 v24, v33, 16, v32
  v_lshl_or_b32 v25, v35, 16, v34
  v_lshl_or_b32 v26, v37, 16, v36
  v_lshl_or_b32 v27, v39, 16, v38
  s_mov_b32 s34, 13500416
  buffer_store_dwordx4 v[24:27], v9, s[8:11], s34 offen sc1
  s_add_u32 s34, s21, 512
  s_nop 0
  v_add_u32 v9, s34, v0
  s_mov_b32 s3, 58255
  v_mul_u32_u24 v10, s3, v9
  v_lshrrev_b32 v10, 25, v10
  v_mul_u32_u24 v11, 576, v10
  v_sub_u32 v11, v9, v11
  v_lshlrev_b32 v9, 4, v9
        v_lshrrev_b32 v4, 1, v10
        v_and_b32 v5, 1, v10
  s_mov_b32 s3, 29
  v_mul_u32_u24 v6, s3, v4
  v_lshrrev_b32 v6, 8, v6
        v_mul_u32_u24 v7, 9, v6
        v_sub_u32 v4, v4, v7
        v_mul_u32_u24 v6, 144, v6
        v_lshrrev_b32 v7, 2, v4
        v_mul_u32_u24 v7, 72, v7
        v_and_b32 v8, 3, v4
        v_mul_u32_u24 v8, 18, v8
        v_add_u32 v7, v7, v8
        v_lshl_add_u32 v7, v5, 3, v7
        v_mul_u32_u24 v8, 72, v5
        v_add_u32 v8, 16, v8
        v_cmp_eq_u32 s[38:39], 8, v4
        v_lshlrev_b32 v11, 1, v11
            v_add_u32 v12, 0, v7
            v_add_u32 v13, 0, v8
            v_cndmask_b32 v12, v12, v13, s[38:39]
            v_add_u32 v12, v12, v6
            v_mul_u32_u24 v12, 1152, v12
            v_add_u32 v12, v12, v11
            buffer_load_ushort v32, v12, s[12:15], 0 offen
            v_add_u32 v12, 1, v7
            v_add_u32 v13, 1, v8
            v_cndmask_b32 v12, v12, v13, s[38:39]
            v_add_u32 v12, v12, v6
            v_mul_u32_u24 v12, 1152, v12
            v_add_u32 v12, v12, v11
            buffer_load_ushort v33, v12, s[12:15], 0 offen
            v_add_u32 v12, 2, v7
            v_add_u32 v13, 18, v8
            v_cndmask_b32 v12, v12, v13, s[38:39]
            v_add_u32 v12, v12, v6
            v_mul_u32_u24 v12, 1152, v12
            v_add_u32 v12, v12, v11
            buffer_load_ushort v34, v12, s[12:15], 0 offen
            v_add_u32 v12, 3, v7
            v_add_u32 v13, 19, v8
            v_cndmask_b32 v12, v12, v13, s[38:39]
            v_add_u32 v12, v12, v6
            v_mul_u32_u24 v12, 1152, v12
            v_add_u32 v12, v12, v11
            buffer_load_ushort v35, v12, s[12:15], 0 offen
            v_add_u32 v12, 4, v7
            v_add_u32 v13, 36, v8
            v_cndmask_b32 v12, v12, v13, s[38:39]
            v_add_u32 v12, v12, v6
            v_mul_u32_u24 v12, 1152, v12
            v_add_u32 v12, v12, v11
            buffer_load_ushort v36, v12, s[12:15], 0 offen
            v_add_u32 v12, 5, v7
            v_add_u32 v13, 37, v8
            v_cndmask_b32 v12, v12, v13, s[38:39]
            v_add_u32 v12, v12, v6
            v_mul_u32_u24 v12, 1152, v12
            v_add_u32 v12, v12, v11
            buffer_load_ushort v37, v12, s[12:15], 0 offen
            v_add_u32 v12, 6, v7
            v_add_u32 v13, 54, v8
            v_cndmask_b32 v12, v12, v13, s[38:39]
            v_add_u32 v12, v12, v6
            v_mul_u32_u24 v12, 1152, v12
            v_add_u32 v12, v12, v11
            buffer_load_ushort v38, v12, s[12:15], 0 offen
            v_add_u32 v12, 7, v7
            v_add_u32 v13, 55, v8
            v_cndmask_b32 v12, v12, v13, s[38:39]
            v_add_u32 v12, v12, v6
            v_mul_u32_u24 v12, 1152, v12
            v_add_u32 v12, v12, v11
            buffer_load_ushort v39, v12, s[12:15], 0 offen
  s_waitcnt vmcnt(0)
  v_lshl_or_b32 v24, v33, 16, v32
  v_lshl_or_b32 v25, v35, 16, v34
  v_lshl_or_b32 v26, v37, 16, v36
  v_lshl_or_b32 v27, v39, 16, v38
  s_mov_b32 s34, 13500416
  buffer_store_dwordx4 v[24:27], v9, s[8:11], s34 offen sc1
k2b_kernel_sfin:
  s_waitcnt vmcnt(0)
k2b_kernel_fin:
k2b_kernel_end:
  s_endpgm
.p2align 8
.type kfb_kernel,@function
kfb_kernel:
  s_cmp_ge_u32 s2, 256
  s_cbranch_scc1 kfb_kernel_end
  s_load_dwordx2 s[4:5], s[0:1], 80
  s_load_dwordx2 s[6:7], s[0:1], 64
    v_lshrrev_b32 v209, 6, v0
    v_and_b32 v208, 63, v0
    v_readfirstlane_b32 s20, v209
    s_and_b32 s21, s2, 7
    s_lshl_b32 s21, s21, 2
    s_lshr_b32 s23, s2, 3
    s_and_b32 s22, s23, 3
    s_add_u32 s21, s21, s22
    s_lshr_b32 s22, s2, 5
    v_and_b32 v210, 31, v208
    v_lshrrev_b32 v211, 5, v208
    v_mul_u32_u24 v206, 16512, v211
    v_lshl_add_u32 v206, v210, 4, v206
    v_mul_u32_u24 v207, 10240, v211
    v_lshlrev_b32 v204, 3, v210
    v_lshl_add_u32 v204, v211, 9, v204
    v_add_u32 v202, 36864, v204
    v_add_u32 v205, 256, v204
    s_lshl_b32 s24, s21, 9
    s_mul_i32 s25, s20, 33024
    s_add_u32 s24, s24, s25
    s_add_u32 s24, s24, 7139328
    s_lshl_b32 s25, s20, 10
    s_mul_i32 s26, s22, 1152
    s_add_u32 s26, s26, 14901248
    s_mov_b32 s27, 20480
    s_mov_b64 s[42:43], -1
    s_waitcnt lgkmcnt(0)
    s_mov_b32 s8, s4
    s_mov_b32 s9, s5
    s_mov_b32 s10, 0x10000000
    s_mov_b32 s11, 0x20000
        s_mov_b32 s12, s6
        s_mov_b32 s13, s7
        s_mov_b32 s14, 2359296
        s_mov_b32 s15, 0x20000
    s_cmp_lt_u32 s20, 2
    s_cbranch_scc1 kfb_kernel_wq
    s_cmp_eq_u32 s20, 2
    s_cbranch_scc1 kfb_kernel_w2
    s_cmp_eq_u32 s20, 7
    s_cbranch_scc1 kfb_kernel_stats
    s_cmp_eq_u32 s20, 3
    s_cbranch_scc0 kfb_kernel_w456
    s_sub_u32 s48, s22, 1
    s_cmp_lt_u32 s48, 2
    s_cbranch_scc0 kfb_kernel_helper
        v_bfe_u32 v212, v210, 2, 1
        v_lshlrev_b32 v212, 3, v212
        v_bfe_u32 v209, v210, 3, 1
        v_lshl_add_u32 v212, v209, 2, v212
        v_and_b32 v209, 3, v210
        v_add_u32 v212, v212, v209
    v_cmp_gt_u32 vcc, 16, v210
    v_mov_b32 v209, 0
  s_nop 0
    v_cndmask_b32 v212, v209, v212, vcc
    v_mov_b32 v209, 16
    v_cmp_eq_u32 vcc, 16, v210
  s_nop 1
    v_cndmask_b32 v212, v212, v209, vcc
    v_mov_b32 v209, 17
    v_cmp_eq_u32 vcc, 20, v210
  s_nop 1
    v_cndmask_b32 v212, v212, v209, vcc
    v_lshl_add_u32 v207, v212, 4, v207
    s_mov_b32 s26, 14910976
    s_branch kfb_kernel_vrole
kfb_kernel_w456:
  s_branch kfb_kernel_xmain
kfb_kernel_wq:
        v_bfe_u32 v212, v210, 2, 1
        v_lshlrev_b32 v212, 3, v212
        v_bfe_u32 v209, v210, 3, 1
        v_lshl_add_u32 v212, v209, 2, v212
        v_and_b32 v209, 3, v210
        v_add_u32 v212, v212, v209
    v_lshrrev_b32 v209, 4, v210
    s_lshl_b32 s34, s20, 1
    v_add_u32 v209, s34, v209
    v_mad_u32_u24 v212, v209, 18, v212
    v_lshl_add_u32 v207, v212, 4, v207
    s_branch kfb_kernel_main
kfb_kernel_w2:
    v_and_b32 v212, 3, v210
    v_mul_u32_u24 v212, 18, v212
    v_bfe_u32 v209, v210, 2, 1
    v_add3_u32 v212, v212, v209, 16
    s_cmp_eq_u32 s22, 0
    s_cbranch_scc1 kfb_kernel_w2k
    v_lshl_add_u32 v207, v212, 4, v207
    s_mov_b32 s42, 0xff
    s_mov_b32 s43, 0xff
    s_branch kfb_kernel_main
kfb_kernel_w2k:
  v_subrev_u32 v216, 8, v210
        v_bfe_u32 v217, v216, 2, 1
        v_lshlrev_b32 v217, 3, v217
        v_bfe_u32 v209, v216, 3, 1
        v_lshl_add_u32 v217, v209, 2, v217
        v_and_b32 v209, 3, v216
        v_add_u32 v217, v217, v209
    v_add_u32 v217, 576, v217
    v_cmp_gt_u32 vcc, 16, v216
  s_nop 1
    v_cndmask_b32 v212, v212, v217, vcc
    v_bfe_u32 v209, v210, 2, 1
    v_add_u32 v209, 592, v209
    v_cmp_le_u32 vcc, 24, v210
  s_nop 1
    v_cndmask_b32 v212, v212, v209, vcc
    v_lshl_add_u32 v207, v212, 4, v207
    s_branch kfb_kernel_main
kfb_kernel_main:
        s_mov_b32 m0, s25
        s_add_u32 s25, s25, 8192
        buffer_load_dwordx4 v206, s[8:11], s24 offen lds
        s_add_u32 s24, s24, 264192
        s_mov_b64 exec, s[42:43]
        buffer_load_dwordx4 v[8:11], v207, s[8:11], s26 offen
        s_mov_b64 exec, -1
        s_add_u32 s26, s26, s27
        s_mov_b64 exec, s[42:43]
        buffer_load_dwordx4 v[12:15], v207, s[8:11], s26 offen
        s_mov_b64 exec, -1
        s_add_u32 s26, s26, s27
        s_mov_b64 exec, s[42:43]
        buffer_load_dwordx4 v[16:19], v207, s[8:11], s26 offen
        s_mov_b64 exec, -1
        s_add_u32 s26, s26, s27
        s_mov_b64 exec, s[42:43]
        buffer_load_dwordx4 v[20:23], v207, s[8:11], s26 offen
        s_mov_b64 exec, -1
        s_add_u32 s26, s26, s27
  s_barrier
        s_mov_b32 m0, s25
        s_add_u32 s25, s25, 8192
        buffer_load_dwordx4 v206, s[8:11], s24 offen lds
        s_add_u32 s24, s24, 264192
        s_mov_b64 exec, s[42:43]
        buffer_load_dwordx4 v[24:27], v207, s[8:11], s26 offen
        s_mov_b64 exec, -1
        s_add_u32 s26, s26, s27
        s_mov_b64 exec, s[42:43]
        buffer_load_dwordx4 v[28:31], v207, s[8:11], s26 offen
        s_mov_b64 exec, -1
        s_add_u32 s26, s26, s27
        s_mov_b64 exec, s[42:43]
        buffer_load_dwordx4 v[32:35], v207, s[8:11], s26 offen
        s_mov_b64 exec, -1
        s_add_u32 s26, s26, s27
        s_mov_b64 exec, s[42:43]
        buffer_load_dwordx4 v[36:39], v207, s[8:11], s26 offen
        s_mov_b64 exec, -1
        s_add_u32 s26, s26, s27
  s_barrier
        s_mov_b32 m0, s25
        s_add_u32 s25, s25, 8192
        buffer_load_dwordx4 v206, s[8:11], s24 offen lds
        s_add_u32 s24, s24, 264192
        s_mov_b64 exec, s[42:43]
        buffer_load_dwordx4 v[40:43], v207, s[8:11], s26 offen
        s_mov_b64 exec, -1
        s_add_u32 s26, s26, s27
        s_mov_b64 exec, s[42:43]
        buffer_load_dwordx4 v[44:47], v207, s[8:11], s26 offen
        s_mov_b64 exec, -1
        s_add_u32 s26, s26, s27
        s_mov_b64 exec, s[42:43]
        buffer_load_dwordx4 v[48:51], v207, s[8:11], s26 offen
        s_mov_b64 exec, -1
        s_add_u32 s26, s26, s27
        s_mov_b64 exec, s[42:43]
        buffer_load_dwordx4 v[52:55], v207, s[8:11], s26 offen
        s_mov_b64 exec, -1
        s_add_u32 s26, s26, s27
        s_mov_b32 m0, s25
        s_add_u32 s25, s25, 8192
        buffer_load_dwordx4 v206, s[8:11], s24 offen lds
        s_add_u32 s24, s24, 264192
        s_mov_b64 exec, s[42:43]
        buffer_load_dwordx4 v[56:59], v207, s[8:11], s26 offen
        s_mov_b64 exec, -1
        s_add_u32 s26, s26, s27
        s_mov_b64 exec, s[42:43]
        buffer_load_dwordx4 v[60:63], v207, s[8:11], s26 offen
        s_mov_b64 exec, -1
        s_add_u32 s26, s26, s27
        s_mov_b64 exec, s[42:43]
        buffer_load_dwordx4 v[64:67], v207, s[8:11], s26 offen
        s_mov_b64 exec, -1
        s_add_u32 s26, s26, s27
        s_mov_b64 exec, s[42:43]
        buffer_load_dwordx4 v[68:71], v207, s[8:11], s26 offen
        s_mov_b64 exec, -1
        s_add_u32 s26, s26, s27
  s_waitcnt vmcnt(15)
  s_barrier
  ds_read2st64_b64 v[184:187], v204 offset0:0 offset1:2
  ds_read2st64_b64 v[188:191], v205 offset0:0 offset1:2
  ds_read2st64_b64 v[192:195], v204 offset0:4 offset1:6
  ds_read2st64_b64 v[196:199], v205 offset0:4 offset1:6
  ds_read2st64_b64 v[248:251], v204 offset0:8 offset1:10
  ds_read2st64_b64 v[252:255], v205 offset0:8 offset1:10
  s_waitcnt lgkmcnt(4)
  v_mfma_f32_32x32x16_bf16 v[152:167], v[8:11], v[184:187], 0
  v_mfma_f32_32x32x16_bf16 v[168:183], v[8:11], v[188:191], 0
        s_mov_b32 m0, s25
        s_add_u32 s25, s25, 8192
        buffer_load_dwordx4 v206, s[8:11], s24 offen lds
        s_add_u32 s24, s24, 264192
        s_mov_b64 exec, s[42:43]
        buffer_load_dwordx4 v[72:75], v207, s[8:11], s26 offen
        s_mov_b64 exec, -1
        s_add_u32 s26, s26, s27
  ds_read2st64_b64 v[184:187], v204 offset0:12 offset1:14
  ds_read2st64_b64 v[188:191], v205 offset0:12 offset1:14
  s_waitcnt lgkmcnt(4)
  v_mfma_f32_32x32x16_bf16 v[152:167], v[12:15], v[192:195], v[152:167]
  v_mfma_f32_32x32x16_bf16 v[168:183], v[12:15], v[196:199], v[168:183]
        s_mov_b64 exec, s[42:43]
        buffer_load_dwordx4 v[76:79], v207, s[8:11], s26 offen
        s_mov_b64 exec, -1
        s_add_u32 s26, s26, s27
  s_waitcnt vmcnt(13)
  s_barrier
  ds_read2st64_b64 v[192:195], v204 offset0:16 offset1:18
  ds_read2st64_b64 v[196:199], v205 offset0:16 offset1:18
  s_waitcnt lgkmcnt(4)
  v_mfma_f32_32x32x16_bf16 v[152:167], v[16:19], v[248:251], v[152:167]
  v_mfma_f32_32x32x16_bf16 v[168:183], v[16:19], v[252:255], v[168:183]
        s_mov_b64 exec, s[42:43]
        buffer_load_dwordx4 v[80:83], v207, s[8:11], s26 offen
        s_mov_b64 exec, -1
        s_add_u32 s26, s26, s27
  ds_read2st64_b64 v[248:251], v204 offset0:20 offset1:22
  ds_read2st64_b64 v[252:255], v205 offset0:20 offset1:22
  s_waitcnt lgkmcnt(4)
  v_mfma_f32_32x32x16_bf16 v[152:167], v[20:23], v[184:187], v[152:167]
  v_mfma_f32_32x32x16_bf16 v[168:183], v[20:23], v[188:191], v[168:183]
        s_mov_b64 exec, s[42:43]
        buffer_load_dwordx4 v[84:87], v207, s[8:11], s26 offen
        s_mov_b64 exec, -1
        s_add_u32 s26, s26, s27
  ds_read2st64_b64 v[184:187], v204 offset0:24 offset1:26
  ds_read2st64_b64 v[188:191], v205 offset0:24 offset1:26
  s_waitcnt lgkmcnt(4)
  v_mfma_f32_32x32x16_bf16 v[152:167], v[24:27], v[192:195], v[152:167]
  v_mfma_f32_32x32x16_bf16 v[168:183], v[24:27], v[196:199], v[168:183]
        s_mov_b32 m0, s25
        s_add_u32 s25, s25, 8192
        buffer_load_dwordx4 v206, s[8:11], s24 offen lds
        s_add_u32 s24, s24, 264192
        s_mov_b64 exec, s[42:43]
        buffer_load_dwordx4 v[88:91], v207, s[8:11], s26 offen
        s_mov_b64 exec, -1
        s_add_u32 s26, s26, s27
  ds_read2st64_b64 v[192:195], v204 offset0:28 offset1:30
  ds_read2st64_b64 v[196:199], v205 offset0:28 offset1:30
  s_waitcnt lgkmcnt(4)
  v_mfma_f32_32x32x16_bf16 v[152:167], v[28:31], v[248:251], v[152:167]
  v_mfma_f32_32x32x16_bf16 v[168:183], v[28:31], v[252:255], v[168:183]
        s_mov_b64 exec, s[42:43]
        buffer_load_dwordx4 v[92:95], v207, s[8:11], s26 offen
        s_mov_b64 exec, -1
        s_add_u32 s26, s26, s27
  s_waitcnt vmcnt(13)
  s_barrier
  ds_read2st64_b64 v[248:251], v204 offset0:32 offset1:34
  ds_read2st64_b64 v[252:255], v205 offset0:32 offset1:34
  s_waitcnt lgkmcnt(4)
  v_mfma_f32_32x32x16_bf16 v[152:167], v[32:35], v[184:187], v[152:167]
  v_mfma_f32_32x32x16_bf16 v[168:183], v[32:35], v[188:191], v[168:183]
        s_mov_b64 exec, s[42:43]
        buffer_load_dwordx4 v[96:99], v207, s[8:11], s26 offen
        s_mov_b64 exec, -1
        s_add_u32 s26, s26, s27
  ds_read2st64_b64 v[184:187], v204 offset0:36 offset1:38
  ds_read2st64_b64 v[188:191], v205 offset0:36 offset1:38
  s_waitcnt lgkmcnt(4)
  v_mfma_f32_32x32x16_bf16 v[152:167], v[36:39], v[192:195], v[152:167]
  v_mfma_f32_32x32x16_bf16 v[168:183], v[36:39], v[196:199], v[168:183]
        s_mov_b64 exec, s[42:43]
        buffer_load_dwordx4 v[100:103], v207, s[8:11], s26 offen
        s_mov_b64 exec, -1
        s_add_u32 s26, s26, s27
  ds_read2st64_b64 v[192:195], v204 offset0:40 offset1:42
  ds_read2st64_b64 v[196:199], v205 offset0:40 offset1:42
  s_waitcnt lgkmcnt(4)
  v_mfma_f32_32x32x16_bf16 v[152:167], v[40:43], v[248:251], v[152:167]
  v_mfma_f32_32x32x16_bf16 v[168:183], v[40:43], v[252:255], v[168:183]
        s_mov_b32 m0, s25
        s_add_u32 s25, s25, 8192
        buffer_load_dwordx4 v206, s[8:11], s24 offen lds
        s_add_u32 s24, s24, 264192
        s_mov_b64 exec, s[42:43]
        buffer_load_dwordx4 v[104:107], v207, s[8:11], s26 offen
        s_mov_b64 exec, -1
        s_add_u32 s26, s26, s27
  ds_read2st64_b64 v[248:251], v204 offset0:44 offset1:46
  ds_read2st64_b64 v[252:255], v205 offset0:44 offset1:46
  s_waitcnt lgkmcnt(4)
  v_mfma_f32_32x32x16_bf16 v[152:167], v[44:47], v[184:187], v[152:167]
  v_mfma_f32_32x32x16_bf16 v[168:183], v[44:47], v[188:191], v[168:183]
        s_mov_b64 exec, s[42:43]
        buffer_load_dwordx4 v[108:111], v207, s[8:11], s26 offen
        s_mov_b64 exec, -1
        s_add_u32 s26, s26, s27
  s_waitcnt vmcnt(13)
  s_barrier
  ds_read2st64_b64 v[184:187], v204 offset0:48 offset1:50
  ds_read2st64_b64 v[188:191], v205 offset0:48 offset1:50
  s_waitcnt lgkmcnt(4)
  v_mfma_f32_32x32x16_bf16 v[152:167], v[48:51], v[192:195], v[152:167]
  v_mfma_f32_32x32x16_bf16 v[168:183], v[48:51], v[196:199], v[168:183]
        s_mov_b64 exec, s[42:43]
        buffer_load_dwordx4 v[112:115], v207, s[8:11], s26 offen
        s_mov_b64 exec, -1
        s_add_u32 s26, s26, s27
  ds_read2st64_b64 v[192:195], v204 offset0:52 offset1:54
  ds_read2st64_b64 v[196:199], v205 offset0:52 offset1:54
  s_waitcnt lgkmcnt(4)
  v_mfma_f32_32x32x16_bf16 v[152:167], v[52:55], v[248:251], v[152:167]
  v_mfma_f32_32x32x16_bf16 v[168:183], v[52:55], v[252:255], v[168:183]
        s_mov_b64 exec, s[42:43]
        buffer_load_dwordx4 v[116:119], v207, s[8:11], s26 offen
        s_mov_b64 exec, -1
        s_add_u32 s26, s26, s27
  ds_read2st64_b64 v[248:251], v204 offset0:56 offset1:58
  ds_read2st64_b64 v[252:255], v205 offset0:56 offset1:58
  s_waitcnt lgkmcnt(4)
  v_mfma_f32_32x32x16_bf16 v[152:167], v[56:59], v[184:187], v[152:167]
  v_mfma_f32_32x32x16_bf16 v[168:183], v[56:59], v[188:191], v[168:183]
        s_mov_b32 m0, s25
        s_add_u32 s25, s25, 8192
        buffer_load_dwordx4 v206, s[8:11], s24 offen lds
        s_add_u32 s24, s24, 264192
        s_mov_b64 exec, s[42:43]
        buffer_load_dwordx4 v[120:123], v207, s[8:11], s26 offen
        s_mov_b64 exec, -1
        s_add_u32 s26, s26, s27
  ds_read2st64_b64 v[184:187], v204 offset0:60 offset1:62
  ds_read2st64_b64 v[188:191], v205 offset0:60 offset1:62
  s_waitcnt lgkmcnt(4)
  v_mfma_f32_32x32x16_bf16 v[152:167], v[60:63], v[192:195], v[152:167]
  v_mfma_f32_32x32x16_bf16 v[168:183], v[60:63], v[196:199], v[168:183]
        s_mov_b64 exec, s[42:43]
        buffer_load_dwordx4 v[124:127], v207, s[8:11], s26 offen
        s_mov_b64 exec, -1
        s_add_u32 s26, s26, s27
  s_waitcnt vmcnt(13)
  s_barrier
  ds_read2st64_b64 v[192:195], v204 offset0:64 offset1:66
  ds_read2st64_b64 v[196:199], v205 offset0:64 offset1:66
  s_waitcnt lgkmcnt(4)
  v_mfma_f32_32x32x16_bf16 v[152:167], v[64:67], v[248:251], v[152:167]
  v_mfma_f32_32x32x16_bf16 v[168:183], v[64:67], v[252:255], v[168:183]
        s_mov_b64 exec, s[42:43]
        buffer_load_dwordx4 v[128:131], v207, s[8:11], s26 offen
        s_mov_b64 exec, -1
        s_add_u32 s26, s26, s27
  ds_read2st64_b64 v[248:251], v204 offset0:68 offset1:70
  ds_read2st64_b64 v[252:255], v205 offset0:68 offset1:70
  s_waitcnt lgkmcnt(4)
  v_mfma_f32_32x32x16_bf16 v[152:167], v[68:71], v[184:187], v[152:167]
  v_mfma_f32_32x32x16_bf16 v[168:183], v[68:71], v[188:191], v[168:183]
        s_mov_b64 exec, s[42:43]
        buffer_load_dwordx4 v[132:135], v207, s[8:11], s26 offen
        s_mov_b64 exec, -1
        s_add_u32 s26, s26, s27
  ds_read2st64_b64 v[184:187], v204 offset0:72 offset1:74
  ds_read2st64_b64 v[188:191], v205 offset0:72 offset1:74
  s_waitcnt lgkmcnt(4)
  v_mfma_f32_32x32x16_bf16 v[152:167], v[72:75], v[192:195], v[152:167]
  v_mfma_f32_32x32x16_bf16 v[168:183], v[72:75], v[196:199], v[168:183]
        s_mov_b32 m0, s25
        s_add_u32 s25, s25, 8192
        buffer_load_dwordx4 v206, s[8:11], s24 offen lds
        s_add_u32 s24, s24, 264192
        s_mov_b64 exec, s[42:43]
        buffer_load_dwordx4 v[136:139], v207, s[8:11], s26 offen
        s_mov_b64 exec, -1
        s_add_u32 s26, s26, s27
  ds_read2st64_b64 v[192:195], v204 offset0:76 offset1:78
  ds_read2st64_b64 v[196:199], v205 offset0:76 offset1:78
  s_waitcnt lgkmcnt(4)
  v_mfma_f32_32x32x16_bf16 v[152:167], v[76:79], v[248:251], v[152:167]
  v_mfma_f32_32x32x16_bf16 v[168:183], v[76:79], v[252:255], v[168:183]
        s_mov_b64 exec, s[42:43]
        buffer_load_dwordx4 v[140:143], v207, s[8:11], s26 offen
        s_mov_b64 exec, -1
        s_add_u32 s26, s26, s27
  s_waitcnt vmcnt(13)
  s_barrier
  ds_read2st64_b64 v[248:251], v204 offset0:80 offset1:82
  ds_read2st64_b64 v[252:255], v205 offset0:80 offset1:82
  s_waitcnt lgkmcnt(4)
  v_mfma_f32_32x32x16_bf16 v[152:167], v[80:83], v[184:187], v[152:167]
  v_mfma_f32_32x32x16_bf16 v[168:183], v[80:83], v[188:191], v[168:183]
        s_mov_b64 exec, s[42:43]
        buffer_load_dwordx4 v[144:147], v207, s[8:11], s26 offen
        s_mov_b64 exec, -1
        s_add_u32 s26, s26, s27
  ds_read2st64_b64 v[184:187], v204 offset0:84 offset1:86
  ds_read2st64_b64 v[188:191], v205 offset0:84 offset1:86
  s_waitcnt lgkmcnt(4)
  v_mfma_f32_32x32x16_bf16 v[152:167], v[84:87], v[192:195], v[152:167]
  v_mfma_f32_32x32x16_bf16 v[168:183], v[84:87], v[196:199], v[168:183]
        s_mov_b64 exec, s[42:43]
        buffer_load_dwordx4 v[148:151], v207, s[8:11], s26 offen
        s_mov_b64 exec, -1
        s_add_u32 s26, s26, s27
  ds_read2st64_b64 v[192:195], v204 offset0:88 offset1:90
  ds_read2st64_b64 v[196:199], v205 offset0:88 offset1:90
  s_waitcnt lgkmcnt(4)
  v_mfma_f32_32x32x16_bf16 v[152:167], v[88:91], v[248:251], v[152:167]
  v_mfma_f32_32x32x16_bf16 v[168:183], v[88:91], v[252:255], v[168:183]
  ds_read2st64_b64 v[248:251], v204 offset0:92 offset1:94
  ds_read2st64_b64 v[252:255], v205 offset0:92 offset1:94
  s_waitcnt lgkmcnt(4)
  v_mfma_f32_32x32x16_bf16 v[152:167], v[92:95], v[184:187], v[152:167]
  v_mfma_f32_32x32x16_bf16 v[168:183], v[92:95], v[188:191], v[168:183]
  s_waitcnt vmcnt(10)
  s_barrier
  ds_read2st64_b64 v[184:187], v204 offset0:96 offset1:98
  ds_read2st64_b64 v[188:191], v205 offset0:96 offset1:98
  s_waitcnt lgkmcnt(4)
  v_mfma_f32_32x32x16_bf16 v[152:167], v[96:99], v[192:195], v[152:167]
  v_mfma_f32_32x32x16_bf16 v[168:183], v[96:99], v[196:199], v[168:183]
  ds_read2st64_b64 v[192:195], v204 offset0:100 offset1:102
  ds_read2st64_b64 v[196:199], v205 offset0:100 offset1:102
  s_waitcnt lgkmcnt(4)
  v_mfma_f32_32x32x16_bf16 v[152:167], v[100:103], v[248:251], v[152:167]
  v_mfma_f32_32x32x16_bf16 v[168:183], v[100:103], v[252:255], v[168:183]
  ds_read2st64_b64 v[248:251], v204 offset0:104 offset1:106
  ds_read2st64_b64 v[252:255], v205 offset0:104 offset1:106
  s_waitcnt lgkmcnt(4)
  v_mfma_f32_32x32x16_bf16 v[152:167], v[104:107], v[184:187], v[152:167]
  v_mfma_f32_32x32x16_bf16 v[168:183], v[104:107], v[188:191], v[168:183]
  ds_read2st64_b64 v[184:187], v204 offset0:108 offset1:110
  ds_read2st64_b64 v[188:191], v205 offset0:108 offset1:110
  s_waitcnt lgkmcnt(4)
  v_mfma_f32_32x32x16_bf16 v[152:167], v[108:111], v[192:195], v[152:167]
  v_mfma_f32_32x32x16_bf16 v[168:183], v[108:111], v[196:199], v[168:183]
  s_waitcnt vmcnt(5)
  s_barrier
  ds_read2st64_b64 v[192:195], v204 offset0:112 offset1:114
  ds_read2st64_b64 v[196:199], v205 offset0:112 offset1:114
  s_waitcnt lgkmcnt(4)
  v_mfma_f32_32x32x16_bf16 v[152:167], v[112:115], v[248:251], v[152:167]
  v_mfma_f32_32x32x16_bf16 v[168:183], v[112:115], v[252:255], v[168:183]
  ds_read2st64_b64 v[248:251], v204 offset0:116 offset1:118
  ds_read2st64_b64 v[252:255], v205 offset0:116 offset1:118
  s_waitcnt lgkmcnt(4)
  v_mfma_f32_32x32x16_bf16 v[152:167], v[116:119], v[184:187], v[152:167]
  v_mfma_f32_32x32x16_bf16 v[168:183], v[116:119], v[188:191], v[168:183]
  ds_read2st64_b64 v[184:187], v204 offset0:120 offset1:122
  ds_read2st64_b64 v[188:191], v205 offset0:120 offset1:122
  s_waitcnt lgkmcnt(4)
  v_mfma_f32_32x32x16_bf16 v[152:167], v[120:123], v[192:195], v[152:167]
  v_mfma_f32_32x32x16_bf16 v[168:183], v[120:123], v[196:199], v[168:183]
  ds_read2st64_b64 v[192:195], v204 offset0:124 offset1:126
  ds_read2st64_b64 v[196:199], v205 offset0:124 offset1:126
  s_waitcnt lgkmcnt(4)
  v_mfma_f32_32x32x16_bf16 v[152:167], v[124:127], v[248:251], v[152:167]
  v_mfma_f32_32x32x16_bf16 v[168:183], v[124:127], v[252:255], v[168:183]
  s_waitcnt vmcnt(0)
  s_barrier
  ds_read2st64_b64 v[248:251], v204 offset0:128 offset1:130
  ds_read2st64_b64 v[252:255], v205 offset0:128 offset1:130
  s_waitcnt lgkmcnt(4)
  v_mfma_f32_32x32x16_bf16 v[152:167], v[128:131], v[184:187], v[152:167]
  v_mfma_f32_32x32x16_bf16 v[168:183], v[128:131], v[188:191], v[168:183]
  ds_read2st64_b64 v[184:187], v204 offset0:132 offset1:134
  ds_read2st64_b64 v[188:191], v205 offset0:132 offset1:134
  s_waitcnt lgkmcnt(4)
  v_mfma_f32_32x32x16_bf16 v[152:167], v[132:135], v[192:195], v[152:167]
  v_mfma_f32_32x32x16_bf16 v[168:183], v[132:135], v[196:199], v[168:183]
  ds_read2st64_b64 v[192:195], v204 offset0:136 offset1:138
  ds_read2st64_b64 v[196:199], v205 offset0:136 offset1:138
  s_waitcnt lgkmcnt(4)
  v_mfma_f32_32x32x16_bf16 v[152:167], v[136:139], v[248:251], v[152:167]
  v_mfma_f32_32x32x16_bf16 v[168:183], v[136:139], v[252:255], v[168:183]
  ds_read2st64_b64 v[248:251], v204 offset0:140 offset1:142
  ds_read2st64_b64 v[252:255], v205 offset0:140 offset1:142
  s_waitcnt lgkmcnt(4)
  v_mfma_f32_32x32x16_bf16 v[152:167], v[140:143], v[184:187], v[152:167]
  v_mfma_f32_32x32x16_bf16 v[168:183], v[140:143], v[188:191], v[168:183]
  s_waitcnt lgkmcnt(2)
  v_mfma_f32_32x32x16_bf16 v[152:167], v[144:147], v[192:195], v[152:167]
  v_mfma_f32_32x32x16_bf16 v[168:183], v[144:147], v[196:199], v[168:183]
  s_waitcnt lgkmcnt(0)
  v_mfma_f32_32x32x16_bf16 v[152:167], v[148:151], v[248:251], v[152:167]
  v_mfma_f32_32x32x16_bf16 v[168:183], v[148:151], v[252:255], v[168:183]
  s_barrier
    v_and_b32 v209, 31, v208
    v_lshlrev_b32 v209, 2, v209
    v_add_u32 v209, 73728, v209
    ds_read_b32 v200, v209
    ds_read_b32 v201, v209 offset:128
    s_lshl_b32 s30, s21, 1
    s_waitcnt lgkmcnt(0)
    s_cmp_eq_u32 s20, 2
    s_cbranch_scc1 kfb_kernel_tail
    v_lshlrev_b32 v214, 4, v208
    s_lshl_b32 s31, s20, 11
    v_add_u32 v214, s31, v214
    v_add_u32 v214, 74240, v214
  v_mul_f32 v211, 0x3eae1a93, v200
  v_mul_f32 v152, v152, v211
  v_mul_f32 v153, v153, v211
  v_mul_f32 v154, v154, v211
  v_mul_f32 v155, v155, v211
  v_mul_f32 v156, v156, v211
  v_mul_f32 v157, v157, v211
  v_mul_f32 v158, v158, v211
  v_mul_f32 v159, v159, v211
  v_cvt_pk_bf16_f32 v216, v152, v153
  v_cvt_pk_bf16_f32 v217, v154, v155
  v_cvt_pk_bf16_f32 v218, v156, v157
  v_cvt_pk_bf16_f32 v219, v158, v159
  ds_write_b128 v214, v[216:219] offset:0
  v_mul_f32 v160, v160, v211
  v_mul_f32 v161, v161, v211
  v_mul_f32 v162, v162, v211
  v_mul_f32 v163, v163, v211
  v_mul_f32 v164, v164, v211
  v_mul_f32 v165, v165, v211
  v_mul_f32 v166, v166, v211
  v_mul_f32 v167, v167, v211
  v_cvt_pk_bf16_f32 v220, v160, v161
  v_cvt_pk_bf16_f32 v221, v162, v163
  v_cvt_pk_bf16_f32 v222, v164, v165
  v_cvt_pk_bf16_f32 v223, v166, v167
  ds_write_b128 v214, v[220:223] offset:1024
  v_mul_f32 v211, 0x3eae1a93, v201
  v_mul_f32 v168, v168, v211
  v_mul_f32 v169, v169, v211
  v_mul_f32 v170, v170, v211
  v_mul_f32 v171, v171, v211
  v_mul_f32 v172, v172, v211
  v_mul_f32 v173, v173, v211
  v_mul_f32 v174, v174, v211
  v_mul_f32 v175, v175, v211
  v_cvt_pk_bf16_f32 v224, v168, v169
  v_cvt_pk_bf16_f32 v225, v170, v171
  v_cvt_pk_bf16_f32 v226, v172, v173
  v_cvt_pk_bf16_f32 v227, v174, v175
  ds_write_b128 v214, v[224:227] offset:4096
  v_mul_f32 v176, v176, v211
  v_mul_f32 v177, v177, v211
  v_mul_f32 v178, v178, v211
  v_mul_f32 v179, v179, v211
  v_mul_f32 v180, v180, v211
  v_mul_f32 v181, v181, v211
  v_mul_f32 v182, v182, v211
  v_mul_f32 v183, v183, v211
  v_cvt_pk_bf16_f32 v228, v176, v177
  v_cvt_pk_bf16_f32 v229, v178, v179
  v_cvt_pk_bf16_f32 v230, v180, v181
  v_cvt_pk_bf16_f32 v231, v182, v183
  ds_write_b128 v214, v[228:231] offset:5120
  v_mul_f32 v232, v152, v152
  v_fmac_f32 v232, v153, v153
  v_fmac_f32 v232, v154, v154
  v_fmac_f32 v232, v155, v155
  v_fmac_f32 v232, v156, v156
  v_fmac_f32 v232, v157, v157
  v_fmac_f32 v232, v158, v158
  v_fmac_f32 v232, v159, v159
  v_mul_f32 v233, v160, v160
  v_fmac_f32 v233, v161, v161
  v_fmac_f32 v233, v162, v162
  v_fmac_f32 v233, v163, v163
  v_fmac_f32 v233, v164, v164
  v_fmac_f32 v233, v165, v165
  v_fmac_f32 v233, v166, v166
  v_fmac_f32 v233, v167, v167
  v_mul_f32 v234, v168, v168
  v_fmac_f32 v234, v169, v169
  v_fmac_f32 v234, v170, v170
  v_fmac_f32 v234, v171, v171
  v_fmac_f32 v234, v172, v172
  v_fmac_f32 v234, v173, v173
  v_fmac_f32 v234, v174, v174
  v_fmac_f32 v234, v175, v175
  v_mul_f32 v235, v176, v176
  v_fmac_f32 v235, v177, v177
  v_fmac_f32 v235, v178, v178
  v_fmac_f32 v235, v179, v179
  v_fmac_f32 v235, v180, v180
  v_fmac_f32 v235, v181, v181
  v_fmac_f32 v235, v182, v182
  v_fmac_f32 v235, v183, v183
    v_mov_b32 v209, v232
    v_mov_b32 v210, v232
  s_nop 1
    v_permlane32_swap_b32 v209, v210
    v_add_f32 v232, v209, v210
    v_mov_b32 v209, v233
    v_mov_b32 v210, v233
  s_nop 1
    v_permlane32_swap_b32 v209, v210
    v_add_f32 v233, v209, v210
    v_mov_b32 v209, v234
    v_mov_b32 v210, v234
  s_nop 1
    v_permlane32_swap_b32 v209, v210
    v_add_f32 v234, v209, v210
    v_mov_b32 v209, v235
    v_mov_b32 v210, v235
  s_nop 1
    v_permlane32_swap_b32 v209, v210
    v_add_f32 v235, v209, v210
  v_max3_f32 v212, v232, v233, v234
  v_max_f32 v212, v212, v235
  s_nop 1
  v_max_f32_dpp v212, v212, v212 row_ror:1 row_mask:0xf bank_mask:0xf
  s_nop 1
  v_max_f32_dpp v212, v212, v212 row_ror:2 row_mask:0xf bank_mask:0xf
  s_nop 1
  v_max_f32_dpp v212, v212, v212 row_ror:4 row_mask:0xf bank_mask:0xf
  s_nop 1
  v_max_f32_dpp v212, v212, v212 row_ror:8 row_mask:0xf bank_mask:0xf
    v_mov_b32 v209, v212
    v_mov_b32 v210, v212
  s_nop 1
    v_permlane16_swap_b32 v209, v210
    v_max_f32 v212, v209, v210
    v_mov_b32 v209, v212
    v_mov_b32 v210, v212
  s_nop 1
    v_permlane32_swap_b32 v209, v210
    v_max_f32 v212, v209, v210
    s_lshl_b32 s31, s20, 2
    s_add_u32 s31, s31, 83456
    v_mov_b32 v209, s31
    ds_write_b32 v209, v212
    s_branch kfb_kernel_adone
kfb_kernel_tail:
    s_cmp_lg_u32 s22, 0
    s_cbranch_scc1 kfb_kernel_nok
    s_lshr_b32 s34, s21, 2
    s_mul_i32 s34, s34, 19456
    s_add_u32 s34, s34, 18194432
    s_and_b32 s35, s21, 3
    s_lshl_b32 s35, s35, 1
    v_lshlrev_b32 v214, 4, v208
    v_lshlrev_b32 v204, 3, v208
  v_mul_f32 v156, v156, v200
  v_mul_f32 v157, v157, v200
  v_mul_f32 v158, v158, v200
  v_mul_f32 v159, v159, v200
  v_mul_f32 v160, v160, v200
  v_mul_f32 v161, v161, v200
  v_mul_f32 v162, v162, v200
  v_mul_f32 v163, v163, v200
  v_mul_f32 v164, v164, v200
  v_cvt_pk_bf16_f32 v220, v156, v157
  v_cvt_pk_bf16_f32 v221, v158, v159
  v_cvt_pk_bf16_f32 v222, v160, v161
  v_cvt_pk_bf16_f32 v223, v162, v163
        v_cvt_pk_bf16_f32 v228, v164, v164
        s_add_u32 s33, s35, 0
        s_lshl_b32 s38, s33, 10
        s_add_u32 s38, s38, s34
        buffer_store_dwordx4 v[220:223], v214, s[8:11], s38 offen sc1
        s_lshr_b32 s38, s33, 2
        s_lshl_b32 s38, s38, 9
        s_and_b32 s33, s33, 3
        s_lshl_b32 s33, s33, 1
        s_add_u32 s38, s38, s33
        s_add_u32 s38, s38, s34
        s_add_u32 s38, s38, 8192
        buffer_store_short v228, v204, s[8:11], s38 offen sc1
        v_mul_f32 v240, v156, v156
  v_fmac_f32 v240, v157, v157
  v_fmac_f32 v240, v158, v158
  v_fmac_f32 v240, v159, v159
  v_fmac_f32 v240, v160, v160
  v_fmac_f32 v240, v161, v161
  v_fmac_f32 v240, v162, v162
  v_fmac_f32 v240, v163, v163
  v_fmac_f32 v240, v164, v164
  v_mul_f32 v172, v172, v201
  v_mul_f32 v173, v173, v201
  v_mul_f32 v174, v174, v201
  v_mul_f32 v175, v175, v201
  v_mul_f32 v176, v176, v201
  v_mul_f32 v177, v177, v201
  v_mul_f32 v178, v178, v201
  v_mul_f32 v179, v179, v201
  v_mul_f32 v180, v180, v201
  v_cvt_pk_bf16_f32 v224, v172, v173
  v_cvt_pk_bf16_f32 v225, v174, v175
  v_cvt_pk_bf16_f32 v226, v176, v177
  v_cvt_pk_bf16_f32 v227, v178, v179
        v_cvt_pk_bf16_f32 v229, v180, v180
        s_add_u32 s33, s35, 1
        s_lshl_b32 s38, s33, 10
        s_add_u32 s38, s38, s34
        buffer_store_dwordx4 v[224:227], v214, s[8:11], s38 offen sc1
        s_lshr_b32 s38, s33, 2
        s_lshl_b32 s38, s38, 9
        s_and_b32 s33, s33, 3
        s_lshl_b32 s33, s33, 1
        s_add_u32 s38, s38, s33
        s_add_u32 s38, s38, s34
        s_add_u32 s38, s38, 8192
        buffer_store_short v229, v204, s[8:11], s38 offen sc1
        v_mul_f32 v241, v172, v172
  v_fmac_f32 v241, v173, v173
  v_fmac_f32 v241, v174, v174
  v_fmac_f32 v241, v175, v175
  v_fmac_f32 v241, v176, v176
  v_fmac_f32 v241, v177, v177
  v_fmac_f32 v241, v178, v178
  v_fmac_f32 v241, v179, v179
  v_fmac_f32 v241, v180, v180
    v_mov_b32 v209, v240
    v_mov_b32 v210, v240
  s_nop 1
    v_permlane32_swap_b32 v209, v210
    v_add_f32 v240, v209, v210
    v_mov_b32 v209, v241
    v_mov_b32 v210, v241
  s_nop 1
    v_permlane32_swap_b32 v209, v210
    v_add_f32 v241, v209, v210
  v_max_f32 v212, v240, v241
  s_nop 1
  v_max_f32_dpp v212, v212, v212 row_ror:1 row_mask:0xf bank_mask:0xf
  s_nop 1
  v_max_f32_dpp v212, v212, v212 row_ror:2 row_mask:0xf bank_mask:0xf
  s_nop 1
  v_max_f32_dpp v212, v212, v212 row_ror:4 row_mask:0xf bank_mask:0xf
  s_nop 1
  v_max_f32_dpp v212, v212, v212 row_ror:8 row_mask:0xf bank_mask:0xf
    v_mov_b32 v209, v212
    v_mov_b32 v210, v212
  s_nop 1
    v_permlane16_swap_b32 v209, v210
    v_max_f32 v212, v209, v210
    v_mov_b32 v209, v212
    v_mov_b32 v210, v212
  s_nop 1
    v_permlane32_swap_b32 v209, v210
    v_max_f32 v212, v209, v210
    s_lshl_b32 s33, s21, 2
    s_add_u32 s33, s33, 9547776
    v_mov_b32 v210, 0
    s_mov_b64 exec, 1
    buffer_store_dword v212, v210, s[8:11], s33 offen sc1
    s_mov_b64 exec, -1
  s_waitcnt vmcnt(0)
        v_lshlrev_b32 v209, 7, v208
        v_mov_b32 v210, 1
        s_and_b32 s33, s21, 7
        s_lshl_b32 s33, s33, 10
        s_add_u32 s33, s33, 26230784
        s_mov_b64 exec, 0xff
        buffer_atomic_add v210, v209, s[8:11], s33 offen sc1
        s_mov_b64 exec, -1
kfb_kernel_nok:
    v_lshlrev_b32 v214, 3, v208
    v_add_u32 v214, 82432, v214
  v_mul_f32 v211, 0x3eae1a93, v200
  v_mul_f32 v152, v152, v211
  v_mul_f32 v153, v153, v211
  v_mul_f32 v154, v154, v211
  v_mul_f32 v155, v155, v211
        v_cvt_pk_bf16_f32 v216, v152, v153
        v_cvt_pk_bf16_f32 v217, v154, v155
        ds_write_b64 v214, v[216:217] offset:0
  v_mul_f32 v232, v152, v152
  v_mul_f32 v233, v153, v153
  v_mul_f32 v234, v154, v154
  v_mul_f32 v235, v155, v155
  v_mul_f32 v211, 0x3eae1a93, v201
  v_mul_f32 v168, v168, v211
  v_mul_f32 v169, v169, v211
  v_mul_f32 v170, v170, v211
  v_mul_f32 v171, v171, v211
        v_cvt_pk_bf16_f32 v218, v168, v169
        v_cvt_pk_bf16_f32 v219, v170, v171
        ds_write_b64 v214, v[218:219] offset:512
  v_mul_f32 v236, v168, v168
  v_mul_f32 v237, v169, v169
  v_mul_f32 v238, v170, v170
  v_mul_f32 v239, v171, v171
    v_mov_b32 v209, v232
    v_mov_b32 v210, v232
  s_nop 1
    v_permlane32_swap_b32 v209, v210
    v_add_f32 v232, v209, v210
    v_mov_b32 v209, v233
    v_mov_b32 v210, v233
  s_nop 1
    v_permlane32_swap_b32 v209, v210
    v_add_f32 v233, v209, v210
    v_mov_b32 v209, v234
    v_mov_b32 v210, v234
  s_nop 1
    v_permlane32_swap_b32 v209, v210
    v_add_f32 v234, v209, v210
    v_mov_b32 v209, v235
    v_mov_b32 v210, v235
  s_nop 1
    v_permlane32_swap_b32 v209, v210
    v_add_f32 v235, v209, v210
    v_mov_b32 v209, v236
    v_mov_b32 v210, v236
  s_nop 1
    v_permlane32_swap_b32 v209, v210
    v_add_f32 v236, v209, v210
    v_mov_b32 v209, v237
    v_mov_b32 v210, v237
  s_nop 1
    v_permlane32_swap_b32 v209, v210
    v_add_f32 v237, v209, v210
    v_mov_b32 v209, v238
    v_mov_b32 v210, v238
  s_nop 1
    v_permlane32_swap_b32 v209, v210
    v_add_f32 v238, v209, v210
    v_mov_b32 v209, v239
    v_mov_b32 v210, v239
  s_nop 1
    v_permlane32_swap_b32 v209, v210
    v_add_f32 v239, v209, v210
    v_max3_f32 v212, v232, v233, v234
    v_max3_f32 v212, v212, v235, v236
    v_max3_f32 v212, v212, v237, v238
    v_max_f32 v212, v212, v239
  s_nop 1
  v_max_f32_dpp v212, v212, v212 row_ror:1 row_mask:0xf bank_mask:0xf
  s_nop 1
  v_max_f32_dpp v212, v212, v212 row_ror:2 row_mask:0xf bank_mask:0xf
  s_nop 1
  v_max_f32_dpp v212, v212, v212 row_ror:4 row_mask:0xf bank_mask:0xf
  s_nop 1
  v_max_f32_dpp v212, v212, v212 row_ror:8 row_mask:0xf bank_mask:0xf
    v_mov_b32 v209, v212
    v_mov_b32 v210, v212
  s_nop 1
    v_permlane16_swap_b32 v209, v210
    v_max_f32 v212, v209, v210
    v_mov_b32 v209, v212
    v_mov_b32 v210, v212
  s_nop 1
    v_permlane32_swap_b32 v209, v210
    v_max_f32 v212, v209, v210
    v_mov_b32 v209, 83464
    ds_write_b32 v209, v212
    s_branch kfb_kernel_adone
kfb_kernel_xmain:
        s_sub_u32 s50, s20, 4
        v_lshrrev_b32 v211, 5, v208
        v_and_b32 v210, 31, v208
        v_mul_u32_u24 v207, 9216, v211
        v_lshl_add_u32 v207, v210, 4, v207
        s_mul_i32 s26, s22, 1152
        s_lshl_b32 s27, s50, 9
        s_add_u32 s26, s26, s27
        s_add_u32 s26, s26, 12836864
        s_mov_b32 s27, 18432
        s_cmp_eq_u32 s50, 2
        s_cbranch_scc0 kfb_kernel_xall
        s_mov_b32 s42, 0xff
        s_mov_b32 s43, 0xff
kfb_kernel_xall:
        s_mov_b32 m0, s25
        s_add_u32 s25, s25, 8192
        buffer_load_dwordx4 v206, s[8:11], s24 offen lds
        s_add_u32 s24, s24, 264192
  s_barrier
        s_mov_b32 m0, s25
        s_add_u32 s25, s25, 8192
        buffer_load_dwordx4 v206, s[8:11], s24 offen lds
        s_add_u32 s24, s24, 264192
  s_barrier
        s_mov_b32 m0, s25
        s_add_u32 s25, s25, 8192
        buffer_load_dwordx4 v206, s[8:11], s24 offen lds
        s_add_u32 s24, s24, 264192
        s_mov_b32 m0, s25
        s_add_u32 s25, s25, 8192
        buffer_load_dwordx4 v206, s[8:11], s24 offen lds
        s_add_u32 s24, s24, 264192
        s_mov_b32 m0, s25
        s_add_u32 s25, s25, 8192
        buffer_load_dwordx4 v206, s[8:11], s24 offen lds
        s_add_u32 s24, s24, 264192
        s_mov_b32 m0, s25
        s_add_u32 s25, s25, 8192
        buffer_load_dwordx4 v206, s[8:11], s24 offen lds
        s_add_u32 s24, s24, 264192
        s_mov_b32 m0, s25
        s_add_u32 s25, s25, 8192
        buffer_load_dwordx4 v206, s[8:11], s24 offen lds
        s_add_u32 s24, s24, 264192
        s_mov_b32 m0, s25
        s_add_u32 s25, s25, 8192
        buffer_load_dwordx4 v206, s[8:11], s24 offen lds
        s_add_u32 s24, s24, 264192
        s_mov_b32 m0, s25
        s_add_u32 s25, s25, 8192
        buffer_load_dwordx4 v206, s[8:11], s24 offen lds
        s_add_u32 s24, s24, 264192
  s_waitcnt vmcnt(8)
  s_barrier
  s_waitcnt vmcnt(7)
  s_barrier
  s_waitcnt vmcnt(6)
  s_barrier
  s_waitcnt vmcnt(5)
  s_barrier
  s_waitcnt vmcnt(4)
  s_barrier
  s_waitcnt vmcnt(3)
  s_barrier
  s_waitcnt vmcnt(2)
  s_barrier
  s_waitcnt vmcnt(1)
  s_barrier
        s_mov_b64 exec, s[42:43]
        buffer_load_dwordx4 v[8:11], v207, s[8:11], s26 offen
        s_mov_b64 exec, -1
        s_add_u32 s26, s26, s27
        s_mov_b64 exec, s[42:43]
        buffer_load_dwordx4 v[12:15], v207, s[8:11], s26 offen
        s_mov_b64 exec, -1
        s_add_u32 s26, s26, s27
        s_mov_b64 exec, s[42:43]
        buffer_load_dwordx4 v[16:19], v207, s[8:11], s26 offen
        s_mov_b64 exec, -1
        s_add_u32 s26, s26, s27
        s_mov_b64 exec, s[42:43]
        buffer_load_dwordx4 v[20:23], v207, s[8:11], s26 offen
        s_mov_b64 exec, -1
        s_add_u32 s26, s26, s27
        s_mov_b64 exec, s[42:43]
        buffer_load_dwordx4 v[24:27], v207, s[8:11], s26 offen
        s_mov_b64 exec, -1
        s_add_u32 s26, s26, s27
        s_mov_b64 exec, s[42:43]
        buffer_load_dwordx4 v[28:31], v207, s[8:11], s26 offen
        s_mov_b64 exec, -1
        s_add_u32 s26, s26, s27
  s_waitcnt vmcnt(6)
  s_barrier
        s_mov_b64 exec, s[42:43]
        buffer_load_dwordx4 v[32:35], v207, s[8:11], s26 offen
        s_mov_b64 exec, -1
        s_add_u32 s26, s26, s27
        s_mov_b64 exec, s[42:43]
        buffer_load_dwordx4 v[36:39], v207, s[8:11], s26 offen
        s_mov_b64 exec, -1
        s_add_u32 s26, s26, s27
        s_mov_b64 exec, s[42:43]
        buffer_load_dwordx4 v[40:43], v207, s[8:11], s26 offen
        s_mov_b64 exec, -1
        s_add_u32 s26, s26, s27
        s_mov_b64 exec, s[42:43]
        buffer_load_dwordx4 v[44:47], v207, s[8:11], s26 offen
        s_mov_b64 exec, -1
        s_add_u32 s26, s26, s27
        s_mov_b64 exec, s[42:43]
        buffer_load_dwordx4 v[48:51], v207, s[8:11], s26 offen
        s_mov_b64 exec, -1
        s_add_u32 s26, s26, s27
        s_mov_b64 exec, s[42:43]
        buffer_load_dwordx4 v[52:55], v207, s[8:11], s26 offen
        s_mov_b64 exec, -1
        s_add_u32 s26, s26, s27
  s_barrier
  ds_read2st64_b64 v[184:187], v204 offset0:0 offset1:2
  ds_read2st64_b64 v[188:191], v205 offset0:0 offset1:2
  ds_read2st64_b64 v[192:195], v204 offset0:4 offset1:6
  ds_read2st64_b64 v[196:199], v205 offset0:4 offset1:6
  ds_read2st64_b64 v[248:251], v204 offset0:8 offset1:10
  ds_read2st64_b64 v[252:255], v205 offset0:8 offset1:10
  s_waitcnt lgkmcnt(4)
  s_waitcnt vmcnt(11)
  v_mfma_f32_32x32x16_bf16 v[152:167], v[8:11], v[184:187], 0
  v_mfma_f32_32x32x16_bf16 v[168:183], v[8:11], v[188:191], 0
        s_mov_b64 exec, s[42:43]
        buffer_load_dwordx4 v[56:59], v207, s[8:11], s26 offen
        s_mov_b64 exec, -1
        s_add_u32 s26, s26, s27
  ds_read2st64_b64 v[184:187], v204 offset0:12 offset1:14
  ds_read2st64_b64 v[188:191], v205 offset0:12 offset1:14
  s_waitcnt lgkmcnt(4)
  s_waitcnt vmcnt(11)
  v_mfma_f32_32x32x16_bf16 v[152:167], v[12:15], v[192:195], v[152:167]
  v_mfma_f32_32x32x16_bf16 v[168:183], v[12:15], v[196:199], v[168:183]
        s_mov_b64 exec, s[42:43]
        buffer_load_dwordx4 v[60:63], v207, s[8:11], s26 offen
        s_mov_b64 exec, -1
        s_add_u32 s26, s26, s27
  ds_read2st64_b64 v[192:195], v204 offset0:16 offset1:18
  ds_read2st64_b64 v[196:199], v205 offset0:16 offset1:18
  s_waitcnt lgkmcnt(4)
  s_waitcnt vmcnt(11)
  v_mfma_f32_32x32x16_bf16 v[152:167], v[16:19], v[248:251], v[152:167]
  v_mfma_f32_32x32x16_bf16 v[168:183], v[16:19], v[252:255], v[168:183]
        s_mov_b64 exec, s[42:43]
        buffer_load_dwordx4 v[64:67], v207, s[8:11], s26 offen
        s_mov_b64 exec, -1
        s_add_u32 s26, s26, s27
  ds_read2st64_b64 v[248:251], v204 offset0:20 offset1:22
  ds_read2st64_b64 v[252:255], v205 offset0:20 offset1:22
  s_waitcnt lgkmcnt(4)
  s_waitcnt vmcnt(11)
  v_mfma_f32_32x32x16_bf16 v[152:167], v[20:23], v[184:187], v[152:167]
  v_mfma_f32_32x32x16_bf16 v[168:183], v[20:23], v[188:191], v[168:183]
        s_mov_b64 exec, s[42:43]
        buffer_load_dwordx4 v[68:71], v207, s[8:11], s26 offen
        s_mov_b64 exec, -1
        s_add_u32 s26, s26, s27
  ds_read2st64_b64 v[184:187], v204 offset0:24 offset1:26
  ds_read2st64_b64 v[188:191], v205 offset0:24 offset1:26
  s_waitcnt lgkmcnt(4)
  s_waitcnt vmcnt(11)
  v_mfma_f32_32x32x16_bf16 v[152:167], v[24:27], v[192:195], v[152:167]
  v_mfma_f32_32x32x16_bf16 v[168:183], v[24:27], v[196:199], v[168:183]
        s_mov_b64 exec, s[42:43]
        buffer_load_dwordx4 v[72:75], v207, s[8:11], s26 offen
        s_mov_b64 exec, -1
        s_add_u32 s26, s26, s27
  ds_read2st64_b64 v[192:195], v204 offset0:28 offset1:30
  ds_read2st64_b64 v[196:199], v205 offset0:28 offset1:30
  s_waitcnt lgkmcnt(4)
  s_waitcnt vmcnt(11)
  v_mfma_f32_32x32x16_bf16 v[152:167], v[28:31], v[248:251], v[152:167]
  v_mfma_f32_32x32x16_bf16 v[168:183], v[28:31], v[252:255], v[168:183]
        s_mov_b64 exec, s[42:43]
        buffer_load_dwordx4 v[76:79], v207, s[8:11], s26 offen
        s_mov_b64 exec, -1
        s_add_u32 s26, s26, s27
  ds_read2st64_b64 v[248:251], v204 offset0:32 offset1:34
  ds_read2st64_b64 v[252:255], v205 offset0:32 offset1:34
  s_waitcnt lgkmcnt(4)
  s_waitcnt vmcnt(11)
  v_mfma_f32_32x32x16_bf16 v[152:167], v[32:35], v[184:187], v[152:167]
  v_mfma_f32_32x32x16_bf16 v[168:183], v[32:35], v[188:191], v[168:183]
        s_mov_b64 exec, s[42:43]
        buffer_load_dwordx4 v[80:83], v207, s[8:11], s26 offen
        s_mov_b64 exec, -1
        s_add_u32 s26, s26, s27
  ds_read2st64_b64 v[184:187], v204 offset0:36 offset1:38
  ds_read2st64_b64 v[188:191], v205 offset0:36 offset1:38
  s_waitcnt lgkmcnt(4)
  s_waitcnt vmcnt(11)
  v_mfma_f32_32x32x16_bf16 v[152:167], v[36:39], v[192:195], v[152:167]
  v_mfma_f32_32x32x16_bf16 v[168:183], v[36:39], v[196:199], v[168:183]
        s_mov_b64 exec, s[42:43]
        buffer_load_dwordx4 v[84:87], v207, s[8:11], s26 offen
        s_mov_b64 exec, -1
        s_add_u32 s26, s26, s27
  ds_read2st64_b64 v[192:195], v204 offset0:40 offset1:42
  ds_read2st64_b64 v[196:199], v205 offset0:40 offset1:42
  s_waitcnt lgkmcnt(4)
  s_waitcnt vmcnt(11)
  v_mfma_f32_32x32x16_bf16 v[152:167], v[40:43], v[248:251], v[152:167]
  v_mfma_f32_32x32x16_bf16 v[168:183], v[40:43], v[252:255], v[168:183]
        s_mov_b64 exec, s[42:43]
        buffer_load_dwordx4 v[88:91], v207, s[8:11], s26 offen
        s_mov_b64 exec, -1
        s_add_u32 s26, s26, s27
  ds_read2st64_b64 v[248:251], v204 offset0:44 offset1:46
  ds_read2st64_b64 v[252:255], v205 offset0:44 offset1:46
  s_waitcnt lgkmcnt(4)
  s_waitcnt vmcnt(11)
  v_mfma_f32_32x32x16_bf16 v[152:167], v[44:47], v[184:187], v[152:167]
  v_mfma_f32_32x32x16_bf16 v[168:183], v[44:47], v[188:191], v[168:183]
        s_mov_b64 exec, s[42:43]
        buffer_load_dwordx4 v[92:95], v207, s[8:11], s26 offen
        s_mov_b64 exec, -1
        s_add_u32 s26, s26, s27
  ds_read2st64_b64 v[184:187], v204 offset0:48 offset1:50
  ds_read2st64_b64 v[188:191], v205 offset0:48 offset1:50
  s_waitcnt lgkmcnt(4)
  s_waitcnt vmcnt(11)
  v_mfma_f32_32x32x16_bf16 v[152:167], v[48:51], v[192:195], v[152:167]
  v_mfma_f32_32x32x16_bf16 v[168:183], v[48:51], v[196:199], v[168:183]
        s_mov_b64 exec, s[42:43]
        buffer_load_dwordx4 v[96:99], v207, s[8:11], s26 offen
        s_mov_b64 exec, -1
        s_add_u32 s26, s26, s27
  ds_read2st64_b64 v[192:195], v204 offset0:52 offset1:54
  ds_read2st64_b64 v[196:199], v205 offset0:52 offset1:54
  s_waitcnt lgkmcnt(4)
  s_waitcnt vmcnt(11)
  v_mfma_f32_32x32x16_bf16 v[152:167], v[52:55], v[248:251], v[152:167]
  v_mfma_f32_32x32x16_bf16 v[168:183], v[52:55], v[252:255], v[168:183]
        s_mov_b64 exec, s[42:43]
        buffer_load_dwordx4 v[100:103], v207, s[8:11], s26 offen
        s_mov_b64 exec, -1
        s_add_u32 s26, s26, s27
  ds_read2st64_b64 v[248:251], v204 offset0:56 offset1:58
  ds_read2st64_b64 v[252:255], v205 offset0:56 offset1:58
  s_waitcnt lgkmcnt(4)
  s_waitcnt vmcnt(11)
  v_mfma_f32_32x32x16_bf16 v[152:167], v[56:59], v[184:187], v[152:167]
  v_mfma_f32_32x32x16_bf16 v[168:183], v[56:59], v[188:191], v[168:183]
        s_mov_b64 exec, s[42:43]
        buffer_load_dwordx4 v[104:107], v207, s[8:11], s26 offen
        s_mov_b64 exec, -1
        s_add_u32 s26, s26, s27
  ds_read2st64_b64 v[184:187], v204 offset0:60 offset1:62
  ds_read2st64_b64 v[188:191], v205 offset0:60 offset1:62
  s_waitcnt lgkmcnt(4)
  s_waitcnt vmcnt(11)
  v_mfma_f32_32x32x16_bf16 v[152:167], v[60:63], v[192:195], v[152:167]
  v_mfma_f32_32x32x16_bf16 v[168:183], v[60:63], v[196:199], v[168:183]
        s_mov_b64 exec, s[42:43]
        buffer_load_dwordx4 v[108:111], v207, s[8:11], s26 offen
        s_mov_b64 exec, -1
        s_add_u32 s26, s26, s27
  ds_read2st64_b64 v[192:195], v204 offset0:64 offset1:66
  ds_read2st64_b64 v[196:199], v205 offset0:64 offset1:66
  s_waitcnt lgkmcnt(4)
  s_waitcnt vmcnt(11)
  v_mfma_f32_32x32x16_bf16 v[152:167], v[64:67], v[248:251], v[152:167]
  v_mfma_f32_32x32x16_bf16 v[168:183], v[64:67], v[252:255], v[168:183]
        s_mov_b64 exec, s[42:43]
        buffer_load_dwordx4 v[112:115], v207, s[8:11], s26 offen
        s_mov_b64 exec, -1
        s_add_u32 s26, s26, s27
  ds_read2st64_b64 v[248:251], v204 offset0:68 offset1:70
  ds_read2st64_b64 v[252:255], v205 offset0:68 offset1:70
  s_waitcnt lgkmcnt(4)
  s_waitcnt vmcnt(11)
  v_mfma_f32_32x32x16_bf16 v[152:167], v[68:71], v[184:187], v[152:167]
  v_mfma_f32_32x32x16_bf16 v[168:183], v[68:71], v[188:191], v[168:183]
        s_mov_b64 exec, s[42:43]
        buffer_load_dwordx4 v[116:119], v207, s[8:11], s26 offen
        s_mov_b64 exec, -1
        s_add_u32 s26, s26, s27
  ds_read2st64_b64 v[184:187], v204 offset0:72 offset1:74
  ds_read2st64_b64 v[188:191], v205 offset0:72 offset1:74
  s_waitcnt lgkmcnt(4)
  s_waitcnt vmcnt(11)
  v_mfma_f32_32x32x16_bf16 v[152:167], v[72:75], v[192:195], v[152:167]
  v_mfma_f32_32x32x16_bf16 v[168:183], v[72:75], v[196:199], v[168:183]
        s_mov_b64 exec, s[42:43]
        buffer_load_dwordx4 v[120:123], v207, s[8:11], s26 offen
        s_mov_b64 exec, -1
        s_add_u32 s26, s26, s27
  ds_read2st64_b64 v[192:195], v204 offset0:76 offset1:78
  ds_read2st64_b64 v[196:199], v205 offset0:76 offset1:78
  s_waitcnt lgkmcnt(4)
  s_waitcnt vmcnt(11)
  v_mfma_f32_32x32x16_bf16 v[152:167], v[76:79], v[248:251], v[152:167]
  v_mfma_f32_32x32x16_bf16 v[168:183], v[76:79], v[252:255], v[168:183]
        s_mov_b64 exec, s[42:43]
        buffer_load_dwordx4 v[124:127], v207, s[8:11], s26 offen
        s_mov_b64 exec, -1
        s_add_u32 s26, s26, s27
  ds_read2st64_b64 v[248:251], v204 offset0:80 offset1:82
  ds_read2st64_b64 v[252:255], v205 offset0:80 offset1:82
  s_waitcnt lgkmcnt(4)
  s_waitcnt vmcnt(11)
  v_mfma_f32_32x32x16_bf16 v[152:167], v[80:83], v[184:187], v[152:167]
  v_mfma_f32_32x32x16_bf16 v[168:183], v[80:83], v[188:191], v[168:183]
        s_mov_b64 exec, s[42:43]
        buffer_load_dwordx4 v[128:131], v207, s[8:11], s26 offen
        s_mov_b64 exec, -1
        s_add_u32 s26, s26, s27
  ds_read2st64_b64 v[184:187], v204 offset0:84 offset1:86
  ds_read2st64_b64 v[188:191], v205 offset0:84 offset1:86
  s_waitcnt lgkmcnt(4)
  s_waitcnt vmcnt(11)
  v_mfma_f32_32x32x16_bf16 v[152:167], v[84:87], v[192:195], v[152:167]
  v_mfma_f32_32x32x16_bf16 v[168:183], v[84:87], v[196:199], v[168:183]
        s_mov_b64 exec, s[42:43]
        buffer_load_dwordx4 v[132:135], v207, s[8:11], s26 offen
        s_mov_b64 exec, -1
        s_add_u32 s26, s26, s27
  ds_read2st64_b64 v[192:195], v204 offset0:88 offset1:90
  ds_read2st64_b64 v[196:199], v205 offset0:88 offset1:90
  s_waitcnt lgkmcnt(4)
  s_waitcnt vmcnt(11)
  v_mfma_f32_32x32x16_bf16 v[152:167], v[88:91], v[248:251], v[152:167]
  v_mfma_f32_32x32x16_bf16 v[168:183], v[88:91], v[252:255], v[168:183]
        s_mov_b64 exec, s[42:43]
        buffer_load_dwordx4 v[136:139], v207, s[8:11], s26 offen
        s_mov_b64 exec, -1
        s_add_u32 s26, s26, s27
  ds_read2st64_b64 v[248:251], v204 offset0:92 offset1:94
  ds_read2st64_b64 v[252:255], v205 offset0:92 offset1:94
  s_waitcnt lgkmcnt(4)
  s_waitcnt vmcnt(11)
  v_mfma_f32_32x32x16_bf16 v[152:167], v[92:95], v[184:187], v[152:167]
  v_mfma_f32_32x32x16_bf16 v[168:183], v[92:95], v[188:191], v[168:183]
        s_mov_b64 exec, s[42:43]
        buffer_load_dwordx4 v[140:143], v207, s[8:11], s26 offen
        s_mov_b64 exec, -1
        s_add_u32 s26, s26, s27
  ds_read2st64_b64 v[184:187], v204 offset0:96 offset1:98
  ds_read2st64_b64 v[188:191], v205 offset0:96 offset1:98
  s_waitcnt lgkmcnt(4)
  s_waitcnt vmcnt(11)
  v_mfma_f32_32x32x16_bf16 v[152:167], v[96:99], v[192:195], v[152:167]
  v_mfma_f32_32x32x16_bf16 v[168:183], v[96:99], v[196:199], v[168:183]
        s_mov_b64 exec, s[42:43]
        buffer_load_dwordx4 v[144:147], v207, s[8:11], s26 offen
        s_mov_b64 exec, -1
        s_add_u32 s26, s26, s27
  ds_read2st64_b64 v[192:195], v204 offset0:100 offset1:102
  ds_read2st64_b64 v[196:199], v205 offset0:100 offset1:102
  s_waitcnt lgkmcnt(4)
  s_waitcnt vmcnt(11)
  v_mfma_f32_32x32x16_bf16 v[152:167], v[100:103], v[248:251], v[152:167]
  v_mfma_f32_32x32x16_bf16 v[168:183], v[100:103], v[252:255], v[168:183]
        s_mov_b64 exec, s[42:43]
        buffer_load_dwordx4 v[148:151], v207, s[8:11], s26 offen
        s_mov_b64 exec, -1
        s_add_u32 s26, s26, s27
  ds_read2st64_b64 v[248:251], v204 offset0:104 offset1:106
  ds_read2st64_b64 v[252:255], v205 offset0:104 offset1:106
  s_waitcnt lgkmcnt(4)
  s_waitcnt vmcnt(11)
  v_mfma_f32_32x32x16_bf16 v[152:167], v[104:107], v[184:187], v[152:167]
  v_mfma_f32_32x32x16_bf16 v[168:183], v[104:107], v[188:191], v[168:183]
  ds_read2st64_b64 v[184:187], v204 offset0:108 offset1:110
  ds_read2st64_b64 v[188:191], v205 offset0:108 offset1:110
  s_waitcnt lgkmcnt(4)
  s_waitcnt vmcnt(10)
  v_mfma_f32_32x32x16_bf16 v[152:167], v[108:111], v[192:195], v[152:167]
  v_mfma_f32_32x32x16_bf16 v[168:183], v[108:111], v[196:199], v[168:183]
  ds_read2st64_b64 v[192:195], v204 offset0:112 offset1:114
  ds_read2st64_b64 v[196:199], v205 offset0:112 offset1:114
  s_waitcnt lgkmcnt(4)
  s_waitcnt vmcnt(9)
  v_mfma_f32_32x32x16_bf16 v[152:167], v[112:115], v[248:251], v[152:167]
  v_mfma_f32_32x32x16_bf16 v[168:183], v[112:115], v[252:255], v[168:183]
  ds_read2st64_b64 v[248:251], v204 offset0:116 offset1:118
  ds_read2st64_b64 v[252:255], v205 offset0:116 offset1:118
  s_waitcnt lgkmcnt(4)
  s_waitcnt vmcnt(8)
  v_mfma_f32_32x32x16_bf16 v[152:167], v[116:119], v[184:187], v[152:167]
  v_mfma_f32_32x32x16_bf16 v[168:183], v[116:119], v[188:191], v[168:183]
  ds_read2st64_b64 v[184:187], v204 offset0:120 offset1:122
  ds_read2st64_b64 v[188:191], v205 offset0:120 offset1:122
  s_waitcnt lgkmcnt(4)
  s_waitcnt vmcnt(7)
  v_mfma_f32_32x32x16_bf16 v[152:167], v[120:123], v[192:195], v[152:167]
  v_mfma_f32_32x32x16_bf16 v[168:183], v[120:123], v[196:199], v[168:183]
  ds_read2st64_b64 v[192:195], v204 offset0:124 offset1:126
  ds_read2st64_b64 v[196:199], v205 offset0:124 offset1:126
  s_waitcnt lgkmcnt(4)
  s_waitcnt vmcnt(6)
  v_mfma_f32_32x32x16_bf16 v[152:167], v[124:127], v[248:251], v[152:167]
  v_mfma_f32_32x32x16_bf16 v[168:183], v[124:127], v[252:255], v[168:183]
  ds_read2st64_b64 v[248:251], v204 offset0:128 offset1:130
  ds_read2st64_b64 v[252:255], v205 offset0:128 offset1:130
  s_waitcnt lgkmcnt(4)
  s_waitcnt vmcnt(5)
  v_mfma_f32_32x32x16_bf16 v[152:167], v[128:131], v[184:187], v[152:167]
  v_mfma_f32_32x32x16_bf16 v[168:183], v[128:131], v[188:191], v[168:183]
  ds_read2st64_b64 v[184:187], v204 offset0:132 offset1:134
  ds_read2st64_b64 v[188:191], v205 offset0:132 offset1:134
  s_waitcnt lgkmcnt(4)
  s_waitcnt vmcnt(4)
  v_mfma_f32_32x32x16_bf16 v[152:167], v[132:135], v[192:195], v[152:167]
  v_mfma_f32_32x32x16_bf16 v[168:183], v[132:135], v[196:199], v[168:183]
  ds_read2st64_b64 v[192:195], v204 offset0:136 offset1:138
  ds_read2st64_b64 v[196:199], v205 offset0:136 offset1:138
  s_waitcnt lgkmcnt(4)
  s_waitcnt vmcnt(3)
  v_mfma_f32_32x32x16_bf16 v[152:167], v[136:139], v[248:251], v[152:167]
  v_mfma_f32_32x32x16_bf16 v[168:183], v[136:139], v[252:255], v[168:183]
  ds_read2st64_b64 v[248:251], v204 offset0:140 offset1:142
  ds_read2st64_b64 v[252:255], v205 offset0:140 offset1:142
  s_waitcnt lgkmcnt(4)
  s_waitcnt vmcnt(2)
  v_mfma_f32_32x32x16_bf16 v[152:167], v[140:143], v[184:187], v[152:167]
  v_mfma_f32_32x32x16_bf16 v[168:183], v[140:143], v[188:191], v[168:183]
  s_waitcnt lgkmcnt(2)
  s_waitcnt vmcnt(1)
  v_mfma_f32_32x32x16_bf16 v[152:167], v[144:147], v[192:195], v[152:167]
  v_mfma_f32_32x32x16_bf16 v[168:183], v[144:147], v[196:199], v[168:183]
  s_waitcnt lgkmcnt(0)
  s_waitcnt vmcnt(0)
  v_mfma_f32_32x32x16_bf16 v[152:167], v[148:151], v[248:251], v[152:167]
  v_mfma_f32_32x32x16_bf16 v[168:183], v[148:151], v[252:255], v[168:183]
        s_lshl_b32 s33, s21, 3
        s_add_u32 s33, s33, s22
        s_mul_i32 s33, s33, 12288
        s_add_u32 s33, s33, 23068672
        s_cmp_eq_u32 s50, 2
        s_cbranch_scc1 kfb_kernel_x2
        s_lshl_b32 s34, s50, 12
        s_add_u32 s33, s33, s34
        v_lshlrev_b32 v214, 4, v208
  s_nop 1
  v_cvt_pk_bf16_f32 v216, v152, v153
  v_cvt_pk_bf16_f32 v217, v154, v155
  v_cvt_pk_bf16_f32 v218, v156, v157
  v_cvt_pk_bf16_f32 v219, v158, v159
  v_cvt_pk_bf16_f32 v220, v160, v161
  v_cvt_pk_bf16_f32 v221, v162, v163
  v_cvt_pk_bf16_f32 v222, v164, v165
  v_cvt_pk_bf16_f32 v223, v166, v167
  buffer_store_dwordx4 v[216:219], v214, s[8:11], s33 offen offset:0 sc1
  buffer_store_dwordx4 v[220:223], v214, s[8:11], s33 offen offset:1024 sc1
  v_cvt_pk_bf16_f32 v224, v168, v169
  v_cvt_pk_bf16_f32 v225, v170, v171
  v_cvt_pk_bf16_f32 v226, v172, v173
  v_cvt_pk_bf16_f32 v227, v174, v175
  v_cvt_pk_bf16_f32 v228, v176, v177
  v_cvt_pk_bf16_f32 v229, v178, v179
  v_cvt_pk_bf16_f32 v230, v180, v181
  v_cvt_pk_bf16_f32 v231, v182, v183
  buffer_store_dwordx4 v[224:227], v214, s[8:11], s33 offen offset:2048 sc1
  buffer_store_dwordx4 v[228:231], v214, s[8:11], s33 offen offset:3072 sc1
  s_branch kfb_kernel_adone
kfb_kernel_x2:
  v_lshlrev_b32 v214, 3, v208
  s_nop 3
  v_cvt_pk_bf16_f32 v216, v152, v153
  v_cvt_pk_bf16_f32 v217, v154, v155
  s_add_u32 s34, s33, 8192
  buffer_store_dwordx2 v[216:217], v214, s[8:11], s34 offen sc1
  v_cvt_pk_bf16_f32 v218, v168, v169
  v_cvt_pk_bf16_f32 v219, v170, v171
  s_add_u32 s34, s33, 10240
  buffer_store_dwordx2 v[218:219], v214, s[8:11], s34 offen sc1
  s_branch kfb_kernel_adone
kfb_kernel_vrole:
    s_lshl_b32 s34, s48, 8
    v_add_u32 v204, s34, v204
        s_mov_b32 m0, s25
        s_add_u32 s25, s25, 8192
        buffer_load_dwordx4 v206, s[8:11], s24 offen lds
        s_add_u32 s24, s24, 264192
        s_mov_b64 exec, s[42:43]
        buffer_load_dwordx4 v[8:11], v207, s[8:11], s26 offen
        s_mov_b64 exec, -1
        s_add_u32 s26, s26, s27
        s_mov_b64 exec, s[42:43]
        buffer_load_dwordx4 v[12:15], v207, s[8:11], s26 offen
        s_mov_b64 exec, -1
        s_add_u32 s26, s26, s27
        s_mov_b64 exec, s[42:43]
        buffer_load_dwordx4 v[16:19], v207, s[8:11], s26 offen
        s_mov_b64 exec, -1
        s_add_u32 s26, s26, s27
        s_mov_b64 exec, s[42:43]
        buffer_load_dwordx4 v[20:23], v207, s[8:11], s26 offen
        s_mov_b64 exec, -1
        s_add_u32 s26, s26, s27
  s_barrier
        s_mov_b32 m0, s25
        s_add_u32 s25, s25, 8192
        buffer_load_dwordx4 v206, s[8:11], s24 offen lds
        s_add_u32 s24, s24, 264192
        s_mov_b64 exec, s[42:43]
        buffer_load_dwordx4 v[24:27], v207, s[8:11], s26 offen
        s_mov_b64 exec, -1
        s_add_u32 s26, s26, s27
        s_mov_b64 exec, s[42:43]
        buffer_load_dwordx4 v[28:31], v207, s[8:11], s26 offen
        s_mov_b64 exec, -1
        s_add_u32 s26, s26, s27
        s_mov_b64 exec, s[42:43]
        buffer_load_dwordx4 v[32:35], v207, s[8:11], s26 offen
        s_mov_b64 exec, -1
        s_add_u32 s26, s26, s27
        s_mov_b64 exec, s[42:43]
        buffer_load_dwordx4 v[36:39], v207, s[8:11], s26 offen
        s_mov_b64 exec, -1
        s_add_u32 s26, s26, s27
  s_barrier
        s_mov_b32 m0, s25
        s_add_u32 s25, s25, 8192
        buffer_load_dwordx4 v206, s[8:11], s24 offen lds
        s_add_u32 s24, s24, 264192
        s_mov_b64 exec, s[42:43]
        buffer_load_dwordx4 v[40:43], v207, s[8:11], s26 offen
        s_mov_b64 exec, -1
        s_add_u32 s26, s26, s27
        s_mov_b64 exec, s[42:43]
        buffer_load_dwordx4 v[44:47], v207, s[8:11], s26 offen
        s_mov_b64 exec, -1
        s_add_u32 s26, s26, s27
        s_mov_b64 exec, s[42:43]
        buffer_load_dwordx4 v[48:51], v207, s[8:11], s26 offen
        s_mov_b64 exec, -1
        s_add_u32 s26, s26, s27
        s_mov_b64 exec, s[42:43]
        buffer_load_dwordx4 v[52:55], v207, s[8:11], s26 offen
        s_mov_b64 exec, -1
        s_add_u32 s26, s26, s27
        s_mov_b32 m0, s25
        s_add_u32 s25, s25, 8192
        buffer_load_dwordx4 v206, s[8:11], s24 offen lds
        s_add_u32 s24, s24, 264192
        s_mov_b64 exec, s[42:43]
        buffer_load_dwordx4 v[56:59], v207, s[8:11], s26 offen
        s_mov_b64 exec, -1
        s_add_u32 s26, s26, s27
        s_mov_b64 exec, s[42:43]
        buffer_load_dwordx4 v[60:63], v207, s[8:11], s26 offen
        s_mov_b64 exec, -1
        s_add_u32 s26, s26, s27
        s_mov_b64 exec, s[42:43]
        buffer_load_dwordx4 v[64:67], v207, s[8:11], s26 offen
        s_mov_b64 exec, -1
        s_add_u32 s26, s26, s27
        s_mov_b64 exec, s[42:43]
        buffer_load_dwordx4 v[68:71], v207, s[8:11], s26 offen
        s_mov_b64 exec, -1
        s_add_u32 s26, s26, s27
        v_and_b32 v210, 31, v208
        v_lshrrev_b32 v211, 5, v208
        v_lshlrev_b32 v213, 4, v211
        s_lshl_b32 s34, s48, 7
        s_add_u32 s34, s34, 73728
        v_add_u32 v213, s34, v213
  v_mov_b32 v214, v210
  v_add_u32 v216, 6, v210
  v_subrev_u32 v217, 4, v210
  v_cmp_gt_u32 vcc, 8, v217
  s_nop 1
  v_cndmask_b32 v214, v214, v216, vcc
  v_subrev_u32 v216, 8, v210
  v_subrev_u32 v217, 12, v210
  v_cmp_gt_u32 vcc, 4, v217
  s_nop 1
  v_cndmask_b32 v214, v214, v216, vcc
  v_add_u32 v216, 2, v210
  v_subrev_u32 v217, 16, v210
  v_cmp_gt_u32 vcc, 2, v217
  s_nop 1
  v_cndmask_b32 v214, v214, v216, vcc
  v_subrev_u32 v216, 12, v210
  v_subrev_u32 v217, 20, v210
  v_cmp_gt_u32 vcc, 2, v217
  s_nop 1
  v_cndmask_b32 v214, v214, v216, vcc
  v_mov_b32 v216, 10
  v_subrev_u32 v217, 18, v210
  v_cmp_gt_u32 vcc, 2, v217
  s_nop 1
  v_cndmask_b32 v214, v214, v216, vcc
  v_mov_b32 v216, 10
  v_subrev_u32 v217, 28, v210
  v_cmp_gt_u32 vcc, 4, v217
  s_nop 1
  v_cndmask_b32 v214, v214, v216, vcc
  v_mov_b32 v216, 0
  v_subrev_u32 v217, 22, v210
  v_cmp_gt_u32 vcc, 6, v217
  s_nop 1
  v_cndmask_b32 v214, v214, v216, vcc
        v_lshlrev_b32 v214, 4, v214
        v_mul_u32_u24 v211, 320, v211
        v_add_u32 v214, v214, v211
        s_lshr_b32 s49, s21, 2
        s_mul_i32 s49, s49, 19456
        s_add_u32 s49, s49, 18203648
        s_and_b32 s35, s21, 3
        s_lshl_b32 s35, s35, 1
        s_add_u32 s35, s35, s48
        s_mul_i32 s35, s35, 1280
        s_add_u32 s49, s49, s35
        v_cmp_gt_u32 s[38:39], 18, v210
        v_subrev_u32 v211, 20, v210
        v_cmp_gt_u32 s[40:41], 2, v211
  s_nop 3
        s_or_b64 s[38:39], s[38:39], s[40:41]
        v_and_b32 v211, 27, v210
        v_cmp_eq_u32 s[40:41], 17, v211
        v_mov_b32 v212, 0x3f803f80
  s_waitcnt vmcnt(15)
  s_barrier
  ds_read2st64_b64 v[184:187], v204 offset0:0 offset1:2
  ds_read2st64_b64 v[192:195], v204 offset0:4 offset1:6
  ds_read2st64_b64 v[248:251], v204 offset0:8 offset1:10
  s_waitcnt lgkmcnt(2)
  v_mfma_f32_32x32x16_bf16 v[152:167], v[184:187], v[8:11], 0
        s_mov_b32 m0, s25
        s_add_u32 s25, s25, 8192
        buffer_load_dwordx4 v206, s[8:11], s24 offen lds
        s_add_u32 s24, s24, 264192
        s_mov_b64 exec, s[42:43]
        buffer_load_dwordx4 v[72:75], v207, s[8:11], s26 offen
        s_mov_b64 exec, -1
        s_add_u32 s26, s26, s27
  ds_read2st64_b64 v[184:187], v204 offset0:12 offset1:14
  s_waitcnt lgkmcnt(2)
  v_mfma_f32_32x32x16_bf16 v[168:183], v[192:195], v[12:15], 0
        s_mov_b64 exec, s[42:43]
        buffer_load_dwordx4 v[76:79], v207, s[8:11], s26 offen
        s_mov_b64 exec, -1
        s_add_u32 s26, s26, s27
  s_waitcnt vmcnt(13)
  s_barrier
  ds_read2st64_b64 v[192:195], v204 offset0:16 offset1:18
  s_waitcnt lgkmcnt(2)
  v_mfma_f32_32x32x16_bf16 v[152:167], v[248:251], v[16:19], v[152:167]
        s_mov_b64 exec, s[42:43]
        buffer_load_dwordx4 v[80:83], v207, s[8:11], s26 offen
        s_mov_b64 exec, -1
        s_add_u32 s26, s26, s27
  ds_read2st64_b64 v[248:251], v204 offset0:20 offset1:22
  s_waitcnt lgkmcnt(2)
  v_mfma_f32_32x32x16_bf16 v[168:183], v[184:187], v[20:23], v[168:183]
        s_mov_b64 exec, s[42:43]
        buffer_load_dwordx4 v[84:87], v207, s[8:11], s26 offen
        s_mov_b64 exec, -1
        s_add_u32 s26, s26, s27
  ds_read2st64_b64 v[184:187], v204 offset0:24 offset1:26
  s_waitcnt lgkmcnt(2)
  v_mfma_f32_32x32x16_bf16 v[152:167], v[192:195], v[24:27], v[152:167]
        s_mov_b32 m0, s25
        s_add_u32 s25, s25, 8192
        buffer_load_dwordx4 v206, s[8:11], s24 offen lds
        s_add_u32 s24, s24, 264192
        s_mov_b64 exec, s[42:43]
        buffer_load_dwordx4 v[88:91], v207, s[8:11], s26 offen
        s_mov_b64 exec, -1
        s_add_u32 s26, s26, s27
  ds_read2st64_b64 v[192:195], v204 offset0:28 offset1:30
  s_waitcnt lgkmcnt(2)
  v_mfma_f32_32x32x16_bf16 v[168:183], v[248:251], v[28:31], v[168:183]
        s_mov_b64 exec, s[42:43]
        buffer_load_dwordx4 v[92:95], v207, s[8:11], s26 offen
        s_mov_b64 exec, -1
        s_add_u32 s26, s26, s27
  s_waitcnt vmcnt(13)
  s_barrier
  ds_read2st64_b64 v[248:251], v204 offset0:32 offset1:34
  s_waitcnt lgkmcnt(2)
  v_mfma_f32_32x32x16_bf16 v[152:167], v[184:187], v[32:35], v[152:167]
        s_mov_b64 exec, s[42:43]
        buffer_load_dwordx4 v[96:99], v207, s[8:11], s26 offen
        s_mov_b64 exec, -1
        s_add_u32 s26, s26, s27
  ds_read2st64_b64 v[184:187], v204 offset0:36 offset1:38
  s_waitcnt lgkmcnt(2)
  v_mfma_f32_32x32x16_bf16 v[168:183], v[192:195], v[36:39], v[168:183]
        s_mov_b64 exec, s[42:43]
        buffer_load_dwordx4 v[100:103], v207, s[8:11], s26 offen
        s_mov_b64 exec, -1
        s_add_u32 s26, s26, s27
  ds_read2st64_b64 v[192:195], v204 offset0:40 offset1:42
  s_waitcnt lgkmcnt(2)
  v_mfma_f32_32x32x16_bf16 v[152:167], v[248:251], v[40:43], v[152:167]
        s_mov_b32 m0, s25
        s_add_u32 s25, s25, 8192
        buffer_load_dwordx4 v206, s[8:11], s24 offen lds
        s_add_u32 s24, s24, 264192
        s_mov_b64 exec, s[42:43]
        buffer_load_dwordx4 v[104:107], v207, s[8:11], s26 offen
        s_mov_b64 exec, -1
        s_add_u32 s26, s26, s27
  ds_read2st64_b64 v[248:251], v204 offset0:44 offset1:46
  s_waitcnt lgkmcnt(2)
  v_mfma_f32_32x32x16_bf16 v[168:183], v[184:187], v[44:47], v[168:183]
        s_mov_b64 exec, s[42:43]
        buffer_load_dwordx4 v[108:111], v207, s[8:11], s26 offen
        s_mov_b64 exec, -1
        s_add_u32 s26, s26, s27
  s_waitcnt vmcnt(13)
  s_barrier
  ds_read2st64_b64 v[184:187], v204 offset0:48 offset1:50
  s_waitcnt lgkmcnt(2)
  v_mfma_f32_32x32x16_bf16 v[152:167], v[192:195], v[48:51], v[152:167]
        s_mov_b64 exec, s[42:43]
        buffer_load_dwordx4 v[112:115], v207, s[8:11], s26 offen
        s_mov_b64 exec, -1
        s_add_u32 s26, s26, s27
  ds_read2st64_b64 v[192:195], v204 offset0:52 offset1:54
  s_waitcnt lgkmcnt(2)
  v_mfma_f32_32x32x16_bf16 v[168:183], v[248:251], v[52:55], v[168:183]
        s_mov_b64 exec, s[42:43]
        buffer_load_dwordx4 v[116:119], v207, s[8:11], s26 offen
        s_mov_b64 exec, -1
        s_add_u32 s26, s26, s27
  ds_read2st64_b64 v[248:251], v204 offset0:56 offset1:58
  s_waitcnt lgkmcnt(2)
  v_mfma_f32_32x32x16_bf16 v[152:167], v[184:187], v[56:59], v[152:167]
        s_mov_b32 m0, s25
        s_add_u32 s25, s25, 8192
        buffer_load_dwordx4 v206, s[8:11], s24 offen lds
        s_add_u32 s24, s24, 264192
        s_mov_b64 exec, s[42:43]
        buffer_load_dwordx4 v[120:123], v207, s[8:11], s26 offen
        s_mov_b64 exec, -1
        s_add_u32 s26, s26, s27
  ds_read2st64_b64 v[184:187], v204 offset0:60 offset1:62
  s_waitcnt lgkmcnt(2)
  v_mfma_f32_32x32x16_bf16 v[168:183], v[192:195], v[60:63], v[168:183]
        s_mov_b64 exec, s[42:43]
        buffer_load_dwordx4 v[124:127], v207, s[8:11], s26 offen
        s_mov_b64 exec, -1
        s_add_u32 s26, s26, s27
  s_waitcnt vmcnt(13)
  s_barrier
  ds_read2st64_b64 v[192:195], v204 offset0:64 offset1:66
  s_waitcnt lgkmcnt(2)
  v_mfma_f32_32x32x16_bf16 v[152:167], v[248:251], v[64:67], v[152:167]
        s_mov_b64 exec, s[42:43]
        buffer_load_dwordx4 v[128:131], v207, s[8:11], s26 offen
        s_mov_b64 exec, -1
        s_add_u32 s26, s26, s27
  ds_read2st64_b64 v[248:251], v204 offset0:68 offset1:70
  s_waitcnt lgkmcnt(2)
  v_mfma_f32_32x32x16_bf16 v[168:183], v[184:187], v[68:71], v[168:183]
        s_mov_b64 exec, s[42:43]
        buffer_load_dwordx4 v[132:135], v207, s[8:11], s26 offen
        s_mov_b64 exec, -1
        s_add_u32 s26, s26, s27
  ds_read2st64_b64 v[184:187], v204 offset0:72 offset1:74
  s_waitcnt lgkmcnt(2)
  v_mfma_f32_32x32x16_bf16 v[152:167], v[192:195], v[72:75], v[152:167]
        s_mov_b32 m0, s25
        s_add_u32 s25, s25, 8192
        buffer_load_dwordx4 v206, s[8:11], s24 offen lds
        s_add_u32 s24, s24, 264192
        s_mov_b64 exec, s[42:43]
        buffer_load_dwordx4 v[136:139], v207, s[8:11], s26 offen
        s_mov_b64 exec, -1
        s_add_u32 s26, s26, s27
  ds_read2st64_b64 v[192:195], v204 offset0:76 offset1:78
  s_waitcnt lgkmcnt(2)
  v_mfma_f32_32x32x16_bf16 v[168:183], v[248:251], v[76:79], v[168:183]
        s_mov_b64 exec, s[42:43]
        buffer_load_dwordx4 v[140:143], v207, s[8:11], s26 offen
        s_mov_b64 exec, -1
        s_add_u32 s26, s26, s27
  s_waitcnt vmcnt(13)
  s_barrier
  ds_read2st64_b64 v[248:251], v204 offset0:80 offset1:82
  s_waitcnt lgkmcnt(2)
  v_mfma_f32_32x32x16_bf16 v[152:167], v[184:187], v[80:83], v[152:167]
        s_mov_b64 exec, s[42:43]
        buffer_load_dwordx4 v[144:147], v207, s[8:11], s26 offen
        s_mov_b64 exec, -1
        s_add_u32 s26, s26, s27
  ds_read2st64_b64 v[184:187], v204 offset0:84 offset1:86
  s_waitcnt lgkmcnt(2)
  v_mfma_f32_32x32x16_bf16 v[168:183], v[192:195], v[84:87], v[168:183]
        s_mov_b64 exec, s[42:43]
        buffer_load_dwordx4 v[148:151], v207, s[8:11], s26 offen
        s_mov_b64 exec, -1
        s_add_u32 s26, s26, s27
  ds_read2st64_b64 v[192:195], v204 offset0:88 offset1:90
  s_waitcnt lgkmcnt(2)
  v_mfma_f32_32x32x16_bf16 v[152:167], v[248:251], v[88:91], v[152:167]
  ds_read2st64_b64 v[248:251], v204 offset0:92 offset1:94
  s_waitcnt lgkmcnt(2)
  v_mfma_f32_32x32x16_bf16 v[168:183], v[184:187], v[92:95], v[168:183]
  s_waitcnt vmcnt(10)
  s_barrier
  ds_read2st64_b64 v[184:187], v204 offset0:96 offset1:98
  s_waitcnt lgkmcnt(2)
  v_mfma_f32_32x32x16_bf16 v[152:167], v[192:195], v[96:99], v[152:167]
  ds_read2st64_b64 v[192:195], v204 offset0:100 offset1:102
  s_waitcnt lgkmcnt(2)
  v_mfma_f32_32x32x16_bf16 v[168:183], v[248:251], v[100:103], v[168:183]
  ds_read2st64_b64 v[248:251], v204 offset0:104 offset1:106
  s_waitcnt lgkmcnt(2)
  v_mfma_f32_32x32x16_bf16 v[152:167], v[184:187], v[104:107], v[152:167]
  ds_read2st64_b64 v[184:187], v204 offset0:108 offset1:110
  s_waitcnt lgkmcnt(2)
  v_mfma_f32_32x32x16_bf16 v[168:183], v[192:195], v[108:111], v[168:183]
  s_waitcnt vmcnt(5)
  s_barrier
  ds_read2st64_b64 v[192:195], v204 offset0:112 offset1:114
  s_waitcnt lgkmcnt(2)
  v_mfma_f32_32x32x16_bf16 v[152:167], v[248:251], v[112:115], v[152:167]
  ds_read2st64_b64 v[248:251], v204 offset0:116 offset1:118
  s_waitcnt lgkmcnt(2)
  v_mfma_f32_32x32x16_bf16 v[168:183], v[184:187], v[116:119], v[168:183]
  ds_read2st64_b64 v[184:187], v204 offset0:120 offset1:122
  s_waitcnt lgkmcnt(2)
  v_mfma_f32_32x32x16_bf16 v[152:167], v[192:195], v[120:123], v[152:167]
  ds_read2st64_b64 v[192:195], v204 offset0:124 offset1:126
  s_waitcnt lgkmcnt(2)
  v_mfma_f32_32x32x16_bf16 v[168:183], v[248:251], v[124:127], v[168:183]
  s_waitcnt vmcnt(0)
  s_barrier
  ds_read2st64_b64 v[248:251], v204 offset0:128 offset1:130
  s_waitcnt lgkmcnt(2)
  v_mfma_f32_32x32x16_bf16 v[152:167], v[184:187], v[128:131], v[152:167]
  ds_read2st64_b64 v[184:187], v204 offset0:132 offset1:134
  s_waitcnt lgkmcnt(2)
  v_mfma_f32_32x32x16_bf16 v[168:183], v[192:195], v[132:135], v[168:183]
  ds_read2st64_b64 v[192:195], v204 offset0:136 offset1:138
  s_waitcnt lgkmcnt(2)
  v_mfma_f32_32x32x16_bf16 v[152:167], v[248:251], v[136:139], v[152:167]
  ds_read2st64_b64 v[248:251], v204 offset0:140 offset1:142
  s_waitcnt lgkmcnt(2)
  v_mfma_f32_32x32x16_bf16 v[168:183], v[184:187], v[140:143], v[168:183]
  s_waitcnt lgkmcnt(1)
  v_mfma_f32_32x32x16_bf16 v[152:167], v[192:195], v[144:147], v[152:167]
  s_waitcnt lgkmcnt(0)
  v_mfma_f32_32x32x16_bf16 v[168:183], v[248:251], v[148:151], v[168:183]
  s_nop 11
  v_add_f32 v152, v152, v168
  v_add_f32 v153, v153, v169
  v_add_f32 v154, v154, v170
  v_add_f32 v155, v155, v171
  v_add_f32 v156, v156, v172
  v_add_f32 v157, v157, v173
  v_add_f32 v158, v158, v174
  v_add_f32 v159, v159, v175
  v_add_f32 v160, v160, v176
  v_add_f32 v161, v161, v177
  v_add_f32 v162, v162, v178
  v_add_f32 v163, v163, v179
  v_add_f32 v164, v164, v180
  v_add_f32 v165, v165, v181
  v_add_f32 v166, v166, v182
  v_add_f32 v167, v167, v183
  s_barrier
  ds_read_b128 v[8:11], v213 offset:0
  ds_read_b128 v[12:15], v213 offset:32
  ds_read_b128 v[16:19], v213 offset:64
  ds_read_b128 v[20:23], v213 offset:96
  s_waitcnt lgkmcnt(0)
  v_mul_f32 v152, v152, v8
  v_mul_f32 v153, v153, v9
  v_mul_f32 v154, v154, v10
  v_mul_f32 v155, v155, v11
  v_mul_f32 v156, v156, v12
  v_mul_f32 v157, v157, v13
  v_mul_f32 v158, v158, v14
  v_mul_f32 v159, v159, v15
  v_mul_f32 v160, v160, v16
  v_mul_f32 v161, v161, v17
  v_mul_f32 v162, v162, v18
  v_mul_f32 v163, v163, v19
  v_mul_f32 v164, v164, v20
  v_mul_f32 v165, v165, v21
  v_mul_f32 v166, v166, v22
  v_mul_f32 v167, v167, v23
  v_cvt_pk_bf16_f32 v216, v152, v153
  v_cndmask_b32 v216, v216, v212, s[40:41]
  v_cvt_pk_bf16_f32 v217, v154, v155
  v_cndmask_b32 v217, v217, v212, s[40:41]
  v_cvt_pk_bf16_f32 v218, v156, v157
  v_cndmask_b32 v218, v218, v212, s[40:41]
  v_cvt_pk_bf16_f32 v219, v158, v159
  v_cndmask_b32 v219, v219, v212, s[40:41]
  v_cvt_pk_bf16_f32 v220, v160, v161
  v_cndmask_b32 v220, v220, v212, s[40:41]
  v_cvt_pk_bf16_f32 v221, v162, v163
  v_cndmask_b32 v221, v221, v212, s[40:41]
  v_cvt_pk_bf16_f32 v222, v164, v165
  v_cndmask_b32 v222, v222, v212, s[40:41]
  v_cvt_pk_bf16_f32 v223, v166, v167
  v_cndmask_b32 v223, v223, v212, s[40:41]
  s_mov_b64 exec, s[38:39]
  buffer_store_dwordx4 v[216:219], v214, s[8:11], s49 offen offset:0 sc1
  buffer_store_dwordx4 v[220:223], v214, s[8:11], s49 offen offset:640 sc1
  s_mov_b64 exec, -1
  s_waitcnt vmcnt(0)
        v_lshlrev_b32 v209, 7, v208
        v_mov_b32 v210, 1
        s_and_b32 s33, s21, 7
        s_lshl_b32 s33, s33, 10
        s_add_u32 s33, s33, 26230784
        s_mov_b64 exec, 0xff
        buffer_atomic_add v210, v209, s[8:11], s33 offen sc1
        s_mov_b64 exec, -1
  s_branch kfb_kernel_adone
kfb_kernel_stats:
    v_lshlrev_b32 v204, 4, v208
    v_add_u32 v202, 36864, v204
    v_lshrrev_b32 v211, 5, v208
    v_cmp_eq_u32 vcc, 0, v211
    v_mov_b32 v213, -1
    v_mov_b32 v212, 0xffff0000
    v_cndmask_b32 v213, v213, v212, vcc
  v_mov_b32 v232, 0
  v_mov_b32 v233, 0
  v_mov_b32 v234, 0
  v_mov_b32 v235, 0
  v_mov_b32 v236, 0
  v_mov_b32 v237, 0
  v_mov_b32 v238, 0
  v_mov_b32 v239, 0
        s_mov_b32 m0, s25
        s_add_u32 s25, s25, 8192
        buffer_load_dwordx4 v206, s[8:11], s24 offen lds
        s_add_u32 s24, s24, 264192
  s_barrier
        s_mov_b32 m0, s25
        s_add_u32 s25, s25, 8192
        buffer_load_dwordx4 v206, s[8:11], s24 offen lds
        s_add_u32 s24, s24, 264192
  s_barrier
        s_mov_b32 m0, s25
        s_add_u32 s25, s25, 8192
        buffer_load_dwordx4 v206, s[8:11], s24 offen lds
        s_add_u32 s24, s24, 264192
        s_mov_b32 m0, s25
        s_add_u32 s25, s25, 8192
        buffer_load_dwordx4 v206, s[8:11], s24 offen lds
        s_add_u32 s24, s24, 264192
  s_waitcnt vmcnt(3)
  s_barrier
  ds_read_b128 v[184:187], v204 offset:0
  ds_read_b128 v[188:191], v204 offset:1024
  ds_read_b128 v[192:195], v204 offset:2048
  ds_read_b128 v[196:199], v204 offset:3072
  ds_read_b128 v[248:251], v204 offset:4096
  ds_read_b128 v[252:255], v204 offset:5120
  s_waitcnt lgkmcnt(4)
  v_and_b32 v184, v213, v184
  v_and_b32 v186, v213, v186
  v_dot2c_f32_bf16 v232, v184, v184
  v_dot2c_f32_bf16 v233, v185, v185
  v_dot2c_f32_bf16 v234, v186, v186
  v_dot2c_f32_bf16 v235, v187, v187
  v_dot2c_f32_bf16 v236, v188, v188
  v_dot2c_f32_bf16 v237, v189, v189
  v_dot2c_f32_bf16 v238, v190, v190
  v_dot2c_f32_bf16 v239, v191, v191
        s_mov_b32 m0, s25
        s_add_u32 s25, s25, 8192
        buffer_load_dwordx4 v206, s[8:11], s24 offen lds
        s_add_u32 s24, s24, 264192
  ds_read_b128 v[184:187], v204 offset:6144
  ds_read_b128 v[188:191], v204 offset:7168
  s_waitcnt lgkmcnt(4)
  v_dot2c_f32_bf16 v232, v192, v192
  v_dot2c_f32_bf16 v233, v193, v193
  v_dot2c_f32_bf16 v234, v194, v194
  v_dot2c_f32_bf16 v235, v195, v195
  v_dot2c_f32_bf16 v236, v196, v196
  v_dot2c_f32_bf16 v237, v197, v197
  v_dot2c_f32_bf16 v238, v198, v198
  v_dot2c_f32_bf16 v239, v199, v199
  s_waitcnt vmcnt(3)
  s_barrier
  ds_read_b128 v[192:195], v204 offset:8192
  ds_read_b128 v[196:199], v204 offset:9216
  s_waitcnt lgkmcnt(4)
  v_dot2c_f32_bf16 v232, v248, v248
  v_dot2c_f32_bf16 v233, v249, v249
  v_dot2c_f32_bf16 v234, v250, v250
  v_dot2c_f32_bf16 v235, v251, v251
  v_dot2c_f32_bf16 v236, v252, v252
  v_dot2c_f32_bf16 v237, v253, v253
  v_dot2c_f32_bf16 v238, v254, v254
  v_dot2c_f32_bf16 v239, v255, v255
  ds_read_b128 v[248:251], v204 offset:10240
  ds_read_b128 v[252:255], v204 offset:11264
  s_waitcnt lgkmcnt(4)
  v_dot2c_f32_bf16 v232, v184, v184
  v_dot2c_f32_bf16 v233, v185, v185
  v_dot2c_f32_bf16 v234, v186, v186
  v_dot2c_f32_bf16 v235, v187, v187
  v_dot2c_f32_bf16 v236, v188, v188
  v_dot2c_f32_bf16 v237, v189, v189
  v_dot2c_f32_bf16 v238, v190, v190
  v_dot2c_f32_bf16 v239, v191, v191
  ds_read_b128 v[184:187], v204 offset:12288
  ds_read_b128 v[188:191], v204 offset:13312
  s_waitcnt lgkmcnt(4)
  v_dot2c_f32_bf16 v232, v192, v192
  v_dot2c_f32_bf16 v233, v193, v193
  v_dot2c_f32_bf16 v234, v194, v194
  v_dot2c_f32_bf16 v235, v195, v195
  v_dot2c_f32_bf16 v236, v196, v196
  v_dot2c_f32_bf16 v237, v197, v197
  v_dot2c_f32_bf16 v238, v198, v198
  v_dot2c_f32_bf16 v239, v199, v199
        s_mov_b32 m0, s25
        s_add_u32 s25, s25, 8192
        buffer_load_dwordx4 v206, s[8:11], s24 offen lds
        s_add_u32 s24, s24, 264192
  ds_read_b128 v[192:195], v204 offset:14336
  ds_read_b128 v[196:199], v204 offset:15360
  s_waitcnt lgkmcnt(4)
  v_dot2c_f32_bf16 v232, v248, v248
  v_dot2c_f32_bf16 v233, v249, v249
  v_dot2c_f32_bf16 v234, v250, v250
  v_dot2c_f32_bf16 v235, v251, v251
  v_dot2c_f32_bf16 v236, v252, v252
  v_dot2c_f32_bf16 v237, v253, v253
  v_dot2c_f32_bf16 v238, v254, v254
  v_dot2c_f32_bf16 v239, v255, v255
  s_waitcnt vmcnt(3)
  s_barrier
  ds_read_b128 v[248:251], v204 offset:16384
  ds_read_b128 v[252:255], v204 offset:17408
  s_waitcnt lgkmcnt(4)
  v_dot2c_f32_bf16 v232, v184, v184
  v_dot2c_f32_bf16 v233, v185, v185
  v_dot2c_f32_bf16 v234, v186, v186
  v_dot2c_f32_bf16 v235, v187, v187
  v_dot2c_f32_bf16 v236, v188, v188
  v_dot2c_f32_bf16 v237, v189, v189
  v_dot2c_f32_bf16 v238, v190, v190
  v_dot2c_f32_bf16 v239, v191, v191
  ds_read_b128 v[184:187], v204 offset:18432
  ds_read_b128 v[188:191], v204 offset:19456
  s_waitcnt lgkmcnt(4)
  v_dot2c_f32_bf16 v232, v192, v192
  v_dot2c_f32_bf16 v233, v193, v193
  v_dot2c_f32_bf16 v234, v194, v194
  v_dot2c_f32_bf16 v235, v195, v195
  v_dot2c_f32_bf16 v236, v196, v196
  v_dot2c_f32_bf16 v237, v197, v197
  v_dot2c_f32_bf16 v238, v198, v198
  v_dot2c_f32_bf16 v239, v199, v199
  ds_read_b128 v[192:195], v204 offset:20480
  ds_read_b128 v[196:199], v204 offset:21504
  s_waitcnt lgkmcnt(4)
  v_dot2c_f32_bf16 v232, v248, v248
  v_dot2c_f32_bf16 v233, v249, v249
  v_dot2c_f32_bf16 v234, v250, v250
  v_dot2c_f32_bf16 v235, v251, v251
  v_dot2c_f32_bf16 v236, v252, v252
  v_dot2c_f32_bf16 v237, v253, v253
  v_dot2c_f32_bf16 v238, v254, v254
  v_dot2c_f32_bf16 v239, v255, v255
        s_mov_b32 m0, s25
        s_add_u32 s25, s25, 8192
        buffer_load_dwordx4 v206, s[8:11], s24 offen lds
        s_add_u32 s24, s24, 264192
  ds_read_b128 v[248:251], v204 offset:22528
  ds_read_b128 v[252:255], v204 offset:23552
  s_waitcnt lgkmcnt(4)
  v_dot2c_f32_bf16 v232, v184, v184
  v_dot2c_f32_bf16 v233, v185, v185
  v_dot2c_f32_bf16 v234, v186, v186
  v_dot2c_f32_bf16 v235, v187, v187
  v_dot2c_f32_bf16 v236, v188, v188
  v_dot2c_f32_bf16 v237, v189, v189
  v_dot2c_f32_bf16 v238, v190, v190
  v_dot2c_f32_bf16 v239, v191, v191
  s_waitcnt vmcnt(3)
  s_barrier
  ds_read_b128 v[184:187], v204 offset:24576
  ds_read_b128 v[188:191], v204 offset:25600
  s_waitcnt lgkmcnt(4)
  v_dot2c_f32_bf16 v232, v192, v192
  v_dot2c_f32_bf16 v233, v193, v193
  v_dot2c_f32_bf16 v234, v194, v194
  v_dot2c_f32_bf16 v235, v195, v195
  v_dot2c_f32_bf16 v236, v196, v196
  v_dot2c_f32_bf16 v237, v197, v197
  v_dot2c_f32_bf16 v238, v198, v198
  v_dot2c_f32_bf16 v239, v199, v199
  ds_read_b128 v[192:195], v204 offset:26624
  ds_read_b128 v[196:199], v204 offset:27648
  s_waitcnt lgkmcnt(4)
  v_dot2c_f32_bf16 v232, v248, v248
  v_dot2c_f32_bf16 v233, v249, v249
  v_dot2c_f32_bf16 v234, v250, v250
  v_dot2c_f32_bf16 v235, v251, v251
  v_dot2c_f32_bf16 v236, v252, v252
  v_dot2c_f32_bf16 v237, v253, v253
  v_dot2c_f32_bf16 v238, v254, v254
  v_dot2c_f32_bf16 v239, v255, v255
  ds_read_b128 v[248:251], v204 offset:28672
  ds_read_b128 v[252:255], v204 offset:29696
  s_waitcnt lgkmcnt(4)
  v_dot2c_f32_bf16 v232, v184, v184
  v_dot2c_f32_bf16 v233, v185, v185
  v_dot2c_f32_bf16 v234, v186, v186
  v_dot2c_f32_bf16 v235, v187, v187
  v_dot2c_f32_bf16 v236, v188, v188
  v_dot2c_f32_bf16 v237, v189, v189
  v_dot2c_f32_bf16 v238, v190, v190
  v_dot2c_f32_bf16 v239, v191, v191
        s_mov_b32 m0, s25
        s_add_u32 s25, s25, 8192
        buffer_load_dwordx4 v206, s[8:11], s24 offen lds
        s_add_u32 s24, s24, 264192
  ds_read_b128 v[184:187], v204 offset:30720
  ds_read_b128 v[188:191], v204 offset:31744
  s_waitcnt lgkmcnt(4)
  v_dot2c_f32_bf16 v232, v192, v192
  v_dot2c_f32_bf16 v233, v193, v193
  v_dot2c_f32_bf16 v234, v194, v194
  v_dot2c_f32_bf16 v235, v195, v195
  v_dot2c_f32_bf16 v236, v196, v196
  v_dot2c_f32_bf16 v237, v197, v197
  v_dot2c_f32_bf16 v238, v198, v198
  v_dot2c_f32_bf16 v239, v199, v199
  s_waitcnt vmcnt(3)
  s_barrier
  ds_read_b128 v[192:195], v204 offset:32768
  ds_read_b128 v[196:199], v204 offset:33792
  s_waitcnt lgkmcnt(4)
  v_dot2c_f32_bf16 v232, v248, v248
  v_dot2c_f32_bf16 v233, v249, v249
  v_dot2c_f32_bf16 v234, v250, v250
  v_dot2c_f32_bf16 v235, v251, v251
  v_dot2c_f32_bf16 v236, v252, v252
  v_dot2c_f32_bf16 v237, v253, v253
  v_dot2c_f32_bf16 v238, v254, v254
  v_dot2c_f32_bf16 v239, v255, v255
  ds_read_b128 v[248:251], v204 offset:34816
  ds_read_b128 v[252:255], v204 offset:35840
  s_waitcnt lgkmcnt(4)
  v_dot2c_f32_bf16 v232, v184, v184
  v_dot2c_f32_bf16 v233, v185, v185
  v_dot2c_f32_bf16 v234, v186, v186
  v_dot2c_f32_bf16 v235, v187, v187
  v_dot2c_f32_bf16 v236, v188, v188
  v_dot2c_f32_bf16 v237, v189, v189
  v_dot2c_f32_bf16 v238, v190, v190
  v_dot2c_f32_bf16 v239, v191, v191
  ds_read_b128 v[184:187], v202 offset:0
  ds_read_b128 v[188:191], v202 offset:1024
  s_waitcnt lgkmcnt(4)
  v_dot2c_f32_bf16 v232, v192, v192
  v_dot2c_f32_bf16 v233, v193, v193
  v_dot2c_f32_bf16 v234, v194, v194
  v_dot2c_f32_bf16 v235, v195, v195
  v_dot2c_f32_bf16 v236, v196, v196
  v_dot2c_f32_bf16 v237, v197, v197
  v_dot2c_f32_bf16 v238, v198, v198
  v_dot2c_f32_bf16 v239, v199, v199
        s_mov_b32 m0, s25
        s_add_u32 s25, s25, 8192
        buffer_load_dwordx4 v206, s[8:11], s24 offen lds
        s_add_u32 s24, s24, 264192
  ds_read_b128 v[192:195], v202 offset:2048
  ds_read_b128 v[196:199], v202 offset:3072
  s_waitcnt lgkmcnt(4)
  v_dot2c_f32_bf16 v232, v248, v248
  v_dot2c_f32_bf16 v233, v249, v249
  v_dot2c_f32_bf16 v234, v250, v250
  v_dot2c_f32_bf16 v235, v251, v251
  v_dot2c_f32_bf16 v236, v252, v252
  v_dot2c_f32_bf16 v237, v253, v253
  v_dot2c_f32_bf16 v238, v254, v254
  v_dot2c_f32_bf16 v239, v255, v255
  s_waitcnt vmcnt(3)
  s_barrier
  ds_read_b128 v[248:251], v202 offset:4096
  ds_read_b128 v[252:255], v202 offset:5120
  s_waitcnt lgkmcnt(4)
  v_dot2c_f32_bf16 v232, v184, v184
  v_dot2c_f32_bf16 v233, v185, v185
  v_dot2c_f32_bf16 v234, v186, v186
  v_dot2c_f32_bf16 v235, v187, v187
  v_dot2c_f32_bf16 v236, v188, v188
  v_dot2c_f32_bf16 v237, v189, v189
  v_dot2c_f32_bf16 v238, v190, v190
  v_dot2c_f32_bf16 v239, v191, v191
  ds_read_b128 v[184:187], v202 offset:6144
  ds_read_b128 v[188:191], v202 offset:7168
  s_waitcnt lgkmcnt(4)
  v_dot2c_f32_bf16 v232, v192, v192
  v_dot2c_f32_bf16 v233, v193, v193
  v_dot2c_f32_bf16 v234, v194, v194
  v_dot2c_f32_bf16 v235, v195, v195
  v_dot2c_f32_bf16 v236, v196, v196
  v_dot2c_f32_bf16 v237, v197, v197
  v_dot2c_f32_bf16 v238, v198, v198
  v_dot2c_f32_bf16 v239, v199, v199
  ds_read_b128 v[192:195], v202 offset:8192
  ds_read_b128 v[196:199], v202 offset:9216
  s_waitcnt lgkmcnt(4)
  v_dot2c_f32_bf16 v232, v248, v248
  v_dot2c_f32_bf16 v233, v249, v249
  v_dot2c_f32_bf16 v234, v250, v250
  v_dot2c_f32_bf16 v235, v251, v251
  v_dot2c_f32_bf16 v236, v252, v252
  v_dot2c_f32_bf16 v237, v253, v253
  v_dot2c_f32_bf16 v238, v254, v254
  v_dot2c_f32_bf16 v239, v255, v255
  ds_read_b128 v[248:251], v202 offset:10240
  ds_read_b128 v[252:255], v202 offset:11264
  s_waitcnt lgkmcnt(4)
  v_dot2c_f32_bf16 v232, v184, v184
  v_dot2c_f32_bf16 v233, v185, v185
  v_dot2c_f32_bf16 v234, v186, v186
  v_dot2c_f32_bf16 v235, v187, v187
  v_dot2c_f32_bf16 v236, v188, v188
  v_dot2c_f32_bf16 v237, v189, v189
  v_dot2c_f32_bf16 v238, v190, v190
  v_dot2c_f32_bf16 v239, v191, v191
  s_waitcnt vmcnt(2)
  s_barrier
  ds_read_b128 v[184:187], v202 offset:12288
  ds_read_b128 v[188:191], v202 offset:13312
  s_waitcnt lgkmcnt(4)
  v_dot2c_f32_bf16 v232, v192, v192
  v_dot2c_f32_bf16 v233, v193, v193
  v_dot2c_f32_bf16 v234, v194, v194
  v_dot2c_f32_bf16 v235, v195, v195
  v_dot2c_f32_bf16 v236, v196, v196
  v_dot2c_f32_bf16 v237, v197, v197
  v_dot2c_f32_bf16 v238, v198, v198
  v_dot2c_f32_bf16 v239, v199, v199
  ds_read_b128 v[192:195], v202 offset:14336
  ds_read_b128 v[196:199], v202 offset:15360
  s_waitcnt lgkmcnt(4)
  v_dot2c_f32_bf16 v232, v248, v248
  v_dot2c_f32_bf16 v233, v249, v249
  v_dot2c_f32_bf16 v234, v250, v250
  v_dot2c_f32_bf16 v235, v251, v251
  v_dot2c_f32_bf16 v236, v252, v252
  v_dot2c_f32_bf16 v237, v253, v253
  v_dot2c_f32_bf16 v238, v254, v254
  v_dot2c_f32_bf16 v239, v255, v255
  ds_read_b128 v[248:251], v202 offset:16384
  ds_read_b128 v[252:255], v202 offset:17408
  s_waitcnt lgkmcnt(4)
  v_dot2c_f32_bf16 v232, v184, v184
  v_dot2c_f32_bf16 v233, v185, v185
  v_dot2c_f32_bf16 v234, v186, v186
  v_dot2c_f32_bf16 v235, v187, v187
  v_dot2c_f32_bf16 v236, v188, v188
  v_dot2c_f32_bf16 v237, v189, v189
  v_dot2c_f32_bf16 v238, v190, v190
  v_dot2c_f32_bf16 v239, v191, v191
  ds_read_b128 v[184:187], v202 offset:18432
  ds_read_b128 v[188:191], v202 offset:19456
  s_waitcnt lgkmcnt(4)
  v_dot2c_f32_bf16 v232, v192, v192
  v_dot2c_f32_bf16 v233, v193, v193
  v_dot2c_f32_bf16 v234, v194, v194
  v_dot2c_f32_bf16 v235, v195, v195
  v_dot2c_f32_bf16 v236, v196, v196
  v_dot2c_f32_bf16 v237, v197, v197
  v_dot2c_f32_bf16 v238, v198, v198
  v_dot2c_f32_bf16 v239, v199, v199
  s_waitcnt vmcnt(1)
  s_barrier
  ds_read_b128 v[192:195], v202 offset:20480
  ds_read_b128 v[196:199], v202 offset:21504
  s_waitcnt lgkmcnt(4)
  v_dot2c_f32_bf16 v232, v248, v248
  v_dot2c_f32_bf16 v233, v249, v249
  v_dot2c_f32_bf16 v234, v250, v250
  v_dot2c_f32_bf16 v235, v251, v251
  v_dot2c_f32_bf16 v236, v252, v252
  v_dot2c_f32_bf16 v237, v253, v253
  v_dot2c_f32_bf16 v238, v254, v254
  v_dot2c_f32_bf16 v239, v255, v255
  ds_read_b128 v[248:251], v202 offset:22528
  ds_read_b128 v[252:255], v202 offset:23552
  s_waitcnt lgkmcnt(4)
  v_dot2c_f32_bf16 v232, v184, v184
  v_dot2c_f32_bf16 v233, v185, v185
  v_dot2c_f32_bf16 v234, v186, v186
  v_dot2c_f32_bf16 v235, v187, v187
  v_dot2c_f32_bf16 v236, v188, v188
  v_dot2c_f32_bf16 v237, v189, v189
  v_dot2c_f32_bf16 v238, v190, v190
  v_dot2c_f32_bf16 v239, v191, v191
  ds_read_b128 v[184:187], v202 offset:24576
  ds_read_b128 v[188:191], v202 offset:25600
  s_waitcnt lgkmcnt(4)
  v_dot2c_f32_bf16 v232, v192, v192
  v_dot2c_f32_bf16 v233, v193, v193
  v_dot2c_f32_bf16 v234, v194, v194
  v_dot2c_f32_bf16 v235, v195, v195
  v_dot2c_f32_bf16 v236, v196, v196
  v_dot2c_f32_bf16 v237, v197, v197
  v_dot2c_f32_bf16 v238, v198, v198
  v_dot2c_f32_bf16 v239, v199, v199
  ds_read_b128 v[192:195], v202 offset:26624
  ds_read_b128 v[196:199], v202 offset:27648
  s_waitcnt lgkmcnt(4)
  v_dot2c_f32_bf16 v232, v248, v248
  v_dot2c_f32_bf16 v233, v249, v249
  v_dot2c_f32_bf16 v234, v250, v250
  v_dot2c_f32_bf16 v235, v251, v251
  v_dot2c_f32_bf16 v236, v252, v252
  v_dot2c_f32_bf16 v237, v253, v253
  v_dot2c_f32_bf16 v238, v254, v254
  v_dot2c_f32_bf16 v239, v255, v255
  s_waitcnt vmcnt(0)
  s_barrier
  ds_read_b128 v[248:251], v202 offset:28672
  ds_read_b128 v[252:255], v202 offset:29696
  s_waitcnt lgkmcnt(4)
  v_dot2c_f32_bf16 v232, v184, v184
  v_dot2c_f32_bf16 v233, v185, v185
  v_dot2c_f32_bf16 v234, v186, v186
  v_dot2c_f32_bf16 v235, v187, v187
  v_dot2c_f32_bf16 v236, v188, v188
  v_dot2c_f32_bf16 v237, v189, v189
  v_dot2c_f32_bf16 v238, v190, v190
  v_dot2c_f32_bf16 v239, v191, v191
  ds_read_b128 v[184:187], v202 offset:30720
  ds_read_b128 v[188:191], v202 offset:31744
  s_waitcnt lgkmcnt(4)
  v_dot2c_f32_bf16 v232, v192, v192
  v_dot2c_f32_bf16 v233, v193, v193
  v_dot2c_f32_bf16 v234, v194, v194
  v_dot2c_f32_bf16 v235, v195, v195
  v_dot2c_f32_bf16 v236, v196, v196
  v_dot2c_f32_bf16 v237, v197, v197
  v_dot2c_f32_bf16 v238, v198, v198
  v_dot2c_f32_bf16 v239, v199, v199
  ds_read_b128 v[192:195], v202 offset:32768
  ds_read_b128 v[196:199], v202 offset:33792
  s_waitcnt lgkmcnt(4)
  v_dot2c_f32_bf16 v232, v248, v248
  v_dot2c_f32_bf16 v233, v249, v249
  v_dot2c_f32_bf16 v234, v250, v250
  v_dot2c_f32_bf16 v235, v251, v251
  v_dot2c_f32_bf16 v236, v252, v252
  v_dot2c_f32_bf16 v237, v253, v253
  v_dot2c_f32_bf16 v238, v254, v254
  v_dot2c_f32_bf16 v239, v255, v255
  ds_read_b128 v[248:251], v202 offset:34816
  ds_read_b128 v[252:255], v202 offset:35840
  s_waitcnt lgkmcnt(4)
  v_dot2c_f32_bf16 v232, v184, v184
  v_dot2c_f32_bf16 v233, v185, v185
  v_dot2c_f32_bf16 v234, v186, v186
  v_dot2c_f32_bf16 v235, v187, v187
  v_dot2c_f32_bf16 v236, v188, v188
  v_dot2c_f32_bf16 v237, v189, v189
  v_dot2c_f32_bf16 v238, v190, v190
  v_dot2c_f32_bf16 v239, v191, v191
  s_waitcnt lgkmcnt(2)
  v_dot2c_f32_bf16 v232, v192, v192
  v_dot2c_f32_bf16 v233, v193, v193
  v_dot2c_f32_bf16 v234, v194, v194
  v_dot2c_f32_bf16 v235, v195, v195
  v_dot2c_f32_bf16 v236, v196, v196
  v_dot2c_f32_bf16 v237, v197, v197
  v_dot2c_f32_bf16 v238, v198, v198
  v_dot2c_f32_bf16 v239, v199, v199
  s_waitcnt lgkmcnt(0)
  v_dot2c_f32_bf16 v232, v248, v248
  v_dot2c_f32_bf16 v233, v249, v249
  v_dot2c_f32_bf16 v234, v250, v250
  v_dot2c_f32_bf16 v235, v251, v251
  v_dot2c_f32_bf16 v236, v252, v252
  v_dot2c_f32_bf16 v237, v253, v253
  v_dot2c_f32_bf16 v238, v254, v254
  v_dot2c_f32_bf16 v239, v255, v255
    v_add_f32 v232, v232, v233
    v_add_f32 v234, v234, v235
    v_add_f32 v236, v236, v237
    v_add_f32 v238, v238, v239
    v_add_f32 v232, v232, v236
    v_add_f32 v233, v234, v238
    v_mov_b32 v209, v232
    v_mov_b32 v210, v232
  s_nop 1
    v_permlane32_swap_b32 v209, v210
    v_add_f32 v232, v209, v210
    v_mov_b32 v209, v233
    v_mov_b32 v210, v233
  s_nop 1
    v_permlane32_swap_b32 v209, v210
    v_add_f32 v233, v209, v210
  s_mov_b32 s29, 0x3ae38e39
  v_mov_b32 v211, 0x3727c5ac
  v_fma_f32 v200, v232, s29, v211
  v_fma_f32 v201, v233, s29, v211
  v_rsq_f32 v200, v200
  v_rsq_f32 v201, v201
    v_and_b32 v209, 31, v208
    v_lshlrev_b32 v209, 3, v209
    v_add_u32 v209, 73728, v209
    ds_write_b64 v209, v[200:201]
    s_waitcnt lgkmcnt(0)
    s_barrier
    s_branch kfb_kernel_adone
kfb_kernel_helper:
        s_mov_b32 m0, s25
        s_add_u32 s25, s25, 8192
        buffer_load_dwordx4 v206, s[8:11], s24 offen lds
        s_add_u32 s24, s24, 264192
  s_barrier
        s_mov_b32 m0, s25
        s_add_u32 s25, s25, 8192
        buffer_load_dwordx4 v206, s[8:11], s24 offen lds
        s_add_u32 s24, s24, 264192
  s_barrier
        s_mov_b32 m0, s25
        s_add_u32 s25, s25, 8192
        buffer_load_dwordx4 v206, s[8:11], s24 offen lds
        s_add_u32 s24, s24, 264192
        s_mov_b32 m0, s25
        s_add_u32 s25, s25, 8192
        buffer_load_dwordx4 v206, s[8:11], s24 offen lds
        s_add_u32 s24, s24, 264192
        s_mov_b32 m0, s25
        s_add_u32 s25, s25, 8192
        buffer_load_dwordx4 v206, s[8:11], s24 offen lds
        s_add_u32 s24, s24, 264192
        s_mov_b32 m0, s25
        s_add_u32 s25, s25, 8192
        buffer_load_dwordx4 v206, s[8:11], s24 offen lds
        s_add_u32 s24, s24, 264192
        s_mov_b32 m0, s25
        s_add_u32 s25, s25, 8192
        buffer_load_dwordx4 v206, s[8:11], s24 offen lds
        s_add_u32 s24, s24, 264192
        s_mov_b32 m0, s25
        s_add_u32 s25, s25, 8192
        buffer_load_dwordx4 v206, s[8:11], s24 offen lds
        s_add_u32 s24, s24, 264192
        s_mov_b32 m0, s25
        s_add_u32 s25, s25, 8192
        buffer_load_dwordx4 v206, s[8:11], s24 offen lds
        s_add_u32 s24, s24, 264192
  s_waitcnt vmcnt(8)
  s_barrier
  s_waitcnt vmcnt(7)
  s_barrier
  s_waitcnt vmcnt(6)
  s_barrier
  s_waitcnt vmcnt(5)
  s_barrier
  s_waitcnt vmcnt(4)
  s_barrier
  s_waitcnt vmcnt(3)
  s_barrier
  s_waitcnt vmcnt(2)
  s_barrier
  s_waitcnt vmcnt(1)
  s_barrier
  s_waitcnt vmcnt(0)
  s_barrier
  s_barrier
kfb_kernel_adone:
    v_mov_b32 v107, v208
    v_lshlrev_b32 v104, 4, v208
    v_lshlrev_b32 v108, 4, v208
    v_lshlrev_b32 v105, 3, v208
    s_lshl_b32 s35, s20, 10
    s_add_u32 s36, s35, 18194432
    s_and_b32 s24, s20, 1
    s_lshr_b32 s23, s20, 1
    s_mul_i32 s26, s22, 1152
    s_lshl_b32 s27, s23, 9
    s_add_u32 s26, s26, s27
    s_add_u32 s26, s26, 13500416
    v_and_b32 v2, 31, v107
  v_mov_b32 v106, v2
  v_add_u32 v109, 6, v2
  v_subrev_u32 v110, 4, v2
  v_cmp_gt_u32 vcc, 8, v110
  s_nop 1
  v_cndmask_b32 v106, v106, v109, vcc
  v_subrev_u32 v109, 8, v2
  v_subrev_u32 v110, 12, v2
  v_cmp_gt_u32 vcc, 4, v110
  s_nop 1
  v_cndmask_b32 v106, v106, v109, vcc
  v_add_u32 v109, 2, v2
  v_subrev_u32 v110, 16, v2
  v_cmp_gt_u32 vcc, 2, v110
  s_nop 1
  v_cndmask_b32 v106, v106, v109, vcc
  v_subrev_u32 v109, 12, v2
  v_subrev_u32 v110, 20, v2
  v_cmp_gt_u32 vcc, 2, v110
  s_nop 1
  v_cndmask_b32 v106, v106, v109, vcc
  v_mov_b32 v109, 10
  v_subrev_u32 v110, 18, v2
  v_cmp_gt_u32 vcc, 2, v110
  s_nop 1
  v_cndmask_b32 v106, v106, v109, vcc
  v_mov_b32 v109, 10
  v_subrev_u32 v110, 28, v2
  v_cmp_gt_u32 vcc, 4, v110
  s_nop 1
  v_cndmask_b32 v106, v106, v109, vcc
  v_mov_b32 v109, 0
  v_subrev_u32 v110, 22, v2
  v_cmp_gt_u32 vcc, 6, v110
  s_nop 1
  v_cndmask_b32 v106, v106, v109, vcc
    v_lshlrev_b32 v106, 4, v106
    v_lshrrev_b32 v109, 5, v107
    v_mul_u32_u24 v110, 320, v109
    v_add_u32 v106, v106, v110
    v_mul_u32_u24 v111, 9216, v109
    v_lshl_add_u32 v111, v2, 4, v111
  v_mov_b32 v16, 0
  v_mov_b32 v64, 0
  v_mov_b32 v17, 0
  v_mov_b32 v65, 0
  v_mov_b32 v18, 0
  v_mov_b32 v66, 0
  v_mov_b32 v19, 0
  v_mov_b32 v67, 0
  v_mov_b32 v20, 0
  v_mov_b32 v68, 0
  v_mov_b32 v21, 0
  v_mov_b32 v69, 0
  v_mov_b32 v22, 0
  v_mov_b32 v70, 0
  v_mov_b32 v23, 0
  v_mov_b32 v71, 0
  v_mov_b32 v24, 0
  v_mov_b32 v72, 0
  v_mov_b32 v25, 0
  v_mov_b32 v73, 0
  v_mov_b32 v26, 0
  v_mov_b32 v74, 0
  v_mov_b32 v27, 0
  v_mov_b32 v75, 0
  v_mov_b32 v28, 0
  v_mov_b32 v76, 0
  v_mov_b32 v29, 0
  v_mov_b32 v77, 0
  v_mov_b32 v30, 0
  v_mov_b32 v78, 0
  v_mov_b32 v31, 0
  v_mov_b32 v79, 0
  v_mov_b32 v9, 0
  v_mov_b32 v11, 0
  v_mov_b32 v12, 0
  v_mov_b32 v14, 0
  v_mov_b32 v84, 0
  v_mov_b32 v85, 0
  v_mov_b32 v86, 0
  v_mov_b32 v87, 0
    s_lshr_b32 s53, s22, 1
    s_mul_i32 s53, s53, 9
    s_and_b32 s38, s22, 1
    s_lshl_b32 s52, s38, 2
    s_add_u32 s52, s52, s53
    s_add_u32 s52, s52, s23
    s_add_u32 s53, s53, 8
    s_mul_i32 s40, s21, 36
    s_add_u32 s52, s52, s40
    s_add_u32 s53, s53, s40
    s_lshl_b32 s52, s52, 1
    s_lshl_b32 s53, s53, 1
    s_add_u32 s52, s52, s24
    s_add_u32 s53, s53, s24
    s_lshl_b32 s52, s52, 10
    s_lshl_b32 s53, s53, 10
    s_add_u32 s52, s52, 20709376
    s_add_u32 s53, s53, 20709376
    s_lshl_b32 s38, s38, 9
    s_lshl_b32 s40, s23, 2
    s_add_u32 s38, s38, s40
    s_add_u32 s53, s53, s38
    s_lshl_b32 s54, s21, 7
    s_add_u32 s54, s54, 26238976
    s_mul_i32 s46, s21, 73728
    s_lshl_b32 s47, s20, 10
    s_add_u32 s46, s46, s47
    s_add_u32 s46, s46, 20709376
        s_lshl_b32 s31, s21, 3
        s_add_u32 s31, s31, s22
        s_mul_i32 s31, s31, 12288
        s_add_u32 s31, s31, 23068672
        s_lshl_b32 s34, s23, 12
        s_add_u32 s31, s31, s34
        s_lshl_b32 s34, s24, 11
        s_add_u32 s31, s31, s34
    s_lshl_b32 s37, s24, 12
    s_lshl_b32 s38, s23, 10
    s_add_u32 s37, s37, s38
    s_add_u32 s37, s37, 74240
    v_add_u32 v32, s37, v104
    s_lshl_b32 s37, s24, 9
    s_lshl_b32 s38, s23, 1
    s_add_u32 s37, s37, s38
    s_add_u32 s37, s37, 82432
    v_add_u32 v33, s37, v105
    v_mov_b32 v34, 83456
    v_lshlrev_b32 v35, 2, v107
    v_and_b32 v35, 0x7c, v35
    s_mov_b32 s37, 9547776
    s_cmp_eq_u32 s20, 7
    s_cbranch_scc0 kfb_kernel_nopoll
    s_and_b32 s33, s2, 7
    s_lshl_b32 s33, s33, 7
    s_add_u32 s33, s33, 26230784
  s_mov_b32 s44, 0
  s_mov_b32 s45, 12
  v_lshlrev_b32 v109, 10, v107
  s_mov_b64 exec, 0xff
kfb_kernel_pollkv:
        buffer_load_dword v110, v109, s[8:11], s33 offen sc1
        s_waitcnt vmcnt(0)
        v_cmp_le_u32 vcc, s45, v110
        s_add_u32 s44, s44, 1
        s_cmp_ge_u32 s44, 262144
        s_cbranch_scc1 kfb_kernel_pdkv
  s_nop 0
        s_cmp_eq_u64 vcc, exec
        s_cbranch_scc1 kfb_kernel_pdkv
        s_sleep 1
        s_branch kfb_kernel_pollkv
kfb_kernel_pdkv:
  s_mov_b64 exec, -1
kfb_kernel_nopoll:
  s_waitcnt lgkmcnt(0)
  s_barrier
  buffer_load_dword v1, v35, s[8:11], s37 offen sc1
        s_mov_b32 m0, s35
        s_add_u32 s35, s35, 8192
        buffer_load_dwordx4 v104, s[8:11], s36 offen sc1 lds
        s_add_u32 s36, s36, 8192
        s_mov_b32 m0, s35
        s_add_u32 s35, s35, 8192
        buffer_load_dwordx4 v104, s[8:11], s36 offen sc1 lds
        s_add_u32 s36, s36, 8192
        s_mov_b32 m0, s35
        s_add_u32 s35, s35, 8192
        buffer_load_dwordx4 v104, s[8:11], s36 offen sc1 lds
        s_add_u32 s36, s36, 8192
    ds_read_b128 v[4:7], v32
    ds_read_u16 v8, v33
    ds_read_b96 v[48:50], v34
    s_waitcnt lgkmcnt(0)
    v_max_f32 v3, v48, v49
    v_add_f32 v3, v3, v50
    v_lshlrev_b32 v10, 16, v8
    v_mov_b32 v13, v8
    v_mov_b32 v15, v10
    s_waitcnt vmcnt(3)
  v_max_f32_dpp v1, v1, v1 row_ror:1 row_mask:0xf bank_mask:0xf
  s_nop 1
  v_max_f32_dpp v1, v1, v1 row_ror:2 row_mask:0xf bank_mask:0xf
  s_nop 1
  v_max_f32_dpp v1, v1, v1 row_ror:4 row_mask:0xf bank_mask:0xf
  s_nop 1
  v_max_f32_dpp v1, v1, v1 row_ror:8 row_mask:0xf bank_mask:0xf
    v_mov_b32 v109, v1
    v_mov_b32 v110, v1
  s_nop 1
    v_permlane16_swap_b32 v109, v110
    v_max_f32 v1, v109, v110
    v_mov_b32 v109, v1
    v_mov_b32 v110, v1
  s_nop 1
    v_permlane32_swap_b32 v109, v110
    v_max_f32 v1, v109, v110
    v_mul_f32 v109, v3, v1
    v_mov_b32 v110, 0x45610000
    v_cmp_le_f32 vcc, v109, v110
    s_waitcnt vmcnt(0)
    s_barrier
  s_nop 1
    s_cbranch_vccnz kfb_kernel_fast
        s_mov_b32 m0, s35
        s_add_u32 s35, s35, 8192
        buffer_load_dwordx4 v104, s[8:11], s36 offen sc1 lds
        s_add_u32 s36, s36, 8192
        s_mov_b32 m0, s35
        s_add_u32 s35, s35, 8192
        buffer_load_dwordx4 v104, s[8:11], s36 offen sc1 lds
        s_add_u32 s36, s36, 8192
        s_mov_b32 m0, s35
        s_add_u32 s35, s35, 8192
        buffer_load_dwordx4 v104, s[8:11], s36 offen sc1 lds
        s_add_u32 s36, s36, 8192
        s_mov_b32 m0, s35
        s_add_u32 s35, s35, 8192
        buffer_load_dwordx4 v104, s[8:11], s36 offen sc1 lds
        s_add_u32 s36, s36, 8192
        s_mov_b32 m0, s35
        s_add_u32 s35, s35, 8192
        buffer_load_dwordx4 v104, s[8:11], s36 offen sc1 lds
        s_add_u32 s36, s36, 8192
        s_mov_b32 m0, s35
        s_add_u32 s35, s35, 8192
        buffer_load_dwordx4 v104, s[8:11], s36 offen sc1 lds
        s_add_u32 s36, s36, 8192
        s_mov_b32 m0, s35
        s_add_u32 s35, s35, 8192
        buffer_load_dwordx4 v104, s[8:11], s36 offen sc1 lds
        s_add_u32 s36, s36, 8192
        s_mov_b32 m0, s35
        s_add_u32 s35, s35, 8192
        buffer_load_dwordx4 v104, s[8:11], s36 offen sc1 lds
        s_add_u32 s36, s36, 8192
        s_mov_b32 m0, s35
        s_add_u32 s35, s35, 8192
        buffer_load_dwordx4 v104, s[8:11], s36 offen sc1 lds
        s_add_u32 s36, s36, 8192
        s_mov_b32 m0, s35
        s_add_u32 s35, s35, 8192
        buffer_load_dwordx4 v104, s[8:11], s36 offen sc1 lds
        s_add_u32 s36, s36, 8192
        s_mov_b32 m0, s35
        s_add_u32 s35, s35, 8192
        buffer_load_dwordx4 v104, s[8:11], s36 offen sc1 lds
        s_add_u32 s36, s36, 8192
        s_mov_b32 m0, s35
        s_add_u32 s35, s35, 8192
        buffer_load_dwordx4 v104, s[8:11], s36 offen sc1 lds
        s_add_u32 s36, s36, 8192
        s_mov_b32 m0, s35
        s_add_u32 s35, s35, 8192
        buffer_load_dwordx4 v104, s[8:11], s36 offen sc1 lds
        s_add_u32 s36, s36, 8192
        s_mov_b32 m0, s35
        s_add_u32 s35, s35, 8192
        buffer_load_dwordx4 v104, s[8:11], s36 offen sc1 lds
        s_add_u32 s36, s36, 8192
        s_mov_b32 m0, s35
        s_add_u32 s35, s35, 8192
        buffer_load_dwordx4 v104, s[8:11], s36 offen sc1 lds
        s_add_u32 s36, s36, 8192
        s_mov_b32 m0, s35
        s_add_u32 s35, s35, 8192
        buffer_load_dwordx4 v104, s[8:11], s36 offen sc1 lds
        s_add_u32 s36, s36, 8192
    s_waitcnt vmcnt(0)
    s_barrier
    v_mov_b32 v2, 0xff800000
    v_mov_b32 v48, v104
    v_mov_b32 v49, v105
    s_mov_b32 s25, 0
kfb_kernel_mx:
  ds_read_b64 v[92:93], v49 offset:8192
        ds_read_b128 v[88:91], v48 offset:0
        s_waitcnt lgkmcnt(0)
        v_mfma_f32_32x32x16_bf16 v[32:47], v[88:91], v[4:7], 0
        v_mfma_f32_32x32x8_bf16 v[32:47], v[92:93], v[8:9], v[32:47]
  s_nop 11
  v_max3_f32 v2, v32, v33, v2
  v_max3_f32 v2, v34, v35, v2
  v_max3_f32 v2, v36, v37, v2
  v_max3_f32 v2, v38, v39, v2
  v_max3_f32 v2, v40, v41, v2
  v_max3_f32 v2, v42, v43, v2
  v_max3_f32 v2, v44, v45, v2
  v_max3_f32 v2, v46, v47, v2
        ds_read_b128 v[88:91], v48 offset:1024
        s_waitcnt lgkmcnt(0)
        v_mfma_f32_32x32x16_bf16 v[32:47], v[88:91], v[4:7], 0
        v_mfma_f32_32x32x8_bf16 v[32:47], v[92:93], v[10:11], v[32:47]
  s_nop 11
  v_max3_f32 v2, v32, v33, v2
  v_max3_f32 v2, v34, v35, v2
  v_max3_f32 v2, v36, v37, v2
  v_max3_f32 v2, v38, v39, v2
  v_max3_f32 v2, v40, v41, v2
  v_max3_f32 v2, v42, v43, v2
  v_max3_f32 v2, v44, v45, v2
  v_max3_f32 v2, v46, v47, v2
        ds_read_b128 v[88:91], v48 offset:2048
        s_waitcnt lgkmcnt(0)
        v_mfma_f32_32x32x16_bf16 v[32:47], v[88:91], v[4:7], 0
        v_mfma_f32_32x32x8_bf16 v[32:47], v[92:93], v[12:13], v[32:47]
  s_nop 11
  v_max3_f32 v2, v32, v33, v2
  v_max3_f32 v2, v34, v35, v2
  v_max3_f32 v2, v36, v37, v2
  v_max3_f32 v2, v38, v39, v2
  v_max3_f32 v2, v40, v41, v2
  v_max3_f32 v2, v42, v43, v2
  v_max3_f32 v2, v44, v45, v2
  v_max3_f32 v2, v46, v47, v2
        ds_read_b128 v[88:91], v48 offset:3072
        s_waitcnt lgkmcnt(0)
        v_mfma_f32_32x32x16_bf16 v[32:47], v[88:91], v[4:7], 0
        v_mfma_f32_32x32x8_bf16 v[32:47], v[92:93], v[14:15], v[32:47]
  s_nop 11
  v_max3_f32 v2, v32, v33, v2
  v_max3_f32 v2, v34, v35, v2
  v_max3_f32 v2, v36, v37, v2
  v_max3_f32 v2, v38, v39, v2
  v_max3_f32 v2, v40, v41, v2
  v_max3_f32 v2, v42, v43, v2
  v_max3_f32 v2, v44, v45, v2
  v_max3_f32 v2, v46, v47, v2
  ds_read_b64 v[92:93], v49 offset:8704
        ds_read_b128 v[88:91], v48 offset:4096
        s_waitcnt lgkmcnt(0)
        v_mfma_f32_32x32x16_bf16 v[32:47], v[88:91], v[4:7], 0
        v_mfma_f32_32x32x8_bf16 v[32:47], v[92:93], v[8:9], v[32:47]
  s_nop 11
  v_max3_f32 v2, v32, v33, v2
  v_max3_f32 v2, v34, v35, v2
  v_max3_f32 v2, v36, v37, v2
  v_max3_f32 v2, v38, v39, v2
  v_max3_f32 v2, v40, v41, v2
  v_max3_f32 v2, v42, v43, v2
  v_max3_f32 v2, v44, v45, v2
  v_max3_f32 v2, v46, v47, v2
        ds_read_b128 v[88:91], v48 offset:5120
        s_waitcnt lgkmcnt(0)
        v_mfma_f32_32x32x16_bf16 v[32:47], v[88:91], v[4:7], 0
        v_mfma_f32_32x32x8_bf16 v[32:47], v[92:93], v[10:11], v[32:47]
  s_nop 11
  v_max3_f32 v2, v32, v33, v2
  v_max3_f32 v2, v34, v35, v2
  v_max3_f32 v2, v36, v37, v2
  v_max3_f32 v2, v38, v39, v2
  v_max3_f32 v2, v40, v41, v2
  v_max3_f32 v2, v42, v43, v2
  v_max3_f32 v2, v44, v45, v2
  v_max3_f32 v2, v46, v47, v2
        ds_read_b128 v[88:91], v48 offset:6144
        s_waitcnt lgkmcnt(0)
        v_mfma_f32_32x32x16_bf16 v[32:47], v[88:91], v[4:7], 0
        v_mfma_f32_32x32x8_bf16 v[32:47], v[92:93], v[12:13], v[32:47]
  s_nop 11
  v_max3_f32 v2, v32, v33, v2
  v_max3_f32 v2, v34, v35, v2
  v_max3_f32 v2, v36, v37, v2
  v_max3_f32 v2, v38, v39, v2
  v_max3_f32 v2, v40, v41, v2
  v_max3_f32 v2, v42, v43, v2
  v_max3_f32 v2, v44, v45, v2
  v_max3_f32 v2, v46, v47, v2
        ds_read_b128 v[88:91], v48 offset:7168
        s_waitcnt lgkmcnt(0)
        v_mfma_f32_32x32x16_bf16 v[32:47], v[88:91], v[4:7], 0
        v_mfma_f32_32x32x8_bf16 v[32:47], v[92:93], v[14:15], v[32:47]
  s_nop 11
  v_max3_f32 v2, v32, v33, v2
  v_max3_f32 v2, v34, v35, v2
  v_max3_f32 v2, v36, v37, v2
  v_max3_f32 v2, v38, v39, v2
  v_max3_f32 v2, v40, v41, v2
  v_max3_f32 v2, v42, v43, v2
  v_max3_f32 v2, v44, v45, v2
  v_max3_f32 v2, v46, v47, v2
    v_add_u32 v48, 19456, v48
    v_add_u32 v49, 19456, v49
    s_add_u32 s25, s25, 1
    s_cmp_lt_u32 s25, 8
    s_cbranch_scc1 kfb_kernel_mx
    v_mov_b32 v109, v2
    v_mov_b32 v110, v2
  s_nop 1
    v_permlane32_swap_b32 v109, v110
    v_max_f32 v2, v109, v110
  v_sub_f32 v16, 0, v2
  v_sub_f32 v17, 0, v2
  v_sub_f32 v18, 0, v2
  v_sub_f32 v19, 0, v2
  v_sub_f32 v20, 0, v2
  v_sub_f32 v21, 0, v2
  v_sub_f32 v22, 0, v2
  v_sub_f32 v23, 0, v2
  v_sub_f32 v24, 0, v2
  v_sub_f32 v25, 0, v2
  v_sub_f32 v26, 0, v2
  v_sub_f32 v27, 0, v2
  v_sub_f32 v28, 0, v2
  v_sub_f32 v29, 0, v2
  v_sub_f32 v30, 0, v2
  v_sub_f32 v31, 0, v2
  s_mov_b32 s41, 1
  s_branch kfb_kernel_go
kfb_kernel_fast:
  s_mov_b32 s41, 0
kfb_kernel_go:
    ds_read_b128 v[88:91], v104
    ds_read_b64 v[92:93], v105 offset:8192
    s_cmp_ge_u32 s20, 4
    s_cbranch_scc0 kfb_kernel_np
    s_setprio 1
kfb_kernel_np:
    s_waitcnt lgkmcnt(0)
    v_mfma_f32_32x32x16_bf16 v[32:47], v[88:91], v[4:7], v[16:31]
    v_mfma_f32_32x32x8_bf16 v[32:47], v[92:93], v[8:9], v[32:47]
    ds_read_b128 v[88:91], v104 offset:1024
    ds_read_b128 v[100:103], v106 offset:9856
    ds_read_b128 v[96:99], v106 offset:9216
    s_nop 7
  s_cmp_eq_u32 s41, 0
  s_cbranch_scc0 kfb_kernel_nodma0
        s_mov_b32 m0, s35
        s_add_u32 s35, s35, 8192
        buffer_load_dwordx4 v108, s[8:11], s36 offen sc1 lds
        s_add_u32 s36, s36, 8192
kfb_kernel_nodma0:
  v_exp_f32 v32, v32
  s_waitcnt lgkmcnt(0)
  v_mfma_f32_32x32x16_bf16 v[48:63], v[88:91], v[4:7], v[16:31]
  v_exp_f32 v33, v33
  v_exp_f32 v34, v34
  v_cvt_pk_bf16_f32 v80, v32, v33
  v_exp_f32 v35, v35
  v_exp_f32 v36, v36
  v_cvt_pk_bf16_f32 v81, v34, v35
  v_exp_f32 v37, v37
  v_exp_f32 v38, v38
  v_mfma_f32_32x32x8_bf16 v[48:63], v[92:93], v[10:11], v[48:63]
  ds_read_b128 v[88:91], v104 offset:2048
  ds_read_b128 v[0:3], v106 offset:10496
  v_cvt_pk_bf16_f32 v82, v36, v37
  v_exp_f32 v39, v39
  v_exp_f32 v40, v40
  v_cvt_pk_bf16_f32 v83, v38, v39
  v_exp_f32 v41, v41
  v_exp_f32 v42, v42
  v_mfma_f32_32x32x16_bf16 v[64:79], v[100:103], v[84:87], v[64:79]
  ds_read_b128 v[100:103], v106 offset:9856
  v_cvt_pk_bf16_f32 v84, v40, v41
  v_exp_f32 v43, v43
  v_exp_f32 v44, v44
  v_cvt_pk_bf16_f32 v85, v42, v43
  v_exp_f32 v45, v45
  v_mfma_f32_32x32x16_bf16 v[64:79], v[96:99], v[80:83], v[64:79]
  v_exp_f32 v46, v46
  v_exp_f32 v47, v47
  v_cvt_pk_bf16_f32 v86, v44, v45
  v_cvt_pk_bf16_f32 v87, v46, v47
  s_cmp_eq_u32 s41, 0
  s_cbranch_scc0 kfb_kernel_nodma1
        s_mov_b32 m0, s35
        s_add_u32 s35, s35, 8192
        buffer_load_dwordx4 v108, s[8:11], s36 offen sc1 lds
        s_add_u32 s36, s36, 8192
kfb_kernel_nodma1:
  v_exp_f32 v48, v48
  s_waitcnt lgkmcnt(0)
  v_mfma_f32_32x32x16_bf16 v[32:47], v[88:91], v[4:7], v[16:31]
  v_exp_f32 v49, v49
  v_exp_f32 v50, v50
  v_cvt_pk_bf16_f32 v80, v48, v49
  v_exp_f32 v51, v51
  v_exp_f32 v52, v52
  v_cvt_pk_bf16_f32 v81, v50, v51
  v_exp_f32 v53, v53
  v_exp_f32 v54, v54
  v_mfma_f32_32x32x8_bf16 v[32:47], v[92:93], v[12:13], v[32:47]
  ds_read_b128 v[88:91], v104 offset:3072
  ds_read_b128 v[96:99], v106 offset:11776
  v_cvt_pk_bf16_f32 v82, v52, v53
  v_exp_f32 v55, v55
  v_exp_f32 v56, v56
  v_cvt_pk_bf16_f32 v83, v54, v55
  v_exp_f32 v57, v57
  v_exp_f32 v58, v58
  v_mfma_f32_32x32x16_bf16 v[64:79], v[100:103], v[84:87], v[64:79]
  ds_read_b128 v[100:103], v106 offset:11136
  v_cvt_pk_bf16_f32 v84, v56, v57
  v_exp_f32 v59, v59
  v_exp_f32 v60, v60
  v_cvt_pk_bf16_f32 v85, v58, v59
  v_exp_f32 v61, v61
  v_mfma_f32_32x32x16_bf16 v[64:79], v[0:3], v[80:83], v[64:79]
  v_exp_f32 v62, v62
  v_exp_f32 v63, v63
  v_cvt_pk_bf16_f32 v86, v60, v61
  v_cvt_pk_bf16_f32 v87, v62, v63
  s_cmp_eq_u32 s41, 0
  s_cbranch_scc0 kfb_kernel_nodma2
        s_mov_b32 m0, s35
        s_add_u32 s35, s35, 8192
        buffer_load_dwordx4 v108, s[8:11], s36 offen sc1 lds
        s_add_u32 s36, s36, 8192
kfb_kernel_nodma2:
  v_exp_f32 v32, v32
  s_waitcnt lgkmcnt(0)
  v_mfma_f32_32x32x16_bf16 v[48:63], v[88:91], v[4:7], v[16:31]
  v_exp_f32 v33, v33
  v_exp_f32 v34, v34
  v_cvt_pk_bf16_f32 v80, v32, v33
  v_exp_f32 v35, v35
  v_exp_f32 v36, v36
  v_cvt_pk_bf16_f32 v81, v34, v35
  v_exp_f32 v37, v37
  v_exp_f32 v38, v38
  v_mfma_f32_32x32x8_bf16 v[48:63], v[92:93], v[14:15], v[48:63]
  ds_read_b64 v[94:95], v105 offset:8704
  ds_read_b128 v[88:91], v104 offset:4096
  ds_read_b128 v[0:3], v106 offset:13056
  v_cvt_pk_bf16_f32 v82, v36, v37
  v_exp_f32 v39, v39
  v_exp_f32 v40, v40
  v_cvt_pk_bf16_f32 v83, v38, v39
  v_exp_f32 v41, v41
  v_exp_f32 v42, v42
  v_mfma_f32_32x32x16_bf16 v[64:79], v[100:103], v[84:87], v[64:79]
  ds_read_b128 v[100:103], v106 offset:12416
  v_cvt_pk_bf16_f32 v84, v40, v41
  v_exp_f32 v43, v43
  v_exp_f32 v44, v44
  v_cvt_pk_bf16_f32 v85, v42, v43
  v_exp_f32 v45, v45
  v_mfma_f32_32x32x16_bf16 v[64:79], v[96:99], v[80:83], v[64:79]
  v_exp_f32 v46, v46
  v_exp_f32 v47, v47
  v_cvt_pk_bf16_f32 v86, v44, v45
  v_cvt_pk_bf16_f32 v87, v46, v47
  s_cmp_eq_u32 s41, 0
  s_cbranch_scc0 kfb_kernel_nodma3
        s_mov_b32 m0, s35
        s_add_u32 s35, s35, 8192
        buffer_load_dwordx4 v108, s[8:11], s36 offen sc1 lds
        s_add_u32 s36, s36, 8192
kfb_kernel_nodma3:
  v_exp_f32 v48, v48
  s_waitcnt lgkmcnt(0)
  v_mfma_f32_32x32x16_bf16 v[32:47], v[88:91], v[4:7], v[16:31]
  v_exp_f32 v49, v49
  v_exp_f32 v50, v50
  v_cvt_pk_bf16_f32 v80, v48, v49
  v_exp_f32 v51, v51
  v_exp_f32 v52, v52
  v_cvt_pk_bf16_f32 v81, v50, v51
  v_exp_f32 v53, v53
  v_exp_f32 v54, v54
  v_mfma_f32_32x32x8_bf16 v[32:47], v[94:95], v[8:9], v[32:47]
  ds_read_b128 v[88:91], v104 offset:5120
  ds_read_b128 v[96:99], v106 offset:14336
  v_cvt_pk_bf16_f32 v82, v52, v53
  v_exp_f32 v55, v55
  v_exp_f32 v56, v56
  v_cvt_pk_bf16_f32 v83, v54, v55
  v_exp_f32 v57, v57
  v_exp_f32 v58, v58
  v_mfma_f32_32x32x16_bf16 v[64:79], v[100:103], v[84:87], v[64:79]
  ds_read_b128 v[100:103], v106 offset:13696
  v_cvt_pk_bf16_f32 v84, v56, v57
  v_exp_f32 v59, v59
  v_exp_f32 v60, v60
  v_cvt_pk_bf16_f32 v85, v58, v59
  v_exp_f32 v61, v61
  v_mfma_f32_32x32x16_bf16 v[64:79], v[0:3], v[80:83], v[64:79]
  v_exp_f32 v62, v62
  v_exp_f32 v63, v63
  v_cvt_pk_bf16_f32 v86, v60, v61
  v_cvt_pk_bf16_f32 v87, v62, v63
  s_cmp_eq_u32 s41, 0
  s_cbranch_scc0 kfb_kernel_nodma4
        s_mov_b32 m0, s35
        s_add_u32 s35, s35, 8192
        buffer_load_dwordx4 v108, s[8:11], s36 offen sc1 lds
        s_add_u32 s36, s36, 8192
kfb_kernel_nodma4:
  v_exp_f32 v32, v32
  s_waitcnt lgkmcnt(0)
  v_mfma_f32_32x32x16_bf16 v[48:63], v[88:91], v[4:7], v[16:31]
  v_exp_f32 v33, v33
  v_exp_f32 v34, v34
  v_cvt_pk_bf16_f32 v80, v32, v33
  v_exp_f32 v35, v35
  v_exp_f32 v36, v36
  v_cvt_pk_bf16_f32 v81, v34, v35
  v_exp_f32 v37, v37
  v_exp_f32 v38, v38
  v_mfma_f32_32x32x8_bf16 v[48:63], v[94:95], v[10:11], v[48:63]
  ds_read_b128 v[88:91], v104 offset:6144
  ds_read_b128 v[0:3], v106 offset:15616
  v_cvt_pk_bf16_f32 v82, v36, v37
  v_exp_f32 v39, v39
  v_exp_f32 v40, v40
  v_cvt_pk_bf16_f32 v83, v38, v39
  v_exp_f32 v41, v41
  v_exp_f32 v42, v42
  v_mfma_f32_32x32x16_bf16 v[64:79], v[100:103], v[84:87], v[64:79]
  ds_read_b128 v[100:103], v106 offset:14976
  v_cvt_pk_bf16_f32 v84, v40, v41
  v_exp_f32 v43, v43
  v_exp_f32 v44, v44
  v_cvt_pk_bf16_f32 v85, v42, v43
  v_exp_f32 v45, v45
  v_mfma_f32_32x32x16_bf16 v[64:79], v[96:99], v[80:83], v[64:79]
  v_exp_f32 v46, v46
  v_exp_f32 v47, v47
  v_cvt_pk_bf16_f32 v86, v44, v45
  v_cvt_pk_bf16_f32 v87, v46, v47
  s_cmp_eq_u32 s41, 0
  s_cbranch_scc0 kfb_kernel_nodma5
        s_mov_b32 m0, s35
        s_add_u32 s35, s35, 8192
        buffer_load_dwordx4 v108, s[8:11], s36 offen sc1 lds
        s_add_u32 s36, s36, 8192
kfb_kernel_nodma5:
  s_waitcnt vmcnt(4)
  s_barrier
  v_exp_f32 v48, v48
  s_waitcnt lgkmcnt(0)
  v_mfma_f32_32x32x16_bf16 v[32:47], v[88:91], v[4:7], v[16:31]
  v_exp_f32 v49, v49
  v_exp_f32 v50, v50
  v_cvt_pk_bf16_f32 v80, v48, v49
  v_exp_f32 v51, v51
  v_exp_f32 v52, v52
  v_cvt_pk_bf16_f32 v81, v50, v51
  v_exp_f32 v53, v53
  v_exp_f32 v54, v54
  v_mfma_f32_32x32x8_bf16 v[32:47], v[94:95], v[12:13], v[32:47]
  ds_read_b128 v[88:91], v104 offset:7168
  ds_read_b128 v[96:99], v106 offset:16896
  v_cvt_pk_bf16_f32 v82, v52, v53
  v_exp_f32 v55, v55
  v_exp_f32 v56, v56
  v_cvt_pk_bf16_f32 v83, v54, v55
  v_exp_f32 v57, v57
  v_exp_f32 v58, v58
  v_mfma_f32_32x32x16_bf16 v[64:79], v[100:103], v[84:87], v[64:79]
  ds_read_b128 v[100:103], v106 offset:16256
  v_cvt_pk_bf16_f32 v84, v56, v57
  v_exp_f32 v59, v59
  v_exp_f32 v60, v60
  v_cvt_pk_bf16_f32 v85, v58, v59
  v_exp_f32 v61, v61
  v_mfma_f32_32x32x16_bf16 v[64:79], v[0:3], v[80:83], v[64:79]
  v_exp_f32 v62, v62
  v_exp_f32 v63, v63
  v_cvt_pk_bf16_f32 v86, v60, v61
  v_cvt_pk_bf16_f32 v87, v62, v63
  s_cmp_eq_u32 s41, 0
  s_cbranch_scc0 kfb_kernel_nodma6
        s_mov_b32 m0, s35
        s_add_u32 s35, s35, 8192
        buffer_load_dwordx4 v108, s[8:11], s36 offen sc1 lds
        s_add_u32 s36, s36, 8192
kfb_kernel_nodma6:
  v_exp_f32 v32, v32
  s_waitcnt lgkmcnt(0)
  v_mfma_f32_32x32x16_bf16 v[48:63], v[88:91], v[4:7], v[16:31]
  v_exp_f32 v33, v33
  v_exp_f32 v34, v34
  v_cvt_pk_bf16_f32 v80, v32, v33
  v_exp_f32 v35, v35
  v_exp_f32 v36, v36
  v_cvt_pk_bf16_f32 v81, v34, v35
  v_exp_f32 v37, v37
  v_exp_f32 v38, v38
  v_mfma_f32_32x32x8_bf16 v[48:63], v[94:95], v[14:15], v[48:63]
  ds_read_b64 v[92:93], v105 offset:27648
  ds_read_b128 v[88:91], v104 offset:19456
  ds_read_b128 v[0:3], v106 offset:18176
  v_cvt_pk_bf16_f32 v82, v36, v37
  v_exp_f32 v39, v39
  v_exp_f32 v40, v40
  v_cvt_pk_bf16_f32 v83, v38, v39
  v_exp_f32 v41, v41
  v_exp_f32 v42, v42
  v_mfma_f32_32x32x16_bf16 v[64:79], v[100:103], v[84:87], v[64:79]
  ds_read_b128 v[100:103], v106 offset:17536
  v_cvt_pk_bf16_f32 v84, v40, v41
  v_exp_f32 v43, v43
  v_exp_f32 v44, v44
  v_cvt_pk_bf16_f32 v85, v42, v43
  v_exp_f32 v45, v45
  v_mfma_f32_32x32x16_bf16 v[64:79], v[96:99], v[80:83], v[64:79]
  v_exp_f32 v46, v46
  v_exp_f32 v47, v47
  v_cvt_pk_bf16_f32 v86, v44, v45
  v_cvt_pk_bf16_f32 v87, v46, v47
  s_cmp_eq_u32 s41, 0
  s_cbranch_scc0 kfb_kernel_nodma7
        s_mov_b32 m0, s35
        s_add_u32 s35, s35, 8192
        buffer_load_dwordx4 v108, s[8:11], s36 offen sc1 lds
        s_add_u32 s36, s36, 8192
kfb_kernel_nodma7:
  v_exp_f32 v48, v48
  s_waitcnt lgkmcnt(0)
  v_mfma_f32_32x32x16_bf16 v[32:47], v[88:91], v[4:7], v[16:31]
  v_exp_f32 v49, v49
  v_exp_f32 v50, v50
  v_cvt_pk_bf16_f32 v80, v48, v49
  v_exp_f32 v51, v51
  v_exp_f32 v52, v52
  v_cvt_pk_bf16_f32 v81, v50, v51
  v_exp_f32 v53, v53
  v_exp_f32 v54, v54
  v_mfma_f32_32x32x8_bf16 v[32:47], v[92:93], v[8:9], v[32:47]
  ds_read_b128 v[88:91], v104 offset:20480
  ds_read_b128 v[96:99], v106 offset:28672
  v_cvt_pk_bf16_f32 v82, v52, v53
  v_exp_f32 v55, v55
  v_exp_f32 v56, v56
  v_cvt_pk_bf16_f32 v83, v54, v55
  v_exp_f32 v57, v57
  v_exp_f32 v58, v58
  v_mfma_f32_32x32x16_bf16 v[64:79], v[100:103], v[84:87], v[64:79]
  ds_read_b128 v[100:103], v106 offset:18816
  v_cvt_pk_bf16_f32 v84, v56, v57
  v_exp_f32 v59, v59
  v_exp_f32 v60, v60
  v_cvt_pk_bf16_f32 v85, v58, v59
  v_exp_f32 v61, v61
  v_mfma_f32_32x32x16_bf16 v[64:79], v[0:3], v[80:83], v[64:79]
  v_exp_f32 v62, v62
  v_exp_f32 v63, v63
  v_cvt_pk_bf16_f32 v86, v60, v61
  v_cvt_pk_bf16_f32 v87, v62, v63
  s_cmp_eq_u32 s41, 0
  s_cbranch_scc0 kfb_kernel_nodma8
        s_mov_b32 m0, s35
        s_add_u32 s35, s35, 8192
        buffer_load_dwordx4 v108, s[8:11], s36 offen sc1 lds
        s_add_u32 s36, s36, 8192
kfb_kernel_nodma8:
  v_exp_f32 v32, v32
  s_waitcnt lgkmcnt(0)
  v_mfma_f32_32x32x16_bf16 v[48:63], v[88:91], v[4:7], v[16:31]
  v_exp_f32 v33, v33
  v_exp_f32 v34, v34
  v_cvt_pk_bf16_f32 v80, v32, v33
  v_exp_f32 v35, v35
  v_exp_f32 v36, v36
  v_cvt_pk_bf16_f32 v81, v34, v35
  v_exp_f32 v37, v37
  v_exp_f32 v38, v38
  v_mfma_f32_32x32x8_bf16 v[48:63], v[92:93], v[10:11], v[48:63]
  ds_read_b128 v[88:91], v104 offset:21504
  ds_read_b128 v[0:3], v106 offset:29952
  v_cvt_pk_bf16_f32 v82, v36, v37
  v_exp_f32 v39, v39
  v_exp_f32 v40, v40
  v_cvt_pk_bf16_f32 v83, v38, v39
  v_exp_f32 v41, v41
  v_exp_f32 v42, v42
  v_mfma_f32_32x32x16_bf16 v[64:79], v[100:103], v[84:87], v[64:79]
  ds_read_b128 v[100:103], v106 offset:29312
  v_cvt_pk_bf16_f32 v84, v40, v41
  v_exp_f32 v43, v43
  v_exp_f32 v44, v44
  v_cvt_pk_bf16_f32 v85, v42, v43
  v_exp_f32 v45, v45
  v_mfma_f32_32x32x16_bf16 v[64:79], v[96:99], v[80:83], v[64:79]
  v_exp_f32 v46, v46
  v_exp_f32 v47, v47
  v_cvt_pk_bf16_f32 v86, v44, v45
  v_cvt_pk_bf16_f32 v87, v46, v47
  s_cmp_eq_u32 s41, 0
  s_cbranch_scc0 kfb_kernel_nodma9
        s_mov_b32 m0, s35
        s_add_u32 s35, s35, 8192
        buffer_load_dwordx4 v108, s[8:11], s36 offen sc1 lds
        s_add_u32 s36, s36, 8192
kfb_kernel_nodma9:
  v_exp_f32 v48, v48
  s_waitcnt lgkmcnt(0)
  v_mfma_f32_32x32x16_bf16 v[32:47], v[88:91], v[4:7], v[16:31]
  v_exp_f32 v49, v49
  v_exp_f32 v50, v50
  v_cvt_pk_bf16_f32 v80, v48, v49
  v_exp_f32 v51, v51
  v_exp_f32 v52, v52
  v_cvt_pk_bf16_f32 v81, v50, v51
  v_exp_f32 v53, v53
  v_exp_f32 v54, v54
  v_mfma_f32_32x32x8_bf16 v[32:47], v[92:93], v[12:13], v[32:47]
  ds_read_b128 v[88:91], v104 offset:22528
  ds_read_b128 v[96:99], v106 offset:31232
  v_cvt_pk_bf16_f32 v82, v52, v53
  v_exp_f32 v55, v55
  v_exp_f32 v56, v56
  v_cvt_pk_bf16_f32 v83, v54, v55
  v_exp_f32 v57, v57
  v_exp_f32 v58, v58
  v_mfma_f32_32x32x16_bf16 v[64:79], v[100:103], v[84:87], v[64:79]
  ds_read_b128 v[100:103], v106 offset:30592
  v_cvt_pk_bf16_f32 v84, v56, v57
  v_exp_f32 v59, v59
  v_exp_f32 v60, v60
  v_cvt_pk_bf16_f32 v85, v58, v59
  v_exp_f32 v61, v61
  v_mfma_f32_32x32x16_bf16 v[64:79], v[0:3], v[80:83], v[64:79]
  v_exp_f32 v62, v62
  v_exp_f32 v63, v63
  v_cvt_pk_bf16_f32 v86, v60, v61
  v_cvt_pk_bf16_f32 v87, v62, v63
  s_cmp_eq_u32 s41, 0
  s_cbranch_scc0 kfb_kernel_nodma10
        s_mov_b32 m0, s35
        s_add_u32 s35, s35, 8192
        buffer_load_dwordx4 v108, s[8:11], s36 offen sc1 lds
        s_add_u32 s36, s36, 8192
kfb_kernel_nodma10:
  v_exp_f32 v32, v32
  s_waitcnt lgkmcnt(0)
  v_mfma_f32_32x32x16_bf16 v[48:63], v[88:91], v[4:7], v[16:31]
  v_exp_f32 v33, v33
  v_exp_f32 v34, v34
  v_cvt_pk_bf16_f32 v80, v32, v33
  v_exp_f32 v35, v35
  v_exp_f32 v36, v36
  v_cvt_pk_bf16_f32 v81, v34, v35
  v_exp_f32 v37, v37
  v_exp_f32 v38, v38
  v_mfma_f32_32x32x8_bf16 v[48:63], v[92:93], v[14:15], v[48:63]
  ds_read_b64 v[94:95], v105 offset:28160
  ds_read_b128 v[88:91], v104 offset:23552
  ds_read_b128 v[0:3], v106 offset:32512
  v_cvt_pk_bf16_f32 v82, v36, v37
  v_exp_f32 v39, v39
  v_exp_f32 v40, v40
  v_cvt_pk_bf16_f32 v83, v38, v39
  v_exp_f32 v41, v41
  v_exp_f32 v42, v42
  v_mfma_f32_32x32x16_bf16 v[64:79], v[100:103], v[84:87], v[64:79]
  ds_read_b128 v[100:103], v106 offset:31872
  v_cvt_pk_bf16_f32 v84, v40, v41
  v_exp_f32 v43, v43
  v_exp_f32 v44, v44
  v_cvt_pk_bf16_f32 v85, v42, v43
  v_exp_f32 v45, v45
  v_mfma_f32_32x32x16_bf16 v[64:79], v[96:99], v[80:83], v[64:79]
  v_exp_f32 v46, v46
  v_exp_f32 v47, v47
  v_cvt_pk_bf16_f32 v86, v44, v45
  v_cvt_pk_bf16_f32 v87, v46, v47
  s_cmp_eq_u32 s41, 0
  s_cbranch_scc0 kfb_kernel_nodma11
        s_mov_b32 m0, s35
        s_add_u32 s35, s35, 8192
        buffer_load_dwordx4 v108, s[8:11], s36 offen sc1 lds
        s_add_u32 s36, s36, 8192
kfb_kernel_nodma11:
  v_exp_f32 v48, v48
  s_waitcnt lgkmcnt(0)
  v_mfma_f32_32x32x16_bf16 v[32:47], v[88:91], v[4:7], v[16:31]
  v_exp_f32 v49, v49
  v_exp_f32 v50, v50
  v_cvt_pk_bf16_f32 v80, v48, v49
  v_exp_f32 v51, v51
  v_exp_f32 v52, v52
  v_cvt_pk_bf16_f32 v81, v50, v51
  v_exp_f32 v53, v53
  v_exp_f32 v54, v54
  v_mfma_f32_32x32x8_bf16 v[32:47], v[94:95], v[8:9], v[32:47]
  ds_read_b128 v[88:91], v104 offset:24576
  ds_read_b128 v[96:99], v106 offset:33792
  v_cvt_pk_bf16_f32 v82, v52, v53
  v_exp_f32 v55, v55
  v_exp_f32 v56, v56
  v_cvt_pk_bf16_f32 v83, v54, v55
  v_exp_f32 v57, v57
  v_exp_f32 v58, v58
  v_mfma_f32_32x32x16_bf16 v[64:79], v[100:103], v[84:87], v[64:79]
  ds_read_b128 v[100:103], v106 offset:33152
  v_cvt_pk_bf16_f32 v84, v56, v57
  v_exp_f32 v59, v59
  v_exp_f32 v60, v60
  v_cvt_pk_bf16_f32 v85, v58, v59
  v_exp_f32 v61, v61
  v_mfma_f32_32x32x16_bf16 v[64:79], v[0:3], v[80:83], v[64:79]
  v_exp_f32 v62, v62
  v_exp_f32 v63, v63
  v_cvt_pk_bf16_f32 v86, v60, v61
  v_cvt_pk_bf16_f32 v87, v62, v63
  s_cmp_eq_u32 s41, 0
  s_cbranch_scc0 kfb_kernel_nodma12
        s_mov_b32 m0, s35
        s_add_u32 s35, s35, 8192
        buffer_load_dwordx4 v108, s[8:11], s36 offen sc1 lds
        s_add_u32 s36, s36, 8192
kfb_kernel_nodma12:
  v_exp_f32 v32, v32
  s_waitcnt lgkmcnt(0)
  v_mfma_f32_32x32x16_bf16 v[48:63], v[88:91], v[4:7], v[16:31]
  v_exp_f32 v33, v33
  v_exp_f32 v34, v34
  v_cvt_pk_bf16_f32 v80, v32, v33
  v_exp_f32 v35, v35
  v_exp_f32 v36, v36
  v_cvt_pk_bf16_f32 v81, v34, v35
  v_exp_f32 v37, v37
  v_exp_f32 v38, v38
  v_mfma_f32_32x32x8_bf16 v[48:63], v[94:95], v[10:11], v[48:63]
  ds_read_b128 v[88:91], v104 offset:25600
  ds_read_b128 v[0:3], v106 offset:35072
  v_cvt_pk_bf16_f32 v82, v36, v37
  v_exp_f32 v39, v39
  v_exp_f32 v40, v40
  v_cvt_pk_bf16_f32 v83, v38, v39
  v_exp_f32 v41, v41
  v_exp_f32 v42, v42
  v_mfma_f32_32x32x16_bf16 v[64:79], v[100:103], v[84:87], v[64:79]
  ds_read_b128 v[100:103], v106 offset:34432
  v_cvt_pk_bf16_f32 v84, v40, v41
  v_exp_f32 v43, v43
  v_exp_f32 v44, v44
  v_cvt_pk_bf16_f32 v85, v42, v43
  v_exp_f32 v45, v45
  v_mfma_f32_32x32x16_bf16 v[64:79], v[96:99], v[80:83], v[64:79]
  v_exp_f32 v46, v46
  v_exp_f32 v47, v47
  v_cvt_pk_bf16_f32 v86, v44, v45
  v_cvt_pk_bf16_f32 v87, v46, v47
  s_cmp_eq_u32 s41, 0
  s_cbranch_scc0 kfb_kernel_nodma13
        s_mov_b32 m0, s35
        s_add_u32 s35, s35, 8192
        buffer_load_dwordx4 v108, s[8:11], s36 offen sc1 lds
        s_add_u32 s36, s36, 8192
kfb_kernel_nodma13:
  s_waitcnt vmcnt(9)
  s_barrier
  v_exp_f32 v48, v48
  s_waitcnt lgkmcnt(0)
  v_mfma_f32_32x32x16_bf16 v[32:47], v[88:91], v[4:7], v[16:31]
  v_exp_f32 v49, v49
  v_exp_f32 v50, v50
  v_cvt_pk_bf16_f32 v80, v48, v49
  v_exp_f32 v51, v51
  v_exp_f32 v52, v52
  v_cvt_pk_bf16_f32 v81, v50, v51
  v_exp_f32 v53, v53
  v_exp_f32 v54, v54
  v_mfma_f32_32x32x8_bf16 v[32:47], v[94:95], v[12:13], v[32:47]
  ds_read_b128 v[88:91], v104 offset:26624
  ds_read_b128 v[96:99], v106 offset:36352
  v_cvt_pk_bf16_f32 v82, v52, v53
  v_exp_f32 v55, v55
  v_exp_f32 v56, v56
  v_cvt_pk_bf16_f32 v83, v54, v55
  v_exp_f32 v57, v57
  v_exp_f32 v58, v58
  v_mfma_f32_32x32x16_bf16 v[64:79], v[100:103], v[84:87], v[64:79]
  ds_read_b128 v[100:103], v106 offset:35712
  v_cvt_pk_bf16_f32 v84, v56, v57
  v_exp_f32 v59, v59
  v_exp_f32 v60, v60
  v_cvt_pk_bf16_f32 v85, v58, v59
  v_exp_f32 v61, v61
  v_mfma_f32_32x32x16_bf16 v[64:79], v[0:3], v[80:83], v[64:79]
  v_exp_f32 v62, v62
  v_exp_f32 v63, v63
  v_cvt_pk_bf16_f32 v86, v60, v61
  v_cvt_pk_bf16_f32 v87, v62, v63
  s_cmp_eq_u32 s41, 0
  s_cbranch_scc0 kfb_kernel_nodma14
        s_mov_b32 m0, s35
        s_add_u32 s35, s35, 8192
        buffer_load_dwordx4 v108, s[8:11], s36 offen sc1 lds
        s_add_u32 s36, s36, 8192
kfb_kernel_nodma14:
  v_exp_f32 v32, v32
  s_waitcnt lgkmcnt(0)
  v_mfma_f32_32x32x16_bf16 v[48:63], v[88:91], v[4:7], v[16:31]
  v_exp_f32 v33, v33
  v_exp_f32 v34, v34
  v_cvt_pk_bf16_f32 v80, v32, v33
  v_exp_f32 v35, v35
  v_exp_f32 v36, v36
  v_cvt_pk_bf16_f32 v81, v34, v35
  v_exp_f32 v37, v37
  v_exp_f32 v38, v38
  v_mfma_f32_32x32x8_bf16 v[48:63], v[94:95], v[14:15], v[48:63]
  ds_read_b64 v[92:93], v105 offset:47104
  ds_read_b128 v[88:91], v104 offset:38912
  ds_read_b128 v[0:3], v106 offset:37632
  v_cvt_pk_bf16_f32 v82, v36, v37
  v_exp_f32 v39, v39
  v_exp_f32 v40, v40
  v_cvt_pk_bf16_f32 v83, v38, v39
  v_exp_f32 v41, v41
  v_exp_f32 v42, v42
  v_mfma_f32_32x32x16_bf16 v[64:79], v[100:103], v[84:87], v[64:79]
  ds_read_b128 v[100:103], v106 offset:36992
  v_cvt_pk_bf16_f32 v84, v40, v41
  v_exp_f32 v43, v43
  v_exp_f32 v44, v44
  v_cvt_pk_bf16_f32 v85, v42, v43
  v_exp_f32 v45, v45
  v_mfma_f32_32x32x16_bf16 v[64:79], v[96:99], v[80:83], v[64:79]
  v_exp_f32 v46, v46
  v_exp_f32 v47, v47
  v_cvt_pk_bf16_f32 v86, v44, v45
  v_cvt_pk_bf16_f32 v87, v46, v47
  s_cmp_eq_u32 s41, 0
  s_cbranch_scc0 kfb_kernel_nodma15
        s_mov_b32 m0, s35
        s_add_u32 s35, s35, 8192
        buffer_load_dwordx4 v108, s[8:11], s36 offen sc1 lds
        s_add_u32 s36, s36, 8192
kfb_kernel_nodma15:
  v_exp_f32 v48, v48
  s_waitcnt lgkmcnt(0)
  v_mfma_f32_32x32x16_bf16 v[32:47], v[88:91], v[4:7], v[16:31]
  v_exp_f32 v49, v49
  v_exp_f32 v50, v50
  v_cvt_pk_bf16_f32 v80, v48, v49
  v_exp_f32 v51, v51
  v_exp_f32 v52, v52
  v_cvt_pk_bf16_f32 v81, v50, v51
  v_exp_f32 v53, v53
  v_exp_f32 v54, v54
  v_mfma_f32_32x32x8_bf16 v[32:47], v[92:93], v[8:9], v[32:47]
  ds_read_b128 v[88:91], v104 offset:39936
  ds_read_b128 v[96:99], v106 offset:48128
  v_cvt_pk_bf16_f32 v82, v52, v53
  v_exp_f32 v55, v55
  v_exp_f32 v56, v56
  v_cvt_pk_bf16_f32 v83, v54, v55
  v_exp_f32 v57, v57
  v_exp_f32 v58, v58
  v_mfma_f32_32x32x16_bf16 v[64:79], v[100:103], v[84:87], v[64:79]
  ds_read_b128 v[100:103], v106 offset:38272
  v_cvt_pk_bf16_f32 v84, v56, v57
  v_exp_f32 v59, v59
  v_exp_f32 v60, v60
  v_cvt_pk_bf16_f32 v85, v58, v59
  v_exp_f32 v61, v61
  v_mfma_f32_32x32x16_bf16 v[64:79], v[0:3], v[80:83], v[64:79]
  v_exp_f32 v62, v62
  v_exp_f32 v63, v63
  v_cvt_pk_bf16_f32 v86, v60, v61
  v_cvt_pk_bf16_f32 v87, v62, v63
  v_add_u32 v104, 38912, v104
  v_add_u32 v105, 38912, v105
  v_add_u32 v106, 38912, v106
  v_exp_f32 v32, v32
  s_waitcnt lgkmcnt(0)
  v_mfma_f32_32x32x16_bf16 v[48:63], v[88:91], v[4:7], v[16:31]
  v_exp_f32 v33, v33
  v_exp_f32 v34, v34
  v_cvt_pk_bf16_f32 v80, v32, v33
  v_exp_f32 v35, v35
  v_exp_f32 v36, v36
  v_cvt_pk_bf16_f32 v81, v34, v35
  v_exp_f32 v37, v37
  v_exp_f32 v38, v38
  v_mfma_f32_32x32x8_bf16 v[48:63], v[92:93], v[10:11], v[48:63]
  ds_read_b128 v[88:91], v104 offset:2048
  ds_read_b128 v[0:3], v106 offset:10496
  v_cvt_pk_bf16_f32 v82, v36, v37
  v_exp_f32 v39, v39
  v_exp_f32 v40, v40
  v_cvt_pk_bf16_f32 v83, v38, v39
  v_exp_f32 v41, v41
  v_exp_f32 v42, v42
  v_mfma_f32_32x32x16_bf16 v[64:79], v[100:103], v[84:87], v[64:79]
  ds_read_b128 v[100:103], v106 offset:9856
  v_cvt_pk_bf16_f32 v84, v40, v41
  v_exp_f32 v43, v43
  v_exp_f32 v44, v44
  v_cvt_pk_bf16_f32 v85, v42, v43
  v_exp_f32 v45, v45
  v_mfma_f32_32x32x16_bf16 v[64:79], v[96:99], v[80:83], v[64:79]
  v_exp_f32 v46, v46
  v_exp_f32 v47, v47
  v_cvt_pk_bf16_f32 v86, v44, v45
  v_cvt_pk_bf16_f32 v87, v46, v47
  v_exp_f32 v48, v48
  s_waitcnt lgkmcnt(0)
  v_mfma_f32_32x32x16_bf16 v[32:47], v[88:91], v[4:7], v[16:31]
  v_exp_f32 v49, v49
  v_exp_f32 v50, v50
  v_cvt_pk_bf16_f32 v80, v48, v49
  v_exp_f32 v51, v51
  v_exp_f32 v52, v52
  v_cvt_pk_bf16_f32 v81, v50, v51
  v_exp_f32 v53, v53
  v_exp_f32 v54, v54
  v_mfma_f32_32x32x8_bf16 v[32:47], v[92:93], v[12:13], v[32:47]
  ds_read_b128 v[88:91], v104 offset:3072
  ds_read_b128 v[96:99], v106 offset:11776
  v_cvt_pk_bf16_f32 v82, v52, v53
  v_exp_f32 v55, v55
  v_exp_f32 v56, v56
  v_cvt_pk_bf16_f32 v83, v54, v55
  v_exp_f32 v57, v57
  v_exp_f32 v58, v58
  v_mfma_f32_32x32x16_bf16 v[64:79], v[100:103], v[84:87], v[64:79]
  ds_read_b128 v[100:103], v106 offset:11136
  v_cvt_pk_bf16_f32 v84, v56, v57
  v_exp_f32 v59, v59
  v_exp_f32 v60, v60
  v_cvt_pk_bf16_f32 v85, v58, v59
  v_exp_f32 v61, v61
  v_mfma_f32_32x32x16_bf16 v[64:79], v[0:3], v[80:83], v[64:79]
  v_exp_f32 v62, v62
  v_exp_f32 v63, v63
  v_cvt_pk_bf16_f32 v86, v60, v61
  v_cvt_pk_bf16_f32 v87, v62, v63
  v_exp_f32 v32, v32
  s_waitcnt lgkmcnt(0)
  v_mfma_f32_32x32x16_bf16 v[48:63], v[88:91], v[4:7], v[16:31]
  v_exp_f32 v33, v33
  v_exp_f32 v34, v34
  v_cvt_pk_bf16_f32 v80, v32, v33
  v_exp_f32 v35, v35
  v_exp_f32 v36, v36
  v_cvt_pk_bf16_f32 v81, v34, v35
  v_exp_f32 v37, v37
  v_exp_f32 v38, v38
  v_mfma_f32_32x32x8_bf16 v[48:63], v[92:93], v[14:15], v[48:63]
  ds_read_b64 v[94:95], v105 offset:8704
  ds_read_b128 v[88:91], v104 offset:4096
  ds_read_b128 v[0:3], v106 offset:13056
  v_cvt_pk_bf16_f32 v82, v36, v37
  v_exp_f32 v39, v39
  v_exp_f32 v40, v40
  v_cvt_pk_bf16_f32 v83, v38, v39
  v_exp_f32 v41, v41
  v_exp_f32 v42, v42
  v_mfma_f32_32x32x16_bf16 v[64:79], v[100:103], v[84:87], v[64:79]
  ds_read_b128 v[100:103], v106 offset:12416
  v_cvt_pk_bf16_f32 v84, v40, v41
  v_exp_f32 v43, v43
  v_exp_f32 v44, v44
  v_cvt_pk_bf16_f32 v85, v42, v43
  v_exp_f32 v45, v45
  v_mfma_f32_32x32x16_bf16 v[64:79], v[96:99], v[80:83], v[64:79]
  v_exp_f32 v46, v46
  v_exp_f32 v47, v47
  v_cvt_pk_bf16_f32 v86, v44, v45
  v_cvt_pk_bf16_f32 v87, v46, v47
  v_exp_f32 v48, v48
  s_waitcnt lgkmcnt(0)
  v_mfma_f32_32x32x16_bf16 v[32:47], v[88:91], v[4:7], v[16:31]
  v_exp_f32 v49, v49
  v_exp_f32 v50, v50
  v_cvt_pk_bf16_f32 v80, v48, v49
  v_exp_f32 v51, v51
  v_exp_f32 v52, v52
  v_cvt_pk_bf16_f32 v81, v50, v51
  v_exp_f32 v53, v53
  v_exp_f32 v54, v54
  v_mfma_f32_32x32x8_bf16 v[32:47], v[94:95], v[8:9], v[32:47]
  ds_read_b128 v[88:91], v104 offset:5120
  ds_read_b128 v[96:99], v106 offset:14336
  v_cvt_pk_bf16_f32 v82, v52, v53
  v_exp_f32 v55, v55
  v_exp_f32 v56, v56
  v_cvt_pk_bf16_f32 v83, v54, v55
  v_exp_f32 v57, v57
  v_exp_f32 v58, v58
  v_mfma_f32_32x32x16_bf16 v[64:79], v[100:103], v[84:87], v[64:79]
  ds_read_b128 v[100:103], v106 offset:13696
  v_cvt_pk_bf16_f32 v84, v56, v57
  v_exp_f32 v59, v59
  v_exp_f32 v60, v60
  v_cvt_pk_bf16_f32 v85, v58, v59
  v_exp_f32 v61, v61
  v_mfma_f32_32x32x16_bf16 v[64:79], v[0:3], v[80:83], v[64:79]
  v_exp_f32 v62, v62
  v_exp_f32 v63, v63
  v_cvt_pk_bf16_f32 v86, v60, v61
  v_cvt_pk_bf16_f32 v87, v62, v63
  v_exp_f32 v32, v32
  s_waitcnt lgkmcnt(0)
  v_mfma_f32_32x32x16_bf16 v[48:63], v[88:91], v[4:7], v[16:31]
  v_exp_f32 v33, v33
  v_exp_f32 v34, v34
  v_cvt_pk_bf16_f32 v80, v32, v33
  v_exp_f32 v35, v35
  v_exp_f32 v36, v36
  v_cvt_pk_bf16_f32 v81, v34, v35
  v_exp_f32 v37, v37
  v_exp_f32 v38, v38
  v_mfma_f32_32x32x8_bf16 v[48:63], v[94:95], v[10:11], v[48:63]
  ds_read_b128 v[88:91], v104 offset:6144
  ds_read_b128 v[0:3], v106 offset:15616
  v_cvt_pk_bf16_f32 v82, v36, v37
  v_exp_f32 v39, v39
  v_exp_f32 v40, v40
  v_cvt_pk_bf16_f32 v83, v38, v39
  v_exp_f32 v41, v41
  v_exp_f32 v42, v42
  v_mfma_f32_32x32x16_bf16 v[64:79], v[100:103], v[84:87], v[64:79]
  ds_read_b128 v[100:103], v106 offset:14976
  v_cvt_pk_bf16_f32 v84, v40, v41
  v_exp_f32 v43, v43
  v_exp_f32 v44, v44
  v_cvt_pk_bf16_f32 v85, v42, v43
  v_exp_f32 v45, v45
  v_mfma_f32_32x32x16_bf16 v[64:79], v[96:99], v[80:83], v[64:79]
  v_exp_f32 v46, v46
  v_exp_f32 v47, v47
  v_cvt_pk_bf16_f32 v86, v44, v45
  v_cvt_pk_bf16_f32 v87, v46, v47
  s_waitcnt vmcnt(0)
  s_barrier
  v_exp_f32 v48, v48
  s_waitcnt lgkmcnt(0)
  v_mfma_f32_32x32x16_bf16 v[32:47], v[88:91], v[4:7], v[16:31]
  v_exp_f32 v49, v49
  v_exp_f32 v50, v50
  v_cvt_pk_bf16_f32 v80, v48, v49
  v_exp_f32 v51, v51
  v_exp_f32 v52, v52
  v_cvt_pk_bf16_f32 v81, v50, v51
  v_exp_f32 v53, v53
  v_exp_f32 v54, v54
  v_mfma_f32_32x32x8_bf16 v[32:47], v[94:95], v[12:13], v[32:47]
  ds_read_b128 v[88:91], v104 offset:7168
  ds_read_b128 v[96:99], v106 offset:16896
  v_cvt_pk_bf16_f32 v82, v52, v53
  v_exp_f32 v55, v55
  v_exp_f32 v56, v56
  v_cvt_pk_bf16_f32 v83, v54, v55
  v_exp_f32 v57, v57
  v_exp_f32 v58, v58
  v_mfma_f32_32x32x16_bf16 v[64:79], v[100:103], v[84:87], v[64:79]
  ds_read_b128 v[100:103], v106 offset:16256
  v_cvt_pk_bf16_f32 v84, v56, v57
  v_exp_f32 v59, v59
  v_exp_f32 v60, v60
  v_cvt_pk_bf16_f32 v85, v58, v59
  v_exp_f32 v61, v61
  v_mfma_f32_32x32x16_bf16 v[64:79], v[0:3], v[80:83], v[64:79]
  v_exp_f32 v62, v62
  v_exp_f32 v63, v63
  v_cvt_pk_bf16_f32 v86, v60, v61
  v_cvt_pk_bf16_f32 v87, v62, v63
  v_exp_f32 v32, v32
  s_waitcnt lgkmcnt(0)
  v_mfma_f32_32x32x16_bf16 v[48:63], v[88:91], v[4:7], v[16:31]
  v_exp_f32 v33, v33
  v_exp_f32 v34, v34
  v_cvt_pk_bf16_f32 v80, v32, v33
  v_exp_f32 v35, v35
  v_exp_f32 v36, v36
  v_cvt_pk_bf16_f32 v81, v34, v35
  v_exp_f32 v37, v37
  v_exp_f32 v38, v38
  v_mfma_f32_32x32x8_bf16 v[48:63], v[94:95], v[14:15], v[48:63]
  ds_read_b64 v[92:93], v105 offset:27648
  ds_read_b128 v[88:91], v104 offset:19456
  ds_read_b128 v[0:3], v106 offset:18176
  v_cvt_pk_bf16_f32 v82, v36, v37
  v_exp_f32 v39, v39
  v_exp_f32 v40, v40
  v_cvt_pk_bf16_f32 v83, v38, v39
  v_exp_f32 v41, v41
  v_exp_f32 v42, v42
  v_mfma_f32_32x32x16_bf16 v[64:79], v[100:103], v[84:87], v[64:79]
  ds_read_b128 v[100:103], v106 offset:17536
  v_cvt_pk_bf16_f32 v84, v40, v41
  v_exp_f32 v43, v43
  v_exp_f32 v44, v44
  v_cvt_pk_bf16_f32 v85, v42, v43
  v_exp_f32 v45, v45
  v_mfma_f32_32x32x16_bf16 v[64:79], v[96:99], v[80:83], v[64:79]
  v_exp_f32 v46, v46
  v_exp_f32 v47, v47
  v_cvt_pk_bf16_f32 v86, v44, v45
  v_cvt_pk_bf16_f32 v87, v46, v47
  v_exp_f32 v48, v48
  s_waitcnt lgkmcnt(0)
  v_mfma_f32_32x32x16_bf16 v[32:47], v[88:91], v[4:7], v[16:31]
  v_exp_f32 v49, v49
  v_exp_f32 v50, v50
  v_cvt_pk_bf16_f32 v80, v48, v49
  v_exp_f32 v51, v51
  v_exp_f32 v52, v52
  v_cvt_pk_bf16_f32 v81, v50, v51
  v_exp_f32 v53, v53
  v_exp_f32 v54, v54
  v_mfma_f32_32x32x8_bf16 v[32:47], v[92:93], v[8:9], v[32:47]
  ds_read_b128 v[88:91], v104 offset:20480
  ds_read_b128 v[96:99], v106 offset:28672
  v_cvt_pk_bf16_f32 v82, v52, v53
  v_exp_f32 v55, v55
  v_exp_f32 v56, v56
  v_cvt_pk_bf16_f32 v83, v54, v55
  v_exp_f32 v57, v57
  v_exp_f32 v58, v58
  v_mfma_f32_32x32x16_bf16 v[64:79], v[100:103], v[84:87], v[64:79]
  ds_read_b128 v[100:103], v106 offset:18816
  v_cvt_pk_bf16_f32 v84, v56, v57
  v_exp_f32 v59, v59
  v_exp_f32 v60, v60
  v_cvt_pk_bf16_f32 v85, v58, v59
  v_exp_f32 v61, v61
  v_mfma_f32_32x32x16_bf16 v[64:79], v[0:3], v[80:83], v[64:79]
  v_exp_f32 v62, v62
  v_exp_f32 v63, v63
  v_cvt_pk_bf16_f32 v86, v60, v61
  v_cvt_pk_bf16_f32 v87, v62, v63
  buffer_load_dwordx4 v[112:115], v111, s[8:11], s26 offen
  s_add_u32 s26, s26, 18432
  v_exp_f32 v32, v32
  s_waitcnt lgkmcnt(0)
  v_mfma_f32_32x32x16_bf16 v[48:63], v[88:91], v[4:7], v[16:31]
  v_exp_f32 v33, v33
  v_exp_f32 v34, v34
  v_cvt_pk_bf16_f32 v80, v32, v33
  v_exp_f32 v35, v35
  v_exp_f32 v36, v36
  v_cvt_pk_bf16_f32 v81, v34, v35
  v_exp_f32 v37, v37
  v_exp_f32 v38, v38
  v_mfma_f32_32x32x8_bf16 v[48:63], v[92:93], v[10:11], v[48:63]
  ds_read_b128 v[88:91], v104 offset:21504
  ds_read_b128 v[0:3], v106 offset:29952
  v_cvt_pk_bf16_f32 v82, v36, v37
  v_exp_f32 v39, v39
  v_exp_f32 v40, v40
  v_cvt_pk_bf16_f32 v83, v38, v39
  v_exp_f32 v41, v41
  v_exp_f32 v42, v42
  v_mfma_f32_32x32x16_bf16 v[64:79], v[100:103], v[84:87], v[64:79]
  ds_read_b128 v[100:103], v106 offset:29312
  v_cvt_pk_bf16_f32 v84, v40, v41
  v_exp_f32 v43, v43
  v_exp_f32 v44, v44
  v_cvt_pk_bf16_f32 v85, v42, v43
  v_exp_f32 v45, v45
  v_mfma_f32_32x32x16_bf16 v[64:79], v[96:99], v[80:83], v[64:79]
  v_exp_f32 v46, v46
  v_exp_f32 v47, v47
  v_cvt_pk_bf16_f32 v86, v44, v45
  v_cvt_pk_bf16_f32 v87, v46, v47
  buffer_load_dwordx4 v[116:119], v111, s[8:11], s26 offen
  s_add_u32 s26, s26, 18432
  v_exp_f32 v48, v48
  s_waitcnt lgkmcnt(0)
  v_mfma_f32_32x32x16_bf16 v[32:47], v[88:91], v[4:7], v[16:31]
  v_exp_f32 v49, v49
  v_exp_f32 v50, v50
  v_cvt_pk_bf16_f32 v80, v48, v49
  v_exp_f32 v51, v51
  v_exp_f32 v52, v52
  v_cvt_pk_bf16_f32 v81, v50, v51
  v_exp_f32 v53, v53
  v_exp_f32 v54, v54
  v_mfma_f32_32x32x8_bf16 v[32:47], v[92:93], v[12:13], v[32:47]
  ds_read_b128 v[88:91], v104 offset:22528
  ds_read_b128 v[96:99], v106 offset:31232
  v_cvt_pk_bf16_f32 v82, v52, v53
  v_exp_f32 v55, v55
  v_exp_f32 v56, v56
  v_cvt_pk_bf16_f32 v83, v54, v55
  v_exp_f32 v57, v57
  v_exp_f32 v58, v58
  v_mfma_f32_32x32x16_bf16 v[64:79], v[100:103], v[84:87], v[64:79]
  ds_read_b128 v[100:103], v106 offset:30592
  v_cvt_pk_bf16_f32 v84, v56, v57
  v_exp_f32 v59, v59
  v_exp_f32 v60, v60
  v_cvt_pk_bf16_f32 v85, v58, v59
  v_exp_f32 v61, v61
  v_mfma_f32_32x32x16_bf16 v[64:79], v[0:3], v[80:83], v[64:79]
  v_exp_f32 v62, v62
  v_exp_f32 v63, v63
  v_cvt_pk_bf16_f32 v86, v60, v61
  v_cvt_pk_bf16_f32 v87, v62, v63
  buffer_load_dwordx4 v[120:123], v111, s[8:11], s26 offen
  s_add_u32 s26, s26, 18432
  v_exp_f32 v32, v32
  s_waitcnt lgkmcnt(0)
  v_mfma_f32_32x32x16_bf16 v[48:63], v[88:91], v[4:7], v[16:31]
  v_exp_f32 v33, v33
  v_exp_f32 v34, v34
  v_cvt_pk_bf16_f32 v80, v32, v33
  v_exp_f32 v35, v35
  v_exp_f32 v36, v36
  v_cvt_pk_bf16_f32 v81, v34, v35
  v_exp_f32 v37, v37
  v_exp_f32 v38, v38
  v_mfma_f32_32x32x8_bf16 v[48:63], v[92:93], v[14:15], v[48:63]
  ds_read_b64 v[94:95], v105 offset:28160
  ds_read_b128 v[88:91], v104 offset:23552
  ds_read_b128 v[0:3], v106 offset:32512
  v_cvt_pk_bf16_f32 v82, v36, v37
  v_exp_f32 v39, v39
  v_exp_f32 v40, v40
  v_cvt_pk_bf16_f32 v83, v38, v39
  v_exp_f32 v41, v41
  v_exp_f32 v42, v42
  v_mfma_f32_32x32x16_bf16 v[64:79], v[100:103], v[84:87], v[64:79]
  ds_read_b128 v[100:103], v106 offset:31872
  v_cvt_pk_bf16_f32 v84, v40, v41
  v_exp_f32 v43, v43
  v_exp_f32 v44, v44
  v_cvt_pk_bf16_f32 v85, v42, v43
  v_exp_f32 v45, v45
  v_mfma_f32_32x32x16_bf16 v[64:79], v[96:99], v[80:83], v[64:79]
  v_exp_f32 v46, v46
  v_exp_f32 v47, v47
  v_cvt_pk_bf16_f32 v86, v44, v45
  v_cvt_pk_bf16_f32 v87, v46, v47
  buffer_load_dwordx4 v[124:127], v111, s[8:11], s26 offen
  s_add_u32 s26, s26, 18432
  v_exp_f32 v48, v48
  s_waitcnt lgkmcnt(0)
  v_mfma_f32_32x32x16_bf16 v[32:47], v[88:91], v[4:7], v[16:31]
  v_exp_f32 v49, v49
  v_exp_f32 v50, v50
  v_cvt_pk_bf16_f32 v80, v48, v49
  v_exp_f32 v51, v51
  v_exp_f32 v52, v52
  v_cvt_pk_bf16_f32 v81, v50, v51
  v_exp_f32 v53, v53
  v_exp_f32 v54, v54
  v_mfma_f32_32x32x8_bf16 v[32:47], v[94:95], v[8:9], v[32:47]
  ds_read_b128 v[88:91], v104 offset:24576
  ds_read_b128 v[96:99], v106 offset:33792
  v_cvt_pk_bf16_f32 v82, v52, v53
  v_exp_f32 v55, v55
  v_exp_f32 v56, v56
  v_cvt_pk_bf16_f32 v83, v54, v55
  v_exp_f32 v57, v57
  v_exp_f32 v58, v58
  v_mfma_f32_32x32x16_bf16 v[64:79], v[100:103], v[84:87], v[64:79]
  ds_read_b128 v[100:103], v106 offset:33152
  v_cvt_pk_bf16_f32 v84, v56, v57
  v_exp_f32 v59, v59
  v_exp_f32 v60, v60
  v_cvt_pk_bf16_f32 v85, v58, v59
  v_exp_f32 v61, v61
  v_mfma_f32_32x32x16_bf16 v[64:79], v[0:3], v[80:83], v[64:79]
  v_exp_f32 v62, v62
  v_exp_f32 v63, v63
  v_cvt_pk_bf16_f32 v86, v60, v61
  v_cvt_pk_bf16_f32 v87, v62, v63
  buffer_load_dwordx4 v[128:131], v111, s[8:11], s26 offen
  s_add_u32 s26, s26, 18432
  v_exp_f32 v32, v32
  s_waitcnt lgkmcnt(0)
  v_mfma_f32_32x32x16_bf16 v[48:63], v[88:91], v[4:7], v[16:31]
  v_exp_f32 v33, v33
  v_exp_f32 v34, v34
  v_cvt_pk_bf16_f32 v80, v32, v33
  v_exp_f32 v35, v35
  v_exp_f32 v36, v36
  v_cvt_pk_bf16_f32 v81, v34, v35
  v_exp_f32 v37, v37
  v_exp_f32 v38, v38
  v_mfma_f32_32x32x8_bf16 v[48:63], v[94:95], v[10:11], v[48:63]
  ds_read_b128 v[88:91], v104 offset:25600
  ds_read_b128 v[0:3], v106 offset:35072
  v_cvt_pk_bf16_f32 v82, v36, v37
  v_exp_f32 v39, v39
  v_exp_f32 v40, v40
  v_cvt_pk_bf16_f32 v83, v38, v39
  v_exp_f32 v41, v41
  v_exp_f32 v42, v42
  v_mfma_f32_32x32x16_bf16 v[64:79], v[100:103], v[84:87], v[64:79]
  ds_read_b128 v[100:103], v106 offset:34432
  v_cvt_pk_bf16_f32 v84, v40, v41
  v_exp_f32 v43, v43
  v_exp_f32 v44, v44
  v_cvt_pk_bf16_f32 v85, v42, v43
  v_exp_f32 v45, v45
  v_mfma_f32_32x32x16_bf16 v[64:79], v[96:99], v[80:83], v[64:79]
  v_exp_f32 v46, v46
  v_exp_f32 v47, v47
  v_cvt_pk_bf16_f32 v86, v44, v45
  v_cvt_pk_bf16_f32 v87, v46, v47
  buffer_load_dwordx4 v[132:135], v111, s[8:11], s26 offen
  s_add_u32 s26, s26, 18432
  v_exp_f32 v48, v48
  s_waitcnt lgkmcnt(0)
  v_mfma_f32_32x32x16_bf16 v[32:47], v[88:91], v[4:7], v[16:31]
  v_exp_f32 v49, v49
  v_exp_f32 v50, v50
  v_cvt_pk_bf16_f32 v80, v48, v49
  v_exp_f32 v51, v51
  v_exp_f32 v52, v52
  v_cvt_pk_bf16_f32 v81, v50, v51
  v_exp_f32 v53, v53
  v_exp_f32 v54, v54
  v_mfma_f32_32x32x8_bf16 v[32:47], v[94:95], v[12:13], v[32:47]
  ds_read_b128 v[88:91], v104 offset:26624
  ds_read_b128 v[96:99], v106 offset:36352
  v_cvt_pk_bf16_f32 v82, v52, v53
  v_exp_f32 v55, v55
  v_exp_f32 v56, v56
  v_cvt_pk_bf16_f32 v83, v54, v55
  v_exp_f32 v57, v57
  v_exp_f32 v58, v58
  v_mfma_f32_32x32x16_bf16 v[64:79], v[100:103], v[84:87], v[64:79]
  ds_read_b128 v[100:103], v106 offset:35712
  v_cvt_pk_bf16_f32 v84, v56, v57
  v_exp_f32 v59, v59
  v_exp_f32 v60, v60
  v_cvt_pk_bf16_f32 v85, v58, v59
  v_exp_f32 v61, v61
  v_mfma_f32_32x32x16_bf16 v[64:79], v[0:3], v[80:83], v[64:79]
  v_exp_f32 v62, v62
  v_exp_f32 v63, v63
  v_cvt_pk_bf16_f32 v86, v60, v61
  v_cvt_pk_bf16_f32 v87, v62, v63
  buffer_load_dwordx4 v[136:139], v111, s[8:11], s26 offen
  s_add_u32 s26, s26, 18432
  v_exp_f32 v32, v32
  s_waitcnt lgkmcnt(0)
  v_mfma_f32_32x32x16_bf16 v[48:63], v[88:91], v[4:7], v[16:31]
  v_exp_f32 v33, v33
  v_exp_f32 v34, v34
  v_cvt_pk_bf16_f32 v80, v32, v33
  v_exp_f32 v35, v35
  v_exp_f32 v36, v36
  v_cvt_pk_bf16_f32 v81, v34, v35
  v_exp_f32 v37, v37
  v_exp_f32 v38, v38
  v_mfma_f32_32x32x8_bf16 v[48:63], v[94:95], v[14:15], v[48:63]
  ds_read_b64 v[92:93], v105 offset:47104
  ds_read_b128 v[88:91], v104 offset:38912
  ds_read_b128 v[0:3], v106 offset:37632
  v_cvt_pk_bf16_f32 v82, v36, v37
  v_exp_f32 v39, v39
  v_exp_f32 v40, v40
  v_cvt_pk_bf16_f32 v83, v38, v39
  v_exp_f32 v41, v41
  v_exp_f32 v42, v42
  v_mfma_f32_32x32x16_bf16 v[64:79], v[100:103], v[84:87], v[64:79]
  ds_read_b128 v[100:103], v106 offset:36992
  v_cvt_pk_bf16_f32 v84, v40, v41
  v_exp_f32 v43, v43
  v_exp_f32 v44, v44
  v_cvt_pk_bf16_f32 v85, v42, v43
  v_exp_f32 v45, v45
  v_mfma_f32_32x32x16_bf16 v[64:79], v[96:99], v[80:83], v[64:79]
  v_exp_f32 v46, v46
  v_exp_f32 v47, v47
  v_cvt_pk_bf16_f32 v86, v44, v45
  v_cvt_pk_bf16_f32 v87, v46, v47
  buffer_load_dwordx4 v[140:143], v111, s[8:11], s26 offen
  s_add_u32 s26, s26, 18432
  v_exp_f32 v48, v48
  s_waitcnt lgkmcnt(0)
  v_mfma_f32_32x32x16_bf16 v[32:47], v[88:91], v[4:7], v[16:31]
  v_exp_f32 v49, v49
  v_exp_f32 v50, v50
  v_cvt_pk_bf16_f32 v80, v48, v49
  v_exp_f32 v51, v51
  v_exp_f32 v52, v52
  v_cvt_pk_bf16_f32 v81, v50, v51
  v_exp_f32 v53, v53
  v_exp_f32 v54, v54
  v_mfma_f32_32x32x8_bf16 v[32:47], v[92:93], v[8:9], v[32:47]
  ds_read_b128 v[88:91], v104 offset:39936
  ds_read_b128 v[96:99], v106 offset:48128
  v_cvt_pk_bf16_f32 v82, v52, v53
  v_exp_f32 v55, v55
  v_exp_f32 v56, v56
  v_cvt_pk_bf16_f32 v83, v54, v55
  v_exp_f32 v57, v57
  v_exp_f32 v58, v58
  v_mfma_f32_32x32x16_bf16 v[64:79], v[100:103], v[84:87], v[64:79]
  ds_read_b128 v[100:103], v106 offset:38272
  v_cvt_pk_bf16_f32 v84, v56, v57
  v_exp_f32 v59, v59
  v_exp_f32 v60, v60
  v_cvt_pk_bf16_f32 v85, v58, v59
  v_exp_f32 v61, v61
  v_mfma_f32_32x32x16_bf16 v[64:79], v[0:3], v[80:83], v[64:79]
  v_exp_f32 v62, v62
  v_exp_f32 v63, v63
  v_cvt_pk_bf16_f32 v86, v60, v61
  v_cvt_pk_bf16_f32 v87, v62, v63
  v_add_u32 v104, 38912, v104
  v_add_u32 v105, 38912, v105
  v_add_u32 v106, 38912, v106
  buffer_load_dwordx4 v[144:147], v111, s[8:11], s26 offen
  s_add_u32 s26, s26, 18432
  v_exp_f32 v32, v32
  s_waitcnt lgkmcnt(0)
  v_mfma_f32_32x32x16_bf16 v[48:63], v[88:91], v[4:7], v[16:31]
  v_exp_f32 v33, v33
  v_exp_f32 v34, v34
  v_cvt_pk_bf16_f32 v80, v32, v33
  v_exp_f32 v35, v35
  v_exp_f32 v36, v36
  v_cvt_pk_bf16_f32 v81, v34, v35
  v_exp_f32 v37, v37
  v_exp_f32 v38, v38
  v_mfma_f32_32x32x8_bf16 v[48:63], v[92:93], v[10:11], v[48:63]
  ds_read_b128 v[88:91], v104 offset:2048
  ds_read_b128 v[0:3], v106 offset:10496
  v_cvt_pk_bf16_f32 v82, v36, v37
  v_exp_f32 v39, v39
  v_exp_f32 v40, v40
  v_cvt_pk_bf16_f32 v83, v38, v39
  v_exp_f32 v41, v41
  v_exp_f32 v42, v42
  v_mfma_f32_32x32x16_bf16 v[64:79], v[100:103], v[84:87], v[64:79]
  ds_read_b128 v[100:103], v106 offset:9856
  v_cvt_pk_bf16_f32 v84, v40, v41
  v_exp_f32 v43, v43
  v_exp_f32 v44, v44
  v_cvt_pk_bf16_f32 v85, v42, v43
  v_exp_f32 v45, v45
  v_mfma_f32_32x32x16_bf16 v[64:79], v[96:99], v[80:83], v[64:79]
  v_exp_f32 v46, v46
  v_exp_f32 v47, v47
  v_cvt_pk_bf16_f32 v86, v44, v45
  v_cvt_pk_bf16_f32 v87, v46, v47
  buffer_load_dwordx4 v[148:151], v111, s[8:11], s26 offen
  s_add_u32 s26, s26, 18432
  v_exp_f32 v48, v48
  s_waitcnt lgkmcnt(0)
  v_mfma_f32_32x32x16_bf16 v[32:47], v[88:91], v[4:7], v[16:31]
  v_exp_f32 v49, v49
  v_exp_f32 v50, v50
  v_cvt_pk_bf16_f32 v80, v48, v49
  v_exp_f32 v51, v51
  v_exp_f32 v52, v52
  v_cvt_pk_bf16_f32 v81, v50, v51
  v_exp_f32 v53, v53
  v_exp_f32 v54, v54
  v_mfma_f32_32x32x8_bf16 v[32:47], v[92:93], v[12:13], v[32:47]
  ds_read_b128 v[88:91], v104 offset:3072
  ds_read_b128 v[96:99], v106 offset:11776
  v_cvt_pk_bf16_f32 v82, v52, v53
  v_exp_f32 v55, v55
  v_exp_f32 v56, v56
  v_cvt_pk_bf16_f32 v83, v54, v55
  v_exp_f32 v57, v57
  v_exp_f32 v58, v58
  v_mfma_f32_32x32x16_bf16 v[64:79], v[100:103], v[84:87], v[64:79]
  ds_read_b128 v[100:103], v106 offset:11136
  v_cvt_pk_bf16_f32 v84, v56, v57
  v_exp_f32 v59, v59
  v_exp_f32 v60, v60
  v_cvt_pk_bf16_f32 v85, v58, v59
  v_exp_f32 v61, v61
  v_mfma_f32_32x32x16_bf16 v[64:79], v[0:3], v[80:83], v[64:79]
  v_exp_f32 v62, v62
  v_exp_f32 v63, v63
  v_cvt_pk_bf16_f32 v86, v60, v61
  v_cvt_pk_bf16_f32 v87, v62, v63
  buffer_load_dwordx4 v[152:155], v111, s[8:11], s26 offen
  s_add_u32 s26, s26, 18432
  v_exp_f32 v32, v32
  s_waitcnt lgkmcnt(0)
  v_mfma_f32_32x32x16_bf16 v[48:63], v[88:91], v[4:7], v[16:31]
  v_exp_f32 v33, v33
  v_exp_f32 v34, v34
  v_cvt_pk_bf16_f32 v80, v32, v33
  v_exp_f32 v35, v35
  v_exp_f32 v36, v36
  v_cvt_pk_bf16_f32 v81, v34, v35
  v_exp_f32 v37, v37
  v_exp_f32 v38, v38
  v_mfma_f32_32x32x8_bf16 v[48:63], v[92:93], v[14:15], v[48:63]
  ds_read_b64 v[94:95], v105 offset:8704
  ds_read_b128 v[88:91], v104 offset:4096
  ds_read_b128 v[0:3], v106 offset:13056
  v_cvt_pk_bf16_f32 v82, v36, v37
  v_exp_f32 v39, v39
  v_exp_f32 v40, v40
  v_cvt_pk_bf16_f32 v83, v38, v39
  v_exp_f32 v41, v41
  v_exp_f32 v42, v42
  v_mfma_f32_32x32x16_bf16 v[64:79], v[100:103], v[84:87], v[64:79]
  ds_read_b128 v[100:103], v106 offset:12416
  v_cvt_pk_bf16_f32 v84, v40, v41
  v_exp_f32 v43, v43
  v_exp_f32 v44, v44
  v_cvt_pk_bf16_f32 v85, v42, v43
  v_exp_f32 v45, v45
  v_mfma_f32_32x32x16_bf16 v[64:79], v[96:99], v[80:83], v[64:79]
  v_exp_f32 v46, v46
  v_exp_f32 v47, v47
  v_cvt_pk_bf16_f32 v86, v44, v45
  v_cvt_pk_bf16_f32 v87, v46, v47
  buffer_load_dwordx4 v[156:159], v111, s[8:11], s26 offen
  s_add_u32 s26, s26, 18432
  v_exp_f32 v48, v48
  s_waitcnt lgkmcnt(0)
  v_mfma_f32_32x32x16_bf16 v[32:47], v[88:91], v[4:7], v[16:31]
  v_exp_f32 v49, v49
  v_exp_f32 v50, v50
  v_cvt_pk_bf16_f32 v80, v48, v49
  v_exp_f32 v51, v51
  v_exp_f32 v52, v52
  v_cvt_pk_bf16_f32 v81, v50, v51
  v_exp_f32 v53, v53
  v_exp_f32 v54, v54
  v_mfma_f32_32x32x8_bf16 v[32:47], v[94:95], v[8:9], v[32:47]
  ds_read_b128 v[88:91], v104 offset:5120
  ds_read_b128 v[96:99], v106 offset:14336
  v_cvt_pk_bf16_f32 v82, v52, v53
  v_exp_f32 v55, v55
  v_exp_f32 v56, v56
  v_cvt_pk_bf16_f32 v83, v54, v55
  v_exp_f32 v57, v57
  v_exp_f32 v58, v58
  v_mfma_f32_32x32x16_bf16 v[64:79], v[100:103], v[84:87], v[64:79]
  ds_read_b128 v[100:103], v106 offset:13696
  v_cvt_pk_bf16_f32 v84, v56, v57
  v_exp_f32 v59, v59
  v_exp_f32 v60, v60
  v_cvt_pk_bf16_f32 v85, v58, v59
  v_exp_f32 v61, v61
  v_mfma_f32_32x32x16_bf16 v[64:79], v[0:3], v[80:83], v[64:79]
  v_exp_f32 v62, v62
  v_exp_f32 v63, v63
  v_cvt_pk_bf16_f32 v86, v60, v61
  v_cvt_pk_bf16_f32 v87, v62, v63
  buffer_load_dwordx4 v[160:163], v111, s[8:11], s26 offen
  s_add_u32 s26, s26, 18432
  v_exp_f32 v32, v32
  s_waitcnt lgkmcnt(0)
  v_mfma_f32_32x32x16_bf16 v[48:63], v[88:91], v[4:7], v[16:31]
  v_exp_f32 v33, v33
  v_exp_f32 v34, v34
  v_cvt_pk_bf16_f32 v80, v32, v33
  v_exp_f32 v35, v35
  v_exp_f32 v36, v36
  v_cvt_pk_bf16_f32 v81, v34, v35
  v_exp_f32 v37, v37
  v_exp_f32 v38, v38
  v_mfma_f32_32x32x8_bf16 v[48:63], v[94:95], v[10:11], v[48:63]
  ds_read_b128 v[88:91], v104 offset:6144
  ds_read_b128 v[0:3], v106 offset:15616
  v_cvt_pk_bf16_f32 v82, v36, v37
  v_exp_f32 v39, v39
  v_exp_f32 v40, v40
  v_cvt_pk_bf16_f32 v83, v38, v39
  v_exp_f32 v41, v41
  v_exp_f32 v42, v42
  v_mfma_f32_32x32x16_bf16 v[64:79], v[100:103], v[84:87], v[64:79]
  ds_read_b128 v[100:103], v106 offset:14976
  v_cvt_pk_bf16_f32 v84, v40, v41
  v_exp_f32 v43, v43
  v_exp_f32 v44, v44
  v_cvt_pk_bf16_f32 v85, v42, v43
  v_exp_f32 v45, v45
  v_mfma_f32_32x32x16_bf16 v[64:79], v[96:99], v[80:83], v[64:79]
  v_exp_f32 v46, v46
  v_exp_f32 v47, v47
  v_cvt_pk_bf16_f32 v86, v44, v45
  v_cvt_pk_bf16_f32 v87, v46, v47
  buffer_load_dwordx4 v[164:167], v111, s[8:11], s26 offen
  s_add_u32 s26, s26, 18432
  v_exp_f32 v48, v48
  s_waitcnt lgkmcnt(0)
  v_mfma_f32_32x32x16_bf16 v[32:47], v[88:91], v[4:7], v[16:31]
  v_exp_f32 v49, v49
  v_exp_f32 v50, v50
  v_cvt_pk_bf16_f32 v80, v48, v49
  v_exp_f32 v51, v51
  v_exp_f32 v52, v52
  v_cvt_pk_bf16_f32 v81, v50, v51
  v_exp_f32 v53, v53
  v_exp_f32 v54, v54
  v_mfma_f32_32x32x8_bf16 v[32:47], v[94:95], v[12:13], v[32:47]
  ds_read_b128 v[88:91], v104 offset:7168
  ds_read_b128 v[96:99], v106 offset:16896
  v_cvt_pk_bf16_f32 v82, v52, v53
  v_exp_f32 v55, v55
  v_exp_f32 v56, v56
  v_cvt_pk_bf16_f32 v83, v54, v55
  v_exp_f32 v57, v57
  v_exp_f32 v58, v58
  v_mfma_f32_32x32x16_bf16 v[64:79], v[100:103], v[84:87], v[64:79]
  ds_read_b128 v[100:103], v106 offset:16256
  v_cvt_pk_bf16_f32 v84, v56, v57
  v_exp_f32 v59, v59
  v_exp_f32 v60, v60
  v_cvt_pk_bf16_f32 v85, v58, v59
  v_exp_f32 v61, v61
  v_mfma_f32_32x32x16_bf16 v[64:79], v[0:3], v[80:83], v[64:79]
  v_exp_f32 v62, v62
  v_exp_f32 v63, v63
  v_cvt_pk_bf16_f32 v86, v60, v61
  v_cvt_pk_bf16_f32 v87, v62, v63
  buffer_load_dwordx4 v[168:171], v111, s[8:11], s26 offen
  s_add_u32 s26, s26, 18432
  v_exp_f32 v32, v32
  s_waitcnt lgkmcnt(0)
  v_mfma_f32_32x32x16_bf16 v[48:63], v[88:91], v[4:7], v[16:31]
  v_exp_f32 v33, v33
  v_exp_f32 v34, v34
  v_cvt_pk_bf16_f32 v80, v32, v33
  v_exp_f32 v35, v35
  v_exp_f32 v36, v36
  v_cvt_pk_bf16_f32 v81, v34, v35
  v_exp_f32 v37, v37
  v_exp_f32 v38, v38
  v_mfma_f32_32x32x8_bf16 v[48:63], v[94:95], v[14:15], v[48:63]
  ds_read_b64 v[92:93], v105 offset:27648
  ds_read_b128 v[88:91], v104 offset:19456
  ds_read_b128 v[0:3], v106 offset:18176
  v_cvt_pk_bf16_f32 v82, v36, v37
  v_exp_f32 v39, v39
  v_exp_f32 v40, v40
  v_cvt_pk_bf16_f32 v83, v38, v39
  v_exp_f32 v41, v41
  v_exp_f32 v42, v42
  v_mfma_f32_32x32x16_bf16 v[64:79], v[100:103], v[84:87], v[64:79]
  ds_read_b128 v[100:103], v106 offset:17536
  v_cvt_pk_bf16_f32 v84, v40, v41
  v_exp_f32 v43, v43
  v_exp_f32 v44, v44
  v_cvt_pk_bf16_f32 v85, v42, v43
  v_exp_f32 v45, v45
  v_mfma_f32_32x32x16_bf16 v[64:79], v[96:99], v[80:83], v[64:79]
  v_exp_f32 v46, v46
  v_exp_f32 v47, v47
  v_cvt_pk_bf16_f32 v86, v44, v45
  v_cvt_pk_bf16_f32 v87, v46, v47
  buffer_load_dwordx4 v[172:175], v111, s[8:11], s26 offen
  s_add_u32 s26, s26, 18432
  v_exp_f32 v48, v48
  s_waitcnt lgkmcnt(0)
  v_mfma_f32_32x32x16_bf16 v[32:47], v[88:91], v[4:7], v[16:31]
  v_exp_f32 v49, v49
  v_exp_f32 v50, v50
  v_cvt_pk_bf16_f32 v80, v48, v49
  v_exp_f32 v51, v51
  v_exp_f32 v52, v52
  v_cvt_pk_bf16_f32 v81, v50, v51
  v_exp_f32 v53, v53
  v_exp_f32 v54, v54
  v_mfma_f32_32x32x8_bf16 v[32:47], v[92:93], v[8:9], v[32:47]
  ds_read_b128 v[88:91], v104 offset:20480
  ds_read_b128 v[96:99], v106 offset:28672
  v_cvt_pk_bf16_f32 v82, v52, v53
  v_exp_f32 v55, v55
  v_exp_f32 v56, v56
  v_cvt_pk_bf16_f32 v83, v54, v55
  v_exp_f32 v57, v57
  v_exp_f32 v58, v58
  v_mfma_f32_32x32x16_bf16 v[64:79], v[100:103], v[84:87], v[64:79]
  ds_read_b128 v[100:103], v106 offset:18816
  v_cvt_pk_bf16_f32 v84, v56, v57
  v_exp_f32 v59, v59
  v_exp_f32 v60, v60
  v_cvt_pk_bf16_f32 v85, v58, v59
  v_exp_f32 v61, v61
  v_mfma_f32_32x32x16_bf16 v[64:79], v[0:3], v[80:83], v[64:79]
  v_exp_f32 v62, v62
  v_exp_f32 v63, v63
  v_cvt_pk_bf16_f32 v86, v60, v61
  v_cvt_pk_bf16_f32 v87, v62, v63
  buffer_load_dwordx4 v[176:179], v111, s[8:11], s26 offen
  s_add_u32 s26, s26, 18432
  v_exp_f32 v32, v32
  s_waitcnt lgkmcnt(0)
  v_mfma_f32_32x32x16_bf16 v[48:63], v[88:91], v[4:7], v[16:31]
  v_exp_f32 v33, v33
  v_exp_f32 v34, v34
  v_cvt_pk_bf16_f32 v80, v32, v33
  v_exp_f32 v35, v35
  v_exp_f32 v36, v36
  v_cvt_pk_bf16_f32 v81, v34, v35
  v_exp_f32 v37, v37
  v_exp_f32 v38, v38
  v_mfma_f32_32x32x8_bf16 v[48:63], v[92:93], v[10:11], v[48:63]
  ds_read_b128 v[88:91], v104 offset:21504
  ds_read_b128 v[0:3], v106 offset:29952
  v_cvt_pk_bf16_f32 v82, v36, v37
  v_exp_f32 v39, v39
  v_exp_f32 v40, v40
  v_cvt_pk_bf16_f32 v83, v38, v39
  v_exp_f32 v41, v41
  v_exp_f32 v42, v42
  v_mfma_f32_32x32x16_bf16 v[64:79], v[100:103], v[84:87], v[64:79]
  ds_read_b128 v[100:103], v106 offset:29312
  v_cvt_pk_bf16_f32 v84, v40, v41
  v_exp_f32 v43, v43
  v_exp_f32 v44, v44
  v_cvt_pk_bf16_f32 v85, v42, v43
  v_exp_f32 v45, v45
  v_mfma_f32_32x32x16_bf16 v[64:79], v[96:99], v[80:83], v[64:79]
  v_exp_f32 v46, v46
  v_exp_f32 v47, v47
  v_cvt_pk_bf16_f32 v86, v44, v45
  v_cvt_pk_bf16_f32 v87, v46, v47
  buffer_load_dwordx4 v[180:183], v111, s[8:11], s26 offen
  s_add_u32 s26, s26, 18432
  v_exp_f32 v48, v48
  s_waitcnt lgkmcnt(0)
  v_mfma_f32_32x32x16_bf16 v[32:47], v[88:91], v[4:7], v[16:31]
  v_exp_f32 v49, v49
  v_exp_f32 v50, v50
  v_cvt_pk_bf16_f32 v80, v48, v49
  v_exp_f32 v51, v51
  v_exp_f32 v52, v52
  v_cvt_pk_bf16_f32 v81, v50, v51
  v_exp_f32 v53, v53
  v_exp_f32 v54, v54
  v_mfma_f32_32x32x8_bf16 v[32:47], v[92:93], v[12:13], v[32:47]
  ds_read_b128 v[88:91], v104 offset:22528
  ds_read_b128 v[96:99], v106 offset:31232
  v_cvt_pk_bf16_f32 v82, v52, v53
  v_exp_f32 v55, v55
  v_exp_f32 v56, v56
  v_cvt_pk_bf16_f32 v83, v54, v55
  v_exp_f32 v57, v57
  v_exp_f32 v58, v58
  v_mfma_f32_32x32x16_bf16 v[64:79], v[100:103], v[84:87], v[64:79]
  ds_read_b128 v[100:103], v106 offset:30592
  v_cvt_pk_bf16_f32 v84, v56, v57
  v_exp_f32 v59, v59
  v_exp_f32 v60, v60
  v_cvt_pk_bf16_f32 v85, v58, v59
  v_exp_f32 v61, v61
  v_mfma_f32_32x32x16_bf16 v[64:79], v[0:3], v[80:83], v[64:79]
  v_exp_f32 v62, v62
  v_exp_f32 v63, v63
  v_cvt_pk_bf16_f32 v86, v60, v61
  v_cvt_pk_bf16_f32 v87, v62, v63
  buffer_load_dwordx4 v[184:187], v111, s[8:11], s26 offen
  s_add_u32 s26, s26, 18432
  v_exp_f32 v32, v32
  s_waitcnt lgkmcnt(0)
  v_mfma_f32_32x32x16_bf16 v[48:63], v[88:91], v[4:7], v[16:31]
  v_exp_f32 v33, v33
  v_exp_f32 v34, v34
  v_cvt_pk_bf16_f32 v80, v32, v33
  v_exp_f32 v35, v35
  v_exp_f32 v36, v36
  v_cvt_pk_bf16_f32 v81, v34, v35
  v_exp_f32 v37, v37
  v_exp_f32 v38, v38
  v_mfma_f32_32x32x8_bf16 v[48:63], v[92:93], v[14:15], v[48:63]
  ds_read_b64 v[94:95], v105 offset:28160
  ds_read_b128 v[88:91], v104 offset:23552
  ds_read_b128 v[0:3], v106 offset:32512
  v_cvt_pk_bf16_f32 v82, v36, v37
  v_exp_f32 v39, v39
  v_exp_f32 v40, v40
  v_cvt_pk_bf16_f32 v83, v38, v39
  v_exp_f32 v41, v41
  v_exp_f32 v42, v42
  v_mfma_f32_32x32x16_bf16 v[64:79], v[100:103], v[84:87], v[64:79]
  ds_read_b128 v[100:103], v106 offset:31872
  v_cvt_pk_bf16_f32 v84, v40, v41
  v_exp_f32 v43, v43
  v_exp_f32 v44, v44
  v_cvt_pk_bf16_f32 v85, v42, v43
  v_exp_f32 v45, v45
  v_mfma_f32_32x32x16_bf16 v[64:79], v[96:99], v[80:83], v[64:79]
  v_exp_f32 v46, v46
  v_exp_f32 v47, v47
  v_cvt_pk_bf16_f32 v86, v44, v45
  v_cvt_pk_bf16_f32 v87, v46, v47
  buffer_load_dwordx4 v[188:191], v111, s[8:11], s26 offen
  s_add_u32 s26, s26, 18432
  v_exp_f32 v48, v48
  s_waitcnt lgkmcnt(0)
  v_mfma_f32_32x32x16_bf16 v[32:47], v[88:91], v[4:7], v[16:31]
  v_exp_f32 v49, v49
  v_exp_f32 v50, v50
  v_cvt_pk_bf16_f32 v80, v48, v49
  v_exp_f32 v51, v51
  v_exp_f32 v52, v52
  v_cvt_pk_bf16_f32 v81, v50, v51
  v_exp_f32 v53, v53
  v_exp_f32 v54, v54
  v_mfma_f32_32x32x8_bf16 v[32:47], v[94:95], v[8:9], v[32:47]
  ds_read_b128 v[88:91], v104 offset:24576
  ds_read_b128 v[96:99], v106 offset:33792
  v_cvt_pk_bf16_f32 v82, v52, v53
  v_exp_f32 v55, v55
  v_exp_f32 v56, v56
  v_cvt_pk_bf16_f32 v83, v54, v55
  v_exp_f32 v57, v57
  v_exp_f32 v58, v58
  v_mfma_f32_32x32x16_bf16 v[64:79], v[100:103], v[84:87], v[64:79]
  ds_read_b128 v[100:103], v106 offset:33152
  v_cvt_pk_bf16_f32 v84, v56, v57
  v_exp_f32 v59, v59
  v_exp_f32 v60, v60
  v_cvt_pk_bf16_f32 v85, v58, v59
  v_exp_f32 v61, v61
  v_mfma_f32_32x32x16_bf16 v[64:79], v[0:3], v[80:83], v[64:79]
  v_exp_f32 v62, v62
  v_exp_f32 v63, v63
  v_cvt_pk_bf16_f32 v86, v60, v61
  v_cvt_pk_bf16_f32 v87, v62, v63
  buffer_load_dwordx4 v[192:195], v111, s[8:11], s26 offen
  s_add_u32 s26, s26, 18432
  v_exp_f32 v32, v32
  s_waitcnt lgkmcnt(0)
  v_mfma_f32_32x32x16_bf16 v[48:63], v[88:91], v[4:7], v[16:31]
  v_exp_f32 v33, v33
  v_exp_f32 v34, v34
  v_cvt_pk_bf16_f32 v80, v32, v33
  v_exp_f32 v35, v35
  v_exp_f32 v36, v36
  v_cvt_pk_bf16_f32 v81, v34, v35
  v_exp_f32 v37, v37
  v_exp_f32 v38, v38
  v_mfma_f32_32x32x8_bf16 v[48:63], v[94:95], v[10:11], v[48:63]
  ds_read_b128 v[88:91], v104 offset:25600
  ds_read_b128 v[0:3], v106 offset:35072
  v_cvt_pk_bf16_f32 v82, v36, v37
  v_exp_f32 v39, v39
  v_exp_f32 v40, v40
  v_cvt_pk_bf16_f32 v83, v38, v39
  v_exp_f32 v41, v41
  v_exp_f32 v42, v42
  v_mfma_f32_32x32x16_bf16 v[64:79], v[100:103], v[84:87], v[64:79]
  ds_read_b128 v[100:103], v106 offset:34432
  v_cvt_pk_bf16_f32 v84, v40, v41
  v_exp_f32 v43, v43
  v_exp_f32 v44, v44
  v_cvt_pk_bf16_f32 v85, v42, v43
  v_exp_f32 v45, v45
  v_mfma_f32_32x32x16_bf16 v[64:79], v[96:99], v[80:83], v[64:79]
  v_exp_f32 v46, v46
  v_exp_f32 v47, v47
  v_cvt_pk_bf16_f32 v86, v44, v45
  v_cvt_pk_bf16_f32 v87, v46, v47
  buffer_load_dwordx4 v[196:199], v111, s[8:11], s26 offen
  s_add_u32 s26, s26, 18432
  v_exp_f32 v48, v48
  s_waitcnt lgkmcnt(0)
  v_mfma_f32_32x32x16_bf16 v[32:47], v[88:91], v[4:7], v[16:31]
  v_exp_f32 v49, v49
  v_exp_f32 v50, v50
  v_cvt_pk_bf16_f32 v80, v48, v49
  v_exp_f32 v51, v51
  v_exp_f32 v52, v52
  v_cvt_pk_bf16_f32 v81, v50, v51
  v_exp_f32 v53, v53
  v_exp_f32 v54, v54
  v_mfma_f32_32x32x8_bf16 v[32:47], v[94:95], v[12:13], v[32:47]
  ds_read_b128 v[88:91], v104 offset:26624
  ds_read_b128 v[96:99], v106 offset:36352
  v_cvt_pk_bf16_f32 v82, v52, v53
  v_exp_f32 v55, v55
  v_exp_f32 v56, v56
  v_cvt_pk_bf16_f32 v83, v54, v55
  v_exp_f32 v57, v57
  v_exp_f32 v58, v58
  v_mfma_f32_32x32x16_bf16 v[64:79], v[100:103], v[84:87], v[64:79]
  ds_read_b128 v[100:103], v106 offset:35712
  v_cvt_pk_bf16_f32 v84, v56, v57
  v_exp_f32 v59, v59
  v_exp_f32 v60, v60
  v_cvt_pk_bf16_f32 v85, v58, v59
  v_exp_f32 v61, v61
  v_mfma_f32_32x32x16_bf16 v[64:79], v[0:3], v[80:83], v[64:79]
  v_exp_f32 v62, v62
  v_exp_f32 v63, v63
  v_cvt_pk_bf16_f32 v86, v60, v61
  v_cvt_pk_bf16_f32 v87, v62, v63
  buffer_load_dwordx4 v[200:203], v111, s[8:11], s26 offen
  s_add_u32 s26, s26, 18432
  v_exp_f32 v32, v32
  s_waitcnt lgkmcnt(0)
  v_mfma_f32_32x32x16_bf16 v[48:63], v[88:91], v[4:7], v[16:31]
  v_exp_f32 v33, v33
  v_exp_f32 v34, v34
  v_cvt_pk_bf16_f32 v80, v32, v33
  v_exp_f32 v35, v35
  v_exp_f32 v36, v36
  v_cvt_pk_bf16_f32 v81, v34, v35
  v_exp_f32 v37, v37
  v_exp_f32 v38, v38
  v_mfma_f32_32x32x8_bf16 v[48:63], v[94:95], v[14:15], v[48:63]
  ds_read_b64 v[92:93], v105 offset:47104
  ds_read_b128 v[88:91], v104 offset:38912
  ds_read_b128 v[0:3], v106 offset:37632
  v_cvt_pk_bf16_f32 v82, v36, v37
  v_exp_f32 v39, v39
  v_exp_f32 v40, v40
  v_cvt_pk_bf16_f32 v83, v38, v39
  v_exp_f32 v41, v41
  v_exp_f32 v42, v42
  v_mfma_f32_32x32x16_bf16 v[64:79], v[100:103], v[84:87], v[64:79]
  ds_read_b128 v[100:103], v106 offset:36992
  v_cvt_pk_bf16_f32 v84, v40, v41
  v_exp_f32 v43, v43
  v_exp_f32 v44, v44
  v_cvt_pk_bf16_f32 v85, v42, v43
  v_exp_f32 v45, v45
  v_mfma_f32_32x32x16_bf16 v[64:79], v[96:99], v[80:83], v[64:79]
  v_exp_f32 v46, v46
  v_exp_f32 v47, v47
  v_cvt_pk_bf16_f32 v86, v44, v45
  v_cvt_pk_bf16_f32 v87, v46, v47
  buffer_load_dwordx4 v[204:207], v111, s[8:11], s26 offen
  s_add_u32 s26, s26, 18432
  v_exp_f32 v48, v48
  s_waitcnt lgkmcnt(0)
  v_mfma_f32_32x32x16_bf16 v[32:47], v[88:91], v[4:7], v[16:31]
  v_exp_f32 v49, v49
  v_exp_f32 v50, v50
  v_cvt_pk_bf16_f32 v80, v48, v49
  v_exp_f32 v51, v51
  v_exp_f32 v52, v52
  v_cvt_pk_bf16_f32 v81, v50, v51
  v_exp_f32 v53, v53
  v_exp_f32 v54, v54
  v_mfma_f32_32x32x8_bf16 v[32:47], v[92:93], v[8:9], v[32:47]
  ds_read_b128 v[88:91], v104 offset:39936
  ds_read_b128 v[96:99], v106 offset:48128
  v_cvt_pk_bf16_f32 v82, v52, v53
  v_exp_f32 v55, v55
  v_exp_f32 v56, v56
  v_cvt_pk_bf16_f32 v83, v54, v55
  v_exp_f32 v57, v57
  v_exp_f32 v58, v58
  v_mfma_f32_32x32x16_bf16 v[64:79], v[100:103], v[84:87], v[64:79]
  ds_read_b128 v[100:103], v106 offset:38272
  v_cvt_pk_bf16_f32 v84, v56, v57
  v_exp_f32 v59, v59
  v_exp_f32 v60, v60
  v_cvt_pk_bf16_f32 v85, v58, v59
  v_exp_f32 v61, v61
  v_mfma_f32_32x32x16_bf16 v[64:79], v[0:3], v[80:83], v[64:79]
  v_exp_f32 v62, v62
  v_exp_f32 v63, v63
  v_cvt_pk_bf16_f32 v86, v60, v61
  v_cvt_pk_bf16_f32 v87, v62, v63
  v_add_u32 v104, 38912, v104
  v_add_u32 v105, 38912, v105
  v_add_u32 v106, 38912, v106
  buffer_load_dwordx4 v[208:211], v111, s[8:11], s26 offen
  s_add_u32 s26, s26, 18432
  s_setprio 0
  v_exp_f32 v32, v32
  s_waitcnt lgkmcnt(0)
  v_mfma_f32_32x32x16_bf16 v[48:63], v[88:91], v[4:7], v[16:31]
  v_exp_f32 v33, v33
  v_exp_f32 v34, v34
  v_cvt_pk_bf16_f32 v80, v32, v33
  v_exp_f32 v35, v35
  v_exp_f32 v36, v36
  v_cvt_pk_bf16_f32 v81, v34, v35
  v_exp_f32 v37, v37
  v_exp_f32 v38, v38
  v_mfma_f32_32x32x8_bf16 v[48:63], v[92:93], v[10:11], v[48:63]
  ds_read_b128 v[88:91], v104 offset:2048
  ds_read_b128 v[0:3], v106 offset:10496
  v_cvt_pk_bf16_f32 v82, v36, v37
  v_exp_f32 v39, v39
  v_exp_f32 v40, v40
  v_cvt_pk_bf16_f32 v83, v38, v39
  v_exp_f32 v41, v41
  v_exp_f32 v42, v42
  v_mfma_f32_32x32x16_bf16 v[64:79], v[100:103], v[84:87], v[64:79]
  ds_read_b128 v[100:103], v106 offset:9856
  v_cvt_pk_bf16_f32 v84, v40, v41
  v_exp_f32 v43, v43
  v_exp_f32 v44, v44
  v_cvt_pk_bf16_f32 v85, v42, v43
  v_exp_f32 v45, v45
  v_mfma_f32_32x32x16_bf16 v[64:79], v[96:99], v[80:83], v[64:79]
  v_exp_f32 v46, v46
  v_exp_f32 v47, v47
  v_cvt_pk_bf16_f32 v86, v44, v45
  v_cvt_pk_bf16_f32 v87, v46, v47
  buffer_load_dwordx4 v[212:215], v111, s[8:11], s26 offen
  s_add_u32 s26, s26, 18432
  v_exp_f32 v48, v48
  s_waitcnt lgkmcnt(0)
  v_mfma_f32_32x32x16_bf16 v[32:47], v[88:91], v[4:7], v[16:31]
  v_exp_f32 v49, v49
  v_exp_f32 v50, v50
  v_cvt_pk_bf16_f32 v80, v48, v49
  v_exp_f32 v51, v51
  v_exp_f32 v52, v52
  v_cvt_pk_bf16_f32 v81, v50, v51
  v_exp_f32 v53, v53
  v_exp_f32 v54, v54
  v_mfma_f32_32x32x8_bf16 v[32:47], v[92:93], v[12:13], v[32:47]
  ds_read_b128 v[88:91], v104 offset:3072
  ds_read_b128 v[96:99], v106 offset:11776
  v_cvt_pk_bf16_f32 v82, v52, v53
  v_exp_f32 v55, v55
  v_exp_f32 v56, v56
  v_cvt_pk_bf16_f32 v83, v54, v55
  v_exp_f32 v57, v57
  v_exp_f32 v58, v58
  v_mfma_f32_32x32x16_bf16 v[64:79], v[100:103], v[84:87], v[64:79]
  ds_read_b128 v[100:103], v106 offset:11136
  v_cvt_pk_bf16_f32 v84, v56, v57
  v_exp_f32 v59, v59
  v_exp_f32 v60, v60
  v_cvt_pk_bf16_f32 v85, v58, v59
  v_exp_f32 v61, v61
  v_mfma_f32_32x32x16_bf16 v[64:79], v[0:3], v[80:83], v[64:79]
  v_exp_f32 v62, v62
  v_exp_f32 v63, v63
  v_cvt_pk_bf16_f32 v86, v60, v61
  v_cvt_pk_bf16_f32 v87, v62, v63
  buffer_load_dwordx4 v[216:219], v111, s[8:11], s26 offen
  s_add_u32 s26, s26, 18432
  v_exp_f32 v32, v32
  s_waitcnt lgkmcnt(0)
  v_mfma_f32_32x32x16_bf16 v[48:63], v[88:91], v[4:7], v[16:31]
  v_exp_f32 v33, v33
  v_exp_f32 v34, v34
  v_cvt_pk_bf16_f32 v80, v32, v33
  v_exp_f32 v35, v35
  v_exp_f32 v36, v36
  v_cvt_pk_bf16_f32 v81, v34, v35
  v_exp_f32 v37, v37
  v_exp_f32 v38, v38
  v_mfma_f32_32x32x8_bf16 v[48:63], v[92:93], v[14:15], v[48:63]
  ds_read_b64 v[94:95], v105 offset:8704
  ds_read_b128 v[88:91], v104 offset:4096
  ds_read_b128 v[0:3], v106 offset:13056
  v_cvt_pk_bf16_f32 v82, v36, v37
  v_exp_f32 v39, v39
  v_exp_f32 v40, v40
  v_cvt_pk_bf16_f32 v83, v38, v39
  v_exp_f32 v41, v41
  v_exp_f32 v42, v42
  v_mfma_f32_32x32x16_bf16 v[64:79], v[100:103], v[84:87], v[64:79]
  ds_read_b128 v[100:103], v106 offset:12416
  v_cvt_pk_bf16_f32 v84, v40, v41
  v_exp_f32 v43, v43
  v_exp_f32 v44, v44
  v_cvt_pk_bf16_f32 v85, v42, v43
  v_exp_f32 v45, v45
  v_mfma_f32_32x32x16_bf16 v[64:79], v[96:99], v[80:83], v[64:79]
  v_exp_f32 v46, v46
  v_exp_f32 v47, v47
  v_cvt_pk_bf16_f32 v86, v44, v45
  v_cvt_pk_bf16_f32 v87, v46, v47
  buffer_load_dwordx4 v[220:223], v111, s[8:11], s26 offen
  s_add_u32 s26, s26, 18432
  v_exp_f32 v48, v48
  s_waitcnt lgkmcnt(0)
  v_mfma_f32_32x32x16_bf16 v[32:47], v[88:91], v[4:7], v[16:31]
  v_exp_f32 v49, v49
  v_exp_f32 v50, v50
  v_cvt_pk_bf16_f32 v80, v48, v49
  v_exp_f32 v51, v51
  v_exp_f32 v52, v52
  v_cvt_pk_bf16_f32 v81, v50, v51
  v_exp_f32 v53, v53
  v_exp_f32 v54, v54
  v_mfma_f32_32x32x8_bf16 v[32:47], v[94:95], v[8:9], v[32:47]
  ds_read_b128 v[88:91], v104 offset:5120
  ds_read_b128 v[96:99], v106 offset:14336
  v_cvt_pk_bf16_f32 v82, v52, v53
  v_exp_f32 v55, v55
  v_exp_f32 v56, v56
  v_cvt_pk_bf16_f32 v83, v54, v55
  v_exp_f32 v57, v57
  v_exp_f32 v58, v58
  v_mfma_f32_32x32x16_bf16 v[64:79], v[100:103], v[84:87], v[64:79]
  ds_read_b128 v[100:103], v106 offset:13696
  v_cvt_pk_bf16_f32 v84, v56, v57
  v_exp_f32 v59, v59
  v_exp_f32 v60, v60
  v_cvt_pk_bf16_f32 v85, v58, v59
  v_exp_f32 v61, v61
  v_mfma_f32_32x32x16_bf16 v[64:79], v[0:3], v[80:83], v[64:79]
  v_exp_f32 v62, v62
  v_exp_f32 v63, v63
  v_cvt_pk_bf16_f32 v86, v60, v61
  v_cvt_pk_bf16_f32 v87, v62, v63
  buffer_load_dwordx4 v[224:227], v111, s[8:11], s26 offen
  s_add_u32 s26, s26, 18432
  v_exp_f32 v32, v32
  s_waitcnt lgkmcnt(0)
  v_mfma_f32_32x32x16_bf16 v[48:63], v[88:91], v[4:7], v[16:31]
  v_exp_f32 v33, v33
  v_exp_f32 v34, v34
  v_cvt_pk_bf16_f32 v80, v32, v33
  v_exp_f32 v35, v35
  v_exp_f32 v36, v36
  v_cvt_pk_bf16_f32 v81, v34, v35
  v_exp_f32 v37, v37
  v_exp_f32 v38, v38
  v_mfma_f32_32x32x8_bf16 v[48:63], v[94:95], v[10:11], v[48:63]
  ds_read_b128 v[88:91], v104 offset:6144
  ds_read_b128 v[0:3], v106 offset:15616
  v_cvt_pk_bf16_f32 v82, v36, v37
  v_exp_f32 v39, v39
  v_exp_f32 v40, v40
  v_cvt_pk_bf16_f32 v83, v38, v39
  v_exp_f32 v41, v41
  v_exp_f32 v42, v42
  v_mfma_f32_32x32x16_bf16 v[64:79], v[100:103], v[84:87], v[64:79]
  ds_read_b128 v[100:103], v106 offset:14976
  v_cvt_pk_bf16_f32 v84, v40, v41
  v_exp_f32 v43, v43
  v_exp_f32 v44, v44
  v_cvt_pk_bf16_f32 v85, v42, v43
  v_exp_f32 v45, v45
  v_mfma_f32_32x32x16_bf16 v[64:79], v[96:99], v[80:83], v[64:79]
  v_exp_f32 v46, v46
  v_exp_f32 v47, v47
  v_cvt_pk_bf16_f32 v86, v44, v45
  v_cvt_pk_bf16_f32 v87, v46, v47
  buffer_load_dwordx4 v[228:231], v111, s[8:11], s26 offen
  s_add_u32 s26, s26, 18432
  v_exp_f32 v48, v48
  s_waitcnt lgkmcnt(0)
  v_mfma_f32_32x32x16_bf16 v[32:47], v[88:91], v[4:7], v[16:31]
  v_exp_f32 v49, v49
  v_exp_f32 v50, v50
  v_cvt_pk_bf16_f32 v80, v48, v49
  v_exp_f32 v51, v51
  v_exp_f32 v52, v52
  v_cvt_pk_bf16_f32 v81, v50, v51
  v_exp_f32 v53, v53
  v_exp_f32 v54, v54
  v_mfma_f32_32x32x8_bf16 v[32:47], v[94:95], v[12:13], v[32:47]
  ds_read_b128 v[88:91], v104 offset:7168
  ds_read_b128 v[96:99], v106 offset:16896
  v_cvt_pk_bf16_f32 v82, v52, v53
  v_exp_f32 v55, v55
  v_exp_f32 v56, v56
  v_cvt_pk_bf16_f32 v83, v54, v55
  v_exp_f32 v57, v57
  v_exp_f32 v58, v58
  v_mfma_f32_32x32x16_bf16 v[64:79], v[100:103], v[84:87], v[64:79]
  ds_read_b128 v[100:103], v106 offset:16256
  v_cvt_pk_bf16_f32 v84, v56, v57
  v_exp_f32 v59, v59
  v_exp_f32 v60, v60
  v_cvt_pk_bf16_f32 v85, v58, v59
  v_exp_f32 v61, v61
  v_mfma_f32_32x32x16_bf16 v[64:79], v[0:3], v[80:83], v[64:79]
  v_exp_f32 v62, v62
  v_exp_f32 v63, v63
  v_cvt_pk_bf16_f32 v86, v60, v61
  v_cvt_pk_bf16_f32 v87, v62, v63
  buffer_load_dwordx4 v[232:235], v111, s[8:11], s26 offen
  s_add_u32 s26, s26, 18432
  v_exp_f32 v32, v32
  s_waitcnt lgkmcnt(0)
  v_mfma_f32_32x32x16_bf16 v[48:63], v[88:91], v[4:7], v[16:31]
  v_exp_f32 v33, v33
  v_exp_f32 v34, v34
  v_cvt_pk_bf16_f32 v80, v32, v33
  v_exp_f32 v35, v35
  v_exp_f32 v36, v36
  v_cvt_pk_bf16_f32 v81, v34, v35
  v_exp_f32 v37, v37
  v_exp_f32 v38, v38
  v_mfma_f32_32x32x8_bf16 v[48:63], v[94:95], v[14:15], v[48:63]
  ds_read_b64 v[92:93], v105 offset:27648
  ds_read_b128 v[88:91], v104 offset:19456
  ds_read_b128 v[0:3], v106 offset:18176
  v_cvt_pk_bf16_f32 v82, v36, v37
  v_exp_f32 v39, v39
  v_exp_f32 v40, v40
  v_cvt_pk_bf16_f32 v83, v38, v39
  v_exp_f32 v41, v41
  v_exp_f32 v42, v42
  v_mfma_f32_32x32x16_bf16 v[64:79], v[100:103], v[84:87], v[64:79]
  ds_read_b128 v[100:103], v106 offset:17536
  v_cvt_pk_bf16_f32 v84, v40, v41
  v_exp_f32 v43, v43
  v_exp_f32 v44, v44
  v_cvt_pk_bf16_f32 v85, v42, v43
  v_exp_f32 v45, v45
  v_mfma_f32_32x32x16_bf16 v[64:79], v[96:99], v[80:83], v[64:79]
  v_exp_f32 v46, v46
  v_exp_f32 v47, v47
  v_cvt_pk_bf16_f32 v86, v44, v45
  v_cvt_pk_bf16_f32 v87, v46, v47
  buffer_load_dwordx4 v[236:239], v111, s[8:11], s26 offen
  s_add_u32 s26, s26, 18432
  v_exp_f32 v48, v48
  s_waitcnt lgkmcnt(0)
  v_mfma_f32_32x32x16_bf16 v[32:47], v[88:91], v[4:7], v[16:31]
  v_exp_f32 v49, v49
  v_exp_f32 v50, v50
  v_cvt_pk_bf16_f32 v80, v48, v49
  v_exp_f32 v51, v51
  v_exp_f32 v52, v52
  v_cvt_pk_bf16_f32 v81, v50, v51
  v_exp_f32 v53, v53
  v_exp_f32 v54, v54
  v_mfma_f32_32x32x8_bf16 v[32:47], v[92:93], v[8:9], v[32:47]
  ds_read_b128 v[88:91], v104 offset:20480
  ds_read_b128 v[96:99], v106 offset:28672
  v_cvt_pk_bf16_f32 v82, v52, v53
  v_exp_f32 v55, v55
  v_exp_f32 v56, v56
  v_cvt_pk_bf16_f32 v83, v54, v55
  v_exp_f32 v57, v57
  v_exp_f32 v58, v58
  v_mfma_f32_32x32x16_bf16 v[64:79], v[100:103], v[84:87], v[64:79]
  ds_read_b128 v[100:103], v106 offset:18816
  v_cvt_pk_bf16_f32 v84, v56, v57
  v_exp_f32 v59, v59
  v_exp_f32 v60, v60
  v_cvt_pk_bf16_f32 v85, v58, v59
  v_exp_f32 v61, v61
  v_mfma_f32_32x32x16_bf16 v[64:79], v[0:3], v[80:83], v[64:79]
  v_exp_f32 v62, v62
  v_exp_f32 v63, v63
  v_cvt_pk_bf16_f32 v86, v60, v61
  v_cvt_pk_bf16_f32 v87, v62, v63
  buffer_load_dwordx4 v[240:243], v111, s[8:11], s26 offen
  s_add_u32 s26, s26, 18432
  v_exp_f32 v32, v32
  s_waitcnt lgkmcnt(0)
  v_mfma_f32_32x32x16_bf16 v[48:63], v[88:91], v[4:7], v[16:31]
  v_exp_f32 v33, v33
  v_exp_f32 v34, v34
  v_cvt_pk_bf16_f32 v80, v32, v33
  v_exp_f32 v35, v35
  v_exp_f32 v36, v36
  v_cvt_pk_bf16_f32 v81, v34, v35
  v_exp_f32 v37, v37
  v_exp_f32 v38, v38
  v_mfma_f32_32x32x8_bf16 v[48:63], v[92:93], v[10:11], v[48:63]
  ds_read_b128 v[88:91], v104 offset:21504
  ds_read_b128 v[0:3], v106 offset:29952
  v_cvt_pk_bf16_f32 v82, v36, v37
  v_exp_f32 v39, v39
  v_exp_f32 v40, v40
  v_cvt_pk_bf16_f32 v83, v38, v39
  v_exp_f32 v41, v41
  v_exp_f32 v42, v42
  v_mfma_f32_32x32x16_bf16 v[64:79], v[100:103], v[84:87], v[64:79]
  ds_read_b128 v[100:103], v106 offset:29312
  v_cvt_pk_bf16_f32 v84, v40, v41
  v_exp_f32 v43, v43
  v_exp_f32 v44, v44
  v_cvt_pk_bf16_f32 v85, v42, v43
  v_exp_f32 v45, v45
  v_mfma_f32_32x32x16_bf16 v[64:79], v[96:99], v[80:83], v[64:79]
  v_exp_f32 v46, v46
  v_exp_f32 v47, v47
  v_cvt_pk_bf16_f32 v86, v44, v45
  v_cvt_pk_bf16_f32 v87, v46, v47
  buffer_load_dwordx4 v[244:247], v111, s[8:11], s26 offen
  s_add_u32 s26, s26, 18432
  v_exp_f32 v48, v48
  s_waitcnt lgkmcnt(0)
  v_mfma_f32_32x32x16_bf16 v[32:47], v[88:91], v[4:7], v[16:31]
  v_exp_f32 v49, v49
  v_exp_f32 v50, v50
  v_cvt_pk_bf16_f32 v80, v48, v49
  v_exp_f32 v51, v51
  v_exp_f32 v52, v52
  v_cvt_pk_bf16_f32 v81, v50, v51
  v_exp_f32 v53, v53
  v_exp_f32 v54, v54
  v_mfma_f32_32x32x8_bf16 v[32:47], v[92:93], v[12:13], v[32:47]
  ds_read_b128 v[88:91], v104 offset:22528
  ds_read_b128 v[96:99], v106 offset:31232
  v_cvt_pk_bf16_f32 v82, v52, v53
  v_exp_f32 v55, v55
  v_exp_f32 v56, v56
  v_cvt_pk_bf16_f32 v83, v54, v55
  v_exp_f32 v57, v57
  v_exp_f32 v58, v58
  v_mfma_f32_32x32x16_bf16 v[64:79], v[100:103], v[84:87], v[64:79]
  ds_read_b128 v[100:103], v106 offset:30592
  v_cvt_pk_bf16_f32 v84, v56, v57
  v_exp_f32 v59, v59
  v_exp_f32 v60, v60
  v_cvt_pk_bf16_f32 v85, v58, v59
  v_exp_f32 v61, v61
  v_mfma_f32_32x32x16_bf16 v[64:79], v[0:3], v[80:83], v[64:79]
  v_exp_f32 v62, v62
  v_exp_f32 v63, v63
  v_cvt_pk_bf16_f32 v86, v60, v61
  v_cvt_pk_bf16_f32 v87, v62, v63
  buffer_load_dwordx4 v[248:251], v111, s[8:11], s26 offen
  s_add_u32 s26, s26, 18432
  v_exp_f32 v32, v32
  s_waitcnt lgkmcnt(0)
  v_mfma_f32_32x32x16_bf16 v[48:63], v[88:91], v[4:7], v[16:31]
  v_exp_f32 v33, v33
  v_exp_f32 v34, v34
  v_cvt_pk_bf16_f32 v80, v32, v33
  v_exp_f32 v35, v35
  v_exp_f32 v36, v36
  v_cvt_pk_bf16_f32 v81, v34, v35
  v_exp_f32 v37, v37
  v_exp_f32 v38, v38
  v_mfma_f32_32x32x8_bf16 v[48:63], v[92:93], v[14:15], v[48:63]
  ds_read_b64 v[94:95], v105 offset:28160
  ds_read_b128 v[88:91], v104 offset:23552
  ds_read_b128 v[0:3], v106 offset:32512
  v_cvt_pk_bf16_f32 v82, v36, v37
  v_exp_f32 v39, v39
  v_exp_f32 v40, v40
  v_cvt_pk_bf16_f32 v83, v38, v39
  v_exp_f32 v41, v41
  v_exp_f32 v42, v42
  v_mfma_f32_32x32x16_bf16 v[64:79], v[100:103], v[84:87], v[64:79]
  ds_read_b128 v[100:103], v106 offset:31872
  v_cvt_pk_bf16_f32 v84, v40, v41
  v_exp_f32 v43, v43
  v_exp_f32 v44, v44
  v_cvt_pk_bf16_f32 v85, v42, v43
  v_exp_f32 v45, v45
  v_mfma_f32_32x32x16_bf16 v[64:79], v[96:99], v[80:83], v[64:79]
  v_exp_f32 v46, v46
  v_exp_f32 v47, v47
  v_cvt_pk_bf16_f32 v86, v44, v45
  v_cvt_pk_bf16_f32 v87, v46, v47
  buffer_load_dwordx4 v[252:255], v111, s[8:11], s26 offen
  s_add_u32 s26, s26, 18432
  v_exp_f32 v48, v48
  s_waitcnt lgkmcnt(0)
  v_mfma_f32_32x32x16_bf16 v[32:47], v[88:91], v[4:7], v[16:31]
  v_exp_f32 v49, v49
  v_exp_f32 v50, v50
  v_cvt_pk_bf16_f32 v80, v48, v49
  v_exp_f32 v51, v51
  v_exp_f32 v52, v52
  v_cvt_pk_bf16_f32 v81, v50, v51
  v_exp_f32 v53, v53
  v_exp_f32 v54, v54
  v_mfma_f32_32x32x8_bf16 v[32:47], v[94:95], v[8:9], v[32:47]
  ds_read_b128 v[88:91], v104 offset:24576
  ds_read_b128 v[96:99], v106 offset:33792
  v_cvt_pk_bf16_f32 v82, v52, v53
  v_exp_f32 v55, v55
  v_exp_f32 v56, v56
  v_cvt_pk_bf16_f32 v83, v54, v55
  v_exp_f32 v57, v57
  v_exp_f32 v58, v58
  v_mfma_f32_32x32x16_bf16 v[64:79], v[100:103], v[84:87], v[64:79]
  ds_read_b128 v[100:103], v106 offset:33152
  v_cvt_pk_bf16_f32 v84, v56, v57
  v_exp_f32 v59, v59
  v_exp_f32 v60, v60
  v_cvt_pk_bf16_f32 v85, v58, v59
  v_exp_f32 v61, v61
  v_mfma_f32_32x32x16_bf16 v[64:79], v[0:3], v[80:83], v[64:79]
  v_exp_f32 v62, v62
  v_exp_f32 v63, v63
  v_cvt_pk_bf16_f32 v86, v60, v61
  v_cvt_pk_bf16_f32 v87, v62, v63
  v_exp_f32 v32, v32
  s_waitcnt lgkmcnt(0)
  v_mfma_f32_32x32x16_bf16 v[48:63], v[88:91], v[4:7], v[16:31]
  v_exp_f32 v33, v33
  v_exp_f32 v34, v34
  v_cvt_pk_bf16_f32 v80, v32, v33
  v_exp_f32 v35, v35
  v_exp_f32 v36, v36
  v_cvt_pk_bf16_f32 v81, v34, v35
  v_exp_f32 v37, v37
  v_exp_f32 v38, v38
  v_mfma_f32_32x32x8_bf16 v[48:63], v[94:95], v[10:11], v[48:63]
  ds_read_b128 v[88:91], v104 offset:25600
  ds_read_b128 v[0:3], v106 offset:35072
  v_cvt_pk_bf16_f32 v82, v36, v37
  v_exp_f32 v39, v39
  v_exp_f32 v40, v40
  v_cvt_pk_bf16_f32 v83, v38, v39
  v_exp_f32 v41, v41
  v_exp_f32 v42, v42
  v_mfma_f32_32x32x16_bf16 v[64:79], v[100:103], v[84:87], v[64:79]
  ds_read_b128 v[100:103], v106 offset:34432
  v_cvt_pk_bf16_f32 v84, v40, v41
  v_exp_f32 v43, v43
  v_exp_f32 v44, v44
  v_cvt_pk_bf16_f32 v85, v42, v43
  v_exp_f32 v45, v45
  v_mfma_f32_32x32x16_bf16 v[64:79], v[96:99], v[80:83], v[64:79]
  v_exp_f32 v46, v46
  v_exp_f32 v47, v47
  v_cvt_pk_bf16_f32 v86, v44, v45
  v_cvt_pk_bf16_f32 v87, v46, v47
  v_exp_f32 v48, v48
  s_waitcnt lgkmcnt(0)
  v_mfma_f32_32x32x16_bf16 v[32:47], v[88:91], v[4:7], v[16:31]
  v_exp_f32 v49, v49
  v_exp_f32 v50, v50
  v_cvt_pk_bf16_f32 v80, v48, v49
  v_exp_f32 v51, v51
  v_exp_f32 v52, v52
  v_cvt_pk_bf16_f32 v81, v50, v51
  v_exp_f32 v53, v53
  v_exp_f32 v54, v54
  v_mfma_f32_32x32x8_bf16 v[32:47], v[94:95], v[12:13], v[32:47]
  ds_read_b128 v[88:91], v104 offset:26624
  ds_read_b128 v[96:99], v106 offset:36352
  v_cvt_pk_bf16_f32 v82, v52, v53
  v_exp_f32 v55, v55
  v_exp_f32 v56, v56
  v_cvt_pk_bf16_f32 v83, v54, v55
  v_exp_f32 v57, v57
  v_exp_f32 v58, v58
  v_mfma_f32_32x32x16_bf16 v[64:79], v[100:103], v[84:87], v[64:79]
  ds_read_b128 v[100:103], v106 offset:35712
  v_cvt_pk_bf16_f32 v84, v56, v57
  v_exp_f32 v59, v59
  v_exp_f32 v60, v60
  v_cvt_pk_bf16_f32 v85, v58, v59
  v_exp_f32 v61, v61
  v_mfma_f32_32x32x16_bf16 v[64:79], v[0:3], v[80:83], v[64:79]
  v_exp_f32 v62, v62
  v_exp_f32 v63, v63
  v_cvt_pk_bf16_f32 v86, v60, v61
  v_cvt_pk_bf16_f32 v87, v62, v63
  v_exp_f32 v32, v32
  s_waitcnt lgkmcnt(0)
  v_mfma_f32_32x32x16_bf16 v[48:63], v[88:91], v[4:7], v[16:31]
  v_exp_f32 v33, v33
  v_exp_f32 v34, v34
  v_cvt_pk_bf16_f32 v80, v32, v33
  v_exp_f32 v35, v35
  v_exp_f32 v36, v36
  v_cvt_pk_bf16_f32 v81, v34, v35
  v_exp_f32 v37, v37
  v_exp_f32 v38, v38
  v_mfma_f32_32x32x8_bf16 v[48:63], v[94:95], v[14:15], v[48:63]
  ds_read_b64 v[92:93], v105 offset:47104
  ds_read_b128 v[88:91], v104 offset:38912
  ds_read_b128 v[0:3], v106 offset:37632
  v_cvt_pk_bf16_f32 v82, v36, v37
  v_exp_f32 v39, v39
  v_exp_f32 v40, v40
  v_cvt_pk_bf16_f32 v83, v38, v39
  v_exp_f32 v41, v41
  v_exp_f32 v42, v42
  v_mfma_f32_32x32x16_bf16 v[64:79], v[100:103], v[84:87], v[64:79]
  ds_read_b128 v[100:103], v106 offset:36992
  v_cvt_pk_bf16_f32 v84, v40, v41
  v_exp_f32 v43, v43
  v_exp_f32 v44, v44
  v_cvt_pk_bf16_f32 v85, v42, v43
  v_exp_f32 v45, v45
  v_mfma_f32_32x32x16_bf16 v[64:79], v[96:99], v[80:83], v[64:79]
  v_exp_f32 v46, v46
  v_exp_f32 v47, v47
  v_cvt_pk_bf16_f32 v86, v44, v45
  v_cvt_pk_bf16_f32 v87, v46, v47
  v_exp_f32 v48, v48
  s_waitcnt lgkmcnt(0)
  v_mfma_f32_32x32x16_bf16 v[32:47], v[88:91], v[4:7], v[16:31]
  v_exp_f32 v49, v49
  v_exp_f32 v50, v50
  v_cvt_pk_bf16_f32 v80, v48, v49
  v_exp_f32 v51, v51
  v_exp_f32 v52, v52
  v_cvt_pk_bf16_f32 v81, v50, v51
  v_exp_f32 v53, v53
  v_exp_f32 v54, v54
  v_mfma_f32_32x32x8_bf16 v[32:47], v[92:93], v[8:9], v[32:47]
  ds_read_b128 v[88:91], v104 offset:39936
  ds_read_b128 v[96:99], v106 offset:48128
  v_cvt_pk_bf16_f32 v82, v52, v53
  v_exp_f32 v55, v55
  v_exp_f32 v56, v56
  v_cvt_pk_bf16_f32 v83, v54, v55
  v_exp_f32 v57, v57
  v_exp_f32 v58, v58
  v_mfma_f32_32x32x16_bf16 v[64:79], v[100:103], v[84:87], v[64:79]
  ds_read_b128 v[100:103], v106 offset:38272
  v_cvt_pk_bf16_f32 v84, v56, v57
  v_exp_f32 v59, v59
  v_exp_f32 v60, v60
  v_cvt_pk_bf16_f32 v85, v58, v59
  v_exp_f32 v61, v61
  v_mfma_f32_32x32x16_bf16 v[64:79], v[0:3], v[80:83], v[64:79]
  v_exp_f32 v62, v62
  v_exp_f32 v63, v63
  v_cvt_pk_bf16_f32 v86, v60, v61
  v_cvt_pk_bf16_f32 v87, v62, v63
    s_waitcnt lgkmcnt(0)
  s_nop 0
    v_mfma_f32_32x32x16_bf16 v[64:79], v[100:103], v[84:87], v[64:79]
    s_setprio 0
    v_and_b32 v3, 31, v107
    v_lshrrev_b32 v2, 5, v107
    v_lshlrev_b32 v110, 4, v3
    v_lshl_add_u32 v110, v2, 1, v110
  s_nop 6
    v_rcp_f32 v109, v73
  s_nop 0
  v_mul_f32 v64, v64, v109
  v_mul_f32 v65, v65, v109
  v_mul_f32 v66, v66, v109
  v_mul_f32 v67, v67, v109
  v_mul_f32 v68, v68, v109
  v_mul_f32 v69, v69, v109
  v_mul_f32 v70, v70, v109
  v_mul_f32 v71, v71, v109
  v_mul_f32 v72, v72, v109
  v_cvt_pk_bf16_f32 v80, v64, v65
  v_cvt_pk_bf16_f32 v81, v66, v67
  v_cvt_pk_bf16_f32 v82, v68, v69
  v_cvt_pk_bf16_f32 v83, v70, v71
    v_cvt_pk_bf16_f32 v84, v72, v72
    buffer_store_dwordx4 v[80:83], v108, s[8:11], s52 offen sc1
    buffer_store_short v84, v110, s[8:11], s53 offen sc1
    v_add_u32 v5, 36864, v108
    s_waitcnt vmcnt(0)
    s_barrier
    s_cmp_eq_u32 s20, 0
    s_cbranch_scc0 kfb_kernel_nf
    v_mov_b32 v109, 0
    v_mov_b32 v110, 1
    s_mov_b64 exec, 1
    buffer_atomic_add v110, v109, s[8:11], s54 offen sc1
    s_mov_b64 exec, -1
kfb_kernel_nf:
        v_mov_b32 v6, v108
        s_cmp_eq_u32 s23, 2
        s_cbranch_scc0 kfb_kernel_ra
        v_lshlrev_b32 v6, 3, v107
kfb_kernel_ra:
  buffer_load_dwordx4 v[44:47], v6, s[8:11], s31 offen offset:0
  buffer_load_dwordx4 v[48:51], v6, s[8:11], s31 offen offset:1024
  s_cmp_eq_u32 s20, 7
  s_cbranch_scc0 kfb_kernel_np5
  s_mov_b32 s44, 0
  s_mov_b32 s45, 8
  v_lshlrev_b32 v109, 10, v107
  s_mov_b64 exec, 0x1
kfb_kernel_pollo:
        buffer_load_dword v110, v109, s[8:11], s54 offen sc1
        s_waitcnt vmcnt(0)
        v_cmp_le_u32 vcc, s45, v110
        s_add_u32 s44, s44, 1
        s_cmp_ge_u32 s44, 262144
        s_cbranch_scc1 kfb_kernel_pdo
  s_nop 0
        s_cmp_eq_u64 vcc, exec
        s_cbranch_scc1 kfb_kernel_pdo
        s_sleep 1
        s_branch kfb_kernel_pollo
kfb_kernel_pdo:
  s_mov_b64 exec, -1
kfb_kernel_np5:
  s_barrier
    s_lshl_b32 s34, s24, 10
    v_add_u32 v104, s34, v108
    v_add_u32 v5, s34, v5
    s_cmp_ge_u32 s20, 6
    s_cbranch_scc1 kfb_kernel_help5
        s_mov_b32 m0, s47
        s_add_u32 s47, s47, 8192
        buffer_load_dwordx4 v108, s[8:11], s46 offen sc1 lds
        s_add_u32 s46, s46, 8192
  s_barrier
        s_mov_b32 m0, s47
        s_add_u32 s47, s47, 8192
        buffer_load_dwordx4 v108, s[8:11], s46 offen sc1 lds
        s_add_u32 s46, s46, 8192
        s_mov_b32 m0, s47
        s_add_u32 s47, s47, 8192
        buffer_load_dwordx4 v108, s[8:11], s46 offen sc1 lds
        s_add_u32 s46, s46, 8192
        s_mov_b32 m0, s47
        s_add_u32 s47, s47, 8192
        buffer_load_dwordx4 v108, s[8:11], s46 offen sc1 lds
        s_add_u32 s46, s46, 8192
        s_mov_b32 m0, s47
        s_add_u32 s47, s47, 8192
        buffer_load_dwordx4 v108, s[8:11], s46 offen sc1 lds
        s_add_u32 s46, s46, 8192
        s_mov_b32 m0, s47
        s_add_u32 s47, s47, 8192
        buffer_load_dwordx4 v108, s[8:11], s46 offen sc1 lds
        s_add_u32 s46, s46, 8192
        s_mov_b32 m0, s47
        s_add_u32 s47, s47, 8192
        buffer_load_dwordx4 v108, s[8:11], s46 offen sc1 lds
        s_add_u32 s46, s46, 8192
        s_mov_b32 m0, s47
        s_add_u32 s47, s47, 8192
        buffer_load_dwordx4 v108, s[8:11], s46 offen sc1 lds
        s_add_u32 s46, s46, 8192
        s_mov_b32 m0, s47
        s_add_u32 s47, s47, 8192
        buffer_load_dwordx4 v108, s[8:11], s46 offen sc1 lds
        s_add_u32 s46, s46, 8192
  s_waitcnt vmcnt(8)
  s_barrier
  ds_read_b128 v[32:35], v104 offset:0
  ds_read_b128 v[36:39], v104 offset:2048
  v_lshlrev_b32 v16, 16, v44
  v_and_b32 v17, 0xffff0000, v44
  v_lshlrev_b32 v18, 16, v45
  v_and_b32 v19, 0xffff0000, v45
  v_lshlrev_b32 v20, 16, v46
  v_and_b32 v21, 0xffff0000, v46
  v_lshlrev_b32 v22, 16, v47
  v_and_b32 v23, 0xffff0000, v47
  v_lshlrev_b32 v24, 16, v48
  v_and_b32 v25, 0xffff0000, v48
  v_lshlrev_b32 v26, 16, v49
  v_and_b32 v27, 0xffff0000, v49
  v_lshlrev_b32 v28, 16, v50
  v_and_b32 v29, 0xffff0000, v50
  v_lshlrev_b32 v30, 16, v51
  v_and_b32 v31, 0xffff0000, v51
  ds_read_b128 v[40:43], v104 offset:4096
  s_waitcnt lgkmcnt(2)
  v_mfma_f32_32x32x16_bf16 v[16:31], v[112:115], v[32:35], v[16:31]
  ds_read_b128 v[32:35], v104 offset:6144
  s_waitcnt lgkmcnt(2)
  v_mfma_f32_32x32x16_bf16 v[80:95], v[116:119], v[36:39], 0
  s_waitcnt vmcnt(7)
  s_barrier
  ds_read_b128 v[36:39], v104 offset:8192
  s_waitcnt lgkmcnt(2)
  v_mfma_f32_32x32x16_bf16 v[16:31], v[120:123], v[40:43], v[16:31]
  ds_read_b128 v[40:43], v104 offset:10240
  s_waitcnt lgkmcnt(2)
  v_mfma_f32_32x32x16_bf16 v[80:95], v[124:127], v[32:35], v[80:95]
  ds_read_b128 v[32:35], v104 offset:12288
  s_waitcnt lgkmcnt(2)
  v_mfma_f32_32x32x16_bf16 v[16:31], v[128:131], v[36:39], v[16:31]
  ds_read_b128 v[36:39], v104 offset:14336
  s_waitcnt lgkmcnt(2)
  v_mfma_f32_32x32x16_bf16 v[80:95], v[132:135], v[40:43], v[80:95]
  s_waitcnt vmcnt(6)
  s_barrier
  ds_read_b128 v[40:43], v104 offset:16384
  s_waitcnt lgkmcnt(2)
  v_mfma_f32_32x32x16_bf16 v[16:31], v[136:139], v[32:35], v[16:31]
  ds_read_b128 v[32:35], v104 offset:18432
  s_waitcnt lgkmcnt(2)
  v_mfma_f32_32x32x16_bf16 v[80:95], v[140:143], v[36:39], v[80:95]
  ds_read_b128 v[36:39], v104 offset:20480
  s_waitcnt lgkmcnt(2)
  v_mfma_f32_32x32x16_bf16 v[16:31], v[144:147], v[40:43], v[16:31]
  ds_read_b128 v[40:43], v104 offset:22528
  s_waitcnt lgkmcnt(2)
  v_mfma_f32_32x32x16_bf16 v[80:95], v[148:151], v[32:35], v[80:95]
  s_waitcnt vmcnt(5)
  s_barrier
  ds_read_b128 v[32:35], v104 offset:24576
  s_waitcnt lgkmcnt(2)
  v_mfma_f32_32x32x16_bf16 v[16:31], v[152:155], v[36:39], v[16:31]
  ds_read_b128 v[36:39], v104 offset:26624
  s_waitcnt lgkmcnt(2)
  v_mfma_f32_32x32x16_bf16 v[80:95], v[156:159], v[40:43], v[80:95]
  ds_read_b128 v[40:43], v104 offset:28672
  s_waitcnt lgkmcnt(2)
  v_mfma_f32_32x32x16_bf16 v[16:31], v[160:163], v[32:35], v[16:31]
  ds_read_b128 v[32:35], v104 offset:30720
  s_waitcnt lgkmcnt(2)
  v_mfma_f32_32x32x16_bf16 v[80:95], v[164:167], v[36:39], v[80:95]
  s_waitcnt vmcnt(4)
  s_barrier
  ds_read_b128 v[36:39], v104 offset:32768
  s_waitcnt lgkmcnt(2)
  v_mfma_f32_32x32x16_bf16 v[16:31], v[168:171], v[40:43], v[16:31]
  ds_read_b128 v[40:43], v104 offset:34816
  s_waitcnt lgkmcnt(2)
  v_mfma_f32_32x32x16_bf16 v[80:95], v[172:175], v[32:35], v[80:95]
  ds_read_b128 v[32:35], v5 offset:0
  s_waitcnt lgkmcnt(2)
  v_mfma_f32_32x32x16_bf16 v[16:31], v[176:179], v[36:39], v[16:31]
  ds_read_b128 v[36:39], v5 offset:2048
  s_waitcnt lgkmcnt(2)
  v_mfma_f32_32x32x16_bf16 v[80:95], v[180:183], v[40:43], v[80:95]
  s_waitcnt vmcnt(3)
  s_barrier
  ds_read_b128 v[40:43], v5 offset:4096
  s_waitcnt lgkmcnt(2)
  v_mfma_f32_32x32x16_bf16 v[16:31], v[184:187], v[32:35], v[16:31]
  ds_read_b128 v[32:35], v5 offset:6144
  s_waitcnt lgkmcnt(2)
  v_mfma_f32_32x32x16_bf16 v[80:95], v[188:191], v[36:39], v[80:95]
  ds_read_b128 v[36:39], v5 offset:8192
  s_waitcnt lgkmcnt(2)
  v_mfma_f32_32x32x16_bf16 v[16:31], v[192:195], v[40:43], v[16:31]
  ds_read_b128 v[40:43], v5 offset:10240
  s_waitcnt lgkmcnt(2)
  v_mfma_f32_32x32x16_bf16 v[80:95], v[196:199], v[32:35], v[80:95]
  s_waitcnt vmcnt(2)
  s_barrier
  ds_read_b128 v[32:35], v5 offset:12288
  s_waitcnt lgkmcnt(2)
  v_mfma_f32_32x32x16_bf16 v[16:31], v[200:203], v[36:39], v[16:31]
  ds_read_b128 v[36:39], v5 offset:14336
  s_waitcnt lgkmcnt(2)
  v_mfma_f32_32x32x16_bf16 v[80:95], v[204:207], v[40:43], v[80:95]
  ds_read_b128 v[40:43], v5 offset:16384
  s_waitcnt lgkmcnt(2)
  v_mfma_f32_32x32x16_bf16 v[16:31], v[208:211], v[32:35], v[16:31]
  ds_read_b128 v[32:35], v5 offset:18432
  s_waitcnt lgkmcnt(2)
  v_mfma_f32_32x32x16_bf16 v[80:95], v[212:215], v[36:39], v[80:95]
  s_waitcnt vmcnt(1)
  s_barrier
  ds_read_b128 v[36:39], v5 offset:20480
  s_waitcnt lgkmcnt(2)
  v_mfma_f32_32x32x16_bf16 v[16:31], v[216:219], v[40:43], v[16:31]
  ds_read_b128 v[40:43], v5 offset:22528
  s_waitcnt lgkmcnt(2)
  v_mfma_f32_32x32x16_bf16 v[80:95], v[220:223], v[32:35], v[80:95]
  ds_read_b128 v[32:35], v5 offset:24576
  s_waitcnt lgkmcnt(2)
  v_mfma_f32_32x32x16_bf16 v[16:31], v[224:227], v[36:39], v[16:31]
  ds_read_b128 v[36:39], v5 offset:26624
  s_waitcnt lgkmcnt(2)
  v_mfma_f32_32x32x16_bf16 v[80:95], v[228:231], v[40:43], v[80:95]
  s_waitcnt vmcnt(0)
  s_barrier
  ds_read_b128 v[40:43], v5 offset:28672
  s_waitcnt lgkmcnt(2)
  v_mfma_f32_32x32x16_bf16 v[16:31], v[232:235], v[32:35], v[16:31]
  ds_read_b128 v[32:35], v5 offset:30720
  s_waitcnt lgkmcnt(2)
  v_mfma_f32_32x32x16_bf16 v[80:95], v[236:239], v[36:39], v[80:95]
  ds_read_b128 v[36:39], v5 offset:32768
  s_waitcnt lgkmcnt(2)
  v_mfma_f32_32x32x16_bf16 v[16:31], v[240:243], v[40:43], v[16:31]
  ds_read_b128 v[40:43], v5 offset:34816
  s_waitcnt lgkmcnt(2)
  v_mfma_f32_32x32x16_bf16 v[80:95], v[244:247], v[32:35], v[80:95]
  s_waitcnt lgkmcnt(1)
  v_mfma_f32_32x32x16_bf16 v[16:31], v[248:251], v[36:39], v[16:31]
  s_waitcnt lgkmcnt(0)
  v_mfma_f32_32x32x16_bf16 v[80:95], v[252:255], v[40:43], v[80:95]
  s_nop 11
  v_add_f32 v16, v16, v80
  v_add_f32 v17, v17, v81
  v_add_f32 v18, v18, v82
  v_add_f32 v19, v19, v83
  v_add_f32 v20, v20, v84
  v_add_f32 v21, v21, v85
  v_add_f32 v22, v22, v86
  v_add_f32 v23, v23, v87
  v_add_f32 v24, v24, v88
  v_add_f32 v25, v25, v89
  v_add_f32 v26, v26, v90
  v_add_f32 v27, v27, v91
  v_add_f32 v28, v28, v92
  v_add_f32 v29, v29, v93
  v_add_f32 v30, v30, v94
  v_add_f32 v31, v31, v95
    s_lshr_b32 s32, s21, 3
    s_lshl_b32 s32, s32, 9
    s_and_b32 s33, s21, 1
    s_lshl_b32 s33, s33, 8
    s_add_u32 s32, s32, s33
    s_bfe_u32 s33, s21, 0x10001
    s_lshl_b32 s33, s33, 6
    s_add_u32 s32, s32, s33
    s_bfe_u32 s33, s21, 0x10002
    s_lshl_b32 s33, s33, 4
    s_add_u32 s32, s32, s33
        v_and_b32 v109, 31, v107
        v_and_b32 v110, 1, v109
        v_lshrrev_b32 v109, 1, v109
        v_lshl_add_u32 v109, v110, 5, v109
        s_lshl_b32 s34, s24, 7
        s_add_u32 s32, s32, s34
        v_add_u32 v109, s32, v109
        v_mul_u32_u24 v4, 1152, v109
        v_lshrrev_b32 v2, 5, v107
        s_mul_i32 s33, s22, 144
        s_lshl_b32 s34, s23, 6
        s_add_u32 s33, s33, s34
        s_cmp_eq_u32 s23, 2
        s_cbranch_scc1 kfb_kernel_o8
        v_lshl_add_u32 v4, v2, 4, v4
  v_cvt_pk_bf16_f32 v56, v16, v17
  v_cvt_pk_bf16_f32 v57, v18, v19
  v_cvt_pk_bf16_f32 v58, v20, v21
  v_cvt_pk_bf16_f32 v59, v22, v23
  v_cvt_pk_bf16_f32 v60, v24, v25
  v_cvt_pk_bf16_f32 v61, v26, v27
  v_cvt_pk_bf16_f32 v62, v28, v29
  v_cvt_pk_bf16_f32 v63, v30, v31
  v_permlane32_swap_b32 v56, v58
  v_permlane32_swap_b32 v57, v59
  s_add_u32 s34, s33, 0
  buffer_store_dwordx4 v[56:59], v4, s[12:15], s34 offen
  v_permlane32_swap_b32 v60, v62
  v_permlane32_swap_b32 v61, v63
  s_add_u32 s34, s33, 32
  buffer_store_dwordx4 v[60:63], v4, s[12:15], s34 offen
  s_branch kfb_kernel_fin
kfb_kernel_o8:
  v_lshl_add_u32 v4, v2, 3, v4
  v_cvt_pk_bf16_f32 v56, v16, v17
  v_cvt_pk_bf16_f32 v57, v18, v19
  buffer_store_dwordx2 v[56:57], v4, s[12:15], s33 offen
  s_branch kfb_kernel_fin
kfb_kernel_help5:
        s_mov_b32 m0, s47
        s_add_u32 s47, s47, 8192
        buffer_load_dwordx4 v108, s[8:11], s46 offen sc1 lds
        s_add_u32 s46, s46, 8192
  s_barrier
        s_mov_b32 m0, s47
        s_add_u32 s47, s47, 8192
        buffer_load_dwordx4 v108, s[8:11], s46 offen sc1 lds
        s_add_u32 s46, s46, 8192
        s_mov_b32 m0, s47
        s_add_u32 s47, s47, 8192
        buffer_load_dwordx4 v108, s[8:11], s46 offen sc1 lds
        s_add_u32 s46, s46, 8192
        s_mov_b32 m0, s47
        s_add_u32 s47, s47, 8192
        buffer_load_dwordx4 v108, s[8:11], s46 offen sc1 lds
        s_add_u32 s46, s46, 8192
        s_mov_b32 m0, s47
        s_add_u32 s47, s47, 8192
        buffer_load_dwordx4 v108, s[8:11], s46 offen sc1 lds
        s_add_u32 s46, s46, 8192
        s_mov_b32 m0, s47
        s_add_u32 s47, s47, 8192
        buffer_load_dwordx4 v108, s[8:11], s46 offen sc1 lds
        s_add_u32 s46, s46, 8192
        s_mov_b32 m0, s47
        s_add_u32 s47, s47, 8192
        buffer_load_dwordx4 v108, s[8:11], s46 offen sc1 lds
        s_add_u32 s46, s46, 8192
        s_mov_b32 m0, s47
        s_add_u32 s47, s47, 8192
        buffer_load_dwordx4 v108, s[8:11], s46 offen sc1 lds
        s_add_u32 s46, s46, 8192
        s_mov_b32 m0, s47
        s_add_u32 s47, s47, 8192
        buffer_load_dwordx4 v108, s[8:11], s46 offen sc1 lds
        s_add_u32 s46, s46, 8192
  s_waitcnt vmcnt(8)
  s_barrier
  s_waitcnt vmcnt(7)
  s_barrier
  s_waitcnt vmcnt(6)
  s_barrier
  s_waitcnt vmcnt(5)
  s_barrier
  s_waitcnt vmcnt(4)
  s_barrier
  s_waitcnt vmcnt(3)
  s_barrier
  s_waitcnt vmcnt(2)
  s_barrier
  s_waitcnt vmcnt(1)
  s_barrier
  s_waitcnt vmcnt(0)
  s_barrier
kfb_kernel_fin:
  s_waitcnt vmcnt(0)
kfb_kernel_end:
  s_endpgm
.section .rodata,"a"
.p2align 6
.amdhsa_kernel k1_kernel
  .amdhsa_next_free_vgpr 256
  .amdhsa_next_free_sgpr 102
  .amdhsa_accum_offset 256
  .amdhsa_group_segment_fixed_size 0
  .amdhsa_kernarg_size 88
  .amdhsa_user_sgpr_count 2
  .amdhsa_user_sgpr_kernarg_segment_ptr 1
  .amdhsa_system_sgpr_workgroup_id_x 1
  .amdhsa_float_denorm_mode_32 3
.end_amdhsa_kernel
.p2align 6
.amdhsa_kernel k2a_kernel
  .amdhsa_next_free_vgpr 256
  .amdhsa_next_free_sgpr 102
  .amdhsa_accum_offset 256
  .amdhsa_group_segment_fixed_size 0
  .amdhsa_kernarg_size 88
  .amdhsa_user_sgpr_count 2
  .amdhsa_user_sgpr_kernarg_segment_ptr 1
  .amdhsa_system_sgpr_workgroup_id_x 1
  .amdhsa_float_denorm_mode_32 3
.end_amdhsa_kernel
.p2align 6
.amdhsa_kernel kfa_kernel
  .amdhsa_next_free_vgpr 256
  .amdhsa_next_free_sgpr 102
  .amdhsa_accum_offset 256
  .amdhsa_group_segment_fixed_size 0
  .amdhsa_kernarg_size 88
  .amdhsa_user_sgpr_count 2
  .amdhsa_user_sgpr_kernarg_segment_ptr 1
  .amdhsa_system_sgpr_workgroup_id_x 1
  .amdhsa_float_denorm_mode_32 3
.end_amdhsa_kernel
.p2align 6
.amdhsa_kernel k2b_kernel
  .amdhsa_next_free_vgpr 256
  .amdhsa_next_free_sgpr 102
  .amdhsa_accum_offset 256
  .amdhsa_group_segment_fixed_size 0
  .amdhsa_kernarg_size 88
  .amdhsa_user_sgpr_count 2
  .amdhsa_user_sgpr_kernarg_segment_ptr 1
  .amdhsa_system_sgpr_workgroup_id_x 1
  .amdhsa_float_denorm_mode_32 3
.end_amdhsa_kernel
.p2align 6
.amdhsa_kernel kfb_kernel
  .amdhsa_next_free_vgpr 256
  .amdhsa_next_free_sgpr 102
  .amdhsa_accum_offset 256
  .amdhsa_group_segment_fixed_size 0
  .amdhsa_kernarg_size 88
  .amdhsa_user_sgpr_count 2
  .amdhsa_user_sgpr_kernarg_segment_ptr 1
  .amdhsa_system_sgpr_workgroup_id_x 1
  .amdhsa_float_denorm_mode_32 3
.end_amdhsa_kernel
```
